```python
import torch

def _softmax(x, axis=-1):
    return torch.softmax(x, dim=axis)

def _gelu(x):
    return torch.nn.functional.gelu(x, approximate='tanh')

def _silu(x):
    return torch.nn.functional.silu(x)

def _sigmoid(x):
    return torch.sigmoid(x)

def _layernorm(x, axis=-1, eps=1e-05):
    m = x.mean(dim=axis, keepdim=True)
    v = x.var(dim=axis, keepdim=True, unbiased=False)
    return (x - m) / torch.sqrt(v + eps)

def _scatter_add(tgt, idx, src, axis=0):
    return tgt.clone().index_add_(axis, idx, src)

def _segment_sum(src, seg, n):
    out = torch.zeros((n,) + src.shape[1:], dtype=src.dtype)
    return out.index_add_(0, seg, src)

def _pad(x, pw):
    flat = tuple((v for pair in reversed(pw) for v in pair))
    return torch.nn.functional.pad(x, flat)
kernel_name = 'gated_mix__memory_aug_recurrent_mem_tr__glu_gated_swiglu__prompt'

def setup_inputs():

    _w = lambda a: (lambda t: t.to(torch.bfloat16) if t.is_floating_point() else t)(torch.as_tensor(a))

    def _A_setup():
        B, S, Dm = (1, 2048, 512)
        H, Dh = (32, 128)
        M, seg = (8, 32)
        seg = min(seg, S)
        S = S // seg * seg
        return {'x': _w((lambda *s: torch.randn(*s, dtype=torch.bfloat16) * 0.05)(B, S, Dm)), 'mem0': _w((lambda *s: torch.randn(*s, dtype=torch.bfloat16) * 0.4)(B, M, Dm)), 'Wq': _w((lambda *s: torch.randn(*s, dtype=torch.bfloat16) * 6.4)(Dm, H, Dh) * Dm ** (-0.5)), 'Wk': _w((lambda *s: torch.randn(*s, dtype=torch.bfloat16) * 6.4)(Dm, H, Dh) * Dm ** (-0.5)), 'Wv': _w((lambda *s: torch.randn(*s, dtype=torch.bfloat16) * 0.4)(Dm, H, Dh) * Dm ** (-0.5)), 'Wo': _w((lambda *s: torch.randn(*s, dtype=torch.bfloat16) * 0.4)(H, Dh, Dm) * (H * Dh) ** (-0.5)), 'seg_len': seg}
    _A_in = _A_setup()

    def _B_setup():
        B, S, D, F = (1, 2048, 512, 1792)
        return {'x': _w((lambda *s: torch.randn(*s, dtype=torch.bfloat16) * 0.05)(B, S, D)), 'w1': _w((lambda *s: torch.randn(*s, dtype=torch.bfloat16) * 0.8)(D, F) * (2.0 / D) ** 0.5), 'w3': _w((lambda *s: torch.randn(*s, dtype=torch.bfloat16) * 0.8)(D, F) * (2.0 / D) ** 0.5), 'w2': _w((lambda *s: torch.randn(*s, dtype=torch.bfloat16) * 0.8)(F, D) * (2.0 / F) ** 0.5)}
    _B_in = _B_setup()
    return {'A_x': _A_in['x'], 'A_mem0': _A_in['mem0'], 'A_Wq': _A_in['Wq'], 'A_Wk': _A_in['Wk'], 'A_Wv': _A_in['Wv'], 'A_Wo': _A_in['Wo'], 'A_seg_len': _A_in['seg_len'], 'B_x': _B_in['x'], 'B_w1': _B_in['w1'], 'B_w3': _B_in['w3'], 'B_w2': _B_in['w2'], 'gate_w': _w((lambda *s: torch.randn(*s, dtype=torch.bfloat16) * 0.05)(512) * 16.0)}

def reference(A_x, A_mem0, A_Wq, A_Wk, A_Wv, A_Wo, A_seg_len, B_x, B_w1, B_w3, B_w2, gate_w):

    def _A_ref(x, mem0, Wq, Wk, Wv, Wo, seg_len):
        B, S, Dm = x.shape
        H, Dh = (Wq.shape[1], Wq.shape[2])
        M = mem0.shape[1]
        scale = Dh ** (-0.5)
        n_seg = S // seg_len
        L = M + seg_len
        idx = torch.arange(L)
        mask = (idx[:, None] < M) | (idx[:, None] >= idx[None, :])
        mem = mem0
        outs = []
        for s in range(n_seg):
            xs = x[:, s * seg_len:(s + 1) * seg_len, :].clone()
            h = torch.concatenate([mem, xs], axis=1)
            q = torch.einsum('btd,dhe->bhte', h, Wq)
            k = torch.einsum('btd,dhe->bhte', h, Wk)
            v = torch.einsum('btd,dhe->bhte', h, Wv)
            scores = torch.einsum('bhqe,bhke->bhqk', q, k) * scale
            scores = torch.where(mask[None, None], scores, -1000000000.0)
            p = _softmax(scores, axis=-1)
            o = torch.einsum('bhqk,bhke->bhqe', p, v)
            o = torch.einsum('bhte,hed->btd', o, Wo)
            mem = o[:, :M, :].clone()
            outs.append(o[:, M:, :])
        return torch.concatenate(outs, axis=1)

    def _B_ref(x, w1, w3, w2):
        gate = torch.einsum('bsd,df->bsf', x, w1)
        up = torch.einsum('bsd,df->bsf', x, w3)
        h = _silu(gate) * up
        out = torch.einsum('bsf,fd->bsd', h, w2)
        return out
    x = A_x
    g = _sigmoid((x * gate_w).sum(-1, keepdims=True))
    a = _A_ref(x, A_mem0, A_Wq, A_Wk, A_Wv, A_Wo, A_seg_len)
    b = _B_ref(x, B_w1, B_w3, B_w2)
    return g * a + (1 - g) * b
```

```asm
; @launch grid=(256,1,1) block=(256,1,1) lds=163840
.amdgcn_target "amdgcn-amd-amdhsa--gfx950"
.text
.globl gated_mix__memory_aug_recurrent_mem_tr__glu_gated_swiglu__prompt_kernel
.p2align 8
.type gated_mix__memory_aug_recurrent_mem_tr__glu_gated_swiglu__prompt_kernel,@function
gated_mix__memory_aug_recurrent_mem_tr__glu_gated_swiglu__prompt_kernel:
    s_cmp_ge_u32 s2, 256
    s_cbranch_scc1 L_exit_gated_mix__memory_aug_recurrent_mem_tr__glu_gated_swiglu__prompt_kernel
    s_load_dwordx2 s[16:17], s[0:1], 104
    s_memrealtime s[92:93]
    s_getreg_b32 s33, hwreg(HW_REG_XCC_ID)
    s_and_b32 s33, s33, 7
    v_lshrrev_b32 v1, 6, v0
    s_nop 1
    v_readfirstlane_b32 s4, v1
    s_waitcnt lgkmcnt(0)
    v_cmp_eq_u32 vcc, 0, v0
    s_and_saveexec_b64 s[44:45], vcc
    s_cbranch_execz L_t1
    s_lshr_b32 s34, s33, 1
    s_lshl_b32 s34, s34, 2
    s_and_b32 s35, s33, 1
    s_lshl_b32 s35, s35, 4
    s_lshl_b32 s36, 1, s35
    v_mov_b32 v1, s34
    v_mov_b32 v2, s36
    global_atomic_add v3, v1, v2, s[16:17] sc0 sc1
    v_mov_b32 v5, 20
    v_mov_b32 v6, 1
    global_atomic_add v5, v6, s[16:17] sc1
    s_waitcnt vmcnt(1)
    v_lshrrev_b32 v3, s35, v3
    v_and_b32 v3, 0xffff, v3
    s_nop 0
    v_readfirstlane_b32 s37, v3
    s_mov_b32 s46, 1
    s_cmp_lt_u32 s37, 32
    s_cbranch_scc1 L_t_pub
    v_mov_b32 v5, 24
    global_atomic_add v7, v5, v6, s[16:17] sc0 sc1
    s_waitcnt vmcnt(0)
    v_readfirstlane_b32 s39, v7
    s_mov_b32 s40, 0
L_t_wait:
    v_mov_b32 v5, 20
    global_load_dword v7, v5, s[16:17] sc1
    s_waitcnt vmcnt(0)
    v_readfirstlane_b32 s41, v7
    s_cmp_ge_u32 s41, 256
    s_cbranch_scc1 L_t_all
    s_sleep 8
    s_add_u32 s40, s40, 1
    s_cmp_lt_u32 s40, 200000
    s_cbranch_scc1 L_t_wait
L_t_all:
    v_mov_b32 v5, 0
    global_load_dwordx4 v[8:11], v5, s[16:17] sc1
    s_waitcnt vmcnt(0)
    v_readfirstlane_b32 s48, v8
    v_readfirstlane_b32 s49, v9
    v_readfirstlane_b32 s50, v10
    v_readfirstlane_b32 s51, v11
    s_mov_b32 s33, 8
    s_mov_b32 s46, 0x10001
    s_lshr_b32 s42, s48, 0
    s_and_b32 s42, s42, 0xffff
    s_min_u32 s42, s42, 32
    s_sub_u32 s43, 32, s42
    s_cmp_lt_u32 s39, s43
    s_cbranch_scc0 L_t_n0
    s_mov_b32 s33, 0
    s_add_u32 s37, s42, s39
    s_branch L_t_pub
L_t_n0:
    s_sub_u32 s39, s39, s43
    s_lshr_b32 s42, s48, 16
    s_and_b32 s42, s42, 0xffff
    s_min_u32 s42, s42, 32
    s_sub_u32 s43, 32, s42
    s_cmp_lt_u32 s39, s43
    s_cbranch_scc0 L_t_n1
    s_mov_b32 s33, 1
    s_add_u32 s37, s42, s39
    s_branch L_t_pub
L_t_n1:
    s_sub_u32 s39, s39, s43
    s_lshr_b32 s42, s49, 0
    s_and_b32 s42, s42, 0xffff
    s_min_u32 s42, s42, 32
    s_sub_u32 s43, 32, s42
    s_cmp_lt_u32 s39, s43
    s_cbranch_scc0 L_t_n2
    s_mov_b32 s33, 2
    s_add_u32 s37, s42, s39
    s_branch L_t_pub
L_t_n2:
    s_sub_u32 s39, s39, s43
    s_lshr_b32 s42, s49, 16
    s_and_b32 s42, s42, 0xffff
    s_min_u32 s42, s42, 32
    s_sub_u32 s43, 32, s42
    s_cmp_lt_u32 s39, s43
    s_cbranch_scc0 L_t_n3
    s_mov_b32 s33, 3
    s_add_u32 s37, s42, s39
    s_branch L_t_pub
L_t_n3:
    s_sub_u32 s39, s39, s43
    s_lshr_b32 s42, s50, 0
    s_and_b32 s42, s42, 0xffff
    s_min_u32 s42, s42, 32
    s_sub_u32 s43, 32, s42
    s_cmp_lt_u32 s39, s43
    s_cbranch_scc0 L_t_n4
    s_mov_b32 s33, 4
    s_add_u32 s37, s42, s39
    s_branch L_t_pub
L_t_n4:
    s_sub_u32 s39, s39, s43
    s_lshr_b32 s42, s50, 16
    s_and_b32 s42, s42, 0xffff
    s_min_u32 s42, s42, 32
    s_sub_u32 s43, 32, s42
    s_cmp_lt_u32 s39, s43
    s_cbranch_scc0 L_t_n5
    s_mov_b32 s33, 5
    s_add_u32 s37, s42, s39
    s_branch L_t_pub
L_t_n5:
    s_sub_u32 s39, s39, s43
    s_lshr_b32 s42, s51, 0
    s_and_b32 s42, s42, 0xffff
    s_min_u32 s42, s42, 32
    s_sub_u32 s43, 32, s42
    s_cmp_lt_u32 s39, s43
    s_cbranch_scc0 L_t_n6
    s_mov_b32 s33, 6
    s_add_u32 s37, s42, s39
    s_branch L_t_pub
L_t_n6:
    s_sub_u32 s39, s39, s43
    s_lshr_b32 s42, s51, 16
    s_and_b32 s42, s42, 0xffff
    s_min_u32 s42, s42, 32
    s_sub_u32 s43, 32, s42
    s_cmp_lt_u32 s39, s43
    s_cbranch_scc0 L_t_n7
    s_mov_b32 s33, 7
    s_add_u32 s37, s42, s39
    s_branch L_t_pub
L_t_n7:
    s_sub_u32 s39, s39, s43
L_t_pub:
    v_mov_b32 v4, 14336
    v_mov_b32 v8, s33
    v_mov_b32 v9, s37
    v_mov_b32 v10, s46
    ds_write_b64 v4, v[8:9]
    ds_write_b32 v4, v10 offset:8
    s_waitcnt lgkmcnt(0)
L_t1:
    s_mov_b64 exec, s[44:45]
    s_barrier
    v_mov_b32 v4, 14336
    ds_read_b64 v[8:9], v4
    ds_read_b32 v10, v4 offset:8
    s_waitcnt lgkmcnt(0)
    v_readfirstlane_b32 s33, v8
    v_readfirstlane_b32 s3, v9
    v_readfirstlane_b32 s72, v10
    s_barrier
    s_cmp_ge_u32 s33, 8
    s_cbranch_scc1 L_all_end
    s_cmp_ge_u32 s3, 4
    s_cbranch_scc1 L_nopfc
    s_getpc_b64 s[48:49]
L_pcbase:
    s_lshl_b32 s50, s3, 2
    s_add_u32 s50, s50, s4
    s_mul_i32 s50, s50, 8192
    v_and_b32 v20, 63, v0
    v_lshlrev_b32 v20, 7, v20
    v_add_u32 v20, s50, v20
    v_min_u32 v20, L_all_end-L_pcbase, v20
    global_load_dword v21, v20, s[48:49]
L_nopfc:
    s_cmp_lg_u32 s33, 0
    s_cbranch_scc1 L_worker
    s_mov_b32 s73, s92
    s_load_dwordx2 s[18:19], s[0:1], 112
    s_load_dwordx2 s[16:17], s[0:1], 104
    s_load_dwordx2 s[84:85], s[0:1], 16
    s_load_dwordx2 s[88:89], s[0:1], 24
    s_load_dwordx2 s[92:93], s[0:1], 32
    s_load_dwordx2 s[96:97], s[0:1], 40
    s_load_dwordx2 s[12:13], s[0:1], 8
    s_waitcnt lgkmcnt(0)
    s_mov_b32 s8, s18
    s_mov_b32 s9, s19
    s_mov_b32 s10, 268435456
    s_mov_b32 s11, 0x20000
    s_mov_b32 s14, 8192
    s_mov_b32 s15, 0x20000
    s_mov_b32 s86, 0x400000
    s_mov_b32 s87, 0x20000
    s_mov_b32 s90, 0x400000
    s_mov_b32 s91, 0x20000
    s_mov_b32 s94, 0x400000
    s_mov_b32 s95, 0x20000
    s_mov_b32 s98, 0x400000
    s_mov_b32 s99, 0x20000
    s_mov_b32 s6, 20000
    s_cmp_eq_u32 s4, 1
    s_cbranch_scc1 L_wave1
    s_cmp_eq_u32 s4, 2
    s_cbranch_scc1 L_wave2
    s_cmp_eq_u32 s4, 3
    s_cbranch_scc1 L_wave3
L_wave0:
    v_and_b32 v31, 63, v0
    v_lshlrev_b32 v0, 4, v31
    s_lshl_b32 s33, s3, 2
    s_add_u32 s33, s33, 0
    v_lshrrev_b32 v26, 2, v31
    v_lshlrev_b32 v26, 11, v26
    v_and_b32 v27, 3, v31
    v_lshlrev_b32 v27, 4, v27
    v_add_u32 v1, v26, v27
    s_lshr_b32 s34, s33, 4
    s_lshl_b32 s34, s34, 10
    s_and_b32 s35, s33, 3
    s_lshl_b32 s35, s35, 8
    s_add_u32 s34, s34, s35
    s_and_b32 s35, s33, 12
    s_lshl_b32 s35, s35, 4
    s_add_u32 s34, s34, s35
    v_bfe_u32 v26, v31, 4, 1
    v_lshlrev_b32 v26, 5, v26
    v_bfe_u32 v27, v31, 2, 1
    v_lshlrev_b32 v27, 4, v27
    v_and_b32 v28, 3, v31
    v_lshlrev_b32 v28, 2, v28
    v_add3_u32 v26, v26, v27, v28
    v_add_u32 v2, s34, v26
    v_and_b32 v26, 15, v31
    v_lshlrev_b32 v26, 4, v26
    v_lshrrev_b32 v27, 4, v31
    v_lshlrev_b32 v27, 2, v27
    v_add_u32 v26, v26, v27
    v_add_u32 v3, 8192, v26
    v_lshrrev_b32 v26, 5, v31
    v_lshlrev_b32 v26, 9, v26
    v_bfe_u32 v27, v31, 4, 1
    v_lshlrev_b32 v27, 6, v27
    v_bfe_u32 v28, v31, 2, 2
    v_lshlrev_b32 v28, 4, v28
    v_add3_u32 v26, v26, v27, v28
    v_bfe_u32 v27, v31, 1, 1
    v_lshlrev_b32 v27, 3, v27
    v_add_u32 v26, v26, v27
    v_add_u32 v4, 8192, v26
    v_lshrrev_b32 v26, 4, v31
    v_lshlrev_b32 v26, 9, v26
    v_and_b32 v27, 15, v31
    v_lshlrev_b32 v27, 4, v27
    v_add_u32 v26, v26, v27
    v_bfe_u32 v28, v31, 3, 1
    v_lshlrev_b32 v28, 8, v28
    v_add_u32 v5, v26, v28
    v_add_u32 v5, 16384, v5
    v_add_u32 v6, 16512, v26
    v_lshrrev_b32 v26, 4, v31
    v_lshlrev_b32 v26, 7, v26
    v_bfe_u32 v27, v31, 3, 1
    v_lshlrev_b32 v27, 6, v27
    v_and_b32 v28, 3, v31
    v_lshlrev_b32 v28, 4, v28
    v_add3_u32 v7, v26, v27, v28
    v_lshrrev_b32 v26, 4, v31
    v_lshlrev_b32 v26, 8, v26
    v_bfe_u32 v27, v31, 1, 1
    v_lshlrev_b32 v27, 7, v27
    v_bfe_u32 v28, v31, 2, 2
    v_lshlrev_b32 v28, 5, v28
    v_add3_u32 v26, v26, v27, v28
    v_and_b32 v27, 1, v31
    v_lshlrev_b32 v27, 4, v27
    v_add_u32 v26, v26, v27
    v_add_u32 v8, 12288, v26
    v_lshrrev_b32 v26, 5, v31
    v_lshlrev_b32 v26, 10, v26
    v_bfe_u32 v27, v31, 4, 1
    v_lshlrev_b32 v27, 9, v27
    v_and_b32 v28, 15, v31
    v_lshlrev_b32 v28, 4, v28
    v_add3_u32 v9, v26, v27, v28
    v_bfe_u32 v26, v31, 1, 1
    v_mov_b32 v27, 0x4444
    v_mov_b32 v28, 0xeeee
    v_cmp_eq_u32 vcc, 1, v26
    s_nop 1
    v_cndmask_b32 v10, v27, v28, vcc
    v_add_u32 v11, 32768, v0
    v_mov_b32 v13, 0
    v_mov_b32 v15, 0
    v_mov_b32 v24, 0x3f803f80
    v_mov_b32 v25, 0
    v_bfe_u32 v26, v31, 1, 3
    v_cmp_eq_u32 s[48:49], 0, v26
    v_cmp_eq_u32 s[50:51], 1, v26
    v_cmp_eq_u32 s[52:53], 2, v26
    v_cmp_eq_u32 s[54:55], 3, v26
    s_mov_b32 s36, 0x0f0f0f0f
    s_mov_b32 s37, 0x0f0f0f0f
    s_mov_b32 s38, 0xffff0000
    s_mov_b32 s39, 0xffff0000
    s_mov_b32 s40, 0x00ff00ff
    s_mov_b32 s41, 0
    s_mov_b32 s42, 0xf0f0f0f0
    s_mov_b32 s43, 0xf0f0f0f0
    s_mov_b32 s46, 0x3e0293ee
    v_lshrrev_b32 v26, 4, v31
    v_bfe_u32 v27, v31, 1, 3
    v_add_u32 v28, 0, v26
    v_xor_b32 v27, v27, v28
    v_lshlrev_b32 v27, 5, v27
    v_and_b32 v28, 1, v31
    v_lshlrev_b32 v28, 4, v28
    v_add_u32 v27, v27, v28
    v_and_b32 v28, 1, v26
    v_lshlrev_b32 v28, 17, v28
    v_add_u32 v96, v27, v28
    v_lshrrev_b32 v28, 1, v26
    v_lshlrev_b32 v28, 18, v28
    v_add_u32 v96, v96, v28
    v_and_b32 v28, 1, v26
    v_lshlrev_b32 v28, 10, v28
    v_add_u32 v98, v27, v28
    v_lshrrev_b32 v28, 1, v26
    v_lshlrev_b32 v28, 12, v28
    v_add_u32 v98, v98, v28
    v_lshrrev_b32 v26, 4, v31
    v_bfe_u32 v27, v31, 1, 3
    v_add_u32 v28, 4, v26
    v_xor_b32 v27, v27, v28
    v_lshlrev_b32 v27, 5, v27
    v_and_b32 v28, 1, v31
    v_lshlrev_b32 v28, 4, v28
    v_add_u32 v27, v27, v28
    v_and_b32 v28, 1, v26
    v_lshlrev_b32 v28, 17, v28
    v_add_u32 v97, v27, v28
    v_lshrrev_b32 v28, 1, v26
    v_lshlrev_b32 v28, 18, v28
    v_add_u32 v97, v97, v28
    v_and_b32 v28, 1, v26
    v_lshlrev_b32 v28, 10, v28
    v_add_u32 v99, v27, v28
    v_lshrrev_b32 v28, 1, v26
    v_lshlrev_b32 v28, 12, v28
    v_add_u32 v99, v99, v28
    v_lshrrev_b32 v26, 2, v31
    v_lshlrev_b32 v27, 8, v26
    v_and_b32 v26, 7, v26
    v_lshlrev_b32 v26, 5, v26
    v_and_b32 v28, 3, v31
    v_lshlrev_b32 v28, 3, v28
    v_add3_u32 v26, v26, v27, v28
    v_add_u32 v104, 32768, v26
    v_xor_b32 v100, 0, v104
    v_xor_b32 v101, 32, v100
    v_add_u32 v102, 0x10000, v100
    v_add_u32 v103, 0x10000, v101
    s_lshl_b32 s60, s3, 8
    s_add_u32 s60, s60, 0
    s_lshl_b32 s61, s3, 17
    s_add_u32 s61, s61, 0
    v_add_u32 v107, 0xffff8000, v100
    v_add_u32 v108, 0xffff8000, v101
    s_mov_b32 m0, 32768
    s_add_u32 s34, s60, 0
    buffer_load_dwordx4 v96, s[84:87], s34 offen lds
    s_mov_b32 m0, 33792
    s_add_u32 s34, s60, 16384
    buffer_load_dwordx4 v97, s[84:87], s34 offen lds
    s_mov_b32 m0, 34816
    s_add_u32 s34, s60, 32768
    buffer_load_dwordx4 v96, s[84:87], s34 offen lds
    s_mov_b32 m0, 35840
    s_add_u32 s34, s60, 49152
    buffer_load_dwordx4 v97, s[84:87], s34 offen lds
    s_mov_b32 m0, 49152
    s_add_u32 s34, s60, 524288
    buffer_load_dwordx4 v96, s[84:87], s34 offen lds
    s_mov_b32 m0, 50176
    s_add_u32 s34, s60, 540672
    buffer_load_dwordx4 v97, s[84:87], s34 offen lds
    s_mov_b32 m0, 51200
    s_add_u32 s34, s60, 557056
    buffer_load_dwordx4 v96, s[84:87], s34 offen lds
    s_mov_b32 m0, 52224
    s_add_u32 s34, s60, 573440
    buffer_load_dwordx4 v97, s[84:87], s34 offen lds
    s_mov_b32 m0, 65536
    s_add_u32 s34, s60, 1048576
    buffer_load_dwordx4 v96, s[84:87], s34 offen lds
    s_mov_b32 m0, 66560
    s_add_u32 s34, s60, 1064960
    buffer_load_dwordx4 v97, s[84:87], s34 offen lds
    s_mov_b32 m0, 67584
    s_add_u32 s34, s60, 1081344
    buffer_load_dwordx4 v96, s[84:87], s34 offen lds
    s_mov_b32 m0, 68608
    s_add_u32 s34, s60, 1097728
    buffer_load_dwordx4 v97, s[84:87], s34 offen lds
    s_mov_b32 m0, 81920
    s_add_u32 s34, s60, 1572864
    buffer_load_dwordx4 v96, s[84:87], s34 offen lds
    s_mov_b32 m0, 82944
    s_add_u32 s34, s60, 1589248
    buffer_load_dwordx4 v97, s[84:87], s34 offen lds
    s_mov_b32 m0, 83968
    s_add_u32 s34, s60, 1605632
    buffer_load_dwordx4 v96, s[84:87], s34 offen lds
    s_mov_b32 m0, 84992
    s_add_u32 s34, s60, 1622016
    buffer_load_dwordx4 v97, s[84:87], s34 offen lds
    s_mov_b32 m0, 98304
    s_add_u32 s34, s60, 2097152
    buffer_load_dwordx4 v96, s[84:87], s34 offen lds
    s_mov_b32 m0, 99328
    s_add_u32 s34, s60, 2113536
    buffer_load_dwordx4 v97, s[84:87], s34 offen lds
    s_mov_b32 m0, 100352
    s_add_u32 s34, s60, 2129920
    buffer_load_dwordx4 v96, s[84:87], s34 offen lds
    s_mov_b32 m0, 101376
    s_add_u32 s34, s60, 2146304
    buffer_load_dwordx4 v97, s[84:87], s34 offen lds
    s_mov_b32 m0, 114688
    s_add_u32 s34, s60, 2621440
    buffer_load_dwordx4 v96, s[84:87], s34 offen lds
    s_mov_b32 m0, 115712
    s_add_u32 s34, s60, 2637824
    buffer_load_dwordx4 v97, s[84:87], s34 offen lds
    s_mov_b32 m0, 116736
    s_add_u32 s34, s60, 2654208
    buffer_load_dwordx4 v96, s[84:87], s34 offen lds
    s_mov_b32 m0, 117760
    s_add_u32 s34, s60, 2670592
    buffer_load_dwordx4 v97, s[84:87], s34 offen lds
    s_mov_b32 m0, 131072
    s_add_u32 s34, s60, 0
    buffer_load_dwordx4 v96, s[88:91], s34 offen lds
    s_mov_b32 m0, 132096
    s_add_u32 s34, s60, 16384
    buffer_load_dwordx4 v97, s[88:91], s34 offen lds
    s_mov_b32 m0, 133120
    s_add_u32 s34, s60, 32768
    buffer_load_dwordx4 v96, s[88:91], s34 offen lds
    s_mov_b32 m0, 134144
    s_add_u32 s34, s60, 49152
    buffer_load_dwordx4 v97, s[88:91], s34 offen lds
    s_mov_b32 m0, 147456
    s_add_u32 s34, s60, 524288
    buffer_load_dwordx4 v96, s[88:91], s34 offen lds
    s_mov_b32 m0, 148480
    s_add_u32 s34, s60, 540672
    buffer_load_dwordx4 v97, s[88:91], s34 offen lds
    s_mov_b32 m0, 149504
    s_add_u32 s34, s60, 557056
    buffer_load_dwordx4 v96, s[88:91], s34 offen lds
    s_mov_b32 m0, 150528
    s_add_u32 s34, s60, 573440
    buffer_load_dwordx4 v97, s[88:91], s34 offen lds
    s_mov_b32 m0, 0
    s_add_u32 s34, s60, 1048576
    buffer_load_dwordx4 v96, s[88:91], s34 offen lds
    s_mov_b32 m0, 1024
    s_add_u32 s34, s60, 1064960
    buffer_load_dwordx4 v97, s[88:91], s34 offen lds
    s_mov_b32 m0, 2048
    s_add_u32 s34, s60, 1081344
    buffer_load_dwordx4 v96, s[88:91], s34 offen lds
    s_mov_b32 m0, 3072
    s_add_u32 s34, s60, 1097728
    buffer_load_dwordx4 v97, s[88:91], s34 offen lds
    s_mov_b32 m0, 16384
    s_add_u32 s34, s60, 1572864
    buffer_load_dwordx4 v96, s[88:91], s34 offen lds
    s_mov_b32 m0, 17408
    s_add_u32 s34, s60, 1589248
    buffer_load_dwordx4 v97, s[88:91], s34 offen lds
    s_mov_b32 m0, 18432
    s_add_u32 s34, s60, 1605632
    buffer_load_dwordx4 v96, s[88:91], s34 offen lds
    s_mov_b32 m0, 19456
    s_add_u32 s34, s60, 1622016
    buffer_load_dwordx4 v97, s[88:91], s34 offen lds
    s_cmp_lg_u32 s3, 0
    s_cbranch_scc1 L_nofi_0
    v_mov_b64 v[64:65], 0
    v_mov_b64 v[66:67], 0
    s_mov_b32 s33, 262144
    buffer_store_dwordx4 v[64:67], v0, s[8:11], s33 offen offset:0 sc1
    buffer_store_dwordx4 v[64:67], v0, s[8:11], s33 offen offset:1024 sc1
    buffer_store_dwordx4 v[64:67], v0, s[8:11], s33 offen offset:2048 sc1
    buffer_store_dwordx4 v[64:67], v0, s[8:11], s33 offen offset:3072 sc1
L_nofi_0:
    s_nop 1
    v_mov_b32 v64, -1
    v_mov_b32 v65, -1
    v_mov_b32 v66, -1
    v_mov_b32 v67, -1
    s_lshl_b32 s33, s3, 13
    s_add_u32 s33, s33, 1048576
    buffer_store_dwordx4 v[64:67], v0, s[8:11], s33 offen sc1
    buffer_store_dwordx4 v[64:67], v0, s[8:11], s33 offen offset:1024 sc1
    s_add_u32 s33, s33, 262144
    buffer_store_dwordx4 v[64:67], v0, s[8:11], s33 offen sc1
    buffer_store_dwordx4 v[64:67], v0, s[8:11], s33 offen offset:1024 sc1
    s_lshl_b32 s33, s3, 2
    s_add_u32 s33, s33, 0
    s_lshr_b32 s34, s33, 4
    s_lshl_b32 s34, s34, 7
    s_and_b32 s35, s33, 3
    s_lshl_b32 s35, s35, 3
    s_add_u32 s34, s34, s35
    s_bfe_u32 s35, s33, 0x20002
    s_lshl_b32 s35, s35, 11
    s_add_u32 s34, s34, s35
    v_bfe_u32 v68, v31, 4, 1
    v_lshlrev_b32 v68, 6, v68
    v_bfe_u32 v69, v31, 2, 1
    v_lshlrev_b32 v69, 10, v69
    v_and_b32 v70, 3, v31
    v_lshlrev_b32 v70, 1, v70
    v_add3_u32 v68, v68, v69, v70
    v_add_u32 v68, s34, v68
    buffer_load_ushort v69, v68, s[12:15], 0 offen
    buffer_load_ushort v70, v68, s[12:15], 0 offen offset:32
    s_waitcnt vmcnt(0)
    v_lshl_or_b32 v69, v70, 16, v69
    v_min_u32 v69, -2, v69
    s_mov_b64 exec, s[40:41]
    s_mov_b32 s33, 1572864
    buffer_store_dword v69, v2, s[8:11], s33 offen sc1
    s_mov_b32 s33, 1581056
    buffer_store_dword v64, v2, s[8:11], s33 offen sc1
    s_mov_b32 s33, 1589248
    buffer_store_dword v64, v2, s[8:11], s33 offen sc1
    s_mov_b64 exec, -1
    s_waitcnt vmcnt(0)
    s_barrier
    s_cmp_lg_u32 s3, 0
    s_cbranch_scc1 L_nofj
    s_mov_b64 exec, 1
    v_mov_b32 v64, 28
    v_mov_b32 v65, 1
    global_store_dword v64, v65, s[16:17] sc1
    s_mov_b64 exec, -1
L_nofj:
    s_mov_b64 exec, 1
    v_mov_b32 v64, 16
    v_mov_b32 v65, s72
    global_atomic_add v64, v65, s[16:17] sc1
    s_mov_b64 exec, -1
    s_waitcnt vmcnt(0)
    s_waitcnt vmcnt(36) lgkmcnt(0)
    s_barrier
    ds_read_b64_tr_b16 a[0:1], v100 offset:0
    ds_read_b64_tr_b16 a[2:3], v100 offset:4096
    ds_read_b64_tr_b16 a[4:5], v100 offset:8192
    ds_read_b64_tr_b16 a[6:7], v100 offset:12288
    ds_read_b64_tr_b16 a[8:9], v101 offset:0
    ds_read_b64_tr_b16 a[10:11], v101 offset:4096
    ds_read_b64_tr_b16 a[12:13], v101 offset:8192
    ds_read_b64_tr_b16 a[14:15], v101 offset:12288
    s_waitcnt vmcnt(32) lgkmcnt(0)
    s_barrier
    ds_read_b64_tr_b16 a[16:17], v100 offset:16384
    ds_read_b64_tr_b16 a[18:19], v100 offset:20480
    ds_read_b64_tr_b16 a[20:21], v100 offset:24576
    ds_read_b64_tr_b16 a[22:23], v100 offset:28672
    ds_read_b64_tr_b16 a[24:25], v101 offset:16384
    ds_read_b64_tr_b16 a[26:27], v101 offset:20480
    ds_read_b64_tr_b16 a[28:29], v101 offset:24576
    ds_read_b64_tr_b16 a[30:31], v101 offset:28672
    s_mov_b32 m0, 32768
    s_add_u32 s34, s60, 2097152
    buffer_load_dwordx4 v96, s[88:91], s34 offen lds
    s_mov_b32 m0, 33792
    s_add_u32 s34, s60, 2113536
    buffer_load_dwordx4 v97, s[88:91], s34 offen lds
    s_mov_b32 m0, 34816
    s_add_u32 s34, s60, 2129920
    buffer_load_dwordx4 v96, s[88:91], s34 offen lds
    s_mov_b32 m0, 35840
    s_add_u32 s34, s60, 2146304
    buffer_load_dwordx4 v97, s[88:91], s34 offen lds
    s_waitcnt vmcnt(32) lgkmcnt(0)
    s_barrier
    ds_read_b64_tr_b16 a[32:33], v100 offset:32768
    ds_read_b64_tr_b16 a[34:35], v100 offset:36864
    ds_read_b64_tr_b16 a[36:37], v100 offset:40960
    ds_read_b64_tr_b16 a[38:39], v100 offset:45056
    ds_read_b64_tr_b16 a[40:41], v101 offset:32768
    ds_read_b64_tr_b16 a[42:43], v101 offset:36864
    ds_read_b64_tr_b16 a[44:45], v101 offset:40960
    ds_read_b64_tr_b16 a[46:47], v101 offset:45056
    s_mov_b32 m0, 49152
    s_add_u32 s34, s60, 2621440
    buffer_load_dwordx4 v96, s[88:91], s34 offen lds
    s_mov_b32 m0, 50176
    s_add_u32 s34, s60, 2637824
    buffer_load_dwordx4 v97, s[88:91], s34 offen lds
    s_mov_b32 m0, 51200
    s_add_u32 s34, s60, 2654208
    buffer_load_dwordx4 v96, s[88:91], s34 offen lds
    s_mov_b32 m0, 52224
    s_add_u32 s34, s60, 2670592
    buffer_load_dwordx4 v97, s[88:91], s34 offen lds
    s_waitcnt vmcnt(32) lgkmcnt(0)
    s_barrier
    ds_read_b64_tr_b16 a[48:49], v100 offset:49152
    ds_read_b64_tr_b16 a[50:51], v100 offset:53248
    ds_read_b64_tr_b16 a[52:53], v100 offset:57344
    ds_read_b64_tr_b16 a[54:55], v100 offset:61440
    ds_read_b64_tr_b16 a[56:57], v101 offset:49152
    ds_read_b64_tr_b16 a[58:59], v101 offset:53248
    ds_read_b64_tr_b16 a[60:61], v101 offset:57344
    ds_read_b64_tr_b16 a[62:63], v101 offset:61440
    s_mov_b32 m0, 65536
    s_add_u32 s34, s60, 0
    buffer_load_dwordx4 v96, s[92:95], s34 offen lds
    s_mov_b32 m0, 66560
    s_add_u32 s34, s60, 16384
    buffer_load_dwordx4 v97, s[92:95], s34 offen lds
    s_mov_b32 m0, 67584
    s_add_u32 s34, s60, 32768
    buffer_load_dwordx4 v96, s[92:95], s34 offen lds
    s_mov_b32 m0, 68608
    s_add_u32 s34, s60, 49152
    buffer_load_dwordx4 v97, s[92:95], s34 offen lds
    s_waitcnt vmcnt(32) lgkmcnt(0)
    s_barrier
    ds_read_b64_tr_b16 a[64:65], v102 offset:0
    ds_read_b64_tr_b16 a[66:67], v102 offset:4096
    ds_read_b64_tr_b16 a[68:69], v102 offset:8192
    ds_read_b64_tr_b16 a[70:71], v102 offset:12288
    ds_read_b64_tr_b16 a[72:73], v103 offset:0
    ds_read_b64_tr_b16 a[74:75], v103 offset:4096
    ds_read_b64_tr_b16 a[76:77], v103 offset:8192
    ds_read_b64_tr_b16 a[78:79], v103 offset:12288
    s_mov_b32 m0, 81920
    s_add_u32 s34, s60, 524288
    buffer_load_dwordx4 v96, s[92:95], s34 offen lds
    s_mov_b32 m0, 82944
    s_add_u32 s34, s60, 540672
    buffer_load_dwordx4 v97, s[92:95], s34 offen lds
    s_mov_b32 m0, 83968
    s_add_u32 s34, s60, 557056
    buffer_load_dwordx4 v96, s[92:95], s34 offen lds
    s_mov_b32 m0, 84992
    s_add_u32 s34, s60, 573440
    buffer_load_dwordx4 v97, s[92:95], s34 offen lds
    s_waitcnt vmcnt(32) lgkmcnt(0)
    s_barrier
    ds_read_b64_tr_b16 a[80:81], v102 offset:16384
    ds_read_b64_tr_b16 a[82:83], v102 offset:20480
    ds_read_b64_tr_b16 a[84:85], v102 offset:24576
    ds_read_b64_tr_b16 a[86:87], v102 offset:28672
    ds_read_b64_tr_b16 a[88:89], v103 offset:16384
    ds_read_b64_tr_b16 a[90:91], v103 offset:20480
    ds_read_b64_tr_b16 a[92:93], v103 offset:24576
    ds_read_b64_tr_b16 a[94:95], v103 offset:28672
    s_mov_b32 m0, 98304
    s_add_u32 s34, s60, 1048576
    buffer_load_dwordx4 v96, s[92:95], s34 offen lds
    s_mov_b32 m0, 99328
    s_add_u32 s34, s60, 1064960
    buffer_load_dwordx4 v97, s[92:95], s34 offen lds
    s_mov_b32 m0, 100352
    s_add_u32 s34, s60, 1081344
    buffer_load_dwordx4 v96, s[92:95], s34 offen lds
    s_mov_b32 m0, 101376
    s_add_u32 s34, s60, 1097728
    buffer_load_dwordx4 v97, s[92:95], s34 offen lds
    s_waitcnt vmcnt(32) lgkmcnt(0)
    s_barrier
    ds_read_b64_tr_b16 a[96:97], v102 offset:32768
    ds_read_b64_tr_b16 a[98:99], v102 offset:36864
    ds_read_b64_tr_b16 a[100:101], v102 offset:40960
    ds_read_b64_tr_b16 a[102:103], v102 offset:45056
    ds_read_b64_tr_b16 a[104:105], v103 offset:32768
    ds_read_b64_tr_b16 a[106:107], v103 offset:36864
    ds_read_b64_tr_b16 a[108:109], v103 offset:40960
    ds_read_b64_tr_b16 a[110:111], v103 offset:45056
    s_mov_b32 m0, 114688
    s_add_u32 s34, s60, 1572864
    buffer_load_dwordx4 v96, s[92:95], s34 offen lds
    s_mov_b32 m0, 115712
    s_add_u32 s34, s60, 1589248
    buffer_load_dwordx4 v97, s[92:95], s34 offen lds
    s_mov_b32 m0, 116736
    s_add_u32 s34, s60, 1605632
    buffer_load_dwordx4 v96, s[92:95], s34 offen lds
    s_mov_b32 m0, 117760
    s_add_u32 s34, s60, 1622016
    buffer_load_dwordx4 v97, s[92:95], s34 offen lds
    s_waitcnt vmcnt(32) lgkmcnt(0)
    s_barrier
    ds_read_b64_tr_b16 a[112:113], v102 offset:49152
    ds_read_b64_tr_b16 a[114:115], v102 offset:53248
    ds_read_b64_tr_b16 a[116:117], v102 offset:57344
    ds_read_b64_tr_b16 a[118:119], v102 offset:61440
    ds_read_b64_tr_b16 a[120:121], v103 offset:49152
    ds_read_b64_tr_b16 a[122:123], v103 offset:53248
    ds_read_b64_tr_b16 a[124:125], v103 offset:57344
    ds_read_b64_tr_b16 a[126:127], v103 offset:61440
    s_mov_b32 m0, 131072
    s_add_u32 s34, s60, 2097152
    buffer_load_dwordx4 v96, s[92:95], s34 offen lds
    s_mov_b32 m0, 132096
    s_add_u32 s34, s60, 2113536
    buffer_load_dwordx4 v97, s[92:95], s34 offen lds
    s_mov_b32 m0, 133120
    s_add_u32 s34, s60, 2129920
    buffer_load_dwordx4 v96, s[92:95], s34 offen lds
    s_mov_b32 m0, 134144
    s_add_u32 s34, s60, 2146304
    buffer_load_dwordx4 v97, s[92:95], s34 offen lds
    s_waitcnt vmcnt(32) lgkmcnt(0)
    s_barrier
    ds_read_b64_tr_b16 a[128:129], v107 offset:0
    ds_read_b64_tr_b16 a[130:131], v107 offset:4096
    ds_read_b64_tr_b16 a[132:133], v107 offset:8192
    ds_read_b64_tr_b16 a[134:135], v107 offset:12288
    ds_read_b64_tr_b16 a[136:137], v108 offset:0
    ds_read_b64_tr_b16 a[138:139], v108 offset:4096
    ds_read_b64_tr_b16 a[140:141], v108 offset:8192
    ds_read_b64_tr_b16 a[142:143], v108 offset:12288
    s_mov_b32 m0, 147456
    s_add_u32 s34, s60, 2621440
    buffer_load_dwordx4 v96, s[92:95], s34 offen lds
    s_mov_b32 m0, 148480
    s_add_u32 s34, s60, 2637824
    buffer_load_dwordx4 v97, s[92:95], s34 offen lds
    s_mov_b32 m0, 149504
    s_add_u32 s34, s60, 2654208
    buffer_load_dwordx4 v96, s[92:95], s34 offen lds
    s_mov_b32 m0, 150528
    s_add_u32 s34, s60, 2670592
    buffer_load_dwordx4 v97, s[92:95], s34 offen lds
    s_waitcnt vmcnt(32) lgkmcnt(0)
    s_barrier
    ds_read_b64_tr_b16 a[144:145], v107 offset:16384
    ds_read_b64_tr_b16 a[146:147], v107 offset:20480
    ds_read_b64_tr_b16 a[148:149], v107 offset:24576
    ds_read_b64_tr_b16 a[150:151], v107 offset:28672
    ds_read_b64_tr_b16 a[152:153], v108 offset:16384
    ds_read_b64_tr_b16 a[154:155], v108 offset:20480
    ds_read_b64_tr_b16 a[156:157], v108 offset:24576
    ds_read_b64_tr_b16 a[158:159], v108 offset:28672
    s_mov_b32 m0, 0
    s_add_u32 s34, s60, 3145728
    buffer_load_dwordx4 v96, s[92:95], s34 offen lds
    s_mov_b32 m0, 1024
    s_add_u32 s34, s60, 3162112
    buffer_load_dwordx4 v97, s[92:95], s34 offen lds
    s_mov_b32 m0, 2048
    s_add_u32 s34, s60, 3178496
    buffer_load_dwordx4 v96, s[92:95], s34 offen lds
    s_mov_b32 m0, 3072
    s_add_u32 s34, s60, 3194880
    buffer_load_dwordx4 v97, s[92:95], s34 offen lds
    s_waitcnt vmcnt(32) lgkmcnt(0)
    s_barrier
    ds_read_b64_tr_b16 a[160:161], v100 offset:0
    ds_read_b64_tr_b16 a[162:163], v100 offset:4096
    ds_read_b64_tr_b16 a[164:165], v100 offset:8192
    ds_read_b64_tr_b16 a[166:167], v100 offset:12288
    ds_read_b64_tr_b16 a[168:169], v101 offset:0
    ds_read_b64_tr_b16 a[170:171], v101 offset:4096
    ds_read_b64_tr_b16 a[172:173], v101 offset:8192
    ds_read_b64_tr_b16 a[174:175], v101 offset:12288
    s_mov_b32 m0, 16384
    s_add_u32 s34, s60, 3670016
    buffer_load_dwordx4 v96, s[92:95], s34 offen lds
    s_mov_b32 m0, 17408
    s_add_u32 s34, s60, 3686400
    buffer_load_dwordx4 v97, s[92:95], s34 offen lds
    s_mov_b32 m0, 18432
    s_add_u32 s34, s60, 3702784
    buffer_load_dwordx4 v96, s[92:95], s34 offen lds
    s_mov_b32 m0, 19456
    s_add_u32 s34, s60, 3719168
    buffer_load_dwordx4 v97, s[92:95], s34 offen lds
    s_waitcnt vmcnt(32) lgkmcnt(0)
    s_barrier
    ds_read_b64_tr_b16 a[176:177], v100 offset:16384
    ds_read_b64_tr_b16 a[178:179], v100 offset:20480
    ds_read_b64_tr_b16 a[180:181], v100 offset:24576
    ds_read_b64_tr_b16 a[182:183], v100 offset:28672
    ds_read_b64_tr_b16 a[184:185], v101 offset:16384
    ds_read_b64_tr_b16 a[186:187], v101 offset:20480
    ds_read_b64_tr_b16 a[188:189], v101 offset:24576
    ds_read_b64_tr_b16 a[190:191], v101 offset:28672
    s_mov_b32 m0, 32768
    s_add_u32 s34, s61, 0
    buffer_load_dwordx4 v98, s[96:99], s34 offen lds
    s_mov_b32 m0, 33792
    s_add_u32 s34, s61, 16384
    buffer_load_dwordx4 v99, s[96:99], s34 offen lds
    s_mov_b32 m0, 34816
    s_add_u32 s34, s61, 8192
    buffer_load_dwordx4 v98, s[96:99], s34 offen lds
    s_mov_b32 m0, 35840
    s_add_u32 s34, s61, 24576
    buffer_load_dwordx4 v99, s[96:99], s34 offen lds
    s_waitcnt vmcnt(32) lgkmcnt(0)
    s_barrier
    ds_read_b64_tr_b16 v[128:129], v100 offset:32768
    ds_read_b64_tr_b16 v[130:131], v100 offset:36864
    ds_read_b64_tr_b16 v[132:133], v100 offset:40960
    ds_read_b64_tr_b16 v[134:135], v100 offset:45056
    ds_read_b64_tr_b16 v[136:137], v101 offset:32768
    ds_read_b64_tr_b16 v[138:139], v101 offset:36864
    ds_read_b64_tr_b16 v[140:141], v101 offset:40960
    ds_read_b64_tr_b16 v[142:143], v101 offset:45056
    s_mov_b32 m0, 49152
    s_add_u32 s34, s61, 256
    buffer_load_dwordx4 v98, s[96:99], s34 offen lds
    s_mov_b32 m0, 50176
    s_add_u32 s34, s61, 16640
    buffer_load_dwordx4 v99, s[96:99], s34 offen lds
    s_mov_b32 m0, 51200
    s_add_u32 s34, s61, 8448
    buffer_load_dwordx4 v98, s[96:99], s34 offen lds
    s_mov_b32 m0, 52224
    s_add_u32 s34, s61, 24832
    buffer_load_dwordx4 v99, s[96:99], s34 offen lds
    s_waitcnt vmcnt(32) lgkmcnt(0)
    s_barrier
    ds_read_b64_tr_b16 v[144:145], v100 offset:49152
    ds_read_b64_tr_b16 v[146:147], v100 offset:53248
    ds_read_b64_tr_b16 v[148:149], v100 offset:57344
    ds_read_b64_tr_b16 v[150:151], v100 offset:61440
    ds_read_b64_tr_b16 v[152:153], v101 offset:49152
    ds_read_b64_tr_b16 v[154:155], v101 offset:53248
    ds_read_b64_tr_b16 v[156:157], v101 offset:57344
    ds_read_b64_tr_b16 v[158:159], v101 offset:61440
    s_mov_b32 m0, 65536
    s_add_u32 s34, s61, 512
    buffer_load_dwordx4 v98, s[96:99], s34 offen lds
    s_mov_b32 m0, 66560
    s_add_u32 s34, s61, 16896
    buffer_load_dwordx4 v99, s[96:99], s34 offen lds
    s_mov_b32 m0, 67584
    s_add_u32 s34, s61, 8704
    buffer_load_dwordx4 v98, s[96:99], s34 offen lds
    s_mov_b32 m0, 68608
    s_add_u32 s34, s61, 25088
    buffer_load_dwordx4 v99, s[96:99], s34 offen lds
    s_waitcnt vmcnt(32) lgkmcnt(0)
    s_barrier
    ds_read_b64_tr_b16 v[160:161], v102 offset:0
    ds_read_b64_tr_b16 v[162:163], v102 offset:4096
    ds_read_b64_tr_b16 v[164:165], v102 offset:8192
    ds_read_b64_tr_b16 v[166:167], v102 offset:12288
    ds_read_b64_tr_b16 v[168:169], v103 offset:0
    ds_read_b64_tr_b16 v[170:171], v103 offset:4096
    ds_read_b64_tr_b16 v[172:173], v103 offset:8192
    ds_read_b64_tr_b16 v[174:175], v103 offset:12288
    s_mov_b32 m0, 81920
    s_add_u32 s34, s61, 768
    buffer_load_dwordx4 v98, s[96:99], s34 offen lds
    s_mov_b32 m0, 82944
    s_add_u32 s34, s61, 17152
    buffer_load_dwordx4 v99, s[96:99], s34 offen lds
    s_mov_b32 m0, 83968
    s_add_u32 s34, s61, 8960
    buffer_load_dwordx4 v98, s[96:99], s34 offen lds
    s_mov_b32 m0, 84992
    s_add_u32 s34, s61, 25344
    buffer_load_dwordx4 v99, s[96:99], s34 offen lds
    v_mov_b32 v19, 28
    global_load_dword v16, v19, s[16:17] sc1
    v_mov_b32 v20, 16
    global_load_dword v17, v20, s[16:17] sc1
    s_waitcnt vmcnt(32) lgkmcnt(0)
    s_barrier
    ds_read_b64_tr_b16 v[176:177], v102 offset:16384
    ds_read_b64_tr_b16 v[178:179], v102 offset:20480
    ds_read_b64_tr_b16 v[180:181], v102 offset:24576
    ds_read_b64_tr_b16 v[182:183], v102 offset:28672
    ds_read_b64_tr_b16 v[184:185], v103 offset:16384
    ds_read_b64_tr_b16 v[186:187], v103 offset:20480
    ds_read_b64_tr_b16 v[188:189], v103 offset:24576
    ds_read_b64_tr_b16 v[190:191], v103 offset:28672
    s_mov_b32 m0, 98304
    s_add_u32 s34, s60, 3145728
    buffer_load_dwordx4 v96, s[88:91], s34 offen lds
    s_mov_b32 m0, 99328
    s_add_u32 s34, s60, 3162112
    buffer_load_dwordx4 v97, s[88:91], s34 offen lds
    s_mov_b32 m0, 100352
    s_add_u32 s34, s60, 3178496
    buffer_load_dwordx4 v96, s[88:91], s34 offen lds
    s_mov_b32 m0, 101376
    s_add_u32 s34, s60, 3194880
    buffer_load_dwordx4 v97, s[88:91], s34 offen lds
    s_waitcnt vmcnt(32) lgkmcnt(0)
    s_barrier
    ds_read_b64_tr_b16 v[192:193], v102 offset:32768
    ds_read_b64_tr_b16 v[194:195], v102 offset:36864
    ds_read_b64_tr_b16 v[196:197], v102 offset:40960
    ds_read_b64_tr_b16 v[198:199], v102 offset:45056
    ds_read_b64_tr_b16 v[200:201], v103 offset:32768
    ds_read_b64_tr_b16 v[202:203], v103 offset:36864
    ds_read_b64_tr_b16 v[204:205], v103 offset:40960
    ds_read_b64_tr_b16 v[206:207], v103 offset:45056
    s_mov_b32 m0, 114688
    s_add_u32 s34, s61, 66048
    buffer_load_dwordx4 v98, s[96:99], s34 offen lds
    s_mov_b32 m0, 115712
    s_add_u32 s34, s61, 82432
    buffer_load_dwordx4 v99, s[96:99], s34 offen lds
    s_mov_b32 m0, 116736
    s_add_u32 s34, s61, 74240
    buffer_load_dwordx4 v98, s[96:99], s34 offen lds
    s_mov_b32 m0, 117760
    s_add_u32 s34, s61, 90624
    buffer_load_dwordx4 v99, s[96:99], s34 offen lds
    s_waitcnt vmcnt(32) lgkmcnt(0)
    s_barrier
    ds_read_b64_tr_b16 v[208:209], v102 offset:49152
    ds_read_b64_tr_b16 v[210:211], v102 offset:53248
    ds_read_b64_tr_b16 v[212:213], v102 offset:57344
    ds_read_b64_tr_b16 v[214:215], v102 offset:61440
    ds_read_b64_tr_b16 v[216:217], v103 offset:49152
    ds_read_b64_tr_b16 v[218:219], v103 offset:53248
    ds_read_b64_tr_b16 v[220:221], v103 offset:57344
    ds_read_b64_tr_b16 v[222:223], v103 offset:61440
    s_mov_b32 m0, 131072
    s_add_u32 s34, s60, 3670016
    buffer_load_dwordx4 v96, s[88:91], s34 offen lds
    s_mov_b32 m0, 132096
    s_add_u32 s34, s60, 3686400
    buffer_load_dwordx4 v97, s[88:91], s34 offen lds
    s_mov_b32 m0, 133120
    s_add_u32 s34, s60, 3702784
    buffer_load_dwordx4 v96, s[88:91], s34 offen lds
    s_mov_b32 m0, 134144
    s_add_u32 s34, s60, 3719168
    buffer_load_dwordx4 v97, s[88:91], s34 offen lds
    s_waitcnt vmcnt(32) lgkmcnt(0)
    s_barrier
    ds_read_b64_tr_b16 v[224:225], v107 offset:0
    ds_read_b64_tr_b16 v[226:227], v107 offset:4096
    ds_read_b64_tr_b16 v[228:229], v107 offset:8192
    ds_read_b64_tr_b16 v[230:231], v107 offset:12288
    ds_read_b64_tr_b16 v[232:233], v108 offset:0
    ds_read_b64_tr_b16 v[234:235], v108 offset:4096
    ds_read_b64_tr_b16 v[236:237], v108 offset:8192
    ds_read_b64_tr_b16 v[238:239], v108 offset:12288
    s_mov_b32 m0, 147456
    s_add_u32 s34, s61, 66304
    buffer_load_dwordx4 v98, s[96:99], s34 offen lds
    s_mov_b32 m0, 148480
    s_add_u32 s34, s61, 82688
    buffer_load_dwordx4 v99, s[96:99], s34 offen lds
    s_mov_b32 m0, 149504
    s_add_u32 s34, s61, 74496
    buffer_load_dwordx4 v98, s[96:99], s34 offen lds
    s_mov_b32 m0, 150528
    s_add_u32 s34, s61, 90880
    buffer_load_dwordx4 v99, s[96:99], s34 offen lds
    s_waitcnt vmcnt(32) lgkmcnt(0)
    s_barrier
    ds_read_b64_tr_b16 v[240:241], v107 offset:16384
    ds_read_b64_tr_b16 v[242:243], v107 offset:20480
    ds_read_b64_tr_b16 v[244:245], v107 offset:24576
    ds_read_b64_tr_b16 v[246:247], v107 offset:28672
    ds_read_b64_tr_b16 v[248:249], v108 offset:16384
    ds_read_b64_tr_b16 v[250:251], v108 offset:20480
    ds_read_b64_tr_b16 v[252:253], v108 offset:24576
    ds_read_b64_tr_b16 v[254:255], v108 offset:28672
    s_waitcnt vmcnt(28) lgkmcnt(0)
    s_barrier
    v_add_u32 v105, 0, v104
    v_xor_b32 v106, 0, v105
    ds_read_b64_tr_b16 a[192:193], v106 offset:0
    ds_read_b64_tr_b16 a[194:195], v106 offset:4096
    ds_read_b64_tr_b16 a[196:197], v106 offset:8192
    ds_read_b64_tr_b16 a[198:199], v106 offset:12288
    v_xor_b32 v106, 32, v105
    ds_read_b64_tr_b16 a[200:201], v106 offset:0
    ds_read_b64_tr_b16 a[202:203], v106 offset:4096
    ds_read_b64_tr_b16 a[204:205], v106 offset:8192
    ds_read_b64_tr_b16 a[206:207], v106 offset:12288
    s_waitcnt lgkmcnt(0)
    v_xor_b32 v106, 64, v105
    ds_read_b64_tr_b16 a[208:209], v106 offset:0
    ds_read_b64_tr_b16 a[210:211], v106 offset:4096
    ds_read_b64_tr_b16 a[212:213], v106 offset:8192
    ds_read_b64_tr_b16 a[214:215], v106 offset:12288
    v_xor_b32 v106, 96, v105
    ds_read_b64_tr_b16 a[216:217], v106 offset:0
    ds_read_b64_tr_b16 a[218:219], v106 offset:4096
    ds_read_b64_tr_b16 a[220:221], v106 offset:8192
    ds_read_b64_tr_b16 a[222:223], v106 offset:12288
    s_waitcnt lgkmcnt(0)
    v_xor_b32 v106, 128, v105
    ds_read_b64_tr_b16 a[224:225], v106 offset:0
    ds_read_b64_tr_b16 a[226:227], v106 offset:4096
    ds_read_b64_tr_b16 a[228:229], v106 offset:8192
    ds_read_b64_tr_b16 a[230:231], v106 offset:12288
    v_xor_b32 v106, 160, v105
    ds_read_b64_tr_b16 a[232:233], v106 offset:0
    ds_read_b64_tr_b16 a[234:235], v106 offset:4096
    ds_read_b64_tr_b16 a[236:237], v106 offset:8192
    ds_read_b64_tr_b16 a[238:239], v106 offset:12288
    s_waitcnt lgkmcnt(0)
    v_xor_b32 v106, 192, v105
    ds_read_b64_tr_b16 a[240:241], v106 offset:0
    ds_read_b64_tr_b16 a[242:243], v106 offset:4096
    ds_read_b64_tr_b16 a[244:245], v106 offset:8192
    ds_read_b64_tr_b16 a[246:247], v106 offset:12288
    v_xor_b32 v106, 224, v105
    ds_read_b64_tr_b16 a[248:249], v106 offset:0
    ds_read_b64_tr_b16 a[250:251], v106 offset:4096
    ds_read_b64_tr_b16 a[252:253], v106 offset:8192
    ds_read_b64_tr_b16 a[254:255], v106 offset:12288
    s_waitcnt lgkmcnt(0)
    s_waitcnt vmcnt(24) lgkmcnt(0)
    s_barrier
    s_mov_b32 m0, 32768
    s_add_u32 s34, s60, 3145728
    buffer_load_dwordx4 v96, s[84:87], s34 offen lds
    s_mov_b32 m0, 33792
    s_add_u32 s34, s60, 3162112
    buffer_load_dwordx4 v97, s[84:87], s34 offen lds
    s_mov_b32 m0, 34816
    s_add_u32 s34, s60, 3178496
    buffer_load_dwordx4 v96, s[84:87], s34 offen lds
    s_mov_b32 m0, 35840
    s_add_u32 s34, s60, 3194880
    buffer_load_dwordx4 v97, s[84:87], s34 offen lds
    s_waitcnt vmcnt(24) lgkmcnt(0)
    s_barrier
    s_mov_b32 m0, 49152
    s_add_u32 s34, s61, 65536
    buffer_load_dwordx4 v98, s[96:99], s34 offen lds
    s_mov_b32 m0, 50176
    s_add_u32 s34, s61, 81920
    buffer_load_dwordx4 v99, s[96:99], s34 offen lds
    s_mov_b32 m0, 51200
    s_add_u32 s34, s61, 73728
    buffer_load_dwordx4 v98, s[96:99], s34 offen lds
    s_mov_b32 m0, 52224
    s_add_u32 s34, s61, 90112
    buffer_load_dwordx4 v99, s[96:99], s34 offen lds
    s_waitcnt vmcnt(24) lgkmcnt(0)
    s_barrier
    s_mov_b32 m0, 65536
    s_add_u32 s34, s60, 3670016
    buffer_load_dwordx4 v96, s[84:87], s34 offen lds
    s_mov_b32 m0, 66560
    s_add_u32 s34, s60, 3686400
    buffer_load_dwordx4 v97, s[84:87], s34 offen lds
    s_mov_b32 m0, 67584
    s_add_u32 s34, s60, 3702784
    buffer_load_dwordx4 v96, s[84:87], s34 offen lds
    s_mov_b32 m0, 68608
    s_add_u32 s34, s60, 3719168
    buffer_load_dwordx4 v97, s[84:87], s34 offen lds
    s_waitcnt lgkmcnt(0)
    s_barrier
    v_mov_b32 v21, 262144
    buffer_load_dword v18, v21, s[8:11], 0 offen sc1
    s_mov_b32 m0, 81920
    s_add_u32 s34, s61, 65792
    buffer_load_dwordx4 v98, s[96:99], s34 offen lds
    s_mov_b32 m0, 82944
    s_add_u32 s34, s61, 82176
    buffer_load_dwordx4 v99, s[96:99], s34 offen lds
    s_mov_b32 m0, 83968
    s_add_u32 s34, s61, 73984
    buffer_load_dwordx4 v98, s[96:99], s34 offen lds
    s_mov_b32 m0, 84992
    s_add_u32 s34, s61, 90368
    buffer_load_dwordx4 v99, s[96:99], s34 offen lds
    s_waitcnt vmcnt(0)
    s_barrier
    v_readfirstlane_b32 s33, v17
    s_lshr_b32 s71, s33, 16
    s_and_b32 s33, s33, 0xffff
    s_cmp_ge_u32 s33, 32
    s_cbranch_scc1 L_cbd0
    v_mov_b32 v26, 16
    s_mov_b32 s7, 0
L_cb0:
    global_load_dword v27, v26, s[16:17] sc1
    s_waitcnt vmcnt(0)
    v_readfirstlane_b32 s33, v27
    s_lshr_b32 s71, s33, 16
    s_and_b32 s33, s33, 0xffff
    s_cmp_ge_u32 s33, 32
    s_cbranch_scc1 L_cbd0
    s_add_u32 s7, s7, 1
    s_cmp_lt_u32 s7, s6
    s_cbranch_scc1 L_cb0
    s_mov_b32 s6, 0
L_cbd0:
    v_readfirstlane_b32 s33, v16
    v_readfirstlane_b32 s34, v18
    s_and_b32 s34, s34, 0xff
    s_cmp_eq_u32 s34, 128
    s_cselect_b32 s34, s33, 0
    s_cmp_lg_u32 s34, 0
    s_cbranch_scc1 L_kv0d_0
    v_mov_b32 v26, 28
    s_mov_b32 s7, 0
L_ini_0:
    global_load_dword v27, v26, s[16:17] sc1
    s_waitcnt vmcnt(0)
    v_readfirstlane_b32 s33, v27
    s_cmp_lg_u32 s33, 0
    s_cbranch_scc1 L_inid_0
    s_add_u32 s7, s7, 1
    s_cmp_lt_u32 s7, 100000
    s_cbranch_scc1 L_ini_0
L_inid_0:
    v_mov_b32 v26, 262144
    s_mov_b32 s7, 0
L_kv0_0:
    buffer_load_dword v27, v26, s[8:11], 0 offen sc1
    s_waitcnt vmcnt(0)
    v_readfirstlane_b32 s33, v27
    s_and_b32 s33, s33, 0xff
    s_cmp_eq_u32 s33, 128
    s_cbranch_scc1 L_kv0d_0
    s_sleep 2
    s_add_u32 s7, s7, 1
    s_cmp_lt_u32 s7, 400000
    s_cbranch_scc1 L_kv0_0
L_kv0d_0:
    s_lshl_b32 s33, s3, 13
    s_add_u32 s33, s33, 0
    s_add_u32 s28, s33, 16777216
    s_mov_b32 s29, 16384
    s_mov_b32 m0, s29
    s_add_u32 s30, s33, 33554432
    buffer_load_dwordx4 v0, s[8:11], s28 offen lds
    buffer_load_dwordx4 v0, s[8:11], s28 offen offset:1024 lds
    buffer_load_dwordx4 v[16:19], v9, s[8:11], s30 offen
    buffer_load_dwordx4 v[20:23], v9, s[8:11], s30 offen offset:256
    s_add_u32 s28, s28, 0x40000
    s_xor_b32 s29, s29, 8192
    s_add_u32 s30, s30, 0x40000
    s_mov_b32 s5, 0
    s_mov_b32 s20, 1572864
    s_mov_b32 s21, 1581056
    s_mov_b32 s22, 1589248
    s_lshl_b32 s33, s3, 6
    s_add_u32 s23, s33, 1048576
    s_add_u32 s25, s23, 32768
    s_lshl_b32 s33, s3, 13
    s_add_u32 s24, s33, 1048576
    s_add_u32 s26, s24, 262144
    s_lshl_b32 s33, s3, 11
    s_add_u32 s31, s33, 83886080
    s_lshl_b32 s33, s3, 12
    s_add_u32 s32, s33, 92274688
    s_mov_b32 s45, 2097152
    s_mov_b32 s62, 0x0F000000
    s_mov_b32 s63, 0x0F000000
    s_mov_b32 s96, 0x3e0293ee
    s_mov_b32 s97, 0x3e0293ee
    s_mov_b32 s98, 0x3f803f80
    s_mov_b32 s99, 0x3f803f80
    s_mov_b32 s100, 0xaaaaaaaa
    s_mov_b32 s101, 0xaaaaaaaa
    ds_read_b64_tr_b16 v[32:33], v100 offset:0
    ds_read_b64_tr_b16 v[34:35], v100 offset:4096
    ds_read_b64_tr_b16 v[36:37], v100 offset:8192
    ds_read_b64_tr_b16 v[38:39], v100 offset:12288
    ds_read_b64_tr_b16 v[40:41], v101 offset:0
    ds_read_b64_tr_b16 v[42:43], v101 offset:4096
    ds_read_b64_tr_b16 v[44:45], v101 offset:8192
    ds_read_b64_tr_b16 v[46:47], v101 offset:12288
    s_waitcnt lgkmcnt(0)
    ds_read_b64_tr_b16 v[48:49], v100 offset:32768
    ds_read_b64_tr_b16 v[50:51], v100 offset:36864
    ds_read_b64_tr_b16 v[52:53], v100 offset:40960
    ds_read_b64_tr_b16 v[54:55], v100 offset:45056
    ds_read_b64_tr_b16 v[56:57], v101 offset:32768
    ds_read_b64_tr_b16 v[58:59], v101 offset:36864
    ds_read_b64_tr_b16 v[60:61], v101 offset:40960
    ds_read_b64_tr_b16 v[62:63], v101 offset:45056
    s_waitcnt lgkmcnt(0)
    ds_read_b64_tr_b16 v[64:65], v102 offset:0
    ds_read_b64_tr_b16 v[66:67], v102 offset:4096
    ds_read_b64_tr_b16 v[68:69], v102 offset:8192
    ds_read_b64_tr_b16 v[70:71], v102 offset:12288
    ds_read_b64_tr_b16 v[72:73], v103 offset:0
    ds_read_b64_tr_b16 v[74:75], v103 offset:4096
    ds_read_b64_tr_b16 v[76:77], v103 offset:8192
    ds_read_b64_tr_b16 v[78:79], v103 offset:12288
    s_waitcnt lgkmcnt(0)
    ds_read_b64_tr_b16 v[80:81], v102 offset:32768
    ds_read_b64_tr_b16 v[82:83], v102 offset:36864
    ds_read_b64_tr_b16 v[84:85], v102 offset:40960
    ds_read_b64_tr_b16 v[86:87], v102 offset:45056
    ds_read_b64_tr_b16 v[88:89], v103 offset:32768
    ds_read_b64_tr_b16 v[90:91], v103 offset:36864
    ds_read_b64_tr_b16 v[92:93], v103 offset:40960
    ds_read_b64_tr_b16 v[94:95], v103 offset:45056
    s_waitcnt lgkmcnt(0)
    s_barrier
    ds_write_b128 v11, v[32:35] offset:0
    ds_write_b128 v11, v[36:39] offset:1024
    ds_write_b128 v11, v[40:43] offset:2048
    ds_write_b128 v11, v[44:47] offset:3072
    ds_write_b128 v11, v[48:51] offset:4096
    ds_write_b128 v11, v[52:55] offset:5120
    ds_write_b128 v11, v[56:59] offset:6144
    ds_write_b128 v11, v[60:63] offset:7168
    ds_write_b128 v11, v[64:67] offset:8192
    ds_write_b128 v11, v[68:71] offset:9216
    ds_write_b128 v11, v[72:75] offset:10240
    ds_write_b128 v11, v[76:79] offset:11264
    ds_write_b128 v11, v[80:83] offset:12288
    ds_write_b128 v11, v[84:87] offset:13312
    ds_write_b128 v11, v[88:91] offset:14336
    ds_write_b128 v11, v[92:95] offset:15360
    s_waitcnt lgkmcnt(0)
    v_add_u32 v105, 16384, v104
    v_xor_b32 v106, 0, v105
    ds_read_b64_tr_b16 v[32:33], v106 offset:0
    ds_read_b64_tr_b16 v[34:35], v106 offset:4096
    ds_read_b64_tr_b16 v[36:37], v106 offset:8192
    ds_read_b64_tr_b16 v[38:39], v106 offset:12288
    v_xor_b32 v106, 32, v105
    ds_read_b64_tr_b16 v[40:41], v106 offset:0
    ds_read_b64_tr_b16 v[42:43], v106 offset:4096
    ds_read_b64_tr_b16 v[44:45], v106 offset:8192
    ds_read_b64_tr_b16 v[46:47], v106 offset:12288
    s_waitcnt lgkmcnt(0)
    v_xor_b32 v106, 64, v105
    ds_read_b64_tr_b16 v[48:49], v106 offset:0
    ds_read_b64_tr_b16 v[50:51], v106 offset:4096
    ds_read_b64_tr_b16 v[52:53], v106 offset:8192
    ds_read_b64_tr_b16 v[54:55], v106 offset:12288
    v_xor_b32 v106, 96, v105
    ds_read_b64_tr_b16 v[56:57], v106 offset:0
    ds_read_b64_tr_b16 v[58:59], v106 offset:4096
    ds_read_b64_tr_b16 v[60:61], v106 offset:8192
    ds_read_b64_tr_b16 v[62:63], v106 offset:12288
    s_waitcnt lgkmcnt(0)
    v_xor_b32 v106, 128, v105
    ds_read_b64_tr_b16 v[64:65], v106 offset:0
    ds_read_b64_tr_b16 v[66:67], v106 offset:4096
    ds_read_b64_tr_b16 v[68:69], v106 offset:8192
    ds_read_b64_tr_b16 v[70:71], v106 offset:12288
    v_xor_b32 v106, 160, v105
    ds_read_b64_tr_b16 v[72:73], v106 offset:0
    ds_read_b64_tr_b16 v[74:75], v106 offset:4096
    ds_read_b64_tr_b16 v[76:77], v106 offset:8192
    ds_read_b64_tr_b16 v[78:79], v106 offset:12288
    s_waitcnt lgkmcnt(0)
    v_xor_b32 v106, 192, v105
    ds_read_b64_tr_b16 v[80:81], v106 offset:0
    ds_read_b64_tr_b16 v[82:83], v106 offset:4096
    ds_read_b64_tr_b16 v[84:85], v106 offset:8192
    ds_read_b64_tr_b16 v[86:87], v106 offset:12288
    v_xor_b32 v106, 224, v105
    ds_read_b64_tr_b16 v[88:89], v106 offset:0
    ds_read_b64_tr_b16 v[90:91], v106 offset:4096
    ds_read_b64_tr_b16 v[92:93], v106 offset:8192
    ds_read_b64_tr_b16 v[94:95], v106 offset:12288
    s_waitcnt lgkmcnt(0)
    s_waitcnt lgkmcnt(0)
    ds_write_b128 v11, v[32:35] offset:16384
    ds_write_b128 v11, v[36:39] offset:17408
    ds_write_b128 v11, v[40:43] offset:18432
    ds_write_b128 v11, v[44:47] offset:19456
    ds_write_b128 v11, v[48:51] offset:20480
    ds_write_b128 v11, v[52:55] offset:21504
    ds_write_b128 v11, v[56:59] offset:22528
    ds_write_b128 v11, v[60:63] offset:23552
    ds_write_b128 v11, v[64:67] offset:24576
    ds_write_b128 v11, v[68:71] offset:25600
    ds_write_b128 v11, v[72:75] offset:26624
    ds_write_b128 v11, v[76:79] offset:27648
    ds_write_b128 v11, v[80:83] offset:28672
    ds_write_b128 v11, v[84:87] offset:29696
    ds_write_b128 v11, v[88:91] offset:30720
    ds_write_b128 v11, v[92:95] offset:31744
    s_waitcnt lgkmcnt(0)
    s_barrier
    s_mov_b32 s84, 0
    s_mov_b32 s85, 0
    s_mov_b32 s86, 0
    s_mov_b32 s87, 0
    s_mov_b32 s88, 0
    s_mov_b32 s89, 0
    s_mov_b32 s90, 0
    s_mov_b32 s91, 0
    s_mov_b32 s92, 0
    s_mov_b32 s93, 0
    s_waitcnt vmcnt(0)
    s_barrier
    ds_read_b128 v[64:67], v11 offset:0
    ds_read_b128 v[68:71], v11 offset:1024
    ds_read_b128 v[72:75], v11 offset:2048
    ds_read_b128 v[76:79], v11 offset:3072
    ds_read_b128 v[80:83], v11 offset:4096
    ds_read_b128 v[84:87], v11 offset:5120
    ds_read_b128 v[88:91], v11 offset:6144
    ds_read_b128 v[92:95], v11 offset:7168
    v_mov_b32 v112, 0
    v_mov_b32 v113, 0
    v_mov_b32 v114, 0
    v_mov_b32 v115, 0
    v_mov_b32 v116, 0
    v_mov_b32 v117, 0
    v_mov_b32 v118, 0
    v_mov_b32 v119, 0
    v_mov_b32 v120, 0
    v_mov_b32 v121, 0
    v_mov_b32 v122, 0
    v_mov_b32 v123, 0
    v_mov_b32 v124, 0
    v_mov_b32 v125, 0
    v_mov_b32 v126, 0
    v_mov_b32 v127, 0
    v_mov_b64 v[28:29], -1
    v_mov_b64 v[30:31], -1
    v_mov_b64 v[104:105], -1
    v_mov_b64 v[106:107], -1
    s_add_u32 s47, s20, 0
    s_mov_b32 s7, 0
    s_sleep 2
    s_mov_b32 m0, 0
    s_nop 0
    buffer_load_dwordx4 v0, s[8:11], s47 offen sc1 lds
    buffer_load_dwordx4 v0, s[8:11], s47 offen offset:1024 sc1 lds
    s_mov_b32 m0, 0
    s_nop 0
    buffer_load_dwordx4 v0, s[8:11], s47 offen sc1 lds
    buffer_load_dwordx4 v0, s[8:11], s47 offen offset:1024 sc1 lds
    s_memtime s[56:57]
    s_memrealtime s[74:75]
    s_waitcnt vmcnt(0) lgkmcnt(0)
    s_mov_b32 s94, s56
    s_cmp_lg_u32 s71, 0
    s_cbranch_scc1 L_step0s
L_step0:
    s_waitcnt vmcnt(2)
    ds_read_b128 v[32:35], v0 offset:0
    ds_read_b128 v[36:39], v0 offset:1024
    s_waitcnt lgkmcnt(0)
    v_max3_u32 v26, v32, v33, v34
    v_max3_u32 v27, v35, v36, v37
    v_max3_u32 v26, v26, v38, v39
    v_max_u32 v26, v26, v27
    v_cmp_eq_u32 vcc, -1, v26
    s_cbranch_vccnz L_p2r_0m
L_p2d_0m:
    s_barrier
    ds_read_b128 v[56:59], v0 offset:6144
    ds_read_b128 v[60:63], v0 offset:7168
    v_smfmac_f32_16x16x64_bf16 v[112:115], v[32:35], a[0:7], v10
    ds_read_b128 v[40:43], v0 offset:2048
    v_smfmac_f32_16x16x64_bf16 v[116:119], v[32:35], a[8:15], v10
    ds_read_b128 v[44:47], v0 offset:3072
    s_mov_b32 m0, s29
    s_nop 0
    buffer_load_dwordx4 v0, s[8:11], s28 offen lds
    v_smfmac_f32_16x16x64_bf16 v[112:115], v[36:39], a[16:23], v10
    ds_read_b128 v[48:51], v0 offset:4096
    v_smfmac_f32_16x16x64_bf16 v[116:119], v[36:39], a[24:31], v10
    ds_read_b128 v[52:55], v0 offset:5120
    v_smfmac_f32_16x16x64_bf16 v[120:123], v[32:35], a[96:103], v10
    ds_read_b64_tr_b16 v[28:29], v4 offset:256
    buffer_load_dwordx4 v0, s[8:11], s28 offen offset:1024 lds
    v_smfmac_f32_16x16x64_bf16 v[124:127], v[32:35], a[104:111], v10
    ds_read_b64_tr_b16 v[30:31], v4 offset:384
    v_smfmac_f32_16x16x64_bf16 v[120:123], v[36:39], a[112:119], v10
    s_mov_b32 m0, 14336
    s_nop 0
    buffer_load_dword v9, s[8:11], s30 offen lds
    v_smfmac_f32_16x16x64_bf16 v[124:127], v[36:39], a[120:127], v10
    s_waitcnt lgkmcnt(7)
    v_smfmac_f32_16x16x64_bf16 v[112:115], v[56:59], v[64:71], v10
    v_smfmac_f32_16x16x64_bf16 v[116:119], v[56:59], v[72:79], v10
    buffer_load_dword v9, s[8:11], s30 offen offset:256 lds
    s_waitcnt lgkmcnt(6)
    v_smfmac_f32_16x16x64_bf16 v[112:115], v[60:63], v[80:87], v10
    v_smfmac_f32_16x16x64_bf16 v[116:119], v[60:63], v[88:95], v10
    ds_read_b128 v[64:67], v11 offset:8192
    s_lshl_b32 s33, s3, 7
    s_add_u32 s33, s33, 271360
    s_sub_u32 s34, s5, 1
    s_max_i32 s34, s34, 0
    v_mov_b32 v26, s34
    v_mov_b32 v27, 0
    s_mov_b64 exec, 1
    buffer_store_dword v26, v27, s[8:11], s33 offen sc1
    s_mov_b64 exec, -1
    s_waitcnt lgkmcnt(6)
    v_smfmac_f32_16x16x64_bf16 v[112:115], v[40:43], a[32:39], v10
    ds_read_b128 v[68:71], v11 offset:9216
    v_smfmac_f32_16x16x64_bf16 v[116:119], v[40:43], a[40:47], v10
    ds_read_b128 v[72:75], v11 offset:10240
    s_waitcnt lgkmcnt(7)
    v_smfmac_f32_16x16x64_bf16 v[112:115], v[44:47], a[48:55], v10
    ds_read_b128 v[76:79], v11 offset:11264
    v_smfmac_f32_16x16x64_bf16 v[116:119], v[44:47], a[56:63], v10
    ds_read_b128 v[80:83], v11 offset:12288
    s_waitcnt lgkmcnt(8)
    v_smfmac_f32_16x16x64_bf16 v[112:115], v[48:51], a[64:71], v10
    ds_read_b128 v[84:87], v11 offset:13312
    v_smfmac_f32_16x16x64_bf16 v[116:119], v[48:51], a[72:79], v10
    ds_read_b128 v[88:91], v11 offset:14336
    s_waitcnt lgkmcnt(9)
    v_smfmac_f32_16x16x64_bf16 v[112:115], v[52:55], a[80:87], v10
    ds_read_b128 v[92:95], v11 offset:15360
    v_smfmac_f32_16x16x64_bf16 v[116:119], v[52:55], a[88:95], v10
    s_waitcnt lgkmcnt(4)
    v_smfmac_f32_16x16x64_bf16 v[120:123], v[56:59], v[64:71], v10
    v_smfmac_f32_16x16x64_bf16 v[124:127], v[56:59], v[72:79], v10
    v_add_f32 v112, v112, v114
    v_smfmac_f32_16x16x64_bf16 v[120:123], v[40:43], a[128:135], v10
    ds_read_b128 v[64:67], v5 offset:0
    v_add_f32 v113, v113, v115
    v_add_f32 v116, v116, v118
    v_smfmac_f32_16x16x64_bf16 v[124:127], v[40:43], a[136:143], v10
    ds_read_b128 v[68:71], v5 offset:2048
    v_add_f32 v117, v117, v119
    v_cvt_pk_bf16_f32 v112, v112, v113
    s_waitcnt lgkmcnt(2)
    v_smfmac_f32_16x16x64_bf16 v[120:123], v[60:63], v[80:87], v10
    ds_read_b128 v[72:75], v5 offset:4096
    v_cvt_pk_bf16_f32 v116, v116, v117
    v_smfmac_f32_16x16x64_bf16 v[124:127], v[60:63], v[88:95], v10
    ds_write2_b32 v3, v112, v116 offset0:0 offset1:128
    ds_read_b128 v[76:79], v5 offset:6144
    v_smfmac_f32_16x16x64_bf16 v[120:123], v[44:47], a[144:151], v10
    ds_read_b128 v[80:83], v6 offset:0
    v_smfmac_f32_16x16x64_bf16 v[124:127], v[44:47], a[152:159], v10
    ds_read_b128 v[84:87], v6 offset:2048
    buffer_store_dwordx4 v[12:15], v0, s[8:11], s63 offen offset:0 sc1
    v_smfmac_f32_16x16x64_bf16 v[120:123], v[48:51], a[160:167], v10
    ds_read_b128 v[88:91], v6 offset:4096
    s_waitcnt lgkmcnt(4)
    v_smfmac_f32_16x16x64_bf16 v[124:127], v[48:51], a[168:175], v10
    ds_read_b128 v[92:95], v6 offset:6144
    v_mov_b64 v[112:113], 0
    v_smfmac_f32_16x16x64_bf16 v[120:123], v[52:55], a[176:183], v10
    v_mov_b64 v[114:115], 0
    v_smfmac_f32_16x16x64_bf16 v[124:127], v[52:55], a[184:191], v10
    v_mov_b64 v[116:117], 0
    v_mov_b64 v[118:119], 0
    v_smfmac_f32_16x16x64_bf16 v[112:115], v[32:35], v[128:135], v10
    v_smfmac_f32_16x16x64_bf16 v[116:119], v[32:35], v[136:143], v10
    v_add_f32 v120, v120, v122
    v_add_f32 v121, v121, v123
    v_smfmac_f32_16x16x64_bf16 v[112:115], v[36:39], v[144:151], v10
    v_add_f32 v124, v124, v126
    v_add_f32 v125, v125, v127
    v_smfmac_f32_16x16x64_bf16 v[116:119], v[36:39], v[152:159], v10
    v_cvt_pk_bf16_f32 v120, v120, v121
    v_cvt_pk_bf16_f32 v124, v124, v125
    v_smfmac_f32_16x16x64_bf16 v[112:115], v[40:43], v[160:167], v10
    ds_write2_b32 v3, v120, v124 offset0:64 offset1:192
    v_smfmac_f32_16x16x64_bf16 v[116:119], v[40:43], v[168:175], v10
    v_smfmac_f32_16x16x64_bf16 v[112:115], v[44:47], v[176:183], v10
    v_smfmac_f32_16x16x64_bf16 v[116:119], v[44:47], v[184:191], v10
    v_smfmac_f32_16x16x64_bf16 v[112:115], v[48:51], v[192:199], v10
    s_mov_b64 exec, s[36:37]
    buffer_store_dwordx4 v[28:31], v7, s[8:11], s62 offen offset:0 sc1
    s_mov_b64 exec, -1
    s_waitcnt lgkmcnt(0)
    s_barrier
    ds_read_b64_tr_b16 v[96:97], v4 offset:0
    ds_read_b64_tr_b16 v[98:99], v4 offset:128
    v_smfmac_f32_16x16x64_bf16 v[116:119], v[48:51], v[200:207], v10
    ds_read_b64_tr_b16 v[100:101], v4 offset:1024
    ds_read_b64_tr_b16 v[102:103], v4 offset:1152
    v_smfmac_f32_16x16x64_bf16 v[112:115], v[52:55], v[208:215], v10
    ds_read_b64_tr_b16 v[104:105], v4 offset:2048
    ds_read_b64_tr_b16 v[106:107], v4 offset:2176
    v_smfmac_f32_16x16x64_bf16 v[116:119], v[52:55], v[216:223], v10
    ds_read_b64_tr_b16 v[108:109], v4 offset:3072
    ds_read_b64_tr_b16 v[110:111], v4 offset:3200
    v_smfmac_f32_16x16x64_bf16 v[112:115], v[56:59], v[224:231], v10
    v_smfmac_f32_16x16x64_bf16 v[116:119], v[56:59], v[232:239], v10
    v_smfmac_f32_16x16x64_bf16 v[112:115], v[60:63], v[240:247], v10
    v_smfmac_f32_16x16x64_bf16 v[116:119], v[60:63], v[248:255], v10
    s_waitcnt vmcnt(7)
    ds_read_b64_tr_b16 v[32:33], v4 offset:256
    ds_read_b64_tr_b16 v[34:35], v4 offset:384
    ds_read_b64_tr_b16 v[36:37], v4 offset:1280
    ds_read_b64_tr_b16 v[38:39], v4 offset:1408
    s_waitcnt lgkmcnt(10)
    v_mfma_f32_16x16x32_bf16 v[120:123], v[64:67], v[96:99], 0
    ds_read_b64_tr_b16 v[40:41], v4 offset:2304
    s_waitcnt lgkmcnt(9)
    v_mfma_f32_16x16x32_bf16 v[120:123], v[68:71], v[100:103], v[120:123]
    ds_read_b64_tr_b16 v[42:43], v4 offset:2432
    v_add_f32 v112, v112, v114
    v_add_f32 v113, v113, v115
    s_waitcnt lgkmcnt(8)
    v_mfma_f32_16x16x32_bf16 v[120:123], v[72:75], v[104:107], v[120:123]
    ds_read_b64_tr_b16 v[44:45], v4 offset:3328
    v_add_f32 v116, v116, v118
    v_add_f32 v117, v117, v119
    s_waitcnt lgkmcnt(7)
    v_mfma_f32_16x16x32_bf16 v[120:123], v[76:79], v[108:111], v[120:123]
    ds_read_b64_tr_b16 v[46:47], v4 offset:3456
    v_mov_b64 v[52:53], s[98:99]
    v_mov_b64 v[54:55], s[98:99]
    v_mfma_f32_16x16x32_bf16 v[124:127], v[80:83], v[96:99], 0
    ds_read_b128 v[64:67], v11 offset:16384
    v_cvt_pk_bf16_f32 v12, v112, v113
    v_cvt_pk_bf16_f32 v14, v116, v117
    v_mfma_f32_16x16x32_bf16 v[124:127], v[84:87], v[100:103], v[124:127]
    ds_read_b128 v[68:71], v11 offset:17408
    v_mfma_f32_16x16x32_bf16 v[124:127], v[88:91], v[104:107], v[124:127]
    ds_read_b128 v[72:75], v11 offset:18432
    v_max3_f32 v26, v120, v121, v122
    v_mfma_f32_16x16x32_bf16 v[124:127], v[92:95], v[108:111], v[124:127]
    ds_read_b128 v[76:79], v11 offset:19456
    v_max_f32 v26, v26, v123
    s_waitcnt lgkmcnt(10)
    v_mfma_f32_16x16x32_bf16 v[48:51], v[32:35], v[96:99], 0
    ds_read_b128 v[80:83], v11 offset:20480
    s_waitcnt lgkmcnt(9)
    v_mfma_f32_16x16x32_bf16 v[48:51], v[36:39], v[100:103], v[48:51]
    ds_read_b128 v[84:87], v11 offset:21504
    v_max3_f32 v27, v124, v125, v126
    v_mov_b64 v[96:97], 0
    s_waitcnt lgkmcnt(8)
    v_mfma_f32_16x16x32_bf16 v[48:51], v[40:43], v[104:107], v[48:51]
    ds_read_b128 v[88:91], v11 offset:22528
    v_mov_b64 v[98:99], 0
    v_max3_f32 v26, v26, v127, v27
    s_waitcnt lgkmcnt(7)
    v_mfma_f32_16x16x32_bf16 v[48:51], v[44:47], v[108:111], v[48:51]
    ds_read_b128 v[92:95], v11 offset:23552
    v_mov_b64 v[100:101], 0
    v_mov_b64 v[102:103], 0
    v_mov_b64 v[104:105], 0
    v_mov_b64 v[106:107], 0
    v_mov_b64 v[108:109], 0
    v_mov_b64 v[110:111], 0
    s_nop 0
    v_max3_f32 v26, v26, v48, v49
    v_max3_f32 v26, v26, v50, v51
    v_cndmask_b32 v48, v48, v50, s[38:39]
    v_mov_b32 v27, v26
    v_cndmask_b32 v49, v49, v51, s[38:39]
    s_nop 0
    v_permlane16_swap_b32 v26, v27
    v_max_f32 v26, v26, v27
    v_mov_b32 v27, v26
    v_mov_b32 v61, 0
    s_nop 0
    v_permlane32_swap_b32 v26, v27
    v_max_f32 v26, v26, v27
    v_mul_f32 v28, s46, v26
    v_pk_fma_f32 v[120:121], v[120:121], s[96:97], v[28:29] op_sel_hi:[1,1,0] neg_lo:[0,0,1] neg_hi:[0,0,1]
    v_pk_fma_f32 v[122:123], v[122:123], s[96:97], v[28:29] op_sel_hi:[1,1,0] neg_lo:[0,0,1] neg_hi:[0,0,1]
    v_pk_fma_f32 v[124:125], v[124:125], s[96:97], v[28:29] op_sel_hi:[1,1,0] neg_lo:[0,0,1] neg_hi:[0,0,1]
    v_pk_fma_f32 v[126:127], v[126:127], s[96:97], v[28:29] op_sel_hi:[1,1,0] neg_lo:[0,0,1] neg_hi:[0,0,1]
    v_pk_fma_f32 v[48:49], v[48:49], s[96:97], v[28:29] op_sel_hi:[1,1,0] neg_lo:[0,0,1] neg_hi:[0,0,1]
    v_exp_f32 v120, v120
    v_exp_f32 v121, v121
    v_exp_f32 v122, v122
    v_exp_f32 v123, v123
    v_exp_f32 v124, v124
    v_exp_f32 v125, v125
    v_exp_f32 v126, v126
    v_exp_f32 v127, v127
    v_exp_f32 v48, v48
    v_exp_f32 v49, v49
    v_cvt_pk_bf16_f32 v56, v120, v121
    v_cvt_pk_bf16_f32 v57, v122, v123
    v_cvt_pk_bf16_f32 v58, v124, v125
    v_cvt_pk_bf16_f32 v59, v126, v127
    v_cvt_pk_bf16_f32 v60, v48, v49
    s_nop 0
    v_mfma_f32_16x16x32_bf16 v[26:29], v[52:55], v[56:59], 0
    v_mov_b64 v[120:121], 0
    v_mov_b64 v[122:123], 0
    v_mfma_f32_16x16x32_bf16 v[112:115], v[16:19], v[56:59], 0
    ds_read_b128 v[32:35], v11 offset:24576
    v_mov_b64 v[124:125], 0
    v_mfma_f32_16x16x32_bf16 v[116:119], v[20:23], v[56:59], 0
    ds_read_b128 v[36:39], v11 offset:25600
    buffer_load_dwordx4 v[16:19], v9, s[8:11], s30 offen
    v_mfma_f32_16x16x16_bf16 v[26:29], v[24:25], v[60:61], v[26:29]
    ds_read_b128 v[40:43], v11 offset:26624
    buffer_load_dwordx4 v[20:23], v9, s[8:11], s30 offen offset:256
    v_mfma_f32_16x16x16_bf16 v[112:115], v[12:13], v[60:61], v[112:115]
    ds_read_b128 v[44:47], v11 offset:27648
    v_mov_b64 v[126:127], 0
    v_mfma_f32_16x16x16_bf16 v[116:119], v[14:15], v[60:61], v[116:119]
    v_rcp_f32 v30, v26
    s_nop 2
    v_mul_f32 v112, v112, v30
    v_mul_f32 v113, v113, v30
    v_cvt_pk_bf16_f32 v56, v112, v113
    v_mul_f32 v114, v114, v30
    v_mul_f32 v115, v115, v30
    v_cvt_pk_bf16_f32 v57, v114, v115
    v_mul_f32 v116, v116, v30
    v_mul_f32 v117, v117, v30
    v_cvt_pk_bf16_f32 v58, v116, v117
    v_mul_f32 v118, v118, v30
    v_mul_f32 v119, v119, v30
    v_cvt_pk_bf16_f32 v59, v118, v119
    s_mov_b64 exec, s[36:37]
    ds_write_b128 v7, v[56:59] offset:12288
    s_mov_b64 exec, -1
    ds_read_b128 v[48:51], v11 offset:28672
    ds_read_b128 v[52:55], v11 offset:29696
    v_mov_b64 v[28:29], -1
    v_mov_b64 v[30:31], -1
    buffer_store_dwordx4 v[28:31], v0, s[8:11], s26 offen
    s_waitcnt lgkmcnt(2)
    s_barrier
    ds_read_b128 v[56:59], v8 offset:0
    ds_read_b128 v[60:63], v8 offset:1024
    buffer_store_dwordx4 v[28:31], v0, s[8:11], s26 offen offset:1024
    s_waitcnt lgkmcnt(1)
    v_smfmac_f32_16x16x64_bf16 v[96:99], v[56:59], a[192:199], v10
    v_mov_b64 v[112:113], 0
    v_smfmac_f32_16x16x64_bf16 v[100:103], v[56:59], a[200:207], v10
    v_mov_b64 v[114:115], 0
    v_smfmac_f32_16x16x64_bf16 v[104:107], v[56:59], a[208:215], v10
    v_mov_b64 v[116:117], 0
    v_smfmac_f32_16x16x64_bf16 v[108:111], v[56:59], a[216:223], v10
    v_mov_b64 v[118:119], 0
    s_waitcnt lgkmcnt(0)
    v_smfmac_f32_16x16x64_bf16 v[96:99], v[60:63], v[64:71], v10
    v_smfmac_f32_16x16x64_bf16 v[100:103], v[60:63], v[72:79], v10
    ds_read_b128 v[64:67], v11 offset:30720
    v_smfmac_f32_16x16x64_bf16 v[104:107], v[60:63], v[80:87], v10
    ds_read_b128 v[68:71], v11 offset:31744
    v_smfmac_f32_16x16x64_bf16 v[108:111], v[60:63], v[88:95], v10
    v_add_f32 v96, v96, v98
    v_add_f32 v97, v97, v99
    v_cvt_pk_bf16_f32 v96, v96, v97
    v_smfmac_f32_16x16x64_bf16 v[112:115], v[56:59], a[224:231], v10
    v_add_f32 v100, v100, v102
    v_add_f32 v101, v101, v103
    v_cvt_pk_bf16_f32 v97, v100, v101
    v_smfmac_f32_16x16x64_bf16 v[116:119], v[56:59], a[232:239], v10
    v_add_f32 v104, v104, v106
    v_add_f32 v105, v105, v107
    v_cvt_pk_bf16_f32 v98, v104, v105
    v_smfmac_f32_16x16x64_bf16 v[120:123], v[56:59], a[240:247], v10
    v_add_f32 v108, v108, v110
    v_add_f32 v109, v109, v111
    v_cvt_pk_bf16_f32 v99, v108, v109
    v_smfmac_f32_16x16x64_bf16 v[124:127], v[56:59], a[248:255], v10
    buffer_store_dwordx4 v[96:99], v1, s[8:11], s23 offen
    v_smfmac_f32_16x16x64_bf16 v[112:115], v[60:63], v[32:39], v10
    v_smfmac_f32_16x16x64_bf16 v[116:119], v[60:63], v[40:47], v10
    v_smfmac_f32_16x16x64_bf16 v[120:123], v[60:63], v[48:55], v10
    s_waitcnt lgkmcnt(0)
    v_smfmac_f32_16x16x64_bf16 v[124:127], v[60:63], v[64:71], v10
    v_add_f32 v112, v112, v114
    v_add_f32 v113, v113, v115
    v_cvt_pk_bf16_f32 v112, v112, v113
    v_add_f32 v116, v116, v118
    v_add_f32 v117, v117, v119
    v_cvt_pk_bf16_f32 v113, v116, v117
    v_add_f32 v120, v120, v122
    v_add_f32 v121, v121, v123
    v_cvt_pk_bf16_f32 v114, v120, v121
    v_add_f32 v124, v124, v126
    v_add_f32 v125, v125, v127
    v_cvt_pk_bf16_f32 v115, v124, v125
    buffer_store_dwordx4 v[112:115], v1, s[8:11], s25 offen
    v_mov_b32 v26, 0x3f80
    v_mov_b32 v27, 0x3f800000
    v_cndmask_b32 v26, v26, v27, s[100:101]
    v_cndmask_b32 v108, 0, v26, s[48:49]
    v_cndmask_b32 v109, 0, v26, s[50:51]
    v_cndmask_b32 v110, 0, v26, s[52:53]
    v_cndmask_b32 v111, 0, v26, s[54:55]
    ds_read_b128 v[64:67], v11 offset:0
    ds_read_b128 v[68:71], v11 offset:1024
    ds_read_b128 v[72:75], v11 offset:2048
    ds_read_b128 v[76:79], v11 offset:3072
    ds_read_b128 v[80:83], v11 offset:4096
    ds_read_b128 v[84:87], v11 offset:5120
    ds_read_b128 v[88:91], v11 offset:6144
    ds_read_b128 v[92:95], v11 offset:7168
    v_mov_b64 v[112:113], 0
    v_mov_b64 v[114:115], 0
    v_mov_b64 v[116:117], 0
    v_mov_b64 v[118:119], 0
    v_mov_b64 v[120:121], 0
    v_mov_b64 v[122:123], 0
    v_mov_b64 v[124:125], 0
    v_mov_b64 v[126:127], 0
    v_mov_b64 v[28:29], -1
    v_mov_b64 v[30:31], -1
    s_mov_b32 s7, 0
    s_sleep 2
    buffer_load_dwordx4 v[96:99], v0, s[8:11], s24 offen sc1
    buffer_load_dwordx4 v[100:103], v0, s[8:11], s24 offen offset:1024 sc1
    s_sleep 3
    buffer_load_dwordx4 v[96:99], v0, s[8:11], s24 offen sc1
    buffer_load_dwordx4 v[100:103], v0, s[8:11], s24 offen offset:1024 sc1
    s_and_b32 s33, s5, 7
    s_cmp_eq_u32 s33, 6
    s_cbranch_scc0 L_nkv_0m
    s_add_u32 s33, s5, 2
    s_lshr_b32 s33, s33, 3
    s_lshl_b32 s33, s33, 7
    s_add_u32 s33, s33, 262144
    v_mov_b32 v26, s33
    buffer_load_dword v27, v26, s[8:11], 0 offen sc1
    s_waitcnt vmcnt(0)
L_nkv_0m:
L_p1w_0m:
    s_waitcnt vmcnt(2)
    v_mfma_f32_16x16x32_bf16 v[104:107], v[108:111], v[96:99], 0
    v_mfma_f32_16x16x32_bf16 v[104:107], v[108:111], v[100:103], v[104:107]
    s_nop 7
    v_cmp_u_f32 vcc, v104, v104
    s_cbranch_vccnz L_p1r_0m
L_p1d_0m:
    v_add_f32_dpp v104, v104, v104 row_ror:8 row_mask:0xf bank_mask:0xf
    v_add_f32_dpp v105, v105, v105 row_ror:8 row_mask:0xf bank_mask:0xf
    v_add_f32_dpp v106, v106, v106 row_ror:8 row_mask:0xf bank_mask:0xf
    v_add_f32_dpp v107, v107, v107 row_ror:8 row_mask:0xf bank_mask:0xf
    v_add_f32_dpp v104, v104, v104 row_ror:4 row_mask:0xf bank_mask:0xf
    v_add_f32_dpp v105, v105, v105 row_ror:4 row_mask:0xf bank_mask:0xf
    v_add_f32_dpp v106, v106, v106 row_ror:4 row_mask:0xf bank_mask:0xf
    v_add_f32_dpp v107, v107, v107 row_ror:4 row_mask:0xf bank_mask:0xf
    v_cvt_pk_bf16_f32 v104, v104, v106
    v_cvt_pk_bf16_f32 v105, v105, v107
    s_mov_b64 exec, s[40:41]
    v_cndmask_b32 v104, v104, v105, s[42:43]
    v_min_u32 v104, -2, v104
    buffer_store_dword v104, v2, s[8:11], s21 offen
    buffer_store_dword v28, v2, s[8:11], s20 offen
    s_mov_b64 exec, -1
    s_add_u32 s47, s21, 0
    s_mov_b32 s7, 0
    s_add_u32 s5, s5, 1
    s_and_b32 s33, s5, 7
    s_cmp_eq_u32 s33, 7
    s_cbranch_scc0 L_ckv_0m
    s_cmp_ge_u32 s5, 57
    s_cbranch_scc1 L_ckv_0m
L_ckvl_0m:
    v_readfirstlane_b32 s33, v27
    s_and_b32 s33, s33, 0xff
    s_cmp_eq_u32 s33, 128
    s_cbranch_scc1 L_ckv_0m
    s_add_u32 s7, s7, 1
    s_cmp_lt_u32 s7, 400000
    s_cbranch_scc0 L_ckv_0m
    s_sleep 2
    buffer_load_dword v27, v26, s[8:11], 0 offen sc1
    s_waitcnt vmcnt(0)
    s_branch L_ckvl_0m
L_ckv_0m:
    s_mov_b32 s7, 0
    s_sleep 2
    s_mov_b32 m0, 0
    s_nop 0
    buffer_load_dwordx4 v0, s[8:11], s47 offen sc1 lds
    buffer_load_dwordx4 v0, s[8:11], s47 offen offset:1024 sc1 lds
    s_mov_b32 s33, s20
    s_mov_b32 s20, s21
    s_mov_b32 s21, s22
    s_mov_b32 s22, s33
    s_xor_b32 s23, s23, 0x40000
    s_mov_b32 s26, s24
    s_xor_b32 s24, s24, 0x40000
    s_xor_b32 s25, s25, 0x40000
    s_add_u32 s28, s28, 0x40000
    s_xor_b32 s29, s29, 8192
    s_add_u32 s30, s30, 0x40000
    s_mov_b32 s62, s31
    s_mov_b32 s63, s32
    s_add_u32 s31, s31, 65536
    s_add_u32 s32, s32, 131072
    v_xor_b32 v5, 0x2000, v5
    v_xor_b32 v6, 0x2000, v6
    s_sleep 2
    s_mov_b32 m0, 0
    s_nop 0
    buffer_load_dwordx4 v0, s[8:11], s47 offen sc1 lds
    buffer_load_dwordx4 v0, s[8:11], s47 offen offset:1024 sc1 lds
    v_mov_b64 v[104:105], -1
    v_mov_b64 v[106:107], -1
    s_cmp_lt_u32 s5, 63
    s_cbranch_scc1 L_step0
    s_waitcnt vmcnt(2)
    ds_read_b128 v[32:35], v0 offset:0
    ds_read_b128 v[36:39], v0 offset:1024
    s_waitcnt lgkmcnt(0)
    v_max3_u32 v26, v32, v33, v34
    v_max3_u32 v27, v35, v36, v37
    v_max3_u32 v26, v26, v38, v39
    v_max_u32 v26, v26, v27
    v_cmp_eq_u32 vcc, -1, v26
    s_cbranch_vccnz L_p2r_0l
L_p2d_0l:
    s_barrier
    ds_read_b128 v[56:59], v0 offset:6144
    ds_read_b128 v[60:63], v0 offset:7168
    s_lshl_b32 s33, s3, 7
    s_add_u32 s33, s33, 271360
    s_sub_u32 s34, s5, 1
    v_mov_b32 v26, s34
    v_mov_b32 v27, 0
    s_mov_b64 exec, 1
    buffer_store_dword v26, v27, s[8:11], s33 offen sc1
    s_mov_b64 exec, -1
    ds_read_b128 v[40:43], v0 offset:2048
    ds_read_b128 v[44:47], v0 offset:3072
    ds_read_b128 v[48:51], v0 offset:4096
    ds_read_b128 v[52:55], v0 offset:5120
    ds_read_b64_tr_b16 v[28:29], v4 offset:256
    ds_read_b64_tr_b16 v[30:31], v4 offset:384
    buffer_store_dwordx4 v[12:15], v0, s[8:11], s63 offen offset:0 sc1
    s_waitcnt lgkmcnt(0)
    s_mov_b64 exec, s[36:37]
    buffer_store_dwordx4 v[28:31], v7, s[8:11], s62 offen offset:0 sc1
    s_mov_b64 exec, -1
    v_smfmac_f32_16x16x64_bf16 v[120:123], v[32:35], a[96:103], v10
    v_smfmac_f32_16x16x64_bf16 v[124:127], v[32:35], a[104:111], v10
    v_smfmac_f32_16x16x64_bf16 v[120:123], v[36:39], a[112:119], v10
    v_smfmac_f32_16x16x64_bf16 v[124:127], v[36:39], a[120:127], v10
    ds_read_b128 v[64:67], v11 offset:8192
    ds_read_b128 v[68:71], v11 offset:9216
    ds_read_b128 v[72:75], v11 offset:10240
    ds_read_b128 v[76:79], v11 offset:11264
    ds_read_b128 v[80:83], v11 offset:12288
    ds_read_b128 v[84:87], v11 offset:13312
    ds_read_b128 v[88:91], v11 offset:14336
    ds_read_b128 v[92:95], v11 offset:15360
    s_waitcnt lgkmcnt(4)
    v_smfmac_f32_16x16x64_bf16 v[120:123], v[56:59], v[64:71], v10
    v_smfmac_f32_16x16x64_bf16 v[124:127], v[56:59], v[72:79], v10
    v_smfmac_f32_16x16x64_bf16 v[120:123], v[40:43], a[128:135], v10
    v_smfmac_f32_16x16x64_bf16 v[124:127], v[40:43], a[136:143], v10
    s_waitcnt lgkmcnt(0)
    v_smfmac_f32_16x16x64_bf16 v[120:123], v[60:63], v[80:87], v10
    v_smfmac_f32_16x16x64_bf16 v[124:127], v[60:63], v[88:95], v10
    v_smfmac_f32_16x16x64_bf16 v[120:123], v[44:47], a[144:151], v10
    v_smfmac_f32_16x16x64_bf16 v[124:127], v[44:47], a[152:159], v10
    v_smfmac_f32_16x16x64_bf16 v[120:123], v[48:51], a[160:167], v10
    v_smfmac_f32_16x16x64_bf16 v[124:127], v[48:51], a[168:175], v10
    v_smfmac_f32_16x16x64_bf16 v[120:123], v[52:55], a[176:183], v10
    v_smfmac_f32_16x16x64_bf16 v[124:127], v[52:55], a[184:191], v10
    v_mov_b64 v[112:113], 0
    v_mov_b64 v[114:115], 0
    v_mov_b64 v[116:117], 0
    v_mov_b64 v[118:119], 0
    v_smfmac_f32_16x16x64_bf16 v[112:115], v[32:35], v[128:135], v10
    v_smfmac_f32_16x16x64_bf16 v[116:119], v[32:35], v[136:143], v10
    v_add_f32 v120, v120, v122
    v_add_f32 v121, v121, v123
    v_smfmac_f32_16x16x64_bf16 v[112:115], v[36:39], v[144:151], v10
    v_add_f32 v124, v124, v126
    v_add_f32 v125, v125, v127
    v_smfmac_f32_16x16x64_bf16 v[116:119], v[36:39], v[152:159], v10
    v_cvt_pk_bf16_f32 v120, v120, v121
    v_cvt_pk_bf16_f32 v124, v124, v125
    v_smfmac_f32_16x16x64_bf16 v[112:115], v[40:43], v[160:167], v10
    ds_write2_b32 v3, v120, v124 offset0:64 offset1:192
    v_smfmac_f32_16x16x64_bf16 v[116:119], v[40:43], v[168:175], v10
    v_smfmac_f32_16x16x64_bf16 v[112:115], v[44:47], v[176:183], v10
    v_smfmac_f32_16x16x64_bf16 v[116:119], v[44:47], v[184:191], v10
    v_smfmac_f32_16x16x64_bf16 v[112:115], v[48:51], v[192:199], v10
    s_waitcnt lgkmcnt(0)
    s_barrier
    v_smfmac_f32_16x16x64_bf16 v[116:119], v[48:51], v[200:207], v10
    v_smfmac_f32_16x16x64_bf16 v[112:115], v[52:55], v[208:215], v10
    v_smfmac_f32_16x16x64_bf16 v[116:119], v[52:55], v[216:223], v10
    v_smfmac_f32_16x16x64_bf16 v[112:115], v[56:59], v[224:231], v10
    v_smfmac_f32_16x16x64_bf16 v[116:119], v[56:59], v[232:239], v10
    v_smfmac_f32_16x16x64_bf16 v[112:115], v[60:63], v[240:247], v10
    v_smfmac_f32_16x16x64_bf16 v[116:119], v[60:63], v[248:255], v10
    ds_read_b64_tr_b16 v[32:33], v4 offset:256
    ds_read_b64_tr_b16 v[34:35], v4 offset:384
    ds_read_b64_tr_b16 v[36:37], v4 offset:1280
    ds_read_b64_tr_b16 v[38:39], v4 offset:1408
    ds_read_b64_tr_b16 v[40:41], v4 offset:2304
    ds_read_b64_tr_b16 v[42:43], v4 offset:2432
    ds_read_b64_tr_b16 v[44:45], v4 offset:3328
    ds_read_b64_tr_b16 v[46:47], v4 offset:3456
    v_pk_add_f32 v[112:113], v[112:113], v[114:115]
    v_pk_add_f32 v[116:117], v[116:117], v[118:119]
    v_cvt_pk_bf16_f32 v12, v112, v113
    v_cvt_pk_bf16_f32 v14, v116, v117
    buffer_store_dwordx4 v[12:15], v0, s[8:11], s32 offen offset:0 sc1
    s_waitcnt lgkmcnt(0)
    s_mov_b64 exec, s[36:37]
    buffer_store_dwordx4 v[32:35], v7, s[8:11], s31 offen offset:0 sc1
    s_mov_b64 exec, -1
    s_branch L_cfin0
L_step0s:
    s_waitcnt vmcnt(2)
    ds_read_b128 v[32:35], v0 offset:0
    ds_read_b128 v[36:39], v0 offset:1024
    s_waitcnt lgkmcnt(0)
    v_max3_u32 v26, v32, v33, v34
    v_max3_u32 v27, v35, v36, v37
    v_max3_u32 v26, v26, v38, v39
    v_max_u32 v26, v26, v27
    v_cmp_eq_u32 vcc, -1, v26
    s_cbranch_vccnz L_p2r_0ms
L_p2d_0ms:
    s_barrier
    ds_read_b128 v[56:59], v0 offset:6144
    ds_read_b128 v[60:63], v0 offset:7168
    v_smfmac_f32_16x16x64_bf16 v[112:115], v[32:35], a[0:7], v10
    ds_read_b128 v[40:43], v0 offset:2048
    v_smfmac_f32_16x16x64_bf16 v[116:119], v[32:35], a[8:15], v10
    ds_read_b128 v[44:47], v0 offset:3072
    s_mov_b32 m0, s29
    s_nop 0
    buffer_load_dwordx4 v0, s[8:11], s28 offen lds
    v_smfmac_f32_16x16x64_bf16 v[112:115], v[36:39], a[16:23], v10
    ds_read_b128 v[48:51], v0 offset:4096
    v_smfmac_f32_16x16x64_bf16 v[116:119], v[36:39], a[24:31], v10
    ds_read_b128 v[52:55], v0 offset:5120
    v_smfmac_f32_16x16x64_bf16 v[120:123], v[32:35], a[96:103], v10
    ds_read_b64_tr_b16 v[28:29], v4 offset:256
    buffer_load_dwordx4 v0, s[8:11], s28 offen offset:1024 lds
    v_smfmac_f32_16x16x64_bf16 v[124:127], v[32:35], a[104:111], v10
    ds_read_b64_tr_b16 v[30:31], v4 offset:384
    v_smfmac_f32_16x16x64_bf16 v[120:123], v[36:39], a[112:119], v10
    s_mov_b32 m0, 14336
    s_nop 0
    buffer_load_dword v9, s[8:11], s30 offen lds
    v_smfmac_f32_16x16x64_bf16 v[124:127], v[36:39], a[120:127], v10
    s_waitcnt lgkmcnt(7)
    v_smfmac_f32_16x16x64_bf16 v[112:115], v[56:59], v[64:71], v10
    v_smfmac_f32_16x16x64_bf16 v[116:119], v[56:59], v[72:79], v10
    buffer_load_dword v9, s[8:11], s30 offen offset:256 lds
    s_waitcnt lgkmcnt(6)
    v_smfmac_f32_16x16x64_bf16 v[112:115], v[60:63], v[80:87], v10
    v_smfmac_f32_16x16x64_bf16 v[116:119], v[60:63], v[88:95], v10
    ds_read_b128 v[64:67], v11 offset:8192
    s_lshl_b32 s33, s3, 7
    s_add_u32 s33, s33, 271360
    s_sub_u32 s34, s5, 1
    s_max_i32 s34, s34, 0
    v_mov_b32 v26, s34
    v_mov_b32 v27, 0
    s_mov_b64 exec, 1
    buffer_store_dword v26, v27, s[8:11], s33 offen sc1
    s_mov_b64 exec, -1
    s_waitcnt lgkmcnt(6)
    v_smfmac_f32_16x16x64_bf16 v[112:115], v[40:43], a[32:39], v10
    ds_read_b128 v[68:71], v11 offset:9216
    v_smfmac_f32_16x16x64_bf16 v[116:119], v[40:43], a[40:47], v10
    ds_read_b128 v[72:75], v11 offset:10240
    s_waitcnt lgkmcnt(7)
    v_smfmac_f32_16x16x64_bf16 v[112:115], v[44:47], a[48:55], v10
    ds_read_b128 v[76:79], v11 offset:11264
    v_smfmac_f32_16x16x64_bf16 v[116:119], v[44:47], a[56:63], v10
    ds_read_b128 v[80:83], v11 offset:12288
    s_waitcnt lgkmcnt(8)
    v_smfmac_f32_16x16x64_bf16 v[112:115], v[48:51], a[64:71], v10
    ds_read_b128 v[84:87], v11 offset:13312
    v_smfmac_f32_16x16x64_bf16 v[116:119], v[48:51], a[72:79], v10
    ds_read_b128 v[88:91], v11 offset:14336
    s_waitcnt lgkmcnt(9)
    v_smfmac_f32_16x16x64_bf16 v[112:115], v[52:55], a[80:87], v10
    ds_read_b128 v[92:95], v11 offset:15360
    v_smfmac_f32_16x16x64_bf16 v[116:119], v[52:55], a[88:95], v10
    s_waitcnt lgkmcnt(4)
    v_smfmac_f32_16x16x64_bf16 v[120:123], v[56:59], v[64:71], v10
    v_smfmac_f32_16x16x64_bf16 v[124:127], v[56:59], v[72:79], v10
    v_add_f32 v112, v112, v114
    v_smfmac_f32_16x16x64_bf16 v[120:123], v[40:43], a[128:135], v10
    ds_read_b128 v[64:67], v5 offset:0
    v_add_f32 v113, v113, v115
    v_add_f32 v116, v116, v118
    v_smfmac_f32_16x16x64_bf16 v[124:127], v[40:43], a[136:143], v10
    ds_read_b128 v[68:71], v5 offset:2048
    v_add_f32 v117, v117, v119
    v_cvt_pk_bf16_f32 v112, v112, v113
    s_waitcnt lgkmcnt(2)
    v_smfmac_f32_16x16x64_bf16 v[120:123], v[60:63], v[80:87], v10
    ds_read_b128 v[72:75], v5 offset:4096
    v_cvt_pk_bf16_f32 v116, v116, v117
    v_smfmac_f32_16x16x64_bf16 v[124:127], v[60:63], v[88:95], v10
    ds_write2_b32 v3, v112, v116 offset0:0 offset1:128
    ds_read_b128 v[76:79], v5 offset:6144
    v_smfmac_f32_16x16x64_bf16 v[120:123], v[44:47], a[144:151], v10
    ds_read_b128 v[80:83], v6 offset:0
    v_smfmac_f32_16x16x64_bf16 v[124:127], v[44:47], a[152:159], v10
    ds_read_b128 v[84:87], v6 offset:2048
    buffer_store_dwordx4 v[12:15], v0, s[8:11], s63 offen offset:0 sc1
    v_smfmac_f32_16x16x64_bf16 v[120:123], v[48:51], a[160:167], v10
    ds_read_b128 v[88:91], v6 offset:4096
    s_waitcnt lgkmcnt(4)
    v_smfmac_f32_16x16x64_bf16 v[124:127], v[48:51], a[168:175], v10
    ds_read_b128 v[92:95], v6 offset:6144
    v_mov_b64 v[112:113], 0
    v_smfmac_f32_16x16x64_bf16 v[120:123], v[52:55], a[176:183], v10
    v_mov_b64 v[114:115], 0
    v_smfmac_f32_16x16x64_bf16 v[124:127], v[52:55], a[184:191], v10
    v_mov_b64 v[116:117], 0
    v_mov_b64 v[118:119], 0
    v_smfmac_f32_16x16x64_bf16 v[112:115], v[32:35], v[128:135], v10
    v_smfmac_f32_16x16x64_bf16 v[116:119], v[32:35], v[136:143], v10
    v_add_f32 v120, v120, v122
    v_add_f32 v121, v121, v123
    v_smfmac_f32_16x16x64_bf16 v[112:115], v[36:39], v[144:151], v10
    v_add_f32 v124, v124, v126
    v_add_f32 v125, v125, v127
    v_smfmac_f32_16x16x64_bf16 v[116:119], v[36:39], v[152:159], v10
    v_cvt_pk_bf16_f32 v120, v120, v121
    v_cvt_pk_bf16_f32 v124, v124, v125
    v_smfmac_f32_16x16x64_bf16 v[112:115], v[40:43], v[160:167], v10
    ds_write2_b32 v3, v120, v124 offset0:64 offset1:192
    v_smfmac_f32_16x16x64_bf16 v[116:119], v[40:43], v[168:175], v10
    v_smfmac_f32_16x16x64_bf16 v[112:115], v[44:47], v[176:183], v10
    v_smfmac_f32_16x16x64_bf16 v[116:119], v[44:47], v[184:191], v10
    v_smfmac_f32_16x16x64_bf16 v[112:115], v[48:51], v[192:199], v10
    s_mov_b64 exec, s[36:37]
    buffer_store_dwordx4 v[28:31], v7, s[8:11], s62 offen offset:0 sc1
    s_mov_b64 exec, -1
    s_waitcnt lgkmcnt(0)
    s_barrier
    ds_read_b64_tr_b16 v[96:97], v4 offset:0
    ds_read_b64_tr_b16 v[98:99], v4 offset:128
    v_smfmac_f32_16x16x64_bf16 v[116:119], v[48:51], v[200:207], v10
    ds_read_b64_tr_b16 v[100:101], v4 offset:1024
    ds_read_b64_tr_b16 v[102:103], v4 offset:1152
    v_smfmac_f32_16x16x64_bf16 v[112:115], v[52:55], v[208:215], v10
    ds_read_b64_tr_b16 v[104:105], v4 offset:2048
    ds_read_b64_tr_b16 v[106:107], v4 offset:2176
    v_smfmac_f32_16x16x64_bf16 v[116:119], v[52:55], v[216:223], v10
    ds_read_b64_tr_b16 v[108:109], v4 offset:3072
    ds_read_b64_tr_b16 v[110:111], v4 offset:3200
    v_smfmac_f32_16x16x64_bf16 v[112:115], v[56:59], v[224:231], v10
    v_smfmac_f32_16x16x64_bf16 v[116:119], v[56:59], v[232:239], v10
    v_smfmac_f32_16x16x64_bf16 v[112:115], v[60:63], v[240:247], v10
    v_smfmac_f32_16x16x64_bf16 v[116:119], v[60:63], v[248:255], v10
    s_waitcnt vmcnt(7)
    ds_read_b64_tr_b16 v[32:33], v4 offset:256
    ds_read_b64_tr_b16 v[34:35], v4 offset:384
    ds_read_b64_tr_b16 v[36:37], v4 offset:1280
    ds_read_b64_tr_b16 v[38:39], v4 offset:1408
    s_waitcnt lgkmcnt(10)
    v_mfma_f32_16x16x32_bf16 v[120:123], v[64:67], v[96:99], 0
    ds_read_b64_tr_b16 v[40:41], v4 offset:2304
    s_waitcnt lgkmcnt(9)
    v_mfma_f32_16x16x32_bf16 v[120:123], v[68:71], v[100:103], v[120:123]
    ds_read_b64_tr_b16 v[42:43], v4 offset:2432
    v_add_f32 v112, v112, v114
    v_add_f32 v113, v113, v115
    s_waitcnt lgkmcnt(8)
    v_mfma_f32_16x16x32_bf16 v[120:123], v[72:75], v[104:107], v[120:123]
    ds_read_b64_tr_b16 v[44:45], v4 offset:3328
    v_add_f32 v116, v116, v118
    v_add_f32 v117, v117, v119
    s_waitcnt lgkmcnt(7)
    v_mfma_f32_16x16x32_bf16 v[120:123], v[76:79], v[108:111], v[120:123]
    ds_read_b64_tr_b16 v[46:47], v4 offset:3456
    v_mov_b64 v[52:53], s[98:99]
    v_mov_b64 v[54:55], s[98:99]
    v_mfma_f32_16x16x32_bf16 v[124:127], v[80:83], v[96:99], 0
    ds_read_b128 v[64:67], v11 offset:16384
    v_cvt_pk_bf16_f32 v12, v112, v113
    v_cvt_pk_bf16_f32 v14, v116, v117
    v_mfma_f32_16x16x32_bf16 v[124:127], v[84:87], v[100:103], v[124:127]
    ds_read_b128 v[68:71], v11 offset:17408
    v_mfma_f32_16x16x32_bf16 v[124:127], v[88:91], v[104:107], v[124:127]
    ds_read_b128 v[72:75], v11 offset:18432
    v_max3_f32 v26, v120, v121, v122
    v_mfma_f32_16x16x32_bf16 v[124:127], v[92:95], v[108:111], v[124:127]
    ds_read_b128 v[76:79], v11 offset:19456
    v_max_f32 v26, v26, v123
    s_waitcnt lgkmcnt(10)
    v_mfma_f32_16x16x32_bf16 v[48:51], v[32:35], v[96:99], 0
    ds_read_b128 v[80:83], v11 offset:20480
    s_waitcnt lgkmcnt(9)
    v_mfma_f32_16x16x32_bf16 v[48:51], v[36:39], v[100:103], v[48:51]
    ds_read_b128 v[84:87], v11 offset:21504
    v_max3_f32 v27, v124, v125, v126
    v_mov_b64 v[96:97], 0
    s_waitcnt lgkmcnt(8)
    v_mfma_f32_16x16x32_bf16 v[48:51], v[40:43], v[104:107], v[48:51]
    ds_read_b128 v[88:91], v11 offset:22528
    v_mov_b64 v[98:99], 0
    v_max3_f32 v26, v26, v127, v27
    s_waitcnt lgkmcnt(7)
    v_mfma_f32_16x16x32_bf16 v[48:51], v[44:47], v[108:111], v[48:51]
    ds_read_b128 v[92:95], v11 offset:23552
    v_mov_b64 v[100:101], 0
    v_mov_b64 v[102:103], 0
    v_mov_b64 v[104:105], 0
    v_mov_b64 v[106:107], 0
    v_mov_b64 v[108:109], 0
    v_mov_b64 v[110:111], 0
    s_nop 0
    v_max3_f32 v26, v26, v48, v49
    v_max3_f32 v26, v26, v50, v51
    v_cndmask_b32 v48, v48, v50, s[38:39]
    v_mov_b32 v27, v26
    v_cndmask_b32 v49, v49, v51, s[38:39]
    s_nop 0
    v_permlane16_swap_b32 v26, v27
    v_max_f32 v26, v26, v27
    v_mov_b32 v27, v26
    v_mov_b32 v61, 0
    s_nop 0
    v_permlane32_swap_b32 v26, v27
    v_max_f32 v26, v26, v27
    v_mul_f32 v28, s46, v26
    v_pk_fma_f32 v[120:121], v[120:121], s[96:97], v[28:29] op_sel_hi:[1,1,0] neg_lo:[0,0,1] neg_hi:[0,0,1]
    v_pk_fma_f32 v[122:123], v[122:123], s[96:97], v[28:29] op_sel_hi:[1,1,0] neg_lo:[0,0,1] neg_hi:[0,0,1]
    v_pk_fma_f32 v[124:125], v[124:125], s[96:97], v[28:29] op_sel_hi:[1,1,0] neg_lo:[0,0,1] neg_hi:[0,0,1]
    v_pk_fma_f32 v[126:127], v[126:127], s[96:97], v[28:29] op_sel_hi:[1,1,0] neg_lo:[0,0,1] neg_hi:[0,0,1]
    v_pk_fma_f32 v[48:49], v[48:49], s[96:97], v[28:29] op_sel_hi:[1,1,0] neg_lo:[0,0,1] neg_hi:[0,0,1]
    v_exp_f32 v120, v120
    v_exp_f32 v121, v121
    v_exp_f32 v122, v122
    v_exp_f32 v123, v123
    v_exp_f32 v124, v124
    v_exp_f32 v125, v125
    v_exp_f32 v126, v126
    v_exp_f32 v127, v127
    v_exp_f32 v48, v48
    v_exp_f32 v49, v49
    v_cvt_pk_bf16_f32 v56, v120, v121
    v_cvt_pk_bf16_f32 v57, v122, v123
    v_cvt_pk_bf16_f32 v58, v124, v125
    v_cvt_pk_bf16_f32 v59, v126, v127
    v_cvt_pk_bf16_f32 v60, v48, v49
    s_nop 0
    v_mfma_f32_16x16x32_bf16 v[26:29], v[52:55], v[56:59], 0
    v_mov_b64 v[120:121], 0
    v_mov_b64 v[122:123], 0
    v_mfma_f32_16x16x32_bf16 v[112:115], v[16:19], v[56:59], 0
    ds_read_b128 v[32:35], v11 offset:24576
    v_mov_b64 v[124:125], 0
    v_mfma_f32_16x16x32_bf16 v[116:119], v[20:23], v[56:59], 0
    ds_read_b128 v[36:39], v11 offset:25600
    buffer_load_dwordx4 v[16:19], v9, s[8:11], s30 offen
    v_mfma_f32_16x16x16_bf16 v[26:29], v[24:25], v[60:61], v[26:29]
    ds_read_b128 v[40:43], v11 offset:26624
    buffer_load_dwordx4 v[20:23], v9, s[8:11], s30 offen offset:256
    v_mfma_f32_16x16x16_bf16 v[112:115], v[12:13], v[60:61], v[112:115]
    ds_read_b128 v[44:47], v11 offset:27648
    v_mov_b64 v[126:127], 0
    v_mfma_f32_16x16x16_bf16 v[116:119], v[14:15], v[60:61], v[116:119]
    v_rcp_f32 v30, v26
    s_nop 2
    v_mul_f32 v112, v112, v30
    v_mul_f32 v113, v113, v30
    v_cvt_pk_bf16_f32 v56, v112, v113
    v_mul_f32 v114, v114, v30
    v_mul_f32 v115, v115, v30
    v_cvt_pk_bf16_f32 v57, v114, v115
    v_mul_f32 v116, v116, v30
    v_mul_f32 v117, v117, v30
    v_cvt_pk_bf16_f32 v58, v116, v117
    v_mul_f32 v118, v118, v30
    v_mul_f32 v119, v119, v30
    v_cvt_pk_bf16_f32 v59, v118, v119
    s_mov_b64 exec, s[36:37]
    ds_write_b128 v7, v[56:59] offset:12288
    s_mov_b64 exec, -1
    ds_read_b128 v[48:51], v11 offset:28672
    ds_read_b128 v[52:55], v11 offset:29696
    v_mov_b64 v[28:29], -1
    v_mov_b64 v[30:31], -1
    buffer_store_dwordx4 v[28:31], v0, s[8:11], s26 offen sc1
    s_waitcnt lgkmcnt(2)
    s_barrier
    ds_read_b128 v[56:59], v8 offset:0
    ds_read_b128 v[60:63], v8 offset:1024
    buffer_store_dwordx4 v[28:31], v0, s[8:11], s26 offen offset:1024 sc1
    s_waitcnt lgkmcnt(1)
    v_smfmac_f32_16x16x64_bf16 v[96:99], v[56:59], a[192:199], v10
    v_mov_b64 v[112:113], 0
    v_smfmac_f32_16x16x64_bf16 v[100:103], v[56:59], a[200:207], v10
    v_mov_b64 v[114:115], 0
    v_smfmac_f32_16x16x64_bf16 v[104:107], v[56:59], a[208:215], v10
    v_mov_b64 v[116:117], 0
    v_smfmac_f32_16x16x64_bf16 v[108:111], v[56:59], a[216:223], v10
    v_mov_b64 v[118:119], 0
    s_waitcnt lgkmcnt(0)
    v_smfmac_f32_16x16x64_bf16 v[96:99], v[60:63], v[64:71], v10
    v_smfmac_f32_16x16x64_bf16 v[100:103], v[60:63], v[72:79], v10
    ds_read_b128 v[64:67], v11 offset:30720
    v_smfmac_f32_16x16x64_bf16 v[104:107], v[60:63], v[80:87], v10
    ds_read_b128 v[68:71], v11 offset:31744
    v_smfmac_f32_16x16x64_bf16 v[108:111], v[60:63], v[88:95], v10
    v_add_f32 v96, v96, v98
    v_add_f32 v97, v97, v99
    v_cvt_pk_bf16_f32 v96, v96, v97
    v_smfmac_f32_16x16x64_bf16 v[112:115], v[56:59], a[224:231], v10
    v_add_f32 v100, v100, v102
    v_add_f32 v101, v101, v103
    v_cvt_pk_bf16_f32 v97, v100, v101
    v_smfmac_f32_16x16x64_bf16 v[116:119], v[56:59], a[232:239], v10
    v_add_f32 v104, v104, v106
    v_add_f32 v105, v105, v107
    v_cvt_pk_bf16_f32 v98, v104, v105
    v_smfmac_f32_16x16x64_bf16 v[120:123], v[56:59], a[240:247], v10
    v_add_f32 v108, v108, v110
    v_add_f32 v109, v109, v111
    v_cvt_pk_bf16_f32 v99, v108, v109
    v_smfmac_f32_16x16x64_bf16 v[124:127], v[56:59], a[248:255], v10
    buffer_store_dwordx4 v[96:99], v1, s[8:11], s23 offen sc1
    v_smfmac_f32_16x16x64_bf16 v[112:115], v[60:63], v[32:39], v10
    v_smfmac_f32_16x16x64_bf16 v[116:119], v[60:63], v[40:47], v10
    v_smfmac_f32_16x16x64_bf16 v[120:123], v[60:63], v[48:55], v10
    s_waitcnt lgkmcnt(0)
    v_smfmac_f32_16x16x64_bf16 v[124:127], v[60:63], v[64:71], v10
    v_add_f32 v112, v112, v114
    v_add_f32 v113, v113, v115
    v_cvt_pk_bf16_f32 v112, v112, v113
    v_add_f32 v116, v116, v118
    v_add_f32 v117, v117, v119
    v_cvt_pk_bf16_f32 v113, v116, v117
    v_add_f32 v120, v120, v122
    v_add_f32 v121, v121, v123
    v_cvt_pk_bf16_f32 v114, v120, v121
    v_add_f32 v124, v124, v126
    v_add_f32 v125, v125, v127
    v_cvt_pk_bf16_f32 v115, v124, v125
    buffer_store_dwordx4 v[112:115], v1, s[8:11], s25 offen sc1
    v_mov_b32 v26, 0x3f80
    v_mov_b32 v27, 0x3f800000
    v_cndmask_b32 v26, v26, v27, s[100:101]
    v_cndmask_b32 v108, 0, v26, s[48:49]
    v_cndmask_b32 v109, 0, v26, s[50:51]
    v_cndmask_b32 v110, 0, v26, s[52:53]
    v_cndmask_b32 v111, 0, v26, s[54:55]
    ds_read_b128 v[64:67], v11 offset:0
    ds_read_b128 v[68:71], v11 offset:1024
    ds_read_b128 v[72:75], v11 offset:2048
    ds_read_b128 v[76:79], v11 offset:3072
    ds_read_b128 v[80:83], v11 offset:4096
    ds_read_b128 v[84:87], v11 offset:5120
    ds_read_b128 v[88:91], v11 offset:6144
    ds_read_b128 v[92:95], v11 offset:7168
    v_mov_b64 v[112:113], 0
    v_mov_b64 v[114:115], 0
    v_mov_b64 v[116:117], 0
    v_mov_b64 v[118:119], 0
    v_mov_b64 v[120:121], 0
    v_mov_b64 v[122:123], 0
    v_mov_b64 v[124:125], 0
    v_mov_b64 v[126:127], 0
    v_mov_b64 v[28:29], -1
    v_mov_b64 v[30:31], -1
    s_mov_b32 s7, 0
    s_sleep 2
    buffer_load_dwordx4 v[96:99], v0, s[8:11], s24 offen sc1
    buffer_load_dwordx4 v[100:103], v0, s[8:11], s24 offen offset:1024 sc1
    s_sleep 3
    buffer_load_dwordx4 v[96:99], v0, s[8:11], s24 offen sc1
    buffer_load_dwordx4 v[100:103], v0, s[8:11], s24 offen offset:1024 sc1
    s_and_b32 s33, s5, 7
    s_cmp_eq_u32 s33, 6
    s_cbranch_scc0 L_nkv_0ms
    s_add_u32 s33, s5, 2
    s_lshr_b32 s33, s33, 3
    s_lshl_b32 s33, s33, 7
    s_add_u32 s33, s33, 262144
    v_mov_b32 v26, s33
    buffer_load_dword v27, v26, s[8:11], 0 offen sc1
    s_waitcnt vmcnt(0)
L_nkv_0ms:
L_p1w_0ms:
    s_waitcnt vmcnt(2)
    v_mfma_f32_16x16x32_bf16 v[104:107], v[108:111], v[96:99], 0
    v_mfma_f32_16x16x32_bf16 v[104:107], v[108:111], v[100:103], v[104:107]
    s_nop 7
    v_cmp_u_f32 vcc, v104, v104
    s_cbranch_vccnz L_p1r_0ms
L_p1d_0ms:
    v_add_f32_dpp v104, v104, v104 row_ror:8 row_mask:0xf bank_mask:0xf
    v_add_f32_dpp v105, v105, v105 row_ror:8 row_mask:0xf bank_mask:0xf
    v_add_f32_dpp v106, v106, v106 row_ror:8 row_mask:0xf bank_mask:0xf
    v_add_f32_dpp v107, v107, v107 row_ror:8 row_mask:0xf bank_mask:0xf
    v_add_f32_dpp v104, v104, v104 row_ror:4 row_mask:0xf bank_mask:0xf
    v_add_f32_dpp v105, v105, v105 row_ror:4 row_mask:0xf bank_mask:0xf
    v_add_f32_dpp v106, v106, v106 row_ror:4 row_mask:0xf bank_mask:0xf
    v_add_f32_dpp v107, v107, v107 row_ror:4 row_mask:0xf bank_mask:0xf
    v_cvt_pk_bf16_f32 v104, v104, v106
    v_cvt_pk_bf16_f32 v105, v105, v107
    s_mov_b64 exec, s[40:41]
    v_cndmask_b32 v104, v104, v105, s[42:43]
    v_min_u32 v104, -2, v104
    buffer_store_dword v104, v2, s[8:11], s21 offen sc1
    buffer_store_dword v28, v2, s[8:11], s20 offen sc1
    s_mov_b64 exec, -1
    s_add_u32 s47, s21, 0
    s_mov_b32 s7, 0
    s_add_u32 s5, s5, 1
    s_and_b32 s33, s5, 7
    s_cmp_eq_u32 s33, 7
    s_cbranch_scc0 L_ckv_0ms
    s_cmp_ge_u32 s5, 57
    s_cbranch_scc1 L_ckv_0ms
L_ckvl_0ms:
    v_readfirstlane_b32 s33, v27
    s_and_b32 s33, s33, 0xff
    s_cmp_eq_u32 s33, 128
    s_cbranch_scc1 L_ckv_0ms
    s_add_u32 s7, s7, 1
    s_cmp_lt_u32 s7, 400000
    s_cbranch_scc0 L_ckv_0ms
    s_sleep 2
    buffer_load_dword v27, v26, s[8:11], 0 offen sc1
    s_waitcnt vmcnt(0)
    s_branch L_ckvl_0ms
L_ckv_0ms:
    s_mov_b32 s7, 0
    s_sleep 2
    s_mov_b32 m0, 0
    s_nop 0
    buffer_load_dwordx4 v0, s[8:11], s47 offen sc1 lds
    buffer_load_dwordx4 v0, s[8:11], s47 offen offset:1024 sc1 lds
    s_mov_b32 s33, s20
    s_mov_b32 s20, s21
    s_mov_b32 s21, s22
    s_mov_b32 s22, s33
    s_xor_b32 s23, s23, 0x40000
    s_mov_b32 s26, s24
    s_xor_b32 s24, s24, 0x40000
    s_xor_b32 s25, s25, 0x40000
    s_add_u32 s28, s28, 0x40000
    s_xor_b32 s29, s29, 8192
    s_add_u32 s30, s30, 0x40000
    s_mov_b32 s62, s31
    s_mov_b32 s63, s32
    s_add_u32 s31, s31, 65536
    s_add_u32 s32, s32, 131072
    v_xor_b32 v5, 0x2000, v5
    v_xor_b32 v6, 0x2000, v6
    s_sleep 2
    s_mov_b32 m0, 0
    s_nop 0
    buffer_load_dwordx4 v0, s[8:11], s47 offen sc1 lds
    buffer_load_dwordx4 v0, s[8:11], s47 offen offset:1024 sc1 lds
    v_mov_b64 v[104:105], -1
    v_mov_b64 v[106:107], -1
    s_cmp_lt_u32 s5, 63
    s_cbranch_scc1 L_step0s
    s_waitcnt vmcnt(2)
    ds_read_b128 v[32:35], v0 offset:0
    ds_read_b128 v[36:39], v0 offset:1024
    s_waitcnt lgkmcnt(0)
    v_max3_u32 v26, v32, v33, v34
    v_max3_u32 v27, v35, v36, v37
    v_max3_u32 v26, v26, v38, v39
    v_max_u32 v26, v26, v27
    v_cmp_eq_u32 vcc, -1, v26
    s_cbranch_vccnz L_p2r_0ls
L_p2d_0ls:
    s_barrier
    ds_read_b128 v[56:59], v0 offset:6144
    ds_read_b128 v[60:63], v0 offset:7168
    s_lshl_b32 s33, s3, 7
    s_add_u32 s33, s33, 271360
    s_sub_u32 s34, s5, 1
    v_mov_b32 v26, s34
    v_mov_b32 v27, 0
    s_mov_b64 exec, 1
    buffer_store_dword v26, v27, s[8:11], s33 offen sc1
    s_mov_b64 exec, -1
    ds_read_b128 v[40:43], v0 offset:2048
    ds_read_b128 v[44:47], v0 offset:3072
    ds_read_b128 v[48:51], v0 offset:4096
    ds_read_b128 v[52:55], v0 offset:5120
    ds_read_b64_tr_b16 v[28:29], v4 offset:256
    ds_read_b64_tr_b16 v[30:31], v4 offset:384
    buffer_store_dwordx4 v[12:15], v0, s[8:11], s63 offen offset:0 sc1
    s_waitcnt lgkmcnt(0)
    s_mov_b64 exec, s[36:37]
    buffer_store_dwordx4 v[28:31], v7, s[8:11], s62 offen offset:0 sc1
    s_mov_b64 exec, -1
    v_smfmac_f32_16x16x64_bf16 v[120:123], v[32:35], a[96:103], v10
    v_smfmac_f32_16x16x64_bf16 v[124:127], v[32:35], a[104:111], v10
    v_smfmac_f32_16x16x64_bf16 v[120:123], v[36:39], a[112:119], v10
    v_smfmac_f32_16x16x64_bf16 v[124:127], v[36:39], a[120:127], v10
    ds_read_b128 v[64:67], v11 offset:8192
    ds_read_b128 v[68:71], v11 offset:9216
    ds_read_b128 v[72:75], v11 offset:10240
    ds_read_b128 v[76:79], v11 offset:11264
    ds_read_b128 v[80:83], v11 offset:12288
    ds_read_b128 v[84:87], v11 offset:13312
    ds_read_b128 v[88:91], v11 offset:14336
    ds_read_b128 v[92:95], v11 offset:15360
    s_waitcnt lgkmcnt(4)
    v_smfmac_f32_16x16x64_bf16 v[120:123], v[56:59], v[64:71], v10
    v_smfmac_f32_16x16x64_bf16 v[124:127], v[56:59], v[72:79], v10
    v_smfmac_f32_16x16x64_bf16 v[120:123], v[40:43], a[128:135], v10
    v_smfmac_f32_16x16x64_bf16 v[124:127], v[40:43], a[136:143], v10
    s_waitcnt lgkmcnt(0)
    v_smfmac_f32_16x16x64_bf16 v[120:123], v[60:63], v[80:87], v10
    v_smfmac_f32_16x16x64_bf16 v[124:127], v[60:63], v[88:95], v10
    v_smfmac_f32_16x16x64_bf16 v[120:123], v[44:47], a[144:151], v10
    v_smfmac_f32_16x16x64_bf16 v[124:127], v[44:47], a[152:159], v10
    v_smfmac_f32_16x16x64_bf16 v[120:123], v[48:51], a[160:167], v10
    v_smfmac_f32_16x16x64_bf16 v[124:127], v[48:51], a[168:175], v10
    v_smfmac_f32_16x16x64_bf16 v[120:123], v[52:55], a[176:183], v10
    v_smfmac_f32_16x16x64_bf16 v[124:127], v[52:55], a[184:191], v10
    v_mov_b64 v[112:113], 0
    v_mov_b64 v[114:115], 0
    v_mov_b64 v[116:117], 0
    v_mov_b64 v[118:119], 0
    v_smfmac_f32_16x16x64_bf16 v[112:115], v[32:35], v[128:135], v10
    v_smfmac_f32_16x16x64_bf16 v[116:119], v[32:35], v[136:143], v10
    v_add_f32 v120, v120, v122
    v_add_f32 v121, v121, v123
    v_smfmac_f32_16x16x64_bf16 v[112:115], v[36:39], v[144:151], v10
    v_add_f32 v124, v124, v126
    v_add_f32 v125, v125, v127
    v_smfmac_f32_16x16x64_bf16 v[116:119], v[36:39], v[152:159], v10
    v_cvt_pk_bf16_f32 v120, v120, v121
    v_cvt_pk_bf16_f32 v124, v124, v125
    v_smfmac_f32_16x16x64_bf16 v[112:115], v[40:43], v[160:167], v10
    ds_write2_b32 v3, v120, v124 offset0:64 offset1:192
    v_smfmac_f32_16x16x64_bf16 v[116:119], v[40:43], v[168:175], v10
    v_smfmac_f32_16x16x64_bf16 v[112:115], v[44:47], v[176:183], v10
    v_smfmac_f32_16x16x64_bf16 v[116:119], v[44:47], v[184:191], v10
    v_smfmac_f32_16x16x64_bf16 v[112:115], v[48:51], v[192:199], v10
    s_waitcnt lgkmcnt(0)
    s_barrier
    v_smfmac_f32_16x16x64_bf16 v[116:119], v[48:51], v[200:207], v10
    v_smfmac_f32_16x16x64_bf16 v[112:115], v[52:55], v[208:215], v10
    v_smfmac_f32_16x16x64_bf16 v[116:119], v[52:55], v[216:223], v10
    v_smfmac_f32_16x16x64_bf16 v[112:115], v[56:59], v[224:231], v10
    v_smfmac_f32_16x16x64_bf16 v[116:119], v[56:59], v[232:239], v10
    v_smfmac_f32_16x16x64_bf16 v[112:115], v[60:63], v[240:247], v10
    v_smfmac_f32_16x16x64_bf16 v[116:119], v[60:63], v[248:255], v10
    ds_read_b64_tr_b16 v[32:33], v4 offset:256
    ds_read_b64_tr_b16 v[34:35], v4 offset:384
    ds_read_b64_tr_b16 v[36:37], v4 offset:1280
    ds_read_b64_tr_b16 v[38:39], v4 offset:1408
    ds_read_b64_tr_b16 v[40:41], v4 offset:2304
    ds_read_b64_tr_b16 v[42:43], v4 offset:2432
    ds_read_b64_tr_b16 v[44:45], v4 offset:3328
    ds_read_b64_tr_b16 v[46:47], v4 offset:3456
    v_pk_add_f32 v[112:113], v[112:113], v[114:115]
    v_pk_add_f32 v[116:117], v[116:117], v[118:119]
    v_cvt_pk_bf16_f32 v12, v112, v113
    v_cvt_pk_bf16_f32 v14, v116, v117
    buffer_store_dwordx4 v[12:15], v0, s[8:11], s32 offen offset:0 sc1
    s_waitcnt lgkmcnt(0)
    s_mov_b64 exec, s[36:37]
    buffer_store_dwordx4 v[32:35], v7, s[8:11], s31 offen offset:0 sc1
    s_mov_b64 exec, -1
L_cfin0:
    s_waitcnt vmcnt(0)
    s_barrier
    s_memtime s[58:59]
    s_memrealtime s[76:77]
    s_waitcnt lgkmcnt(0)
    s_mov_b64 exec, 1
    v_mov_b32 v26, 64
    s_lshl_b32 s33, s3, 7
    s_add_u32 s33, s33, 271360
    v_mov_b32 v27, 0
    buffer_store_dword v26, v27, s[8:11], s33 offen sc1
    s_mov_b64 exec, -1
    s_branch L_chain_end
L_p2r_0m:
    s_add_u32 s7, s7, 1
    s_cmp_lt_u32 s7, s6
    s_cbranch_scc0 L_p2r_0m_to
    s_mov_b32 m0, 0
    s_nop 0
    buffer_load_dwordx4 v0, s[8:11], s47 offen sc1 lds
    buffer_load_dwordx4 v0, s[8:11], s47 offen offset:1024 sc1 lds
    s_waitcnt vmcnt(2)
    ds_read_b128 v[32:35], v0 offset:0
    ds_read_b128 v[36:39], v0 offset:1024
    s_waitcnt lgkmcnt(0)
    v_max3_u32 v26, v32, v33, v34
    v_max3_u32 v27, v35, v36, v37
    v_max3_u32 v26, v26, v38, v39
    v_max_u32 v26, v26, v27
    v_cmp_eq_u32 vcc, -1, v26
    s_cbranch_vccnz L_p2r_0m
    s_branch L_p2d_0m
L_p2r_0m_to:
    s_mov_b32 s6, 0
    s_branch L_p2d_0m
L_p1r_0m:
    s_add_u32 s7, s7, 1
    s_cmp_lt_u32 s7, s6
    s_cbranch_scc0 L_p1r_0m_to
    buffer_load_dwordx4 v[96:99], v0, s[8:11], s24 offen sc1
    buffer_load_dwordx4 v[100:103], v0, s[8:11], s24 offen offset:1024 sc1
    s_branch L_p1w_0m
L_p1r_0m_to:
    s_mov_b32 s6, 0
    s_branch L_p1d_0m
L_p2r_0l:
    s_add_u32 s7, s7, 1
    s_cmp_lt_u32 s7, s6
    s_cbranch_scc0 L_p2r_0l_to
    s_mov_b32 m0, 0
    s_nop 0
    buffer_load_dwordx4 v0, s[8:11], s47 offen sc1 lds
    buffer_load_dwordx4 v0, s[8:11], s47 offen offset:1024 sc1 lds
    s_waitcnt vmcnt(2)
    ds_read_b128 v[32:35], v0 offset:0
    ds_read_b128 v[36:39], v0 offset:1024
    s_waitcnt lgkmcnt(0)
    v_max3_u32 v26, v32, v33, v34
    v_max3_u32 v27, v35, v36, v37
    v_max3_u32 v26, v26, v38, v39
    v_max_u32 v26, v26, v27
    v_cmp_eq_u32 vcc, -1, v26
    s_cbranch_vccnz L_p2r_0l
    s_branch L_p2d_0l
L_p2r_0l_to:
    s_mov_b32 s6, 0
    s_branch L_p2d_0l
L_p2r_0ms:
    s_add_u32 s7, s7, 1
    s_cmp_lt_u32 s7, s6
    s_cbranch_scc0 L_p2r_0ms_to
    s_mov_b32 m0, 0
    s_nop 0
    buffer_load_dwordx4 v0, s[8:11], s47 offen sc1 lds
    buffer_load_dwordx4 v0, s[8:11], s47 offen offset:1024 sc1 lds
    s_waitcnt vmcnt(2)
    ds_read_b128 v[32:35], v0 offset:0
    ds_read_b128 v[36:39], v0 offset:1024
    s_waitcnt lgkmcnt(0)
    v_max3_u32 v26, v32, v33, v34
    v_max3_u32 v27, v35, v36, v37
    v_max3_u32 v26, v26, v38, v39
    v_max_u32 v26, v26, v27
    v_cmp_eq_u32 vcc, -1, v26
    s_cbranch_vccnz L_p2r_0ms
    s_branch L_p2d_0ms
L_p2r_0ms_to:
    s_mov_b32 s6, 0
    s_branch L_p2d_0ms
L_p1r_0ms:
    s_add_u32 s7, s7, 1
    s_cmp_lt_u32 s7, s6
    s_cbranch_scc0 L_p1r_0ms_to
    buffer_load_dwordx4 v[96:99], v0, s[8:11], s24 offen sc1
    buffer_load_dwordx4 v[100:103], v0, s[8:11], s24 offen offset:1024 sc1
    s_branch L_p1w_0ms
L_p1r_0ms_to:
    s_mov_b32 s6, 0
    s_branch L_p1d_0ms
L_p2r_0ls:
    s_add_u32 s7, s7, 1
    s_cmp_lt_u32 s7, s6
    s_cbranch_scc0 L_p2r_0ls_to
    s_mov_b32 m0, 0
    s_nop 0
    buffer_load_dwordx4 v0, s[8:11], s47 offen sc1 lds
    buffer_load_dwordx4 v0, s[8:11], s47 offen offset:1024 sc1 lds
    s_waitcnt vmcnt(2)
    ds_read_b128 v[32:35], v0 offset:0
    ds_read_b128 v[36:39], v0 offset:1024
    s_waitcnt lgkmcnt(0)
    v_max3_u32 v26, v32, v33, v34
    v_max3_u32 v27, v35, v36, v37
    v_max3_u32 v26, v26, v38, v39
    v_max_u32 v26, v26, v27
    v_cmp_eq_u32 vcc, -1, v26
    s_cbranch_vccnz L_p2r_0ls
    s_branch L_p2d_0ls
L_p2r_0ls_to:
    s_mov_b32 s6, 0
    s_branch L_p2d_0ls
L_wave1:
    v_and_b32 v31, 63, v0
    v_lshlrev_b32 v0, 4, v31
    s_lshl_b32 s33, s3, 2
    s_add_u32 s33, s33, 1
    v_lshrrev_b32 v26, 2, v31
    v_lshlrev_b32 v26, 11, v26
    v_and_b32 v27, 3, v31
    v_lshlrev_b32 v27, 4, v27
    v_add_u32 v1, v26, v27
    s_lshr_b32 s34, s33, 4
    s_lshl_b32 s34, s34, 10
    s_and_b32 s35, s33, 3
    s_lshl_b32 s35, s35, 8
    s_add_u32 s34, s34, s35
    s_and_b32 s35, s33, 12
    s_lshl_b32 s35, s35, 4
    s_add_u32 s34, s34, s35
    v_bfe_u32 v26, v31, 4, 1
    v_lshlrev_b32 v26, 5, v26
    v_bfe_u32 v27, v31, 2, 1
    v_lshlrev_b32 v27, 4, v27
    v_and_b32 v28, 3, v31
    v_lshlrev_b32 v28, 2, v28
    v_add3_u32 v26, v26, v27, v28
    v_add_u32 v2, s34, v26
    v_and_b32 v26, 15, v31
    v_lshlrev_b32 v26, 4, v26
    v_lshrrev_b32 v27, 4, v31
    v_lshlrev_b32 v27, 2, v27
    v_add_u32 v26, v26, v27
    v_add_u32 v3, 9216, v26
    v_lshrrev_b32 v26, 5, v31
    v_lshlrev_b32 v26, 9, v26
    v_bfe_u32 v27, v31, 4, 1
    v_lshlrev_b32 v27, 6, v27
    v_bfe_u32 v28, v31, 2, 2
    v_lshlrev_b32 v28, 4, v28
    v_add3_u32 v26, v26, v27, v28
    v_bfe_u32 v27, v31, 1, 1
    v_lshlrev_b32 v27, 3, v27
    v_add_u32 v26, v26, v27
    v_add_u32 v4, 8192, v26
    v_lshrrev_b32 v26, 4, v31
    v_lshlrev_b32 v26, 9, v26
    v_and_b32 v27, 15, v31
    v_lshlrev_b32 v27, 4, v27
    v_add_u32 v26, v26, v27
    v_bfe_u32 v28, v31, 3, 1
    v_lshlrev_b32 v28, 8, v28
    v_add_u32 v5, v26, v28
    v_add_u32 v5, 16384, v5
    v_add_u32 v6, 16512, v26
    v_lshrrev_b32 v26, 4, v31
    v_lshlrev_b32 v26, 7, v26
    v_bfe_u32 v27, v31, 3, 1
    v_lshlrev_b32 v27, 6, v27
    v_and_b32 v28, 3, v31
    v_lshlrev_b32 v28, 4, v28
    v_add3_u32 v7, v26, v27, v28
    v_lshrrev_b32 v26, 4, v31
    v_lshlrev_b32 v26, 8, v26
    v_bfe_u32 v27, v31, 1, 1
    v_lshlrev_b32 v27, 7, v27
    v_bfe_u32 v28, v31, 2, 2
    v_lshlrev_b32 v28, 5, v28
    v_add3_u32 v26, v26, v27, v28
    v_and_b32 v27, 1, v31
    v_lshlrev_b32 v27, 4, v27
    v_add_u32 v26, v26, v27
    v_add_u32 v8, 12288, v26
    v_lshrrev_b32 v26, 5, v31
    v_lshlrev_b32 v26, 10, v26
    v_bfe_u32 v27, v31, 4, 1
    v_lshlrev_b32 v27, 9, v27
    v_and_b32 v28, 15, v31
    v_lshlrev_b32 v28, 4, v28
    v_add3_u32 v9, v26, v27, v28
    v_bfe_u32 v26, v31, 1, 1
    v_mov_b32 v27, 0x4444
    v_mov_b32 v28, 0xeeee
    v_cmp_eq_u32 vcc, 1, v26
    s_nop 1
    v_cndmask_b32 v10, v27, v28, vcc
    v_add_u32 v11, 65536, v0
    v_mov_b32 v13, 0
    v_mov_b32 v15, 0
    v_mov_b32 v24, 0x3f803f80
    v_mov_b32 v25, 0
    v_bfe_u32 v26, v31, 1, 3
    v_cmp_eq_u32 s[48:49], 0, v26
    v_cmp_eq_u32 s[50:51], 1, v26
    v_cmp_eq_u32 s[52:53], 2, v26
    v_cmp_eq_u32 s[54:55], 3, v26
    s_mov_b32 s36, 0x0f0f0f0f
    s_mov_b32 s37, 0x0f0f0f0f
    s_mov_b32 s38, 0xffff0000
    s_mov_b32 s39, 0xffff0000
    s_mov_b32 s40, 0x00ff00ff
    s_mov_b32 s41, 0
    s_mov_b32 s42, 0xf0f0f0f0
    s_mov_b32 s43, 0xf0f0f0f0
    s_mov_b32 s46, 0x3e0293ee
    v_lshrrev_b32 v26, 4, v31
    v_bfe_u32 v27, v31, 1, 3
    v_add_u32 v28, 0, v26
    v_xor_b32 v27, v27, v28
    v_lshlrev_b32 v27, 5, v27
    v_and_b32 v28, 1, v31
    v_lshlrev_b32 v28, 4, v28
    v_add_u32 v27, v27, v28
    v_and_b32 v28, 1, v26
    v_lshlrev_b32 v28, 17, v28
    v_add_u32 v96, v27, v28
    v_lshrrev_b32 v28, 1, v26
    v_lshlrev_b32 v28, 18, v28
    v_add_u32 v96, v96, v28
    v_and_b32 v28, 1, v26
    v_lshlrev_b32 v28, 10, v28
    v_add_u32 v98, v27, v28
    v_lshrrev_b32 v28, 1, v26
    v_lshlrev_b32 v28, 12, v28
    v_add_u32 v98, v98, v28
    v_lshrrev_b32 v26, 4, v31
    v_bfe_u32 v27, v31, 1, 3
    v_add_u32 v28, 4, v26
    v_xor_b32 v27, v27, v28
    v_lshlrev_b32 v27, 5, v27
    v_and_b32 v28, 1, v31
    v_lshlrev_b32 v28, 4, v28
    v_add_u32 v27, v27, v28
    v_and_b32 v28, 1, v26
    v_lshlrev_b32 v28, 17, v28
    v_add_u32 v97, v27, v28
    v_lshrrev_b32 v28, 1, v26
    v_lshlrev_b32 v28, 18, v28
    v_add_u32 v97, v97, v28
    v_and_b32 v28, 1, v26
    v_lshlrev_b32 v28, 10, v28
    v_add_u32 v99, v27, v28
    v_lshrrev_b32 v28, 1, v26
    v_lshlrev_b32 v28, 12, v28
    v_add_u32 v99, v99, v28
    v_lshrrev_b32 v26, 2, v31
    v_lshlrev_b32 v27, 8, v26
    v_and_b32 v26, 7, v26
    v_lshlrev_b32 v26, 5, v26
    v_and_b32 v28, 3, v31
    v_lshlrev_b32 v28, 3, v28
    v_add3_u32 v26, v26, v27, v28
    v_add_u32 v104, 32768, v26
    v_xor_b32 v100, 64, v104
    v_xor_b32 v101, 32, v100
    v_add_u32 v102, 0x10000, v100
    v_add_u32 v103, 0x10000, v101
    s_lshl_b32 s60, s3, 8
    s_add_u32 s60, s60, 8192
    s_lshl_b32 s61, s3, 17
    s_add_u32 s61, s61, 2048
    v_add_u32 v107, 0xffff8000, v100
    v_add_u32 v108, 0xffff8000, v101
    s_mov_b32 m0, 36864
    s_add_u32 s34, s60, 0
    buffer_load_dwordx4 v96, s[84:87], s34 offen lds
    s_mov_b32 m0, 37888
    s_add_u32 s34, s60, 16384
    buffer_load_dwordx4 v97, s[84:87], s34 offen lds
    s_mov_b32 m0, 38912
    s_add_u32 s34, s60, 32768
    buffer_load_dwordx4 v96, s[84:87], s34 offen lds
    s_mov_b32 m0, 39936
    s_add_u32 s34, s60, 49152
    buffer_load_dwordx4 v97, s[84:87], s34 offen lds
    s_mov_b32 m0, 53248
    s_add_u32 s34, s60, 524288
    buffer_load_dwordx4 v96, s[84:87], s34 offen lds
    s_mov_b32 m0, 54272
    s_add_u32 s34, s60, 540672
    buffer_load_dwordx4 v97, s[84:87], s34 offen lds
    s_mov_b32 m0, 55296
    s_add_u32 s34, s60, 557056
    buffer_load_dwordx4 v96, s[84:87], s34 offen lds
    s_mov_b32 m0, 56320
    s_add_u32 s34, s60, 573440
    buffer_load_dwordx4 v97, s[84:87], s34 offen lds
    s_mov_b32 m0, 69632
    s_add_u32 s34, s60, 1048576
    buffer_load_dwordx4 v96, s[84:87], s34 offen lds
    s_mov_b32 m0, 70656
    s_add_u32 s34, s60, 1064960
    buffer_load_dwordx4 v97, s[84:87], s34 offen lds
    s_mov_b32 m0, 71680
    s_add_u32 s34, s60, 1081344
    buffer_load_dwordx4 v96, s[84:87], s34 offen lds
    s_mov_b32 m0, 72704
    s_add_u32 s34, s60, 1097728
    buffer_load_dwordx4 v97, s[84:87], s34 offen lds
    s_mov_b32 m0, 86016
    s_add_u32 s34, s60, 1572864
    buffer_load_dwordx4 v96, s[84:87], s34 offen lds
    s_mov_b32 m0, 87040
    s_add_u32 s34, s60, 1589248
    buffer_load_dwordx4 v97, s[84:87], s34 offen lds
    s_mov_b32 m0, 88064
    s_add_u32 s34, s60, 1605632
    buffer_load_dwordx4 v96, s[84:87], s34 offen lds
    s_mov_b32 m0, 89088
    s_add_u32 s34, s60, 1622016
    buffer_load_dwordx4 v97, s[84:87], s34 offen lds
    s_mov_b32 m0, 102400
    s_add_u32 s34, s60, 2097152
    buffer_load_dwordx4 v96, s[84:87], s34 offen lds
    s_mov_b32 m0, 103424
    s_add_u32 s34, s60, 2113536
    buffer_load_dwordx4 v97, s[84:87], s34 offen lds
    s_mov_b32 m0, 104448
    s_add_u32 s34, s60, 2129920
    buffer_load_dwordx4 v96, s[84:87], s34 offen lds
    s_mov_b32 m0, 105472
    s_add_u32 s34, s60, 2146304
    buffer_load_dwordx4 v97, s[84:87], s34 offen lds
    s_mov_b32 m0, 118784
    s_add_u32 s34, s60, 2621440
    buffer_load_dwordx4 v96, s[84:87], s34 offen lds
    s_mov_b32 m0, 119808
    s_add_u32 s34, s60, 2637824
    buffer_load_dwordx4 v97, s[84:87], s34 offen lds
    s_mov_b32 m0, 120832
    s_add_u32 s34, s60, 2654208
    buffer_load_dwordx4 v96, s[84:87], s34 offen lds
    s_mov_b32 m0, 121856
    s_add_u32 s34, s60, 2670592
    buffer_load_dwordx4 v97, s[84:87], s34 offen lds
    s_mov_b32 m0, 135168
    s_add_u32 s34, s60, 0
    buffer_load_dwordx4 v96, s[88:91], s34 offen lds
    s_mov_b32 m0, 136192
    s_add_u32 s34, s60, 16384
    buffer_load_dwordx4 v97, s[88:91], s34 offen lds
    s_mov_b32 m0, 137216
    s_add_u32 s34, s60, 32768
    buffer_load_dwordx4 v96, s[88:91], s34 offen lds
    s_mov_b32 m0, 138240
    s_add_u32 s34, s60, 49152
    buffer_load_dwordx4 v97, s[88:91], s34 offen lds
    s_mov_b32 m0, 151552
    s_add_u32 s34, s60, 524288
    buffer_load_dwordx4 v96, s[88:91], s34 offen lds
    s_mov_b32 m0, 152576
    s_add_u32 s34, s60, 540672
    buffer_load_dwordx4 v97, s[88:91], s34 offen lds
    s_mov_b32 m0, 153600
    s_add_u32 s34, s60, 557056
    buffer_load_dwordx4 v96, s[88:91], s34 offen lds
    s_mov_b32 m0, 154624
    s_add_u32 s34, s60, 573440
    buffer_load_dwordx4 v97, s[88:91], s34 offen lds
    s_mov_b32 m0, 4096
    s_add_u32 s34, s60, 1048576
    buffer_load_dwordx4 v96, s[88:91], s34 offen lds
    s_mov_b32 m0, 5120
    s_add_u32 s34, s60, 1064960
    buffer_load_dwordx4 v97, s[88:91], s34 offen lds
    s_mov_b32 m0, 6144
    s_add_u32 s34, s60, 1081344
    buffer_load_dwordx4 v96, s[88:91], s34 offen lds
    s_mov_b32 m0, 7168
    s_add_u32 s34, s60, 1097728
    buffer_load_dwordx4 v97, s[88:91], s34 offen lds
    s_mov_b32 m0, 20480
    s_add_u32 s34, s60, 1572864
    buffer_load_dwordx4 v96, s[88:91], s34 offen lds
    s_mov_b32 m0, 21504
    s_add_u32 s34, s60, 1589248
    buffer_load_dwordx4 v97, s[88:91], s34 offen lds
    s_mov_b32 m0, 22528
    s_add_u32 s34, s60, 1605632
    buffer_load_dwordx4 v96, s[88:91], s34 offen lds
    s_mov_b32 m0, 23552
    s_add_u32 s34, s60, 1622016
    buffer_load_dwordx4 v97, s[88:91], s34 offen lds
    s_cmp_lg_u32 s3, 0
    s_cbranch_scc1 L_nofi_1
    v_mov_b64 v[64:65], 0
    v_mov_b64 v[66:67], 0
    s_mov_b32 s33, 266240
    buffer_store_dwordx4 v[64:67], v0, s[8:11], s33 offen offset:0 sc1
    buffer_store_dwordx4 v[64:67], v0, s[8:11], s33 offen offset:1024 sc1
    buffer_store_dwordx4 v[64:67], v0, s[8:11], s33 offen offset:2048 sc1
    buffer_store_dwordx4 v[64:67], v0, s[8:11], s33 offen offset:3072 sc1
L_nofi_1:
    s_nop 1
    v_mov_b32 v64, -1
    v_mov_b32 v65, -1
    v_mov_b32 v66, -1
    v_mov_b32 v67, -1
    s_lshl_b32 s33, s3, 13
    s_add_u32 s33, s33, 1050624
    buffer_store_dwordx4 v[64:67], v0, s[8:11], s33 offen sc1
    buffer_store_dwordx4 v[64:67], v0, s[8:11], s33 offen offset:1024 sc1
    s_add_u32 s33, s33, 262144
    buffer_store_dwordx4 v[64:67], v0, s[8:11], s33 offen sc1
    buffer_store_dwordx4 v[64:67], v0, s[8:11], s33 offen offset:1024 sc1
    s_lshl_b32 s33, s3, 2
    s_add_u32 s33, s33, 1
    s_lshr_b32 s34, s33, 4
    s_lshl_b32 s34, s34, 7
    s_and_b32 s35, s33, 3
    s_lshl_b32 s35, s35, 3
    s_add_u32 s34, s34, s35
    s_bfe_u32 s35, s33, 0x20002
    s_lshl_b32 s35, s35, 11
    s_add_u32 s34, s34, s35
    v_bfe_u32 v68, v31, 4, 1
    v_lshlrev_b32 v68, 6, v68
    v_bfe_u32 v69, v31, 2, 1
    v_lshlrev_b32 v69, 10, v69
    v_and_b32 v70, 3, v31
    v_lshlrev_b32 v70, 1, v70
    v_add3_u32 v68, v68, v69, v70
    v_add_u32 v68, s34, v68
    buffer_load_ushort v69, v68, s[12:15], 0 offen
    buffer_load_ushort v70, v68, s[12:15], 0 offen offset:32
    s_waitcnt vmcnt(0)
    v_lshl_or_b32 v69, v70, 16, v69
    v_min_u32 v69, -2, v69
    s_mov_b64 exec, s[40:41]
    s_mov_b32 s33, 1572864
    buffer_store_dword v69, v2, s[8:11], s33 offen sc1
    s_mov_b32 s33, 1581056
    buffer_store_dword v64, v2, s[8:11], s33 offen sc1
    s_mov_b32 s33, 1589248
    buffer_store_dword v64, v2, s[8:11], s33 offen sc1
    s_mov_b64 exec, -1
    s_waitcnt vmcnt(0)
    s_barrier
    s_waitcnt vmcnt(36) lgkmcnt(0)
    s_barrier
    ds_read_b64_tr_b16 a[0:1], v100 offset:0
    ds_read_b64_tr_b16 a[2:3], v100 offset:4096
    ds_read_b64_tr_b16 a[4:5], v100 offset:8192
    ds_read_b64_tr_b16 a[6:7], v100 offset:12288
    ds_read_b64_tr_b16 a[8:9], v101 offset:0
    ds_read_b64_tr_b16 a[10:11], v101 offset:4096
    ds_read_b64_tr_b16 a[12:13], v101 offset:8192
    ds_read_b64_tr_b16 a[14:15], v101 offset:12288
    s_waitcnt vmcnt(32) lgkmcnt(0)
    s_barrier
    ds_read_b64_tr_b16 a[16:17], v100 offset:16384
    ds_read_b64_tr_b16 a[18:19], v100 offset:20480
    ds_read_b64_tr_b16 a[20:21], v100 offset:24576
    ds_read_b64_tr_b16 a[22:23], v100 offset:28672
    ds_read_b64_tr_b16 a[24:25], v101 offset:16384
    ds_read_b64_tr_b16 a[26:27], v101 offset:20480
    ds_read_b64_tr_b16 a[28:29], v101 offset:24576
    ds_read_b64_tr_b16 a[30:31], v101 offset:28672
    s_mov_b32 m0, 36864
    s_add_u32 s34, s60, 2097152
    buffer_load_dwordx4 v96, s[88:91], s34 offen lds
    s_mov_b32 m0, 37888
    s_add_u32 s34, s60, 2113536
    buffer_load_dwordx4 v97, s[88:91], s34 offen lds
    s_mov_b32 m0, 38912
    s_add_u32 s34, s60, 2129920
    buffer_load_dwordx4 v96, s[88:91], s34 offen lds
    s_mov_b32 m0, 39936
    s_add_u32 s34, s60, 2146304
    buffer_load_dwordx4 v97, s[88:91], s34 offen lds
    s_waitcnt vmcnt(32) lgkmcnt(0)
    s_barrier
    ds_read_b64_tr_b16 a[32:33], v100 offset:32768
    ds_read_b64_tr_b16 a[34:35], v100 offset:36864
    ds_read_b64_tr_b16 a[36:37], v100 offset:40960
    ds_read_b64_tr_b16 a[38:39], v100 offset:45056
    ds_read_b64_tr_b16 a[40:41], v101 offset:32768
    ds_read_b64_tr_b16 a[42:43], v101 offset:36864
    ds_read_b64_tr_b16 a[44:45], v101 offset:40960
    ds_read_b64_tr_b16 a[46:47], v101 offset:45056
    s_mov_b32 m0, 53248
    s_add_u32 s34, s60, 2621440
    buffer_load_dwordx4 v96, s[88:91], s34 offen lds
    s_mov_b32 m0, 54272
    s_add_u32 s34, s60, 2637824
    buffer_load_dwordx4 v97, s[88:91], s34 offen lds
    s_mov_b32 m0, 55296
    s_add_u32 s34, s60, 2654208
    buffer_load_dwordx4 v96, s[88:91], s34 offen lds
    s_mov_b32 m0, 56320
    s_add_u32 s34, s60, 2670592
    buffer_load_dwordx4 v97, s[88:91], s34 offen lds
    s_waitcnt vmcnt(32) lgkmcnt(0)
    s_barrier
    ds_read_b64_tr_b16 a[48:49], v100 offset:49152
    ds_read_b64_tr_b16 a[50:51], v100 offset:53248
    ds_read_b64_tr_b16 a[52:53], v100 offset:57344
    ds_read_b64_tr_b16 a[54:55], v100 offset:61440
    ds_read_b64_tr_b16 a[56:57], v101 offset:49152
    ds_read_b64_tr_b16 a[58:59], v101 offset:53248
    ds_read_b64_tr_b16 a[60:61], v101 offset:57344
    ds_read_b64_tr_b16 a[62:63], v101 offset:61440
    s_mov_b32 m0, 69632
    s_add_u32 s34, s60, 0
    buffer_load_dwordx4 v96, s[92:95], s34 offen lds
    s_mov_b32 m0, 70656
    s_add_u32 s34, s60, 16384
    buffer_load_dwordx4 v97, s[92:95], s34 offen lds
    s_mov_b32 m0, 71680
    s_add_u32 s34, s60, 32768
    buffer_load_dwordx4 v96, s[92:95], s34 offen lds
    s_mov_b32 m0, 72704
    s_add_u32 s34, s60, 49152
    buffer_load_dwordx4 v97, s[92:95], s34 offen lds
    s_waitcnt vmcnt(32) lgkmcnt(0)
    s_barrier
    ds_read_b64_tr_b16 a[64:65], v102 offset:0
    ds_read_b64_tr_b16 a[66:67], v102 offset:4096
    ds_read_b64_tr_b16 a[68:69], v102 offset:8192
    ds_read_b64_tr_b16 a[70:71], v102 offset:12288
    ds_read_b64_tr_b16 a[72:73], v103 offset:0
    ds_read_b64_tr_b16 a[74:75], v103 offset:4096
    ds_read_b64_tr_b16 a[76:77], v103 offset:8192
    ds_read_b64_tr_b16 a[78:79], v103 offset:12288
    s_mov_b32 m0, 86016
    s_add_u32 s34, s60, 524288
    buffer_load_dwordx4 v96, s[92:95], s34 offen lds
    s_mov_b32 m0, 87040
    s_add_u32 s34, s60, 540672
    buffer_load_dwordx4 v97, s[92:95], s34 offen lds
    s_mov_b32 m0, 88064
    s_add_u32 s34, s60, 557056
    buffer_load_dwordx4 v96, s[92:95], s34 offen lds
    s_mov_b32 m0, 89088
    s_add_u32 s34, s60, 573440
    buffer_load_dwordx4 v97, s[92:95], s34 offen lds
    s_waitcnt vmcnt(32) lgkmcnt(0)
    s_barrier
    ds_read_b64_tr_b16 a[80:81], v102 offset:16384
    ds_read_b64_tr_b16 a[82:83], v102 offset:20480
    ds_read_b64_tr_b16 a[84:85], v102 offset:24576
    ds_read_b64_tr_b16 a[86:87], v102 offset:28672
    ds_read_b64_tr_b16 a[88:89], v103 offset:16384
    ds_read_b64_tr_b16 a[90:91], v103 offset:20480
    ds_read_b64_tr_b16 a[92:93], v103 offset:24576
    ds_read_b64_tr_b16 a[94:95], v103 offset:28672
    s_mov_b32 m0, 102400
    s_add_u32 s34, s60, 1048576
    buffer_load_dwordx4 v96, s[92:95], s34 offen lds
    s_mov_b32 m0, 103424
    s_add_u32 s34, s60, 1064960
    buffer_load_dwordx4 v97, s[92:95], s34 offen lds
    s_mov_b32 m0, 104448
    s_add_u32 s34, s60, 1081344
    buffer_load_dwordx4 v96, s[92:95], s34 offen lds
    s_mov_b32 m0, 105472
    s_add_u32 s34, s60, 1097728
    buffer_load_dwordx4 v97, s[92:95], s34 offen lds
    s_waitcnt vmcnt(32) lgkmcnt(0)
    s_barrier
    ds_read_b64_tr_b16 a[96:97], v102 offset:32768
    ds_read_b64_tr_b16 a[98:99], v102 offset:36864
    ds_read_b64_tr_b16 a[100:101], v102 offset:40960
    ds_read_b64_tr_b16 a[102:103], v102 offset:45056
    ds_read_b64_tr_b16 a[104:105], v103 offset:32768
    ds_read_b64_tr_b16 a[106:107], v103 offset:36864
    ds_read_b64_tr_b16 a[108:109], v103 offset:40960
    ds_read_b64_tr_b16 a[110:111], v103 offset:45056
    s_mov_b32 m0, 118784
    s_add_u32 s34, s60, 1572864
    buffer_load_dwordx4 v96, s[92:95], s34 offen lds
    s_mov_b32 m0, 119808
    s_add_u32 s34, s60, 1589248
    buffer_load_dwordx4 v97, s[92:95], s34 offen lds
    s_mov_b32 m0, 120832
    s_add_u32 s34, s60, 1605632
    buffer_load_dwordx4 v96, s[92:95], s34 offen lds
    s_mov_b32 m0, 121856
    s_add_u32 s34, s60, 1622016
    buffer_load_dwordx4 v97, s[92:95], s34 offen lds
    s_waitcnt vmcnt(32) lgkmcnt(0)
    s_barrier
    ds_read_b64_tr_b16 a[112:113], v102 offset:49152
    ds_read_b64_tr_b16 a[114:115], v102 offset:53248
    ds_read_b64_tr_b16 a[116:117], v102 offset:57344
    ds_read_b64_tr_b16 a[118:119], v102 offset:61440
    ds_read_b64_tr_b16 a[120:121], v103 offset:49152
    ds_read_b64_tr_b16 a[122:123], v103 offset:53248
    ds_read_b64_tr_b16 a[124:125], v103 offset:57344
    ds_read_b64_tr_b16 a[126:127], v103 offset:61440
    s_mov_b32 m0, 135168
    s_add_u32 s34, s60, 2097152
    buffer_load_dwordx4 v96, s[92:95], s34 offen lds
    s_mov_b32 m0, 136192
    s_add_u32 s34, s60, 2113536
    buffer_load_dwordx4 v97, s[92:95], s34 offen lds
    s_mov_b32 m0, 137216
    s_add_u32 s34, s60, 2129920
    buffer_load_dwordx4 v96, s[92:95], s34 offen lds
    s_mov_b32 m0, 138240
    s_add_u32 s34, s60, 2146304
    buffer_load_dwordx4 v97, s[92:95], s34 offen lds
    s_waitcnt vmcnt(32) lgkmcnt(0)
    s_barrier
    ds_read_b64_tr_b16 a[128:129], v107 offset:0
    ds_read_b64_tr_b16 a[130:131], v107 offset:4096
    ds_read_b64_tr_b16 a[132:133], v107 offset:8192
    ds_read_b64_tr_b16 a[134:135], v107 offset:12288
    ds_read_b64_tr_b16 a[136:137], v108 offset:0
    ds_read_b64_tr_b16 a[138:139], v108 offset:4096
    ds_read_b64_tr_b16 a[140:141], v108 offset:8192
    ds_read_b64_tr_b16 a[142:143], v108 offset:12288
    s_mov_b32 m0, 151552
    s_add_u32 s34, s60, 2621440
    buffer_load_dwordx4 v96, s[92:95], s34 offen lds
    s_mov_b32 m0, 152576
    s_add_u32 s34, s60, 2637824
    buffer_load_dwordx4 v97, s[92:95], s34 offen lds
    s_mov_b32 m0, 153600
    s_add_u32 s34, s60, 2654208
    buffer_load_dwordx4 v96, s[92:95], s34 offen lds
    s_mov_b32 m0, 154624
    s_add_u32 s34, s60, 2670592
    buffer_load_dwordx4 v97, s[92:95], s34 offen lds
    s_waitcnt vmcnt(32) lgkmcnt(0)
    s_barrier
    ds_read_b64_tr_b16 a[144:145], v107 offset:16384
    ds_read_b64_tr_b16 a[146:147], v107 offset:20480
    ds_read_b64_tr_b16 a[148:149], v107 offset:24576
    ds_read_b64_tr_b16 a[150:151], v107 offset:28672
    ds_read_b64_tr_b16 a[152:153], v108 offset:16384
    ds_read_b64_tr_b16 a[154:155], v108 offset:20480
    ds_read_b64_tr_b16 a[156:157], v108 offset:24576
    ds_read_b64_tr_b16 a[158:159], v108 offset:28672
    s_mov_b32 m0, 4096
    s_add_u32 s34, s60, 3145728
    buffer_load_dwordx4 v96, s[92:95], s34 offen lds
    s_mov_b32 m0, 5120
    s_add_u32 s34, s60, 3162112
    buffer_load_dwordx4 v97, s[92:95], s34 offen lds
    s_mov_b32 m0, 6144
    s_add_u32 s34, s60, 3178496
    buffer_load_dwordx4 v96, s[92:95], s34 offen lds
    s_mov_b32 m0, 7168
    s_add_u32 s34, s60, 3194880
    buffer_load_dwordx4 v97, s[92:95], s34 offen lds
    s_waitcnt vmcnt(32) lgkmcnt(0)
    s_barrier
    ds_read_b64_tr_b16 a[160:161], v100 offset:0
    ds_read_b64_tr_b16 a[162:163], v100 offset:4096
    ds_read_b64_tr_b16 a[164:165], v100 offset:8192
    ds_read_b64_tr_b16 a[166:167], v100 offset:12288
    ds_read_b64_tr_b16 a[168:169], v101 offset:0
    ds_read_b64_tr_b16 a[170:171], v101 offset:4096
    ds_read_b64_tr_b16 a[172:173], v101 offset:8192
    ds_read_b64_tr_b16 a[174:175], v101 offset:12288
    s_mov_b32 m0, 20480
    s_add_u32 s34, s60, 3670016
    buffer_load_dwordx4 v96, s[92:95], s34 offen lds
    s_mov_b32 m0, 21504
    s_add_u32 s34, s60, 3686400
    buffer_load_dwordx4 v97, s[92:95], s34 offen lds
    s_mov_b32 m0, 22528
    s_add_u32 s34, s60, 3702784
    buffer_load_dwordx4 v96, s[92:95], s34 offen lds
    s_mov_b32 m0, 23552
    s_add_u32 s34, s60, 3719168
    buffer_load_dwordx4 v97, s[92:95], s34 offen lds
    s_waitcnt vmcnt(32) lgkmcnt(0)
    s_barrier
    ds_read_b64_tr_b16 a[176:177], v100 offset:16384
    ds_read_b64_tr_b16 a[178:179], v100 offset:20480
    ds_read_b64_tr_b16 a[180:181], v100 offset:24576
    ds_read_b64_tr_b16 a[182:183], v100 offset:28672
    ds_read_b64_tr_b16 a[184:185], v101 offset:16384
    ds_read_b64_tr_b16 a[186:187], v101 offset:20480
    ds_read_b64_tr_b16 a[188:189], v101 offset:24576
    ds_read_b64_tr_b16 a[190:191], v101 offset:28672
    s_mov_b32 m0, 36864
    s_add_u32 s34, s61, 0
    buffer_load_dwordx4 v98, s[96:99], s34 offen lds
    s_mov_b32 m0, 37888
    s_add_u32 s34, s61, 16384
    buffer_load_dwordx4 v99, s[96:99], s34 offen lds
    s_mov_b32 m0, 38912
    s_add_u32 s34, s61, 8192
    buffer_load_dwordx4 v98, s[96:99], s34 offen lds
    s_mov_b32 m0, 39936
    s_add_u32 s34, s61, 24576
    buffer_load_dwordx4 v99, s[96:99], s34 offen lds
    s_waitcnt vmcnt(32) lgkmcnt(0)
    s_barrier
    ds_read_b64_tr_b16 v[128:129], v100 offset:32768
    ds_read_b64_tr_b16 v[130:131], v100 offset:36864
    ds_read_b64_tr_b16 v[132:133], v100 offset:40960
    ds_read_b64_tr_b16 v[134:135], v100 offset:45056
    ds_read_b64_tr_b16 v[136:137], v101 offset:32768
    ds_read_b64_tr_b16 v[138:139], v101 offset:36864
    ds_read_b64_tr_b16 v[140:141], v101 offset:40960
    ds_read_b64_tr_b16 v[142:143], v101 offset:45056
    s_mov_b32 m0, 53248
    s_add_u32 s34, s61, 256
    buffer_load_dwordx4 v98, s[96:99], s34 offen lds
    s_mov_b32 m0, 54272
    s_add_u32 s34, s61, 16640
    buffer_load_dwordx4 v99, s[96:99], s34 offen lds
    s_mov_b32 m0, 55296
    s_add_u32 s34, s61, 8448
    buffer_load_dwordx4 v98, s[96:99], s34 offen lds
    s_mov_b32 m0, 56320
    s_add_u32 s34, s61, 24832
    buffer_load_dwordx4 v99, s[96:99], s34 offen lds
    s_waitcnt vmcnt(32) lgkmcnt(0)
    s_barrier
    ds_read_b64_tr_b16 v[144:145], v100 offset:49152
    ds_read_b64_tr_b16 v[146:147], v100 offset:53248
    ds_read_b64_tr_b16 v[148:149], v100 offset:57344
    ds_read_b64_tr_b16 v[150:151], v100 offset:61440
    ds_read_b64_tr_b16 v[152:153], v101 offset:49152
    ds_read_b64_tr_b16 v[154:155], v101 offset:53248
    ds_read_b64_tr_b16 v[156:157], v101 offset:57344
    ds_read_b64_tr_b16 v[158:159], v101 offset:61440
    s_mov_b32 m0, 69632
    s_add_u32 s34, s61, 512
    buffer_load_dwordx4 v98, s[96:99], s34 offen lds
    s_mov_b32 m0, 70656
    s_add_u32 s34, s61, 16896
    buffer_load_dwordx4 v99, s[96:99], s34 offen lds
    s_mov_b32 m0, 71680
    s_add_u32 s34, s61, 8704
    buffer_load_dwordx4 v98, s[96:99], s34 offen lds
    s_mov_b32 m0, 72704
    s_add_u32 s34, s61, 25088
    buffer_load_dwordx4 v99, s[96:99], s34 offen lds
    s_waitcnt vmcnt(32) lgkmcnt(0)
    s_barrier
    ds_read_b64_tr_b16 v[160:161], v102 offset:0
    ds_read_b64_tr_b16 v[162:163], v102 offset:4096
    ds_read_b64_tr_b16 v[164:165], v102 offset:8192
    ds_read_b64_tr_b16 v[166:167], v102 offset:12288
    ds_read_b64_tr_b16 v[168:169], v103 offset:0
    ds_read_b64_tr_b16 v[170:171], v103 offset:4096
    ds_read_b64_tr_b16 v[172:173], v103 offset:8192
    ds_read_b64_tr_b16 v[174:175], v103 offset:12288
    s_mov_b32 m0, 86016
    s_add_u32 s34, s61, 768
    buffer_load_dwordx4 v98, s[96:99], s34 offen lds
    s_mov_b32 m0, 87040
    s_add_u32 s34, s61, 17152
    buffer_load_dwordx4 v99, s[96:99], s34 offen lds
    s_mov_b32 m0, 88064
    s_add_u32 s34, s61, 8960
    buffer_load_dwordx4 v98, s[96:99], s34 offen lds
    s_mov_b32 m0, 89088
    s_add_u32 s34, s61, 25344
    buffer_load_dwordx4 v99, s[96:99], s34 offen lds
    v_mov_b32 v19, 28
    global_load_dword v16, v19, s[16:17] sc1
    v_mov_b32 v20, 16
    global_load_dword v17, v20, s[16:17] sc1
    s_waitcnt vmcnt(32) lgkmcnt(0)
    s_barrier
    ds_read_b64_tr_b16 v[176:177], v102 offset:16384
    ds_read_b64_tr_b16 v[178:179], v102 offset:20480
    ds_read_b64_tr_b16 v[180:181], v102 offset:24576
    ds_read_b64_tr_b16 v[182:183], v102 offset:28672
    ds_read_b64_tr_b16 v[184:185], v103 offset:16384
    ds_read_b64_tr_b16 v[186:187], v103 offset:20480
    ds_read_b64_tr_b16 v[188:189], v103 offset:24576
    ds_read_b64_tr_b16 v[190:191], v103 offset:28672
    s_mov_b32 m0, 102400
    s_add_u32 s34, s60, 3145728
    buffer_load_dwordx4 v96, s[88:91], s34 offen lds
    s_mov_b32 m0, 103424
    s_add_u32 s34, s60, 3162112
    buffer_load_dwordx4 v97, s[88:91], s34 offen lds
    s_mov_b32 m0, 104448
    s_add_u32 s34, s60, 3178496
    buffer_load_dwordx4 v96, s[88:91], s34 offen lds
    s_mov_b32 m0, 105472
    s_add_u32 s34, s60, 3194880
    buffer_load_dwordx4 v97, s[88:91], s34 offen lds
    s_waitcnt vmcnt(32) lgkmcnt(0)
    s_barrier
    ds_read_b64_tr_b16 v[192:193], v102 offset:32768
    ds_read_b64_tr_b16 v[194:195], v102 offset:36864
    ds_read_b64_tr_b16 v[196:197], v102 offset:40960
    ds_read_b64_tr_b16 v[198:199], v102 offset:45056
    ds_read_b64_tr_b16 v[200:201], v103 offset:32768
    ds_read_b64_tr_b16 v[202:203], v103 offset:36864
    ds_read_b64_tr_b16 v[204:205], v103 offset:40960
    ds_read_b64_tr_b16 v[206:207], v103 offset:45056
    s_mov_b32 m0, 118784
    s_add_u32 s34, s61, 66048
    buffer_load_dwordx4 v98, s[96:99], s34 offen lds
    s_mov_b32 m0, 119808
    s_add_u32 s34, s61, 82432
    buffer_load_dwordx4 v99, s[96:99], s34 offen lds
    s_mov_b32 m0, 120832
    s_add_u32 s34, s61, 74240
    buffer_load_dwordx4 v98, s[96:99], s34 offen lds
    s_mov_b32 m0, 121856
    s_add_u32 s34, s61, 90624
    buffer_load_dwordx4 v99, s[96:99], s34 offen lds
    s_waitcnt vmcnt(32) lgkmcnt(0)
    s_barrier
    ds_read_b64_tr_b16 v[208:209], v102 offset:49152
    ds_read_b64_tr_b16 v[210:211], v102 offset:53248
    ds_read_b64_tr_b16 v[212:213], v102 offset:57344
    ds_read_b64_tr_b16 v[214:215], v102 offset:61440
    ds_read_b64_tr_b16 v[216:217], v103 offset:49152
    ds_read_b64_tr_b16 v[218:219], v103 offset:53248
    ds_read_b64_tr_b16 v[220:221], v103 offset:57344
    ds_read_b64_tr_b16 v[222:223], v103 offset:61440
    s_mov_b32 m0, 135168
    s_add_u32 s34, s60, 3670016
    buffer_load_dwordx4 v96, s[88:91], s34 offen lds
    s_mov_b32 m0, 136192
    s_add_u32 s34, s60, 3686400
    buffer_load_dwordx4 v97, s[88:91], s34 offen lds
    s_mov_b32 m0, 137216
    s_add_u32 s34, s60, 3702784
    buffer_load_dwordx4 v96, s[88:91], s34 offen lds
    s_mov_b32 m0, 138240
    s_add_u32 s34, s60, 3719168
    buffer_load_dwordx4 v97, s[88:91], s34 offen lds
    s_waitcnt vmcnt(32) lgkmcnt(0)
    s_barrier
    ds_read_b64_tr_b16 v[224:225], v107 offset:0
    ds_read_b64_tr_b16 v[226:227], v107 offset:4096
    ds_read_b64_tr_b16 v[228:229], v107 offset:8192
    ds_read_b64_tr_b16 v[230:231], v107 offset:12288
    ds_read_b64_tr_b16 v[232:233], v108 offset:0
    ds_read_b64_tr_b16 v[234:235], v108 offset:4096
    ds_read_b64_tr_b16 v[236:237], v108 offset:8192
    ds_read_b64_tr_b16 v[238:239], v108 offset:12288
    s_mov_b32 m0, 151552
    s_add_u32 s34, s61, 66304
    buffer_load_dwordx4 v98, s[96:99], s34 offen lds
    s_mov_b32 m0, 152576
    s_add_u32 s34, s61, 82688
    buffer_load_dwordx4 v99, s[96:99], s34 offen lds
    s_mov_b32 m0, 153600
    s_add_u32 s34, s61, 74496
    buffer_load_dwordx4 v98, s[96:99], s34 offen lds
    s_mov_b32 m0, 154624
    s_add_u32 s34, s61, 90880
    buffer_load_dwordx4 v99, s[96:99], s34 offen lds
    s_waitcnt vmcnt(32) lgkmcnt(0)
    s_barrier
    ds_read_b64_tr_b16 v[240:241], v107 offset:16384
    ds_read_b64_tr_b16 v[242:243], v107 offset:20480
    ds_read_b64_tr_b16 v[244:245], v107 offset:24576
    ds_read_b64_tr_b16 v[246:247], v107 offset:28672
    ds_read_b64_tr_b16 v[248:249], v108 offset:16384
    ds_read_b64_tr_b16 v[250:251], v108 offset:20480
    ds_read_b64_tr_b16 v[252:253], v108 offset:24576
    ds_read_b64_tr_b16 v[254:255], v108 offset:28672
    s_waitcnt vmcnt(28) lgkmcnt(0)
    s_barrier
    s_waitcnt vmcnt(24) lgkmcnt(0)
    s_barrier
    v_add_u32 v105, 16384, v104
    v_xor_b32 v106, 0, v105
    ds_read_b64_tr_b16 a[192:193], v106 offset:0
    ds_read_b64_tr_b16 a[194:195], v106 offset:4096
    ds_read_b64_tr_b16 a[196:197], v106 offset:8192
    ds_read_b64_tr_b16 a[198:199], v106 offset:12288
    v_xor_b32 v106, 32, v105
    ds_read_b64_tr_b16 a[200:201], v106 offset:0
    ds_read_b64_tr_b16 a[202:203], v106 offset:4096
    ds_read_b64_tr_b16 a[204:205], v106 offset:8192
    ds_read_b64_tr_b16 a[206:207], v106 offset:12288
    s_waitcnt lgkmcnt(0)
    v_xor_b32 v106, 64, v105
    ds_read_b64_tr_b16 a[208:209], v106 offset:0
    ds_read_b64_tr_b16 a[210:211], v106 offset:4096
    ds_read_b64_tr_b16 a[212:213], v106 offset:8192
    ds_read_b64_tr_b16 a[214:215], v106 offset:12288
    v_xor_b32 v106, 96, v105
    ds_read_b64_tr_b16 a[216:217], v106 offset:0
    ds_read_b64_tr_b16 a[218:219], v106 offset:4096
    ds_read_b64_tr_b16 a[220:221], v106 offset:8192
    ds_read_b64_tr_b16 a[222:223], v106 offset:12288
    s_waitcnt lgkmcnt(0)
    v_xor_b32 v106, 128, v105
    ds_read_b64_tr_b16 a[224:225], v106 offset:0
    ds_read_b64_tr_b16 a[226:227], v106 offset:4096
    ds_read_b64_tr_b16 a[228:229], v106 offset:8192
    ds_read_b64_tr_b16 a[230:231], v106 offset:12288
    v_xor_b32 v106, 160, v105
    ds_read_b64_tr_b16 a[232:233], v106 offset:0
    ds_read_b64_tr_b16 a[234:235], v106 offset:4096
    ds_read_b64_tr_b16 a[236:237], v106 offset:8192
    ds_read_b64_tr_b16 a[238:239], v106 offset:12288
    s_waitcnt lgkmcnt(0)
    v_xor_b32 v106, 192, v105
    ds_read_b64_tr_b16 a[240:241], v106 offset:0
    ds_read_b64_tr_b16 a[242:243], v106 offset:4096
    ds_read_b64_tr_b16 a[244:245], v106 offset:8192
    ds_read_b64_tr_b16 a[246:247], v106 offset:12288
    v_xor_b32 v106, 224, v105
    ds_read_b64_tr_b16 a[248:249], v106 offset:0
    ds_read_b64_tr_b16 a[250:251], v106 offset:4096
    ds_read_b64_tr_b16 a[252:253], v106 offset:8192
    ds_read_b64_tr_b16 a[254:255], v106 offset:12288
    s_waitcnt lgkmcnt(0)
    s_mov_b32 m0, 36864
    s_add_u32 s34, s60, 3145728
    buffer_load_dwordx4 v96, s[84:87], s34 offen lds
    s_mov_b32 m0, 37888
    s_add_u32 s34, s60, 3162112
    buffer_load_dwordx4 v97, s[84:87], s34 offen lds
    s_mov_b32 m0, 38912
    s_add_u32 s34, s60, 3178496
    buffer_load_dwordx4 v96, s[84:87], s34 offen lds
    s_mov_b32 m0, 39936
    s_add_u32 s34, s60, 3194880
    buffer_load_dwordx4 v97, s[84:87], s34 offen lds
    s_waitcnt vmcnt(24) lgkmcnt(0)
    s_barrier
    s_mov_b32 m0, 53248
    s_add_u32 s34, s61, 65536
    buffer_load_dwordx4 v98, s[96:99], s34 offen lds
    s_mov_b32 m0, 54272
    s_add_u32 s34, s61, 81920
    buffer_load_dwordx4 v99, s[96:99], s34 offen lds
    s_mov_b32 m0, 55296
    s_add_u32 s34, s61, 73728
    buffer_load_dwordx4 v98, s[96:99], s34 offen lds
    s_mov_b32 m0, 56320
    s_add_u32 s34, s61, 90112
    buffer_load_dwordx4 v99, s[96:99], s34 offen lds
    s_waitcnt vmcnt(24) lgkmcnt(0)
    s_barrier
    s_mov_b32 m0, 69632
    s_add_u32 s34, s60, 3670016
    buffer_load_dwordx4 v96, s[84:87], s34 offen lds
    s_mov_b32 m0, 70656
    s_add_u32 s34, s60, 3686400
    buffer_load_dwordx4 v97, s[84:87], s34 offen lds
    s_mov_b32 m0, 71680
    s_add_u32 s34, s60, 3702784
    buffer_load_dwordx4 v96, s[84:87], s34 offen lds
    s_mov_b32 m0, 72704
    s_add_u32 s34, s60, 3719168
    buffer_load_dwordx4 v97, s[84:87], s34 offen lds
    s_waitcnt lgkmcnt(0)
    s_barrier
    v_mov_b32 v21, 262144
    buffer_load_dword v18, v21, s[8:11], 0 offen sc1
    s_mov_b32 m0, 86016
    s_add_u32 s34, s61, 65792
    buffer_load_dwordx4 v98, s[96:99], s34 offen lds
    s_mov_b32 m0, 87040
    s_add_u32 s34, s61, 82176
    buffer_load_dwordx4 v99, s[96:99], s34 offen lds
    s_mov_b32 m0, 88064
    s_add_u32 s34, s61, 73984
    buffer_load_dwordx4 v98, s[96:99], s34 offen lds
    s_mov_b32 m0, 89088
    s_add_u32 s34, s61, 90368
    buffer_load_dwordx4 v99, s[96:99], s34 offen lds
    s_waitcnt vmcnt(0)
    s_barrier
    v_readfirstlane_b32 s33, v17
    s_lshr_b32 s71, s33, 16
    s_and_b32 s33, s33, 0xffff
    s_cmp_ge_u32 s33, 32
    s_cbranch_scc1 L_cbd1
    v_mov_b32 v26, 16
    s_mov_b32 s7, 0
L_cb1:
    global_load_dword v27, v26, s[16:17] sc1
    s_waitcnt vmcnt(0)
    v_readfirstlane_b32 s33, v27
    s_lshr_b32 s71, s33, 16
    s_and_b32 s33, s33, 0xffff
    s_cmp_ge_u32 s33, 32
    s_cbranch_scc1 L_cbd1
    s_add_u32 s7, s7, 1
    s_cmp_lt_u32 s7, s6
    s_cbranch_scc1 L_cb1
    s_mov_b32 s6, 0
L_cbd1:
    v_readfirstlane_b32 s33, v16
    v_readfirstlane_b32 s34, v18
    s_and_b32 s34, s34, 0xff
    s_cmp_eq_u32 s34, 128
    s_cselect_b32 s34, s33, 0
    s_cmp_lg_u32 s34, 0
    s_cbranch_scc1 L_kv0d_1
    v_mov_b32 v26, 28
    s_mov_b32 s7, 0
L_ini_1:
    global_load_dword v27, v26, s[16:17] sc1
    s_waitcnt vmcnt(0)
    v_readfirstlane_b32 s33, v27
    s_cmp_lg_u32 s33, 0
    s_cbranch_scc1 L_inid_1
    s_add_u32 s7, s7, 1
    s_cmp_lt_u32 s7, 100000
    s_cbranch_scc1 L_ini_1
L_inid_1:
    v_mov_b32 v26, 262144
    s_mov_b32 s7, 0
L_kv0_1:
    buffer_load_dword v27, v26, s[8:11], 0 offen sc1
    s_waitcnt vmcnt(0)
    v_readfirstlane_b32 s33, v27
    s_and_b32 s33, s33, 0xff
    s_cmp_eq_u32 s33, 128
    s_cbranch_scc1 L_kv0d_1
    s_sleep 2
    s_add_u32 s7, s7, 1
    s_cmp_lt_u32 s7, 400000
    s_cbranch_scc1 L_kv0_1
L_kv0d_1:
    s_lshl_b32 s33, s3, 13
    s_add_u32 s33, s33, 2048
    s_add_u32 s28, s33, 16777216
    s_mov_b32 s29, 18432
    s_mov_b32 m0, s29
    s_add_u32 s30, s33, 33554432
    buffer_load_dwordx4 v0, s[8:11], s28 offen lds
    buffer_load_dwordx4 v0, s[8:11], s28 offen offset:1024 lds
    buffer_load_dwordx4 v[16:19], v9, s[8:11], s30 offen
    buffer_load_dwordx4 v[20:23], v9, s[8:11], s30 offen offset:256
    s_add_u32 s28, s28, 0x40000
    s_xor_b32 s29, s29, 8192
    s_add_u32 s30, s30, 0x40000
    s_mov_b32 s5, 0
    s_mov_b32 s20, 1572864
    s_mov_b32 s21, 1581056
    s_mov_b32 s22, 1589248
    s_lshl_b32 s33, s3, 6
    s_add_u32 s23, s33, 1114112
    s_add_u32 s25, s23, 32768
    s_lshl_b32 s33, s3, 13
    s_add_u32 s24, s33, 1050624
    s_add_u32 s26, s24, 262144
    s_lshl_b32 s33, s3, 11
    s_add_u32 s31, s33, 83886080
    s_lshl_b32 s33, s3, 12
    s_add_u32 s32, s33, 92274688
    s_mov_b32 s45, 2097152
    s_mov_b32 s62, 0x0F000000
    s_mov_b32 s63, 0x0F000000
    s_mov_b32 s96, 0x3e0293ee
    s_mov_b32 s97, 0x3e0293ee
    s_mov_b32 s98, 0x3f803f80
    s_mov_b32 s99, 0x3f803f80
    s_mov_b32 s100, 0xaaaaaaaa
    s_mov_b32 s101, 0xaaaaaaaa
    ds_read_b64_tr_b16 v[32:33], v100 offset:0
    ds_read_b64_tr_b16 v[34:35], v100 offset:4096
    ds_read_b64_tr_b16 v[36:37], v100 offset:8192
    ds_read_b64_tr_b16 v[38:39], v100 offset:12288
    ds_read_b64_tr_b16 v[40:41], v101 offset:0
    ds_read_b64_tr_b16 v[42:43], v101 offset:4096
    ds_read_b64_tr_b16 v[44:45], v101 offset:8192
    ds_read_b64_tr_b16 v[46:47], v101 offset:12288
    s_waitcnt lgkmcnt(0)
    ds_read_b64_tr_b16 v[48:49], v100 offset:32768
    ds_read_b64_tr_b16 v[50:51], v100 offset:36864
    ds_read_b64_tr_b16 v[52:53], v100 offset:40960
    ds_read_b64_tr_b16 v[54:55], v100 offset:45056
    ds_read_b64_tr_b16 v[56:57], v101 offset:32768
    ds_read_b64_tr_b16 v[58:59], v101 offset:36864
    ds_read_b64_tr_b16 v[60:61], v101 offset:40960
    ds_read_b64_tr_b16 v[62:63], v101 offset:45056
    s_waitcnt lgkmcnt(0)
    ds_read_b64_tr_b16 v[64:65], v102 offset:0
    ds_read_b64_tr_b16 v[66:67], v102 offset:4096
    ds_read_b64_tr_b16 v[68:69], v102 offset:8192
    ds_read_b64_tr_b16 v[70:71], v102 offset:12288
    ds_read_b64_tr_b16 v[72:73], v103 offset:0
    ds_read_b64_tr_b16 v[74:75], v103 offset:4096
    ds_read_b64_tr_b16 v[76:77], v103 offset:8192
    ds_read_b64_tr_b16 v[78:79], v103 offset:12288
    s_waitcnt lgkmcnt(0)
    ds_read_b64_tr_b16 v[80:81], v102 offset:32768
    ds_read_b64_tr_b16 v[82:83], v102 offset:36864
    ds_read_b64_tr_b16 v[84:85], v102 offset:40960
    ds_read_b64_tr_b16 v[86:87], v102 offset:45056
    ds_read_b64_tr_b16 v[88:89], v103 offset:32768
    ds_read_b64_tr_b16 v[90:91], v103 offset:36864
    ds_read_b64_tr_b16 v[92:93], v103 offset:40960
    ds_read_b64_tr_b16 v[94:95], v103 offset:45056
    s_waitcnt lgkmcnt(0)
    s_barrier
    ds_write_b128 v11, v[32:35] offset:0
    ds_write_b128 v11, v[36:39] offset:1024
    ds_write_b128 v11, v[40:43] offset:2048
    ds_write_b128 v11, v[44:47] offset:3072
    ds_write_b128 v11, v[48:51] offset:4096
    ds_write_b128 v11, v[52:55] offset:5120
    ds_write_b128 v11, v[56:59] offset:6144
    ds_write_b128 v11, v[60:63] offset:7168
    ds_write_b128 v11, v[64:67] offset:8192
    ds_write_b128 v11, v[68:71] offset:9216
    ds_write_b128 v11, v[72:75] offset:10240
    ds_write_b128 v11, v[76:79] offset:11264
    ds_write_b128 v11, v[80:83] offset:12288
    ds_write_b128 v11, v[84:87] offset:13312
    ds_write_b128 v11, v[88:91] offset:14336
    ds_write_b128 v11, v[92:95] offset:15360
    s_waitcnt lgkmcnt(0)
    v_add_u32 v105, 49152, v104
    v_xor_b32 v106, 0, v105
    ds_read_b64_tr_b16 v[32:33], v106 offset:0
    ds_read_b64_tr_b16 v[34:35], v106 offset:4096
    ds_read_b64_tr_b16 v[36:37], v106 offset:8192
    ds_read_b64_tr_b16 v[38:39], v106 offset:12288
    v_xor_b32 v106, 32, v105
    ds_read_b64_tr_b16 v[40:41], v106 offset:0
    ds_read_b64_tr_b16 v[42:43], v106 offset:4096
    ds_read_b64_tr_b16 v[44:45], v106 offset:8192
    ds_read_b64_tr_b16 v[46:47], v106 offset:12288
    s_waitcnt lgkmcnt(0)
    v_xor_b32 v106, 64, v105
    ds_read_b64_tr_b16 v[48:49], v106 offset:0
    ds_read_b64_tr_b16 v[50:51], v106 offset:4096
    ds_read_b64_tr_b16 v[52:53], v106 offset:8192
    ds_read_b64_tr_b16 v[54:55], v106 offset:12288
    v_xor_b32 v106, 96, v105
    ds_read_b64_tr_b16 v[56:57], v106 offset:0
    ds_read_b64_tr_b16 v[58:59], v106 offset:4096
    ds_read_b64_tr_b16 v[60:61], v106 offset:8192
    ds_read_b64_tr_b16 v[62:63], v106 offset:12288
    s_waitcnt lgkmcnt(0)
    v_xor_b32 v106, 128, v105
    ds_read_b64_tr_b16 v[64:65], v106 offset:0
    ds_read_b64_tr_b16 v[66:67], v106 offset:4096
    ds_read_b64_tr_b16 v[68:69], v106 offset:8192
    ds_read_b64_tr_b16 v[70:71], v106 offset:12288
    v_xor_b32 v106, 160, v105
    ds_read_b64_tr_b16 v[72:73], v106 offset:0
    ds_read_b64_tr_b16 v[74:75], v106 offset:4096
    ds_read_b64_tr_b16 v[76:77], v106 offset:8192
    ds_read_b64_tr_b16 v[78:79], v106 offset:12288
    s_waitcnt lgkmcnt(0)
    v_xor_b32 v106, 192, v105
    ds_read_b64_tr_b16 v[80:81], v106 offset:0
    ds_read_b64_tr_b16 v[82:83], v106 offset:4096
    ds_read_b64_tr_b16 v[84:85], v106 offset:8192
    ds_read_b64_tr_b16 v[86:87], v106 offset:12288
    v_xor_b32 v106, 224, v105
    ds_read_b64_tr_b16 v[88:89], v106 offset:0
    ds_read_b64_tr_b16 v[90:91], v106 offset:4096
    ds_read_b64_tr_b16 v[92:93], v106 offset:8192
    ds_read_b64_tr_b16 v[94:95], v106 offset:12288
    s_waitcnt lgkmcnt(0)
    s_waitcnt lgkmcnt(0)
    ds_write_b128 v11, v[32:35] offset:16384
    ds_write_b128 v11, v[36:39] offset:17408
    ds_write_b128 v11, v[40:43] offset:18432
    ds_write_b128 v11, v[44:47] offset:19456
    ds_write_b128 v11, v[48:51] offset:20480
    ds_write_b128 v11, v[52:55] offset:21504
    ds_write_b128 v11, v[56:59] offset:22528
    ds_write_b128 v11, v[60:63] offset:23552
    ds_write_b128 v11, v[64:67] offset:24576
    ds_write_b128 v11, v[68:71] offset:25600
    ds_write_b128 v11, v[72:75] offset:26624
    ds_write_b128 v11, v[76:79] offset:27648
    ds_write_b128 v11, v[80:83] offset:28672
    ds_write_b128 v11, v[84:87] offset:29696
    ds_write_b128 v11, v[88:91] offset:30720
    ds_write_b128 v11, v[92:95] offset:31744
    s_waitcnt lgkmcnt(0)
    s_barrier
    s_mov_b32 s84, 0
    s_mov_b32 s85, 0
    s_mov_b32 s86, 0
    s_mov_b32 s87, 0
    s_mov_b32 s88, 0
    s_mov_b32 s89, 0
    s_mov_b32 s90, 0
    s_mov_b32 s91, 0
    s_mov_b32 s92, 0
    s_mov_b32 s93, 0
    s_waitcnt vmcnt(0)
    s_barrier
    ds_read_b128 v[64:67], v11 offset:0
    ds_read_b128 v[68:71], v11 offset:1024
    ds_read_b128 v[72:75], v11 offset:2048
    ds_read_b128 v[76:79], v11 offset:3072
    ds_read_b128 v[80:83], v11 offset:4096
    ds_read_b128 v[84:87], v11 offset:5120
    ds_read_b128 v[88:91], v11 offset:6144
    ds_read_b128 v[92:95], v11 offset:7168
    v_mov_b32 v112, 0
    v_mov_b32 v113, 0
    v_mov_b32 v114, 0
    v_mov_b32 v115, 0
    v_mov_b32 v116, 0
    v_mov_b32 v117, 0
    v_mov_b32 v118, 0
    v_mov_b32 v119, 0
    v_mov_b32 v120, 0
    v_mov_b32 v121, 0
    v_mov_b32 v122, 0
    v_mov_b32 v123, 0
    v_mov_b32 v124, 0
    v_mov_b32 v125, 0
    v_mov_b32 v126, 0
    v_mov_b32 v127, 0
    v_mov_b64 v[28:29], -1
    v_mov_b64 v[30:31], -1
    v_mov_b64 v[104:105], -1
    v_mov_b64 v[106:107], -1
    s_add_u32 s47, s20, 2048
    s_mov_b32 s7, 0
    s_sleep 2
    s_mov_b32 m0, 2048
    s_nop 0
    buffer_load_dwordx4 v0, s[8:11], s47 offen sc1 lds
    buffer_load_dwordx4 v0, s[8:11], s47 offen offset:1024 sc1 lds
    s_mov_b32 m0, 2048
    s_nop 0
    buffer_load_dwordx4 v0, s[8:11], s47 offen sc1 lds
    buffer_load_dwordx4 v0, s[8:11], s47 offen offset:1024 sc1 lds
    s_memtime s[56:57]
    s_memrealtime s[74:75]
    s_waitcnt vmcnt(0) lgkmcnt(0)
    s_mov_b32 s94, s56
    s_cmp_lg_u32 s71, 0
    s_cbranch_scc1 L_step1s
L_step1:
    s_waitcnt vmcnt(2)
    ds_read_b128 v[40:43], v0 offset:2048
    ds_read_b128 v[44:47], v0 offset:3072
    s_waitcnt lgkmcnt(0)
    v_max3_u32 v26, v40, v41, v42
    v_max3_u32 v27, v43, v44, v45
    v_max3_u32 v26, v26, v46, v47
    v_max_u32 v26, v26, v27
    v_cmp_eq_u32 vcc, -1, v26
    s_cbranch_vccnz L_p2r_1m
L_p2d_1m:
    s_barrier
    ds_read_b128 v[56:59], v0 offset:6144
    ds_read_b128 v[60:63], v0 offset:7168
    v_smfmac_f32_16x16x64_bf16 v[112:115], v[40:43], a[32:39], v10
    ds_read_b128 v[32:35], v0 offset:0
    v_smfmac_f32_16x16x64_bf16 v[116:119], v[40:43], a[40:47], v10
    ds_read_b128 v[36:39], v0 offset:1024
    s_mov_b32 m0, s29
    s_nop 0
    buffer_load_dwordx4 v0, s[8:11], s28 offen lds
    v_smfmac_f32_16x16x64_bf16 v[112:115], v[44:47], a[48:55], v10
    ds_read_b128 v[48:51], v0 offset:4096
    v_smfmac_f32_16x16x64_bf16 v[116:119], v[44:47], a[56:63], v10
    ds_read_b128 v[52:55], v0 offset:5120
    v_smfmac_f32_16x16x64_bf16 v[120:123], v[40:43], a[128:135], v10
    ds_read_b64_tr_b16 v[28:29], v4 offset:1280
    buffer_load_dwordx4 v0, s[8:11], s28 offen offset:1024 lds
    v_smfmac_f32_16x16x64_bf16 v[124:127], v[40:43], a[136:143], v10
    ds_read_b64_tr_b16 v[30:31], v4 offset:1408
    v_smfmac_f32_16x16x64_bf16 v[120:123], v[44:47], a[144:151], v10
    s_mov_b32 m0, 14848
    s_nop 0
    buffer_load_dword v9, s[8:11], s30 offen lds
    v_smfmac_f32_16x16x64_bf16 v[124:127], v[44:47], a[152:159], v10
    s_waitcnt lgkmcnt(7)
    v_smfmac_f32_16x16x64_bf16 v[112:115], v[56:59], v[64:71], v10
    v_smfmac_f32_16x16x64_bf16 v[116:119], v[56:59], v[72:79], v10
    buffer_load_dword v9, s[8:11], s30 offen offset:256 lds
    s_waitcnt lgkmcnt(6)
    v_smfmac_f32_16x16x64_bf16 v[112:115], v[60:63], v[80:87], v10
    v_smfmac_f32_16x16x64_bf16 v[116:119], v[60:63], v[88:95], v10
    ds_read_b128 v[64:67], v11 offset:8192
    s_waitcnt lgkmcnt(6)
    v_smfmac_f32_16x16x64_bf16 v[112:115], v[32:35], a[0:7], v10
    ds_read_b128 v[68:71], v11 offset:9216
    v_smfmac_f32_16x16x64_bf16 v[116:119], v[32:35], a[8:15], v10
    ds_read_b128 v[72:75], v11 offset:10240
    s_waitcnt lgkmcnt(7)
    v_smfmac_f32_16x16x64_bf16 v[112:115], v[36:39], a[16:23], v10
    ds_read_b128 v[76:79], v11 offset:11264
    v_smfmac_f32_16x16x64_bf16 v[116:119], v[36:39], a[24:31], v10
    ds_read_b128 v[80:83], v11 offset:12288
    s_waitcnt lgkmcnt(8)
    v_smfmac_f32_16x16x64_bf16 v[112:115], v[48:51], a[64:71], v10
    ds_read_b128 v[84:87], v11 offset:13312
    v_smfmac_f32_16x16x64_bf16 v[116:119], v[48:51], a[72:79], v10
    ds_read_b128 v[88:91], v11 offset:14336
    s_waitcnt lgkmcnt(9)
    v_smfmac_f32_16x16x64_bf16 v[112:115], v[52:55], a[80:87], v10
    ds_read_b128 v[92:95], v11 offset:15360
    v_smfmac_f32_16x16x64_bf16 v[116:119], v[52:55], a[88:95], v10
    s_waitcnt lgkmcnt(4)
    v_smfmac_f32_16x16x64_bf16 v[120:123], v[56:59], v[64:71], v10
    v_smfmac_f32_16x16x64_bf16 v[124:127], v[56:59], v[72:79], v10
    v_add_f32 v112, v112, v114
    v_smfmac_f32_16x16x64_bf16 v[120:123], v[32:35], a[96:103], v10
    ds_read_b128 v[64:67], v5 offset:0
    v_add_f32 v113, v113, v115
    v_add_f32 v116, v116, v118
    v_smfmac_f32_16x16x64_bf16 v[124:127], v[32:35], a[104:111], v10
    ds_read_b128 v[68:71], v5 offset:2048
    v_add_f32 v117, v117, v119
    v_cvt_pk_bf16_f32 v112, v112, v113
    s_waitcnt lgkmcnt(2)
    v_smfmac_f32_16x16x64_bf16 v[120:123], v[60:63], v[80:87], v10
    ds_read_b128 v[72:75], v5 offset:4096
    v_cvt_pk_bf16_f32 v116, v116, v117
    v_smfmac_f32_16x16x64_bf16 v[124:127], v[60:63], v[88:95], v10
    ds_write2_b32 v3, v112, v116 offset0:0 offset1:128
    ds_read_b128 v[76:79], v5 offset:6144
    v_smfmac_f32_16x16x64_bf16 v[120:123], v[36:39], a[112:119], v10
    ds_read_b128 v[80:83], v6 offset:0
    v_smfmac_f32_16x16x64_bf16 v[124:127], v[36:39], a[120:127], v10
    ds_read_b128 v[84:87], v6 offset:2048
    buffer_store_dwordx4 v[12:15], v0, s[8:11], s63 offen offset:1024 sc1
    v_smfmac_f32_16x16x64_bf16 v[120:123], v[48:51], a[160:167], v10
    ds_read_b128 v[88:91], v6 offset:4096
    s_waitcnt lgkmcnt(4)
    v_smfmac_f32_16x16x64_bf16 v[124:127], v[48:51], a[168:175], v10
    ds_read_b128 v[92:95], v6 offset:6144
    v_mov_b64 v[112:113], 0
    v_smfmac_f32_16x16x64_bf16 v[120:123], v[52:55], a[176:183], v10
    v_mov_b64 v[114:115], 0
    v_smfmac_f32_16x16x64_bf16 v[124:127], v[52:55], a[184:191], v10
    v_mov_b64 v[116:117], 0
    v_mov_b64 v[118:119], 0
    v_smfmac_f32_16x16x64_bf16 v[112:115], v[32:35], v[128:135], v10
    v_smfmac_f32_16x16x64_bf16 v[116:119], v[32:35], v[136:143], v10
    v_add_f32 v120, v120, v122
    v_add_f32 v121, v121, v123
    v_smfmac_f32_16x16x64_bf16 v[112:115], v[36:39], v[144:151], v10
    v_add_f32 v124, v124, v126
    v_add_f32 v125, v125, v127
    v_smfmac_f32_16x16x64_bf16 v[116:119], v[36:39], v[152:159], v10
    v_cvt_pk_bf16_f32 v120, v120, v121
    v_cvt_pk_bf16_f32 v124, v124, v125
    v_smfmac_f32_16x16x64_bf16 v[112:115], v[40:43], v[160:167], v10
    ds_write2_b32 v3, v120, v124 offset0:64 offset1:192
    v_smfmac_f32_16x16x64_bf16 v[116:119], v[40:43], v[168:175], v10
    v_smfmac_f32_16x16x64_bf16 v[112:115], v[44:47], v[176:183], v10
    v_smfmac_f32_16x16x64_bf16 v[116:119], v[44:47], v[184:191], v10
    v_smfmac_f32_16x16x64_bf16 v[112:115], v[48:51], v[192:199], v10
    s_mov_b64 exec, s[36:37]
    buffer_store_dwordx4 v[28:31], v7, s[8:11], s62 offen offset:512 sc1
    s_mov_b64 exec, -1
    s_waitcnt lgkmcnt(0)
    s_barrier
    ds_read_b64_tr_b16 v[96:97], v4 offset:0
    ds_read_b64_tr_b16 v[98:99], v4 offset:128
    v_smfmac_f32_16x16x64_bf16 v[116:119], v[48:51], v[200:207], v10
    ds_read_b64_tr_b16 v[100:101], v4 offset:1024
    ds_read_b64_tr_b16 v[102:103], v4 offset:1152
    v_smfmac_f32_16x16x64_bf16 v[112:115], v[52:55], v[208:215], v10
    ds_read_b64_tr_b16 v[104:105], v4 offset:2048
    ds_read_b64_tr_b16 v[106:107], v4 offset:2176
    v_smfmac_f32_16x16x64_bf16 v[116:119], v[52:55], v[216:223], v10
    ds_read_b64_tr_b16 v[108:109], v4 offset:3072
    ds_read_b64_tr_b16 v[110:111], v4 offset:3200
    v_smfmac_f32_16x16x64_bf16 v[112:115], v[56:59], v[224:231], v10
    v_smfmac_f32_16x16x64_bf16 v[116:119], v[56:59], v[232:239], v10
    v_smfmac_f32_16x16x64_bf16 v[112:115], v[60:63], v[240:247], v10
    v_smfmac_f32_16x16x64_bf16 v[116:119], v[60:63], v[248:255], v10
    s_waitcnt vmcnt(6)
    ds_read_b64_tr_b16 v[32:33], v4 offset:256
    ds_read_b64_tr_b16 v[34:35], v4 offset:384
    ds_read_b64_tr_b16 v[36:37], v4 offset:1280
    ds_read_b64_tr_b16 v[38:39], v4 offset:1408
    s_waitcnt lgkmcnt(10)
    v_mfma_f32_16x16x32_bf16 v[120:123], v[64:67], v[96:99], 0
    ds_read_b64_tr_b16 v[40:41], v4 offset:2304
    s_waitcnt lgkmcnt(9)
    v_mfma_f32_16x16x32_bf16 v[120:123], v[68:71], v[100:103], v[120:123]
    ds_read_b64_tr_b16 v[42:43], v4 offset:2432
    v_add_f32 v112, v112, v114
    v_add_f32 v113, v113, v115
    s_waitcnt lgkmcnt(8)
    v_mfma_f32_16x16x32_bf16 v[120:123], v[72:75], v[104:107], v[120:123]
    ds_read_b64_tr_b16 v[44:45], v4 offset:3328
    v_add_f32 v116, v116, v118
    v_add_f32 v117, v117, v119
    s_waitcnt lgkmcnt(7)
    v_mfma_f32_16x16x32_bf16 v[120:123], v[76:79], v[108:111], v[120:123]
    ds_read_b64_tr_b16 v[46:47], v4 offset:3456
    v_mov_b64 v[52:53], s[98:99]
    v_mov_b64 v[54:55], s[98:99]
    v_mfma_f32_16x16x32_bf16 v[124:127], v[80:83], v[96:99], 0
    ds_read_b128 v[64:67], v11 offset:16384
    v_cvt_pk_bf16_f32 v12, v112, v113
    v_cvt_pk_bf16_f32 v14, v116, v117
    v_mfma_f32_16x16x32_bf16 v[124:127], v[84:87], v[100:103], v[124:127]
    ds_read_b128 v[68:71], v11 offset:17408
    v_mfma_f32_16x16x32_bf16 v[124:127], v[88:91], v[104:107], v[124:127]
    ds_read_b128 v[72:75], v11 offset:18432
    v_max3_f32 v26, v120, v121, v122
    v_mfma_f32_16x16x32_bf16 v[124:127], v[92:95], v[108:111], v[124:127]
    ds_read_b128 v[76:79], v11 offset:19456
    v_max_f32 v26, v26, v123
    s_waitcnt lgkmcnt(10)
    v_mfma_f32_16x16x32_bf16 v[48:51], v[32:35], v[96:99], 0
    ds_read_b128 v[80:83], v11 offset:20480
    s_waitcnt lgkmcnt(9)
    v_mfma_f32_16x16x32_bf16 v[48:51], v[36:39], v[100:103], v[48:51]
    ds_read_b128 v[84:87], v11 offset:21504
    v_max3_f32 v27, v124, v125, v126
    v_mov_b64 v[96:97], 0
    s_waitcnt lgkmcnt(8)
    v_mfma_f32_16x16x32_bf16 v[48:51], v[40:43], v[104:107], v[48:51]
    ds_read_b128 v[88:91], v11 offset:22528
    v_mov_b64 v[98:99], 0
    v_max3_f32 v26, v26, v127, v27
    s_waitcnt lgkmcnt(7)
    v_mfma_f32_16x16x32_bf16 v[48:51], v[44:47], v[108:111], v[48:51]
    ds_read_b128 v[92:95], v11 offset:23552
    v_mov_b64 v[100:101], 0
    v_mov_b64 v[102:103], 0
    v_mov_b64 v[104:105], 0
    v_mov_b64 v[106:107], 0
    v_mov_b64 v[108:109], 0
    v_mov_b64 v[110:111], 0
    s_nop 0
    v_max3_f32 v26, v26, v48, v49
    v_max3_f32 v26, v26, v50, v51
    v_cndmask_b32 v48, v48, v50, s[38:39]
    v_mov_b32 v27, v26
    v_cndmask_b32 v49, v49, v51, s[38:39]
    s_nop 0
    v_permlane16_swap_b32 v26, v27
    v_max_f32 v26, v26, v27
    v_mov_b32 v27, v26
    v_mov_b32 v61, 0
    s_nop 0
    v_permlane32_swap_b32 v26, v27
    v_max_f32 v26, v26, v27
    v_mul_f32 v28, s46, v26
    v_pk_fma_f32 v[120:121], v[120:121], s[96:97], v[28:29] op_sel_hi:[1,1,0] neg_lo:[0,0,1] neg_hi:[0,0,1]
    v_pk_fma_f32 v[122:123], v[122:123], s[96:97], v[28:29] op_sel_hi:[1,1,0] neg_lo:[0,0,1] neg_hi:[0,0,1]
    v_pk_fma_f32 v[124:125], v[124:125], s[96:97], v[28:29] op_sel_hi:[1,1,0] neg_lo:[0,0,1] neg_hi:[0,0,1]
    v_pk_fma_f32 v[126:127], v[126:127], s[96:97], v[28:29] op_sel_hi:[1,1,0] neg_lo:[0,0,1] neg_hi:[0,0,1]
    v_pk_fma_f32 v[48:49], v[48:49], s[96:97], v[28:29] op_sel_hi:[1,1,0] neg_lo:[0,0,1] neg_hi:[0,0,1]
    v_exp_f32 v120, v120
    v_exp_f32 v121, v121
    v_exp_f32 v122, v122
    v_exp_f32 v123, v123
    v_exp_f32 v124, v124
    v_exp_f32 v125, v125
    v_exp_f32 v126, v126
    v_exp_f32 v127, v127
    v_exp_f32 v48, v48
    v_exp_f32 v49, v49
    v_cvt_pk_bf16_f32 v56, v120, v121
    v_cvt_pk_bf16_f32 v57, v122, v123
    v_cvt_pk_bf16_f32 v58, v124, v125
    v_cvt_pk_bf16_f32 v59, v126, v127
    v_cvt_pk_bf16_f32 v60, v48, v49
    s_nop 0
    v_mfma_f32_16x16x32_bf16 v[26:29], v[52:55], v[56:59], 0
    v_mov_b64 v[120:121], 0
    v_mov_b64 v[122:123], 0
    v_mfma_f32_16x16x32_bf16 v[112:115], v[16:19], v[56:59], 0
    ds_read_b128 v[32:35], v11 offset:24576
    v_mov_b64 v[124:125], 0
    v_mfma_f32_16x16x32_bf16 v[116:119], v[20:23], v[56:59], 0
    ds_read_b128 v[36:39], v11 offset:25600
    buffer_load_dwordx4 v[16:19], v9, s[8:11], s30 offen
    v_mfma_f32_16x16x16_bf16 v[26:29], v[24:25], v[60:61], v[26:29]
    ds_read_b128 v[40:43], v11 offset:26624
    buffer_load_dwordx4 v[20:23], v9, s[8:11], s30 offen offset:256
    v_mfma_f32_16x16x16_bf16 v[112:115], v[12:13], v[60:61], v[112:115]
    ds_read_b128 v[44:47], v11 offset:27648
    v_mov_b64 v[126:127], 0
    v_mfma_f32_16x16x16_bf16 v[116:119], v[14:15], v[60:61], v[116:119]
    v_rcp_f32 v30, v26
    s_nop 2
    v_mul_f32 v112, v112, v30
    v_mul_f32 v113, v113, v30
    v_cvt_pk_bf16_f32 v56, v112, v113
    v_mul_f32 v114, v114, v30
    v_mul_f32 v115, v115, v30
    v_cvt_pk_bf16_f32 v57, v114, v115
    v_mul_f32 v116, v116, v30
    v_mul_f32 v117, v117, v30
    v_cvt_pk_bf16_f32 v58, v116, v117
    v_mul_f32 v118, v118, v30
    v_mul_f32 v119, v119, v30
    v_cvt_pk_bf16_f32 v59, v118, v119
    s_mov_b64 exec, s[36:37]
    ds_write_b128 v7, v[56:59] offset:12800
    s_mov_b64 exec, -1
    ds_read_b128 v[48:51], v11 offset:28672
    ds_read_b128 v[52:55], v11 offset:29696
    v_mov_b64 v[28:29], -1
    v_mov_b64 v[30:31], -1
    buffer_store_dwordx4 v[28:31], v0, s[8:11], s26 offen
    s_waitcnt lgkmcnt(2)
    s_barrier
    ds_read_b128 v[56:59], v8 offset:0
    ds_read_b128 v[60:63], v8 offset:1024
    buffer_store_dwordx4 v[28:31], v0, s[8:11], s26 offen offset:1024
    s_waitcnt lgkmcnt(1)
    v_smfmac_f32_16x16x64_bf16 v[96:99], v[56:59], a[192:199], v10
    v_mov_b64 v[112:113], 0
    v_smfmac_f32_16x16x64_bf16 v[100:103], v[56:59], a[200:207], v10
    v_mov_b64 v[114:115], 0
    v_smfmac_f32_16x16x64_bf16 v[104:107], v[56:59], a[208:215], v10
    v_mov_b64 v[116:117], 0
    v_smfmac_f32_16x16x64_bf16 v[108:111], v[56:59], a[216:223], v10
    v_mov_b64 v[118:119], 0
    s_waitcnt lgkmcnt(0)
    v_smfmac_f32_16x16x64_bf16 v[96:99], v[60:63], v[64:71], v10
    v_smfmac_f32_16x16x64_bf16 v[100:103], v[60:63], v[72:79], v10
    ds_read_b128 v[64:67], v11 offset:30720
    v_smfmac_f32_16x16x64_bf16 v[104:107], v[60:63], v[80:87], v10
    ds_read_b128 v[68:71], v11 offset:31744
    v_smfmac_f32_16x16x64_bf16 v[108:111], v[60:63], v[88:95], v10
    v_add_f32 v96, v96, v98
    v_add_f32 v97, v97, v99
    v_cvt_pk_bf16_f32 v96, v96, v97
    v_smfmac_f32_16x16x64_bf16 v[112:115], v[56:59], a[224:231], v10
    v_add_f32 v100, v100, v102
    v_add_f32 v101, v101, v103
    v_cvt_pk_bf16_f32 v97, v100, v101
    v_smfmac_f32_16x16x64_bf16 v[116:119], v[56:59], a[232:239], v10
    v_add_f32 v104, v104, v106
    v_add_f32 v105, v105, v107
    v_cvt_pk_bf16_f32 v98, v104, v105
    v_smfmac_f32_16x16x64_bf16 v[120:123], v[56:59], a[240:247], v10
    v_add_f32 v108, v108, v110
    v_add_f32 v109, v109, v111
    v_cvt_pk_bf16_f32 v99, v108, v109
    v_smfmac_f32_16x16x64_bf16 v[124:127], v[56:59], a[248:255], v10
    buffer_store_dwordx4 v[96:99], v1, s[8:11], s23 offen
    v_smfmac_f32_16x16x64_bf16 v[112:115], v[60:63], v[32:39], v10
    v_smfmac_f32_16x16x64_bf16 v[116:119], v[60:63], v[40:47], v10
    v_smfmac_f32_16x16x64_bf16 v[120:123], v[60:63], v[48:55], v10
    s_waitcnt lgkmcnt(0)
    v_smfmac_f32_16x16x64_bf16 v[124:127], v[60:63], v[64:71], v10
    v_add_f32 v112, v112, v114
    v_add_f32 v113, v113, v115
    v_cvt_pk_bf16_f32 v112, v112, v113
    v_add_f32 v116, v116, v118
    v_add_f32 v117, v117, v119
    v_cvt_pk_bf16_f32 v113, v116, v117
    v_add_f32 v120, v120, v122
    v_add_f32 v121, v121, v123
    v_cvt_pk_bf16_f32 v114, v120, v121
    v_add_f32 v124, v124, v126
    v_add_f32 v125, v125, v127
    v_cvt_pk_bf16_f32 v115, v124, v125
    buffer_store_dwordx4 v[112:115], v1, s[8:11], s25 offen
    v_mov_b32 v26, 0x3f80
    v_mov_b32 v27, 0x3f800000
    v_cndmask_b32 v26, v26, v27, s[100:101]
    v_cndmask_b32 v108, 0, v26, s[48:49]
    v_cndmask_b32 v109, 0, v26, s[50:51]
    v_cndmask_b32 v110, 0, v26, s[52:53]
    v_cndmask_b32 v111, 0, v26, s[54:55]
    ds_read_b128 v[64:67], v11 offset:0
    ds_read_b128 v[68:71], v11 offset:1024
    ds_read_b128 v[72:75], v11 offset:2048
    ds_read_b128 v[76:79], v11 offset:3072
    ds_read_b128 v[80:83], v11 offset:4096
    ds_read_b128 v[84:87], v11 offset:5120
    ds_read_b128 v[88:91], v11 offset:6144
    ds_read_b128 v[92:95], v11 offset:7168
    v_mov_b64 v[112:113], 0
    v_mov_b64 v[114:115], 0
    v_mov_b64 v[116:117], 0
    v_mov_b64 v[118:119], 0
    v_mov_b64 v[120:121], 0
    v_mov_b64 v[122:123], 0
    v_mov_b64 v[124:125], 0
    v_mov_b64 v[126:127], 0
    v_mov_b64 v[28:29], -1
    v_mov_b64 v[30:31], -1
    s_mov_b32 s7, 0
    s_sleep 2
    buffer_load_dwordx4 v[96:99], v0, s[8:11], s24 offen sc1
    buffer_load_dwordx4 v[100:103], v0, s[8:11], s24 offen offset:1024 sc1
    s_sleep 3
    buffer_load_dwordx4 v[96:99], v0, s[8:11], s24 offen sc1
    buffer_load_dwordx4 v[100:103], v0, s[8:11], s24 offen offset:1024 sc1
    s_and_b32 s33, s5, 7
    s_cmp_eq_u32 s33, 6
    s_cbranch_scc0 L_nkv_1m
    s_add_u32 s33, s5, 2
    s_lshr_b32 s33, s33, 3
    s_lshl_b32 s33, s33, 7
    s_add_u32 s33, s33, 262144
    v_mov_b32 v26, s33
    buffer_load_dword v27, v26, s[8:11], 0 offen sc1
    s_waitcnt vmcnt(0)
L_nkv_1m:
L_p1w_1m:
    s_waitcnt vmcnt(2)
    v_mfma_f32_16x16x32_bf16 v[104:107], v[108:111], v[96:99], 0
    v_mfma_f32_16x16x32_bf16 v[104:107], v[108:111], v[100:103], v[104:107]
    s_nop 7
    v_cmp_u_f32 vcc, v104, v104
    s_cbranch_vccnz L_p1r_1m
L_p1d_1m:
    v_add_f32_dpp v104, v104, v104 row_ror:8 row_mask:0xf bank_mask:0xf
    v_add_f32_dpp v105, v105, v105 row_ror:8 row_mask:0xf bank_mask:0xf
    v_add_f32_dpp v106, v106, v106 row_ror:8 row_mask:0xf bank_mask:0xf
    v_add_f32_dpp v107, v107, v107 row_ror:8 row_mask:0xf bank_mask:0xf
    v_add_f32_dpp v104, v104, v104 row_ror:4 row_mask:0xf bank_mask:0xf
    v_add_f32_dpp v105, v105, v105 row_ror:4 row_mask:0xf bank_mask:0xf
    v_add_f32_dpp v106, v106, v106 row_ror:4 row_mask:0xf bank_mask:0xf
    v_add_f32_dpp v107, v107, v107 row_ror:4 row_mask:0xf bank_mask:0xf
    v_cvt_pk_bf16_f32 v104, v104, v106
    v_cvt_pk_bf16_f32 v105, v105, v107
    s_mov_b64 exec, s[40:41]
    v_cndmask_b32 v104, v104, v105, s[42:43]
    v_min_u32 v104, -2, v104
    buffer_store_dword v104, v2, s[8:11], s21 offen
    buffer_store_dword v28, v2, s[8:11], s20 offen
    s_mov_b64 exec, -1
    s_add_u32 s47, s21, 2048
    s_mov_b32 s7, 0
    s_add_u32 s5, s5, 1
    s_and_b32 s33, s5, 7
    s_cmp_eq_u32 s33, 7
    s_cbranch_scc0 L_ckv_1m
    s_cmp_ge_u32 s5, 57
    s_cbranch_scc1 L_ckv_1m
L_ckvl_1m:
    v_readfirstlane_b32 s33, v27
    s_and_b32 s33, s33, 0xff
    s_cmp_eq_u32 s33, 128
    s_cbranch_scc1 L_ckv_1m
    s_add_u32 s7, s7, 1
    s_cmp_lt_u32 s7, 400000
    s_cbranch_scc0 L_ckv_1m
    s_sleep 2
    buffer_load_dword v27, v26, s[8:11], 0 offen sc1
    s_waitcnt vmcnt(0)
    s_branch L_ckvl_1m
L_ckv_1m:
    s_mov_b32 s7, 0
    s_sleep 2
    s_mov_b32 m0, 2048
    s_nop 0
    buffer_load_dwordx4 v0, s[8:11], s47 offen sc1 lds
    buffer_load_dwordx4 v0, s[8:11], s47 offen offset:1024 sc1 lds
    s_mov_b32 s33, s20
    s_mov_b32 s20, s21
    s_mov_b32 s21, s22
    s_mov_b32 s22, s33
    s_xor_b32 s23, s23, 0x40000
    s_mov_b32 s26, s24
    s_xor_b32 s24, s24, 0x40000
    s_xor_b32 s25, s25, 0x40000
    s_add_u32 s28, s28, 0x40000
    s_xor_b32 s29, s29, 8192
    s_add_u32 s30, s30, 0x40000
    s_mov_b32 s62, s31
    s_mov_b32 s63, s32
    s_add_u32 s31, s31, 65536
    s_add_u32 s32, s32, 131072
    v_xor_b32 v5, 0x2000, v5
    v_xor_b32 v6, 0x2000, v6
    s_sleep 2
    s_mov_b32 m0, 2048
    s_nop 0
    buffer_load_dwordx4 v0, s[8:11], s47 offen sc1 lds
    buffer_load_dwordx4 v0, s[8:11], s47 offen offset:1024 sc1 lds
    v_mov_b64 v[104:105], -1
    v_mov_b64 v[106:107], -1
    s_cmp_lt_u32 s5, 63
    s_cbranch_scc1 L_step1
    s_waitcnt vmcnt(2)
    ds_read_b128 v[40:43], v0 offset:2048
    ds_read_b128 v[44:47], v0 offset:3072
    s_waitcnt lgkmcnt(0)
    v_max3_u32 v26, v40, v41, v42
    v_max3_u32 v27, v43, v44, v45
    v_max3_u32 v26, v26, v46, v47
    v_max_u32 v26, v26, v27
    v_cmp_eq_u32 vcc, -1, v26
    s_cbranch_vccnz L_p2r_1l
L_p2d_1l:
    s_barrier
    ds_read_b128 v[56:59], v0 offset:6144
    ds_read_b128 v[60:63], v0 offset:7168
    ds_read_b128 v[32:35], v0 offset:0
    ds_read_b128 v[36:39], v0 offset:1024
    ds_read_b128 v[48:51], v0 offset:4096
    ds_read_b128 v[52:55], v0 offset:5120
    ds_read_b64_tr_b16 v[28:29], v4 offset:1280
    ds_read_b64_tr_b16 v[30:31], v4 offset:1408
    buffer_store_dwordx4 v[12:15], v0, s[8:11], s63 offen offset:1024 sc1
    s_waitcnt lgkmcnt(0)
    s_mov_b64 exec, s[36:37]
    buffer_store_dwordx4 v[28:31], v7, s[8:11], s62 offen offset:512 sc1
    s_mov_b64 exec, -1
    v_smfmac_f32_16x16x64_bf16 v[120:123], v[40:43], a[128:135], v10
    v_smfmac_f32_16x16x64_bf16 v[124:127], v[40:43], a[136:143], v10
    v_smfmac_f32_16x16x64_bf16 v[120:123], v[44:47], a[144:151], v10
    v_smfmac_f32_16x16x64_bf16 v[124:127], v[44:47], a[152:159], v10
    ds_read_b128 v[64:67], v11 offset:8192
    ds_read_b128 v[68:71], v11 offset:9216
    ds_read_b128 v[72:75], v11 offset:10240
    ds_read_b128 v[76:79], v11 offset:11264
    ds_read_b128 v[80:83], v11 offset:12288
    ds_read_b128 v[84:87], v11 offset:13312
    ds_read_b128 v[88:91], v11 offset:14336
    ds_read_b128 v[92:95], v11 offset:15360
    s_waitcnt lgkmcnt(4)
    v_smfmac_f32_16x16x64_bf16 v[120:123], v[56:59], v[64:71], v10
    v_smfmac_f32_16x16x64_bf16 v[124:127], v[56:59], v[72:79], v10
    v_smfmac_f32_16x16x64_bf16 v[120:123], v[32:35], a[96:103], v10
    v_smfmac_f32_16x16x64_bf16 v[124:127], v[32:35], a[104:111], v10
    s_waitcnt lgkmcnt(0)
    v_smfmac_f32_16x16x64_bf16 v[120:123], v[60:63], v[80:87], v10
    v_smfmac_f32_16x16x64_bf16 v[124:127], v[60:63], v[88:95], v10
    v_smfmac_f32_16x16x64_bf16 v[120:123], v[36:39], a[112:119], v10
    v_smfmac_f32_16x16x64_bf16 v[124:127], v[36:39], a[120:127], v10
    v_smfmac_f32_16x16x64_bf16 v[120:123], v[48:51], a[160:167], v10
    v_smfmac_f32_16x16x64_bf16 v[124:127], v[48:51], a[168:175], v10
    v_smfmac_f32_16x16x64_bf16 v[120:123], v[52:55], a[176:183], v10
    v_smfmac_f32_16x16x64_bf16 v[124:127], v[52:55], a[184:191], v10
    v_mov_b64 v[112:113], 0
    v_mov_b64 v[114:115], 0
    v_mov_b64 v[116:117], 0
    v_mov_b64 v[118:119], 0
    v_smfmac_f32_16x16x64_bf16 v[112:115], v[32:35], v[128:135], v10
    v_smfmac_f32_16x16x64_bf16 v[116:119], v[32:35], v[136:143], v10
    v_add_f32 v120, v120, v122
    v_add_f32 v121, v121, v123
    v_smfmac_f32_16x16x64_bf16 v[112:115], v[36:39], v[144:151], v10
    v_add_f32 v124, v124, v126
    v_add_f32 v125, v125, v127
    v_smfmac_f32_16x16x64_bf16 v[116:119], v[36:39], v[152:159], v10
    v_cvt_pk_bf16_f32 v120, v120, v121
    v_cvt_pk_bf16_f32 v124, v124, v125
    v_smfmac_f32_16x16x64_bf16 v[112:115], v[40:43], v[160:167], v10
    ds_write2_b32 v3, v120, v124 offset0:64 offset1:192
    v_smfmac_f32_16x16x64_bf16 v[116:119], v[40:43], v[168:175], v10
    v_smfmac_f32_16x16x64_bf16 v[112:115], v[44:47], v[176:183], v10
    v_smfmac_f32_16x16x64_bf16 v[116:119], v[44:47], v[184:191], v10
    v_smfmac_f32_16x16x64_bf16 v[112:115], v[48:51], v[192:199], v10
    s_waitcnt lgkmcnt(0)
    s_barrier
    v_smfmac_f32_16x16x64_bf16 v[116:119], v[48:51], v[200:207], v10
    v_smfmac_f32_16x16x64_bf16 v[112:115], v[52:55], v[208:215], v10
    v_smfmac_f32_16x16x64_bf16 v[116:119], v[52:55], v[216:223], v10
    v_smfmac_f32_16x16x64_bf16 v[112:115], v[56:59], v[224:231], v10
    v_smfmac_f32_16x16x64_bf16 v[116:119], v[56:59], v[232:239], v10
    v_smfmac_f32_16x16x64_bf16 v[112:115], v[60:63], v[240:247], v10
    v_smfmac_f32_16x16x64_bf16 v[116:119], v[60:63], v[248:255], v10
    ds_read_b64_tr_b16 v[32:33], v4 offset:256
    ds_read_b64_tr_b16 v[34:35], v4 offset:384
    ds_read_b64_tr_b16 v[36:37], v4 offset:1280
    ds_read_b64_tr_b16 v[38:39], v4 offset:1408
    ds_read_b64_tr_b16 v[40:41], v4 offset:2304
    ds_read_b64_tr_b16 v[42:43], v4 offset:2432
    ds_read_b64_tr_b16 v[44:45], v4 offset:3328
    ds_read_b64_tr_b16 v[46:47], v4 offset:3456
    v_pk_add_f32 v[112:113], v[112:113], v[114:115]
    v_pk_add_f32 v[116:117], v[116:117], v[118:119]
    v_cvt_pk_bf16_f32 v12, v112, v113
    v_cvt_pk_bf16_f32 v14, v116, v117
    buffer_store_dwordx4 v[12:15], v0, s[8:11], s32 offen offset:1024 sc1
    s_waitcnt lgkmcnt(0)
    s_mov_b64 exec, s[36:37]
    buffer_store_dwordx4 v[36:39], v7, s[8:11], s31 offen offset:512 sc1
    s_mov_b64 exec, -1
    s_branch L_cfin1
L_step1s:
    s_waitcnt vmcnt(2)
    ds_read_b128 v[40:43], v0 offset:2048
    ds_read_b128 v[44:47], v0 offset:3072
    s_waitcnt lgkmcnt(0)
    v_max3_u32 v26, v40, v41, v42
    v_max3_u32 v27, v43, v44, v45
    v_max3_u32 v26, v26, v46, v47
    v_max_u32 v26, v26, v27
    v_cmp_eq_u32 vcc, -1, v26
    s_cbranch_vccnz L_p2r_1ms
L_p2d_1ms:
    s_barrier
    ds_read_b128 v[56:59], v0 offset:6144
    ds_read_b128 v[60:63], v0 offset:7168
    v_smfmac_f32_16x16x64_bf16 v[112:115], v[40:43], a[32:39], v10
    ds_read_b128 v[32:35], v0 offset:0
    v_smfmac_f32_16x16x64_bf16 v[116:119], v[40:43], a[40:47], v10
    ds_read_b128 v[36:39], v0 offset:1024
    s_mov_b32 m0, s29
    s_nop 0
    buffer_load_dwordx4 v0, s[8:11], s28 offen lds
    v_smfmac_f32_16x16x64_bf16 v[112:115], v[44:47], a[48:55], v10
    ds_read_b128 v[48:51], v0 offset:4096
    v_smfmac_f32_16x16x64_bf16 v[116:119], v[44:47], a[56:63], v10
    ds_read_b128 v[52:55], v0 offset:5120
    v_smfmac_f32_16x16x64_bf16 v[120:123], v[40:43], a[128:135], v10
    ds_read_b64_tr_b16 v[28:29], v4 offset:1280
    buffer_load_dwordx4 v0, s[8:11], s28 offen offset:1024 lds
    v_smfmac_f32_16x16x64_bf16 v[124:127], v[40:43], a[136:143], v10
    ds_read_b64_tr_b16 v[30:31], v4 offset:1408
    v_smfmac_f32_16x16x64_bf16 v[120:123], v[44:47], a[144:151], v10
    s_mov_b32 m0, 14848
    s_nop 0
    buffer_load_dword v9, s[8:11], s30 offen lds
    v_smfmac_f32_16x16x64_bf16 v[124:127], v[44:47], a[152:159], v10
    s_waitcnt lgkmcnt(7)
    v_smfmac_f32_16x16x64_bf16 v[112:115], v[56:59], v[64:71], v10
    v_smfmac_f32_16x16x64_bf16 v[116:119], v[56:59], v[72:79], v10
    buffer_load_dword v9, s[8:11], s30 offen offset:256 lds
    s_waitcnt lgkmcnt(6)
    v_smfmac_f32_16x16x64_bf16 v[112:115], v[60:63], v[80:87], v10
    v_smfmac_f32_16x16x64_bf16 v[116:119], v[60:63], v[88:95], v10
    ds_read_b128 v[64:67], v11 offset:8192
    s_waitcnt lgkmcnt(6)
    v_smfmac_f32_16x16x64_bf16 v[112:115], v[32:35], a[0:7], v10
    ds_read_b128 v[68:71], v11 offset:9216
    v_smfmac_f32_16x16x64_bf16 v[116:119], v[32:35], a[8:15], v10
    ds_read_b128 v[72:75], v11 offset:10240
    s_waitcnt lgkmcnt(7)
    v_smfmac_f32_16x16x64_bf16 v[112:115], v[36:39], a[16:23], v10
    ds_read_b128 v[76:79], v11 offset:11264
    v_smfmac_f32_16x16x64_bf16 v[116:119], v[36:39], a[24:31], v10
    ds_read_b128 v[80:83], v11 offset:12288
    s_waitcnt lgkmcnt(8)
    v_smfmac_f32_16x16x64_bf16 v[112:115], v[48:51], a[64:71], v10
    ds_read_b128 v[84:87], v11 offset:13312
    v_smfmac_f32_16x16x64_bf16 v[116:119], v[48:51], a[72:79], v10
    ds_read_b128 v[88:91], v11 offset:14336
    s_waitcnt lgkmcnt(9)
    v_smfmac_f32_16x16x64_bf16 v[112:115], v[52:55], a[80:87], v10
    ds_read_b128 v[92:95], v11 offset:15360
    v_smfmac_f32_16x16x64_bf16 v[116:119], v[52:55], a[88:95], v10
    s_waitcnt lgkmcnt(4)
    v_smfmac_f32_16x16x64_bf16 v[120:123], v[56:59], v[64:71], v10
    v_smfmac_f32_16x16x64_bf16 v[124:127], v[56:59], v[72:79], v10
    v_add_f32 v112, v112, v114
    v_smfmac_f32_16x16x64_bf16 v[120:123], v[32:35], a[96:103], v10
    ds_read_b128 v[64:67], v5 offset:0
    v_add_f32 v113, v113, v115
    v_add_f32 v116, v116, v118
    v_smfmac_f32_16x16x64_bf16 v[124:127], v[32:35], a[104:111], v10
    ds_read_b128 v[68:71], v5 offset:2048
    v_add_f32 v117, v117, v119
    v_cvt_pk_bf16_f32 v112, v112, v113
    s_waitcnt lgkmcnt(2)
    v_smfmac_f32_16x16x64_bf16 v[120:123], v[60:63], v[80:87], v10
    ds_read_b128 v[72:75], v5 offset:4096
    v_cvt_pk_bf16_f32 v116, v116, v117
    v_smfmac_f32_16x16x64_bf16 v[124:127], v[60:63], v[88:95], v10
    ds_write2_b32 v3, v112, v116 offset0:0 offset1:128
    ds_read_b128 v[76:79], v5 offset:6144
    v_smfmac_f32_16x16x64_bf16 v[120:123], v[36:39], a[112:119], v10
    ds_read_b128 v[80:83], v6 offset:0
    v_smfmac_f32_16x16x64_bf16 v[124:127], v[36:39], a[120:127], v10
    ds_read_b128 v[84:87], v6 offset:2048
    buffer_store_dwordx4 v[12:15], v0, s[8:11], s63 offen offset:1024 sc1
    v_smfmac_f32_16x16x64_bf16 v[120:123], v[48:51], a[160:167], v10
    ds_read_b128 v[88:91], v6 offset:4096
    s_waitcnt lgkmcnt(4)
    v_smfmac_f32_16x16x64_bf16 v[124:127], v[48:51], a[168:175], v10
    ds_read_b128 v[92:95], v6 offset:6144
    v_mov_b64 v[112:113], 0
    v_smfmac_f32_16x16x64_bf16 v[120:123], v[52:55], a[176:183], v10
    v_mov_b64 v[114:115], 0
    v_smfmac_f32_16x16x64_bf16 v[124:127], v[52:55], a[184:191], v10
    v_mov_b64 v[116:117], 0
    v_mov_b64 v[118:119], 0
    v_smfmac_f32_16x16x64_bf16 v[112:115], v[32:35], v[128:135], v10
    v_smfmac_f32_16x16x64_bf16 v[116:119], v[32:35], v[136:143], v10
    v_add_f32 v120, v120, v122
    v_add_f32 v121, v121, v123
    v_smfmac_f32_16x16x64_bf16 v[112:115], v[36:39], v[144:151], v10
    v_add_f32 v124, v124, v126
    v_add_f32 v125, v125, v127
    v_smfmac_f32_16x16x64_bf16 v[116:119], v[36:39], v[152:159], v10
    v_cvt_pk_bf16_f32 v120, v120, v121
    v_cvt_pk_bf16_f32 v124, v124, v125
    v_smfmac_f32_16x16x64_bf16 v[112:115], v[40:43], v[160:167], v10
    ds_write2_b32 v3, v120, v124 offset0:64 offset1:192
    v_smfmac_f32_16x16x64_bf16 v[116:119], v[40:43], v[168:175], v10
    v_smfmac_f32_16x16x64_bf16 v[112:115], v[44:47], v[176:183], v10
    v_smfmac_f32_16x16x64_bf16 v[116:119], v[44:47], v[184:191], v10
    v_smfmac_f32_16x16x64_bf16 v[112:115], v[48:51], v[192:199], v10
    s_mov_b64 exec, s[36:37]
    buffer_store_dwordx4 v[28:31], v7, s[8:11], s62 offen offset:512 sc1
    s_mov_b64 exec, -1
    s_waitcnt lgkmcnt(0)
    s_barrier
    ds_read_b64_tr_b16 v[96:97], v4 offset:0
    ds_read_b64_tr_b16 v[98:99], v4 offset:128
    v_smfmac_f32_16x16x64_bf16 v[116:119], v[48:51], v[200:207], v10
    ds_read_b64_tr_b16 v[100:101], v4 offset:1024
    ds_read_b64_tr_b16 v[102:103], v4 offset:1152
    v_smfmac_f32_16x16x64_bf16 v[112:115], v[52:55], v[208:215], v10
    ds_read_b64_tr_b16 v[104:105], v4 offset:2048
    ds_read_b64_tr_b16 v[106:107], v4 offset:2176
    v_smfmac_f32_16x16x64_bf16 v[116:119], v[52:55], v[216:223], v10
    ds_read_b64_tr_b16 v[108:109], v4 offset:3072
    ds_read_b64_tr_b16 v[110:111], v4 offset:3200
    v_smfmac_f32_16x16x64_bf16 v[112:115], v[56:59], v[224:231], v10
    v_smfmac_f32_16x16x64_bf16 v[116:119], v[56:59], v[232:239], v10
    v_smfmac_f32_16x16x64_bf16 v[112:115], v[60:63], v[240:247], v10
    v_smfmac_f32_16x16x64_bf16 v[116:119], v[60:63], v[248:255], v10
    s_waitcnt vmcnt(6)
    ds_read_b64_tr_b16 v[32:33], v4 offset:256
    ds_read_b64_tr_b16 v[34:35], v4 offset:384
    ds_read_b64_tr_b16 v[36:37], v4 offset:1280
    ds_read_b64_tr_b16 v[38:39], v4 offset:1408
    s_waitcnt lgkmcnt(10)
    v_mfma_f32_16x16x32_bf16 v[120:123], v[64:67], v[96:99], 0
    ds_read_b64_tr_b16 v[40:41], v4 offset:2304
    s_waitcnt lgkmcnt(9)
    v_mfma_f32_16x16x32_bf16 v[120:123], v[68:71], v[100:103], v[120:123]
    ds_read_b64_tr_b16 v[42:43], v4 offset:2432
    v_add_f32 v112, v112, v114
    v_add_f32 v113, v113, v115
    s_waitcnt lgkmcnt(8)
    v_mfma_f32_16x16x32_bf16 v[120:123], v[72:75], v[104:107], v[120:123]
    ds_read_b64_tr_b16 v[44:45], v4 offset:3328
    v_add_f32 v116, v116, v118
    v_add_f32 v117, v117, v119
    s_waitcnt lgkmcnt(7)
    v_mfma_f32_16x16x32_bf16 v[120:123], v[76:79], v[108:111], v[120:123]
    ds_read_b64_tr_b16 v[46:47], v4 offset:3456
    v_mov_b64 v[52:53], s[98:99]
    v_mov_b64 v[54:55], s[98:99]
    v_mfma_f32_16x16x32_bf16 v[124:127], v[80:83], v[96:99], 0
    ds_read_b128 v[64:67], v11 offset:16384
    v_cvt_pk_bf16_f32 v12, v112, v113
    v_cvt_pk_bf16_f32 v14, v116, v117
    v_mfma_f32_16x16x32_bf16 v[124:127], v[84:87], v[100:103], v[124:127]
    ds_read_b128 v[68:71], v11 offset:17408
    v_mfma_f32_16x16x32_bf16 v[124:127], v[88:91], v[104:107], v[124:127]
    ds_read_b128 v[72:75], v11 offset:18432
    v_max3_f32 v26, v120, v121, v122
    v_mfma_f32_16x16x32_bf16 v[124:127], v[92:95], v[108:111], v[124:127]
    ds_read_b128 v[76:79], v11 offset:19456
    v_max_f32 v26, v26, v123
    s_waitcnt lgkmcnt(10)
    v_mfma_f32_16x16x32_bf16 v[48:51], v[32:35], v[96:99], 0
    ds_read_b128 v[80:83], v11 offset:20480
    s_waitcnt lgkmcnt(9)
    v_mfma_f32_16x16x32_bf16 v[48:51], v[36:39], v[100:103], v[48:51]
    ds_read_b128 v[84:87], v11 offset:21504
    v_max3_f32 v27, v124, v125, v126
    v_mov_b64 v[96:97], 0
    s_waitcnt lgkmcnt(8)
    v_mfma_f32_16x16x32_bf16 v[48:51], v[40:43], v[104:107], v[48:51]
    ds_read_b128 v[88:91], v11 offset:22528
    v_mov_b64 v[98:99], 0
    v_max3_f32 v26, v26, v127, v27
    s_waitcnt lgkmcnt(7)
    v_mfma_f32_16x16x32_bf16 v[48:51], v[44:47], v[108:111], v[48:51]
    ds_read_b128 v[92:95], v11 offset:23552
    v_mov_b64 v[100:101], 0
    v_mov_b64 v[102:103], 0
    v_mov_b64 v[104:105], 0
    v_mov_b64 v[106:107], 0
    v_mov_b64 v[108:109], 0
    v_mov_b64 v[110:111], 0
    s_nop 0
    v_max3_f32 v26, v26, v48, v49
    v_max3_f32 v26, v26, v50, v51
    v_cndmask_b32 v48, v48, v50, s[38:39]
    v_mov_b32 v27, v26
    v_cndmask_b32 v49, v49, v51, s[38:39]
    s_nop 0
    v_permlane16_swap_b32 v26, v27
    v_max_f32 v26, v26, v27
    v_mov_b32 v27, v26
    v_mov_b32 v61, 0
    s_nop 0
    v_permlane32_swap_b32 v26, v27
    v_max_f32 v26, v26, v27
    v_mul_f32 v28, s46, v26
    v_pk_fma_f32 v[120:121], v[120:121], s[96:97], v[28:29] op_sel_hi:[1,1,0] neg_lo:[0,0,1] neg_hi:[0,0,1]
    v_pk_fma_f32 v[122:123], v[122:123], s[96:97], v[28:29] op_sel_hi:[1,1,0] neg_lo:[0,0,1] neg_hi:[0,0,1]
    v_pk_fma_f32 v[124:125], v[124:125], s[96:97], v[28:29] op_sel_hi:[1,1,0] neg_lo:[0,0,1] neg_hi:[0,0,1]
    v_pk_fma_f32 v[126:127], v[126:127], s[96:97], v[28:29] op_sel_hi:[1,1,0] neg_lo:[0,0,1] neg_hi:[0,0,1]
    v_pk_fma_f32 v[48:49], v[48:49], s[96:97], v[28:29] op_sel_hi:[1,1,0] neg_lo:[0,0,1] neg_hi:[0,0,1]
    v_exp_f32 v120, v120
    v_exp_f32 v121, v121
    v_exp_f32 v122, v122
    v_exp_f32 v123, v123
    v_exp_f32 v124, v124
    v_exp_f32 v125, v125
    v_exp_f32 v126, v126
    v_exp_f32 v127, v127
    v_exp_f32 v48, v48
    v_exp_f32 v49, v49
    v_cvt_pk_bf16_f32 v56, v120, v121
    v_cvt_pk_bf16_f32 v57, v122, v123
    v_cvt_pk_bf16_f32 v58, v124, v125
    v_cvt_pk_bf16_f32 v59, v126, v127
    v_cvt_pk_bf16_f32 v60, v48, v49
    s_nop 0
    v_mfma_f32_16x16x32_bf16 v[26:29], v[52:55], v[56:59], 0
    v_mov_b64 v[120:121], 0
    v_mov_b64 v[122:123], 0
    v_mfma_f32_16x16x32_bf16 v[112:115], v[16:19], v[56:59], 0
    ds_read_b128 v[32:35], v11 offset:24576
    v_mov_b64 v[124:125], 0
    v_mfma_f32_16x16x32_bf16 v[116:119], v[20:23], v[56:59], 0
    ds_read_b128 v[36:39], v11 offset:25600
    buffer_load_dwordx4 v[16:19], v9, s[8:11], s30 offen
    v_mfma_f32_16x16x16_bf16 v[26:29], v[24:25], v[60:61], v[26:29]
    ds_read_b128 v[40:43], v11 offset:26624
    buffer_load_dwordx4 v[20:23], v9, s[8:11], s30 offen offset:256
    v_mfma_f32_16x16x16_bf16 v[112:115], v[12:13], v[60:61], v[112:115]
    ds_read_b128 v[44:47], v11 offset:27648
    v_mov_b64 v[126:127], 0
    v_mfma_f32_16x16x16_bf16 v[116:119], v[14:15], v[60:61], v[116:119]
    v_rcp_f32 v30, v26
    s_nop 2
    v_mul_f32 v112, v112, v30
    v_mul_f32 v113, v113, v30
    v_cvt_pk_bf16_f32 v56, v112, v113
    v_mul_f32 v114, v114, v30
    v_mul_f32 v115, v115, v30
    v_cvt_pk_bf16_f32 v57, v114, v115
    v_mul_f32 v116, v116, v30
    v_mul_f32 v117, v117, v30
    v_cvt_pk_bf16_f32 v58, v116, v117
    v_mul_f32 v118, v118, v30
    v_mul_f32 v119, v119, v30
    v_cvt_pk_bf16_f32 v59, v118, v119
    s_mov_b64 exec, s[36:37]
    ds_write_b128 v7, v[56:59] offset:12800
    s_mov_b64 exec, -1
    ds_read_b128 v[48:51], v11 offset:28672
    ds_read_b128 v[52:55], v11 offset:29696
    v_mov_b64 v[28:29], -1
    v_mov_b64 v[30:31], -1
    buffer_store_dwordx4 v[28:31], v0, s[8:11], s26 offen sc1
    s_waitcnt lgkmcnt(2)
    s_barrier
    ds_read_b128 v[56:59], v8 offset:0
    ds_read_b128 v[60:63], v8 offset:1024
    buffer_store_dwordx4 v[28:31], v0, s[8:11], s26 offen offset:1024 sc1
    s_waitcnt lgkmcnt(1)
    v_smfmac_f32_16x16x64_bf16 v[96:99], v[56:59], a[192:199], v10
    v_mov_b64 v[112:113], 0
    v_smfmac_f32_16x16x64_bf16 v[100:103], v[56:59], a[200:207], v10
    v_mov_b64 v[114:115], 0
    v_smfmac_f32_16x16x64_bf16 v[104:107], v[56:59], a[208:215], v10
    v_mov_b64 v[116:117], 0
    v_smfmac_f32_16x16x64_bf16 v[108:111], v[56:59], a[216:223], v10
    v_mov_b64 v[118:119], 0
    s_waitcnt lgkmcnt(0)
    v_smfmac_f32_16x16x64_bf16 v[96:99], v[60:63], v[64:71], v10
    v_smfmac_f32_16x16x64_bf16 v[100:103], v[60:63], v[72:79], v10
    ds_read_b128 v[64:67], v11 offset:30720
    v_smfmac_f32_16x16x64_bf16 v[104:107], v[60:63], v[80:87], v10
    ds_read_b128 v[68:71], v11 offset:31744
    v_smfmac_f32_16x16x64_bf16 v[108:111], v[60:63], v[88:95], v10
    v_add_f32 v96, v96, v98
    v_add_f32 v97, v97, v99
    v_cvt_pk_bf16_f32 v96, v96, v97
    v_smfmac_f32_16x16x64_bf16 v[112:115], v[56:59], a[224:231], v10
    v_add_f32 v100, v100, v102
    v_add_f32 v101, v101, v103
    v_cvt_pk_bf16_f32 v97, v100, v101
    v_smfmac_f32_16x16x64_bf16 v[116:119], v[56:59], a[232:239], v10
    v_add_f32 v104, v104, v106
    v_add_f32 v105, v105, v107
    v_cvt_pk_bf16_f32 v98, v104, v105
    v_smfmac_f32_16x16x64_bf16 v[120:123], v[56:59], a[240:247], v10
    v_add_f32 v108, v108, v110
    v_add_f32 v109, v109, v111
    v_cvt_pk_bf16_f32 v99, v108, v109
    v_smfmac_f32_16x16x64_bf16 v[124:127], v[56:59], a[248:255], v10
    buffer_store_dwordx4 v[96:99], v1, s[8:11], s23 offen sc1
    v_smfmac_f32_16x16x64_bf16 v[112:115], v[60:63], v[32:39], v10
    v_smfmac_f32_16x16x64_bf16 v[116:119], v[60:63], v[40:47], v10
    v_smfmac_f32_16x16x64_bf16 v[120:123], v[60:63], v[48:55], v10
    s_waitcnt lgkmcnt(0)
    v_smfmac_f32_16x16x64_bf16 v[124:127], v[60:63], v[64:71], v10
    v_add_f32 v112, v112, v114
    v_add_f32 v113, v113, v115
    v_cvt_pk_bf16_f32 v112, v112, v113
    v_add_f32 v116, v116, v118
    v_add_f32 v117, v117, v119
    v_cvt_pk_bf16_f32 v113, v116, v117
    v_add_f32 v120, v120, v122
    v_add_f32 v121, v121, v123
    v_cvt_pk_bf16_f32 v114, v120, v121
    v_add_f32 v124, v124, v126
    v_add_f32 v125, v125, v127
    v_cvt_pk_bf16_f32 v115, v124, v125
    buffer_store_dwordx4 v[112:115], v1, s[8:11], s25 offen sc1
    v_mov_b32 v26, 0x3f80
    v_mov_b32 v27, 0x3f800000
    v_cndmask_b32 v26, v26, v27, s[100:101]
    v_cndmask_b32 v108, 0, v26, s[48:49]
    v_cndmask_b32 v109, 0, v26, s[50:51]
    v_cndmask_b32 v110, 0, v26, s[52:53]
    v_cndmask_b32 v111, 0, v26, s[54:55]
    ds_read_b128 v[64:67], v11 offset:0
    ds_read_b128 v[68:71], v11 offset:1024
    ds_read_b128 v[72:75], v11 offset:2048
    ds_read_b128 v[76:79], v11 offset:3072
    ds_read_b128 v[80:83], v11 offset:4096
    ds_read_b128 v[84:87], v11 offset:5120
    ds_read_b128 v[88:91], v11 offset:6144
    ds_read_b128 v[92:95], v11 offset:7168
    v_mov_b64 v[112:113], 0
    v_mov_b64 v[114:115], 0
    v_mov_b64 v[116:117], 0
    v_mov_b64 v[118:119], 0
    v_mov_b64 v[120:121], 0
    v_mov_b64 v[122:123], 0
    v_mov_b64 v[124:125], 0
    v_mov_b64 v[126:127], 0
    v_mov_b64 v[28:29], -1
    v_mov_b64 v[30:31], -1
    s_mov_b32 s7, 0
    s_sleep 2
    buffer_load_dwordx4 v[96:99], v0, s[8:11], s24 offen sc1
    buffer_load_dwordx4 v[100:103], v0, s[8:11], s24 offen offset:1024 sc1
    s_sleep 3
    buffer_load_dwordx4 v[96:99], v0, s[8:11], s24 offen sc1
    buffer_load_dwordx4 v[100:103], v0, s[8:11], s24 offen offset:1024 sc1
    s_and_b32 s33, s5, 7
    s_cmp_eq_u32 s33, 6
    s_cbranch_scc0 L_nkv_1ms
    s_add_u32 s33, s5, 2
    s_lshr_b32 s33, s33, 3
    s_lshl_b32 s33, s33, 7
    s_add_u32 s33, s33, 262144
    v_mov_b32 v26, s33
    buffer_load_dword v27, v26, s[8:11], 0 offen sc1
    s_waitcnt vmcnt(0)
L_nkv_1ms:
L_p1w_1ms:
    s_waitcnt vmcnt(2)
    v_mfma_f32_16x16x32_bf16 v[104:107], v[108:111], v[96:99], 0
    v_mfma_f32_16x16x32_bf16 v[104:107], v[108:111], v[100:103], v[104:107]
    s_nop 7
    v_cmp_u_f32 vcc, v104, v104
    s_cbranch_vccnz L_p1r_1ms
L_p1d_1ms:
    v_add_f32_dpp v104, v104, v104 row_ror:8 row_mask:0xf bank_mask:0xf
    v_add_f32_dpp v105, v105, v105 row_ror:8 row_mask:0xf bank_mask:0xf
    v_add_f32_dpp v106, v106, v106 row_ror:8 row_mask:0xf bank_mask:0xf
    v_add_f32_dpp v107, v107, v107 row_ror:8 row_mask:0xf bank_mask:0xf
    v_add_f32_dpp v104, v104, v104 row_ror:4 row_mask:0xf bank_mask:0xf
    v_add_f32_dpp v105, v105, v105 row_ror:4 row_mask:0xf bank_mask:0xf
    v_add_f32_dpp v106, v106, v106 row_ror:4 row_mask:0xf bank_mask:0xf
    v_add_f32_dpp v107, v107, v107 row_ror:4 row_mask:0xf bank_mask:0xf
    v_cvt_pk_bf16_f32 v104, v104, v106
    v_cvt_pk_bf16_f32 v105, v105, v107
    s_mov_b64 exec, s[40:41]
    v_cndmask_b32 v104, v104, v105, s[42:43]
    v_min_u32 v104, -2, v104
    buffer_store_dword v104, v2, s[8:11], s21 offen sc1
    buffer_store_dword v28, v2, s[8:11], s20 offen sc1
    s_mov_b64 exec, -1
    s_add_u32 s47, s21, 2048
    s_mov_b32 s7, 0
    s_add_u32 s5, s5, 1
    s_and_b32 s33, s5, 7
    s_cmp_eq_u32 s33, 7
    s_cbranch_scc0 L_ckv_1ms
    s_cmp_ge_u32 s5, 57
    s_cbranch_scc1 L_ckv_1ms
L_ckvl_1ms:
    v_readfirstlane_b32 s33, v27
    s_and_b32 s33, s33, 0xff
    s_cmp_eq_u32 s33, 128
    s_cbranch_scc1 L_ckv_1ms
    s_add_u32 s7, s7, 1
    s_cmp_lt_u32 s7, 400000
    s_cbranch_scc0 L_ckv_1ms
    s_sleep 2
    buffer_load_dword v27, v26, s[8:11], 0 offen sc1
    s_waitcnt vmcnt(0)
    s_branch L_ckvl_1ms
L_ckv_1ms:
    s_mov_b32 s7, 0
    s_sleep 2
    s_mov_b32 m0, 2048
    s_nop 0
    buffer_load_dwordx4 v0, s[8:11], s47 offen sc1 lds
    buffer_load_dwordx4 v0, s[8:11], s47 offen offset:1024 sc1 lds
    s_mov_b32 s33, s20
    s_mov_b32 s20, s21
    s_mov_b32 s21, s22
    s_mov_b32 s22, s33
    s_xor_b32 s23, s23, 0x40000
    s_mov_b32 s26, s24
    s_xor_b32 s24, s24, 0x40000
    s_xor_b32 s25, s25, 0x40000
    s_add_u32 s28, s28, 0x40000
    s_xor_b32 s29, s29, 8192
    s_add_u32 s30, s30, 0x40000
    s_mov_b32 s62, s31
    s_mov_b32 s63, s32
    s_add_u32 s31, s31, 65536
    s_add_u32 s32, s32, 131072
    v_xor_b32 v5, 0x2000, v5
    v_xor_b32 v6, 0x2000, v6
    s_sleep 2
    s_mov_b32 m0, 2048
    s_nop 0
    buffer_load_dwordx4 v0, s[8:11], s47 offen sc1 lds
    buffer_load_dwordx4 v0, s[8:11], s47 offen offset:1024 sc1 lds
    v_mov_b64 v[104:105], -1
    v_mov_b64 v[106:107], -1
    s_cmp_lt_u32 s5, 63
    s_cbranch_scc1 L_step1s
    s_waitcnt vmcnt(2)
    ds_read_b128 v[40:43], v0 offset:2048
    ds_read_b128 v[44:47], v0 offset:3072
    s_waitcnt lgkmcnt(0)
    v_max3_u32 v26, v40, v41, v42
    v_max3_u32 v27, v43, v44, v45
    v_max3_u32 v26, v26, v46, v47
    v_max_u32 v26, v26, v27
    v_cmp_eq_u32 vcc, -1, v26
    s_cbranch_vccnz L_p2r_1ls
L_p2d_1ls:
    s_barrier
    ds_read_b128 v[56:59], v0 offset:6144
    ds_read_b128 v[60:63], v0 offset:7168
    ds_read_b128 v[32:35], v0 offset:0
    ds_read_b128 v[36:39], v0 offset:1024
    ds_read_b128 v[48:51], v0 offset:4096
    ds_read_b128 v[52:55], v0 offset:5120
    ds_read_b64_tr_b16 v[28:29], v4 offset:1280
    ds_read_b64_tr_b16 v[30:31], v4 offset:1408
    buffer_store_dwordx4 v[12:15], v0, s[8:11], s63 offen offset:1024 sc1
    s_waitcnt lgkmcnt(0)
    s_mov_b64 exec, s[36:37]
    buffer_store_dwordx4 v[28:31], v7, s[8:11], s62 offen offset:512 sc1
    s_mov_b64 exec, -1
    v_smfmac_f32_16x16x64_bf16 v[120:123], v[40:43], a[128:135], v10
    v_smfmac_f32_16x16x64_bf16 v[124:127], v[40:43], a[136:143], v10
    v_smfmac_f32_16x16x64_bf16 v[120:123], v[44:47], a[144:151], v10
    v_smfmac_f32_16x16x64_bf16 v[124:127], v[44:47], a[152:159], v10
    ds_read_b128 v[64:67], v11 offset:8192
    ds_read_b128 v[68:71], v11 offset:9216
    ds_read_b128 v[72:75], v11 offset:10240
    ds_read_b128 v[76:79], v11 offset:11264
    ds_read_b128 v[80:83], v11 offset:12288
    ds_read_b128 v[84:87], v11 offset:13312
    ds_read_b128 v[88:91], v11 offset:14336
    ds_read_b128 v[92:95], v11 offset:15360
    s_waitcnt lgkmcnt(4)
    v_smfmac_f32_16x16x64_bf16 v[120:123], v[56:59], v[64:71], v10
    v_smfmac_f32_16x16x64_bf16 v[124:127], v[56:59], v[72:79], v10
    v_smfmac_f32_16x16x64_bf16 v[120:123], v[32:35], a[96:103], v10
    v_smfmac_f32_16x16x64_bf16 v[124:127], v[32:35], a[104:111], v10
    s_waitcnt lgkmcnt(0)
    v_smfmac_f32_16x16x64_bf16 v[120:123], v[60:63], v[80:87], v10
    v_smfmac_f32_16x16x64_bf16 v[124:127], v[60:63], v[88:95], v10
    v_smfmac_f32_16x16x64_bf16 v[120:123], v[36:39], a[112:119], v10
    v_smfmac_f32_16x16x64_bf16 v[124:127], v[36:39], a[120:127], v10
    v_smfmac_f32_16x16x64_bf16 v[120:123], v[48:51], a[160:167], v10
    v_smfmac_f32_16x16x64_bf16 v[124:127], v[48:51], a[168:175], v10
    v_smfmac_f32_16x16x64_bf16 v[120:123], v[52:55], a[176:183], v10
    v_smfmac_f32_16x16x64_bf16 v[124:127], v[52:55], a[184:191], v10
    v_mov_b64 v[112:113], 0
    v_mov_b64 v[114:115], 0
    v_mov_b64 v[116:117], 0
    v_mov_b64 v[118:119], 0
    v_smfmac_f32_16x16x64_bf16 v[112:115], v[32:35], v[128:135], v10
    v_smfmac_f32_16x16x64_bf16 v[116:119], v[32:35], v[136:143], v10
    v_add_f32 v120, v120, v122
    v_add_f32 v121, v121, v123
    v_smfmac_f32_16x16x64_bf16 v[112:115], v[36:39], v[144:151], v10
    v_add_f32 v124, v124, v126
    v_add_f32 v125, v125, v127
    v_smfmac_f32_16x16x64_bf16 v[116:119], v[36:39], v[152:159], v10
    v_cvt_pk_bf16_f32 v120, v120, v121
    v_cvt_pk_bf16_f32 v124, v124, v125
    v_smfmac_f32_16x16x64_bf16 v[112:115], v[40:43], v[160:167], v10
    ds_write2_b32 v3, v120, v124 offset0:64 offset1:192
    v_smfmac_f32_16x16x64_bf16 v[116:119], v[40:43], v[168:175], v10
    v_smfmac_f32_16x16x64_bf16 v[112:115], v[44:47], v[176:183], v10
    v_smfmac_f32_16x16x64_bf16 v[116:119], v[44:47], v[184:191], v10
    v_smfmac_f32_16x16x64_bf16 v[112:115], v[48:51], v[192:199], v10
    s_waitcnt lgkmcnt(0)
    s_barrier
    v_smfmac_f32_16x16x64_bf16 v[116:119], v[48:51], v[200:207], v10
    v_smfmac_f32_16x16x64_bf16 v[112:115], v[52:55], v[208:215], v10
    v_smfmac_f32_16x16x64_bf16 v[116:119], v[52:55], v[216:223], v10
    v_smfmac_f32_16x16x64_bf16 v[112:115], v[56:59], v[224:231], v10
    v_smfmac_f32_16x16x64_bf16 v[116:119], v[56:59], v[232:239], v10
    v_smfmac_f32_16x16x64_bf16 v[112:115], v[60:63], v[240:247], v10
    v_smfmac_f32_16x16x64_bf16 v[116:119], v[60:63], v[248:255], v10
    ds_read_b64_tr_b16 v[32:33], v4 offset:256
    ds_read_b64_tr_b16 v[34:35], v4 offset:384
    ds_read_b64_tr_b16 v[36:37], v4 offset:1280
    ds_read_b64_tr_b16 v[38:39], v4 offset:1408
    ds_read_b64_tr_b16 v[40:41], v4 offset:2304
    ds_read_b64_tr_b16 v[42:43], v4 offset:2432
    ds_read_b64_tr_b16 v[44:45], v4 offset:3328
    ds_read_b64_tr_b16 v[46:47], v4 offset:3456
    v_pk_add_f32 v[112:113], v[112:113], v[114:115]
    v_pk_add_f32 v[116:117], v[116:117], v[118:119]
    v_cvt_pk_bf16_f32 v12, v112, v113
    v_cvt_pk_bf16_f32 v14, v116, v117
    buffer_store_dwordx4 v[12:15], v0, s[8:11], s32 offen offset:1024 sc1
    s_waitcnt lgkmcnt(0)
    s_mov_b64 exec, s[36:37]
    buffer_store_dwordx4 v[36:39], v7, s[8:11], s31 offen offset:512 sc1
    s_mov_b64 exec, -1
L_cfin1:
    s_waitcnt vmcnt(0)
    s_barrier
    s_memtime s[58:59]
    s_memrealtime s[76:77]
    s_waitcnt lgkmcnt(0)
    s_branch L_chain_end
L_p2r_1m:
    s_add_u32 s7, s7, 1
    s_cmp_lt_u32 s7, s6
    s_cbranch_scc0 L_p2r_1m_to
    s_mov_b32 m0, 2048
    s_nop 0
    buffer_load_dwordx4 v0, s[8:11], s47 offen sc1 lds
    buffer_load_dwordx4 v0, s[8:11], s47 offen offset:1024 sc1 lds
    s_waitcnt vmcnt(2)
    ds_read_b128 v[40:43], v0 offset:2048
    ds_read_b128 v[44:47], v0 offset:3072
    s_waitcnt lgkmcnt(0)
    v_max3_u32 v26, v40, v41, v42
    v_max3_u32 v27, v43, v44, v45
    v_max3_u32 v26, v26, v46, v47
    v_max_u32 v26, v26, v27
    v_cmp_eq_u32 vcc, -1, v26
    s_cbranch_vccnz L_p2r_1m
    s_branch L_p2d_1m
L_p2r_1m_to:
    s_mov_b32 s6, 0
    s_branch L_p2d_1m
L_p1r_1m:
    s_add_u32 s7, s7, 1
    s_cmp_lt_u32 s7, s6
    s_cbranch_scc0 L_p1r_1m_to
    buffer_load_dwordx4 v[96:99], v0, s[8:11], s24 offen sc1
    buffer_load_dwordx4 v[100:103], v0, s[8:11], s24 offen offset:1024 sc1
    s_branch L_p1w_1m
L_p1r_1m_to:
    s_mov_b32 s6, 0
    s_branch L_p1d_1m
L_p2r_1l:
    s_add_u32 s7, s7, 1
    s_cmp_lt_u32 s7, s6
    s_cbranch_scc0 L_p2r_1l_to
    s_mov_b32 m0, 2048
    s_nop 0
    buffer_load_dwordx4 v0, s[8:11], s47 offen sc1 lds
    buffer_load_dwordx4 v0, s[8:11], s47 offen offset:1024 sc1 lds
    s_waitcnt vmcnt(2)
    ds_read_b128 v[40:43], v0 offset:2048
    ds_read_b128 v[44:47], v0 offset:3072
    s_waitcnt lgkmcnt(0)
    v_max3_u32 v26, v40, v41, v42
    v_max3_u32 v27, v43, v44, v45
    v_max3_u32 v26, v26, v46, v47
    v_max_u32 v26, v26, v27
    v_cmp_eq_u32 vcc, -1, v26
    s_cbranch_vccnz L_p2r_1l
    s_branch L_p2d_1l
L_p2r_1l_to:
    s_mov_b32 s6, 0
    s_branch L_p2d_1l
L_p2r_1ms:
    s_add_u32 s7, s7, 1
    s_cmp_lt_u32 s7, s6
    s_cbranch_scc0 L_p2r_1ms_to
    s_mov_b32 m0, 2048
    s_nop 0
    buffer_load_dwordx4 v0, s[8:11], s47 offen sc1 lds
    buffer_load_dwordx4 v0, s[8:11], s47 offen offset:1024 sc1 lds
    s_waitcnt vmcnt(2)
    ds_read_b128 v[40:43], v0 offset:2048
    ds_read_b128 v[44:47], v0 offset:3072
    s_waitcnt lgkmcnt(0)
    v_max3_u32 v26, v40, v41, v42
    v_max3_u32 v27, v43, v44, v45
    v_max3_u32 v26, v26, v46, v47
    v_max_u32 v26, v26, v27
    v_cmp_eq_u32 vcc, -1, v26
    s_cbranch_vccnz L_p2r_1ms
    s_branch L_p2d_1ms
L_p2r_1ms_to:
    s_mov_b32 s6, 0
    s_branch L_p2d_1ms
L_p1r_1ms:
    s_add_u32 s7, s7, 1
    s_cmp_lt_u32 s7, s6
    s_cbranch_scc0 L_p1r_1ms_to
    buffer_load_dwordx4 v[96:99], v0, s[8:11], s24 offen sc1
    buffer_load_dwordx4 v[100:103], v0, s[8:11], s24 offen offset:1024 sc1
    s_branch L_p1w_1ms
L_p1r_1ms_to:
    s_mov_b32 s6, 0
    s_branch L_p1d_1ms
L_p2r_1ls:
    s_add_u32 s7, s7, 1
    s_cmp_lt_u32 s7, s6
    s_cbranch_scc0 L_p2r_1ls_to
    s_mov_b32 m0, 2048
    s_nop 0
    buffer_load_dwordx4 v0, s[8:11], s47 offen sc1 lds
    buffer_load_dwordx4 v0, s[8:11], s47 offen offset:1024 sc1 lds
    s_waitcnt vmcnt(2)
    ds_read_b128 v[40:43], v0 offset:2048
    ds_read_b128 v[44:47], v0 offset:3072
    s_waitcnt lgkmcnt(0)
    v_max3_u32 v26, v40, v41, v42
    v_max3_u32 v27, v43, v44, v45
    v_max3_u32 v26, v26, v46, v47
    v_max_u32 v26, v26, v27
    v_cmp_eq_u32 vcc, -1, v26
    s_cbranch_vccnz L_p2r_1ls
    s_branch L_p2d_1ls
L_p2r_1ls_to:
    s_mov_b32 s6, 0
    s_branch L_p2d_1ls
L_wave2:
    v_and_b32 v31, 63, v0
    v_lshlrev_b32 v0, 4, v31
    s_lshl_b32 s33, s3, 2
    s_add_u32 s33, s33, 2
    v_lshrrev_b32 v26, 2, v31
    v_lshlrev_b32 v26, 11, v26
    v_and_b32 v27, 3, v31
    v_lshlrev_b32 v27, 4, v27
    v_add_u32 v1, v26, v27
    s_lshr_b32 s34, s33, 4
    s_lshl_b32 s34, s34, 10
    s_and_b32 s35, s33, 3
    s_lshl_b32 s35, s35, 8
    s_add_u32 s34, s34, s35
    s_and_b32 s35, s33, 12
    s_lshl_b32 s35, s35, 4
    s_add_u32 s34, s34, s35
    v_bfe_u32 v26, v31, 4, 1
    v_lshlrev_b32 v26, 5, v26
    v_bfe_u32 v27, v31, 2, 1
    v_lshlrev_b32 v27, 4, v27
    v_and_b32 v28, 3, v31
    v_lshlrev_b32 v28, 2, v28
    v_add3_u32 v26, v26, v27, v28
    v_add_u32 v2, s34, v26
    v_and_b32 v26, 15, v31
    v_lshlrev_b32 v26, 4, v26
    v_lshrrev_b32 v27, 4, v31
    v_lshlrev_b32 v27, 2, v27
    v_add_u32 v26, v26, v27
    v_add_u32 v3, 10240, v26
    v_lshrrev_b32 v26, 5, v31
    v_lshlrev_b32 v26, 9, v26
    v_bfe_u32 v27, v31, 4, 1
    v_lshlrev_b32 v27, 6, v27
    v_bfe_u32 v28, v31, 2, 2
    v_lshlrev_b32 v28, 4, v28
    v_add3_u32 v26, v26, v27, v28
    v_bfe_u32 v27, v31, 1, 1
    v_lshlrev_b32 v27, 3, v27
    v_add_u32 v26, v26, v27
    v_add_u32 v4, 8192, v26
    v_lshrrev_b32 v26, 4, v31
    v_lshlrev_b32 v26, 9, v26
    v_and_b32 v27, 15, v31
    v_lshlrev_b32 v27, 4, v27
    v_add_u32 v26, v26, v27
    v_bfe_u32 v28, v31, 3, 1
    v_lshlrev_b32 v28, 8, v28
    v_add_u32 v5, v26, v28
    v_add_u32 v5, 16384, v5
    v_add_u32 v6, 16512, v26
    v_lshrrev_b32 v26, 4, v31
    v_lshlrev_b32 v26, 7, v26
    v_bfe_u32 v27, v31, 3, 1
    v_lshlrev_b32 v27, 6, v27
    v_and_b32 v28, 3, v31
    v_lshlrev_b32 v28, 4, v28
    v_add3_u32 v7, v26, v27, v28
    v_lshrrev_b32 v26, 4, v31
    v_lshlrev_b32 v26, 8, v26
    v_bfe_u32 v27, v31, 1, 1
    v_lshlrev_b32 v27, 7, v27
    v_bfe_u32 v28, v31, 2, 2
    v_lshlrev_b32 v28, 5, v28
    v_add3_u32 v26, v26, v27, v28
    v_and_b32 v27, 1, v31
    v_lshlrev_b32 v27, 4, v27
    v_add_u32 v26, v26, v27
    v_add_u32 v8, 12288, v26
    v_lshrrev_b32 v26, 5, v31
    v_lshlrev_b32 v26, 10, v26
    v_bfe_u32 v27, v31, 4, 1
    v_lshlrev_b32 v27, 9, v27
    v_and_b32 v28, 15, v31
    v_lshlrev_b32 v28, 4, v28
    v_add3_u32 v9, v26, v27, v28
    v_bfe_u32 v26, v31, 1, 1
    v_mov_b32 v27, 0x4444
    v_mov_b32 v28, 0xeeee
    v_cmp_eq_u32 vcc, 1, v26
    s_nop 1
    v_cndmask_b32 v10, v27, v28, vcc
    v_add_u32 v11, 98304, v0
    v_mov_b32 v13, 0
    v_mov_b32 v15, 0
    v_mov_b32 v24, 0x3f803f80
    v_mov_b32 v25, 0
    v_bfe_u32 v26, v31, 1, 3
    v_cmp_eq_u32 s[48:49], 0, v26
    v_cmp_eq_u32 s[50:51], 1, v26
    v_cmp_eq_u32 s[52:53], 2, v26
    v_cmp_eq_u32 s[54:55], 3, v26
    s_mov_b32 s36, 0x0f0f0f0f
    s_mov_b32 s37, 0x0f0f0f0f
    s_mov_b32 s38, 0xffff0000
    s_mov_b32 s39, 0xffff0000
    s_mov_b32 s40, 0x00ff00ff
    s_mov_b32 s41, 0
    s_mov_b32 s42, 0xf0f0f0f0
    s_mov_b32 s43, 0xf0f0f0f0
    s_mov_b32 s46, 0x3e0293ee
    v_lshrrev_b32 v26, 4, v31
    v_bfe_u32 v27, v31, 1, 3
    v_add_u32 v28, 0, v26
    v_xor_b32 v27, v27, v28
    v_lshlrev_b32 v27, 5, v27
    v_and_b32 v28, 1, v31
    v_lshlrev_b32 v28, 4, v28
    v_add_u32 v27, v27, v28
    v_and_b32 v28, 1, v26
    v_lshlrev_b32 v28, 17, v28
    v_add_u32 v96, v27, v28
    v_lshrrev_b32 v28, 1, v26
    v_lshlrev_b32 v28, 18, v28
    v_add_u32 v96, v96, v28
    v_and_b32 v28, 1, v26
    v_lshlrev_b32 v28, 10, v28
    v_add_u32 v98, v27, v28
    v_lshrrev_b32 v28, 1, v26
    v_lshlrev_b32 v28, 12, v28
    v_add_u32 v98, v98, v28
    v_lshrrev_b32 v26, 4, v31
    v_bfe_u32 v27, v31, 1, 3
    v_add_u32 v28, 4, v26
    v_xor_b32 v27, v27, v28
    v_lshlrev_b32 v27, 5, v27
    v_and_b32 v28, 1, v31
    v_lshlrev_b32 v28, 4, v28
    v_add_u32 v27, v27, v28
    v_and_b32 v28, 1, v26
    v_lshlrev_b32 v28, 17, v28
    v_add_u32 v97, v27, v28
    v_lshrrev_b32 v28, 1, v26
    v_lshlrev_b32 v28, 18, v28
    v_add_u32 v97, v97, v28
    v_and_b32 v28, 1, v26
    v_lshlrev_b32 v28, 10, v28
    v_add_u32 v99, v27, v28
    v_lshrrev_b32 v28, 1, v26
    v_lshlrev_b32 v28, 12, v28
    v_add_u32 v99, v99, v28
    v_lshrrev_b32 v26, 2, v31
    v_lshlrev_b32 v27, 8, v26
    v_and_b32 v26, 7, v26
    v_lshlrev_b32 v26, 5, v26
    v_and_b32 v28, 3, v31
    v_lshlrev_b32 v28, 3, v28
    v_add3_u32 v26, v26, v27, v28
    v_add_u32 v104, 32768, v26
    v_xor_b32 v100, 128, v104
    v_xor_b32 v101, 32, v100
    v_add_u32 v102, 0x10000, v100
    v_add_u32 v103, 0x10000, v101
    s_lshl_b32 s60, s3, 8
    s_add_u32 s60, s60, 65536
    s_lshl_b32 s61, s3, 17
    s_add_u32 s61, s61, 32768
    v_add_u32 v107, 0xffff8000, v100
    v_add_u32 v108, 0xffff8000, v101
    s_mov_b32 m0, 40960
    s_add_u32 s34, s60, 0
    buffer_load_dwordx4 v96, s[84:87], s34 offen lds
    s_mov_b32 m0, 41984
    s_add_u32 s34, s60, 16384
    buffer_load_dwordx4 v97, s[84:87], s34 offen lds
    s_mov_b32 m0, 43008
    s_add_u32 s34, s60, 32768
    buffer_load_dwordx4 v96, s[84:87], s34 offen lds
    s_mov_b32 m0, 44032
    s_add_u32 s34, s60, 49152
    buffer_load_dwordx4 v97, s[84:87], s34 offen lds
    s_mov_b32 m0, 57344
    s_add_u32 s34, s60, 524288
    buffer_load_dwordx4 v96, s[84:87], s34 offen lds
    s_mov_b32 m0, 58368
    s_add_u32 s34, s60, 540672
    buffer_load_dwordx4 v97, s[84:87], s34 offen lds
    s_mov_b32 m0, 59392
    s_add_u32 s34, s60, 557056
    buffer_load_dwordx4 v96, s[84:87], s34 offen lds
    s_mov_b32 m0, 60416
    s_add_u32 s34, s60, 573440
    buffer_load_dwordx4 v97, s[84:87], s34 offen lds
    s_mov_b32 m0, 73728
    s_add_u32 s34, s60, 1048576
    buffer_load_dwordx4 v96, s[84:87], s34 offen lds
    s_mov_b32 m0, 74752
    s_add_u32 s34, s60, 1064960
    buffer_load_dwordx4 v97, s[84:87], s34 offen lds
    s_mov_b32 m0, 75776
    s_add_u32 s34, s60, 1081344
    buffer_load_dwordx4 v96, s[84:87], s34 offen lds
    s_mov_b32 m0, 76800
    s_add_u32 s34, s60, 1097728
    buffer_load_dwordx4 v97, s[84:87], s34 offen lds
    s_mov_b32 m0, 90112
    s_add_u32 s34, s60, 1572864
    buffer_load_dwordx4 v96, s[84:87], s34 offen lds
    s_mov_b32 m0, 91136
    s_add_u32 s34, s60, 1589248
    buffer_load_dwordx4 v97, s[84:87], s34 offen lds
    s_mov_b32 m0, 92160
    s_add_u32 s34, s60, 1605632
    buffer_load_dwordx4 v96, s[84:87], s34 offen lds
    s_mov_b32 m0, 93184
    s_add_u32 s34, s60, 1622016
    buffer_load_dwordx4 v97, s[84:87], s34 offen lds
    s_mov_b32 m0, 106496
    s_add_u32 s34, s60, 2097152
    buffer_load_dwordx4 v96, s[84:87], s34 offen lds
    s_mov_b32 m0, 107520
    s_add_u32 s34, s60, 2113536
    buffer_load_dwordx4 v97, s[84:87], s34 offen lds
    s_mov_b32 m0, 108544
    s_add_u32 s34, s60, 2129920
    buffer_load_dwordx4 v96, s[84:87], s34 offen lds
    s_mov_b32 m0, 109568
    s_add_u32 s34, s60, 2146304
    buffer_load_dwordx4 v97, s[84:87], s34 offen lds
    s_mov_b32 m0, 122880
    s_add_u32 s34, s60, 2621440
    buffer_load_dwordx4 v96, s[84:87], s34 offen lds
    s_mov_b32 m0, 123904
    s_add_u32 s34, s60, 2637824
    buffer_load_dwordx4 v97, s[84:87], s34 offen lds
    s_mov_b32 m0, 124928
    s_add_u32 s34, s60, 2654208
    buffer_load_dwordx4 v96, s[84:87], s34 offen lds
    s_mov_b32 m0, 125952
    s_add_u32 s34, s60, 2670592
    buffer_load_dwordx4 v97, s[84:87], s34 offen lds
    s_mov_b32 m0, 139264
    s_add_u32 s34, s60, 0
    buffer_load_dwordx4 v96, s[88:91], s34 offen lds
    s_mov_b32 m0, 140288
    s_add_u32 s34, s60, 16384
    buffer_load_dwordx4 v97, s[88:91], s34 offen lds
    s_mov_b32 m0, 141312
    s_add_u32 s34, s60, 32768
    buffer_load_dwordx4 v96, s[88:91], s34 offen lds
    s_mov_b32 m0, 142336
    s_add_u32 s34, s60, 49152
    buffer_load_dwordx4 v97, s[88:91], s34 offen lds
    s_mov_b32 m0, 155648
    s_add_u32 s34, s60, 524288
    buffer_load_dwordx4 v96, s[88:91], s34 offen lds
    s_mov_b32 m0, 156672
    s_add_u32 s34, s60, 540672
    buffer_load_dwordx4 v97, s[88:91], s34 offen lds
    s_mov_b32 m0, 157696
    s_add_u32 s34, s60, 557056
    buffer_load_dwordx4 v96, s[88:91], s34 offen lds
    s_mov_b32 m0, 158720
    s_add_u32 s34, s60, 573440
    buffer_load_dwordx4 v97, s[88:91], s34 offen lds
    s_mov_b32 m0, 8192
    s_add_u32 s34, s60, 1048576
    buffer_load_dwordx4 v96, s[88:91], s34 offen lds
    s_mov_b32 m0, 9216
    s_add_u32 s34, s60, 1064960
    buffer_load_dwordx4 v97, s[88:91], s34 offen lds
    s_mov_b32 m0, 10240
    s_add_u32 s34, s60, 1081344
    buffer_load_dwordx4 v96, s[88:91], s34 offen lds
    s_mov_b32 m0, 11264
    s_add_u32 s34, s60, 1097728
    buffer_load_dwordx4 v97, s[88:91], s34 offen lds
    s_mov_b32 m0, 24576
    s_add_u32 s34, s60, 1572864
    buffer_load_dwordx4 v96, s[88:91], s34 offen lds
    s_mov_b32 m0, 25600
    s_add_u32 s34, s60, 1589248
    buffer_load_dwordx4 v97, s[88:91], s34 offen lds
    s_mov_b32 m0, 26624
    s_add_u32 s34, s60, 1605632
    buffer_load_dwordx4 v96, s[88:91], s34 offen lds
    s_mov_b32 m0, 27648
    s_add_u32 s34, s60, 1622016
    buffer_load_dwordx4 v97, s[88:91], s34 offen lds
    s_cmp_lg_u32 s3, 0
    s_cbranch_scc1 L_nofi_2
    v_mov_b64 v[64:65], 0
    v_mov_b64 v[66:67], 0
    s_mov_b32 s33, 270336
    buffer_store_dwordx4 v[64:67], v0, s[8:11], s33 offen offset:0 sc1
    buffer_store_dwordx4 v[64:67], v0, s[8:11], s33 offen offset:1024 sc1
    buffer_store_dwordx4 v[64:67], v0, s[8:11], s33 offen offset:2048 sc1
    buffer_store_dwordx4 v[64:67], v0, s[8:11], s33 offen offset:3072 sc1
L_nofi_2:
    s_nop 1
    v_mov_b32 v64, -1
    v_mov_b32 v65, -1
    v_mov_b32 v66, -1
    v_mov_b32 v67, -1
    s_lshl_b32 s33, s3, 13
    s_add_u32 s33, s33, 1052672
    buffer_store_dwordx4 v[64:67], v0, s[8:11], s33 offen sc1
    buffer_store_dwordx4 v[64:67], v0, s[8:11], s33 offen offset:1024 sc1
    s_add_u32 s33, s33, 262144
    buffer_store_dwordx4 v[64:67], v0, s[8:11], s33 offen sc1
    buffer_store_dwordx4 v[64:67], v0, s[8:11], s33 offen offset:1024 sc1
    s_lshl_b32 s33, s3, 2
    s_add_u32 s33, s33, 2
    s_lshr_b32 s34, s33, 4
    s_lshl_b32 s34, s34, 7
    s_and_b32 s35, s33, 3
    s_lshl_b32 s35, s35, 3
    s_add_u32 s34, s34, s35
    s_bfe_u32 s35, s33, 0x20002
    s_lshl_b32 s35, s35, 11
    s_add_u32 s34, s34, s35
    v_bfe_u32 v68, v31, 4, 1
    v_lshlrev_b32 v68, 6, v68
    v_bfe_u32 v69, v31, 2, 1
    v_lshlrev_b32 v69, 10, v69
    v_and_b32 v70, 3, v31
    v_lshlrev_b32 v70, 1, v70
    v_add3_u32 v68, v68, v69, v70
    v_add_u32 v68, s34, v68
    buffer_load_ushort v69, v68, s[12:15], 0 offen
    buffer_load_ushort v70, v68, s[12:15], 0 offen offset:32
    s_waitcnt vmcnt(0)
    v_lshl_or_b32 v69, v70, 16, v69
    v_min_u32 v69, -2, v69
    s_mov_b64 exec, s[40:41]
    s_mov_b32 s33, 1572864
    buffer_store_dword v69, v2, s[8:11], s33 offen sc1
    s_mov_b32 s33, 1581056
    buffer_store_dword v64, v2, s[8:11], s33 offen sc1
    s_mov_b32 s33, 1589248
    buffer_store_dword v64, v2, s[8:11], s33 offen sc1
    s_mov_b64 exec, -1
    s_waitcnt vmcnt(0)
    s_barrier
    s_waitcnt vmcnt(36) lgkmcnt(0)
    s_barrier
    ds_read_b64_tr_b16 a[0:1], v100 offset:0
    ds_read_b64_tr_b16 a[2:3], v100 offset:4096
    ds_read_b64_tr_b16 a[4:5], v100 offset:8192
    ds_read_b64_tr_b16 a[6:7], v100 offset:12288
    ds_read_b64_tr_b16 a[8:9], v101 offset:0
    ds_read_b64_tr_b16 a[10:11], v101 offset:4096
    ds_read_b64_tr_b16 a[12:13], v101 offset:8192
    ds_read_b64_tr_b16 a[14:15], v101 offset:12288
    s_waitcnt vmcnt(32) lgkmcnt(0)
    s_barrier
    ds_read_b64_tr_b16 a[16:17], v100 offset:16384
    ds_read_b64_tr_b16 a[18:19], v100 offset:20480
    ds_read_b64_tr_b16 a[20:21], v100 offset:24576
    ds_read_b64_tr_b16 a[22:23], v100 offset:28672
    ds_read_b64_tr_b16 a[24:25], v101 offset:16384
    ds_read_b64_tr_b16 a[26:27], v101 offset:20480
    ds_read_b64_tr_b16 a[28:29], v101 offset:24576
    ds_read_b64_tr_b16 a[30:31], v101 offset:28672
    s_mov_b32 m0, 40960
    s_add_u32 s34, s60, 2097152
    buffer_load_dwordx4 v96, s[88:91], s34 offen lds
    s_mov_b32 m0, 41984
    s_add_u32 s34, s60, 2113536
    buffer_load_dwordx4 v97, s[88:91], s34 offen lds
    s_mov_b32 m0, 43008
    s_add_u32 s34, s60, 2129920
    buffer_load_dwordx4 v96, s[88:91], s34 offen lds
    s_mov_b32 m0, 44032
    s_add_u32 s34, s60, 2146304
    buffer_load_dwordx4 v97, s[88:91], s34 offen lds
    s_waitcnt vmcnt(32) lgkmcnt(0)
    s_barrier
    ds_read_b64_tr_b16 a[32:33], v100 offset:32768
    ds_read_b64_tr_b16 a[34:35], v100 offset:36864
    ds_read_b64_tr_b16 a[36:37], v100 offset:40960
    ds_read_b64_tr_b16 a[38:39], v100 offset:45056
    ds_read_b64_tr_b16 a[40:41], v101 offset:32768
    ds_read_b64_tr_b16 a[42:43], v101 offset:36864
    ds_read_b64_tr_b16 a[44:45], v101 offset:40960
    ds_read_b64_tr_b16 a[46:47], v101 offset:45056
    s_mov_b32 m0, 57344
    s_add_u32 s34, s60, 2621440
    buffer_load_dwordx4 v96, s[88:91], s34 offen lds
    s_mov_b32 m0, 58368
    s_add_u32 s34, s60, 2637824
    buffer_load_dwordx4 v97, s[88:91], s34 offen lds
    s_mov_b32 m0, 59392
    s_add_u32 s34, s60, 2654208
    buffer_load_dwordx4 v96, s[88:91], s34 offen lds
    s_mov_b32 m0, 60416
    s_add_u32 s34, s60, 2670592
    buffer_load_dwordx4 v97, s[88:91], s34 offen lds
    s_waitcnt vmcnt(32) lgkmcnt(0)
    s_barrier
    ds_read_b64_tr_b16 a[48:49], v100 offset:49152
    ds_read_b64_tr_b16 a[50:51], v100 offset:53248
    ds_read_b64_tr_b16 a[52:53], v100 offset:57344
    ds_read_b64_tr_b16 a[54:55], v100 offset:61440
    ds_read_b64_tr_b16 a[56:57], v101 offset:49152
    ds_read_b64_tr_b16 a[58:59], v101 offset:53248
    ds_read_b64_tr_b16 a[60:61], v101 offset:57344
    ds_read_b64_tr_b16 a[62:63], v101 offset:61440
    s_mov_b32 m0, 73728
    s_add_u32 s34, s60, 0
    buffer_load_dwordx4 v96, s[92:95], s34 offen lds
    s_mov_b32 m0, 74752
    s_add_u32 s34, s60, 16384
    buffer_load_dwordx4 v97, s[92:95], s34 offen lds
    s_mov_b32 m0, 75776
    s_add_u32 s34, s60, 32768
    buffer_load_dwordx4 v96, s[92:95], s34 offen lds
    s_mov_b32 m0, 76800
    s_add_u32 s34, s60, 49152
    buffer_load_dwordx4 v97, s[92:95], s34 offen lds
    s_waitcnt vmcnt(32) lgkmcnt(0)
    s_barrier
    ds_read_b64_tr_b16 a[64:65], v102 offset:0
    ds_read_b64_tr_b16 a[66:67], v102 offset:4096
    ds_read_b64_tr_b16 a[68:69], v102 offset:8192
    ds_read_b64_tr_b16 a[70:71], v102 offset:12288
    ds_read_b64_tr_b16 a[72:73], v103 offset:0
    ds_read_b64_tr_b16 a[74:75], v103 offset:4096
    ds_read_b64_tr_b16 a[76:77], v103 offset:8192
    ds_read_b64_tr_b16 a[78:79], v103 offset:12288
    s_mov_b32 m0, 90112
    s_add_u32 s34, s60, 524288
    buffer_load_dwordx4 v96, s[92:95], s34 offen lds
    s_mov_b32 m0, 91136
    s_add_u32 s34, s60, 540672
    buffer_load_dwordx4 v97, s[92:95], s34 offen lds
    s_mov_b32 m0, 92160
    s_add_u32 s34, s60, 557056
    buffer_load_dwordx4 v96, s[92:95], s34 offen lds
    s_mov_b32 m0, 93184
    s_add_u32 s34, s60, 573440
    buffer_load_dwordx4 v97, s[92:95], s34 offen lds
    s_waitcnt vmcnt(32) lgkmcnt(0)
    s_barrier
    ds_read_b64_tr_b16 a[80:81], v102 offset:16384
    ds_read_b64_tr_b16 a[82:83], v102 offset:20480
    ds_read_b64_tr_b16 a[84:85], v102 offset:24576
    ds_read_b64_tr_b16 a[86:87], v102 offset:28672
    ds_read_b64_tr_b16 a[88:89], v103 offset:16384
    ds_read_b64_tr_b16 a[90:91], v103 offset:20480
    ds_read_b64_tr_b16 a[92:93], v103 offset:24576
    ds_read_b64_tr_b16 a[94:95], v103 offset:28672
    s_mov_b32 m0, 106496
    s_add_u32 s34, s60, 1048576
    buffer_load_dwordx4 v96, s[92:95], s34 offen lds
    s_mov_b32 m0, 107520
    s_add_u32 s34, s60, 1064960
    buffer_load_dwordx4 v97, s[92:95], s34 offen lds
    s_mov_b32 m0, 108544
    s_add_u32 s34, s60, 1081344
    buffer_load_dwordx4 v96, s[92:95], s34 offen lds
    s_mov_b32 m0, 109568
    s_add_u32 s34, s60, 1097728
    buffer_load_dwordx4 v97, s[92:95], s34 offen lds
    s_waitcnt vmcnt(32) lgkmcnt(0)
    s_barrier
    ds_read_b64_tr_b16 a[96:97], v102 offset:32768
    ds_read_b64_tr_b16 a[98:99], v102 offset:36864
    ds_read_b64_tr_b16 a[100:101], v102 offset:40960
    ds_read_b64_tr_b16 a[102:103], v102 offset:45056
    ds_read_b64_tr_b16 a[104:105], v103 offset:32768
    ds_read_b64_tr_b16 a[106:107], v103 offset:36864
    ds_read_b64_tr_b16 a[108:109], v103 offset:40960
    ds_read_b64_tr_b16 a[110:111], v103 offset:45056
    s_mov_b32 m0, 122880
    s_add_u32 s34, s60, 1572864
    buffer_load_dwordx4 v96, s[92:95], s34 offen lds
    s_mov_b32 m0, 123904
    s_add_u32 s34, s60, 1589248
    buffer_load_dwordx4 v97, s[92:95], s34 offen lds
    s_mov_b32 m0, 124928
    s_add_u32 s34, s60, 1605632
    buffer_load_dwordx4 v96, s[92:95], s34 offen lds
    s_mov_b32 m0, 125952
    s_add_u32 s34, s60, 1622016
    buffer_load_dwordx4 v97, s[92:95], s34 offen lds
    s_waitcnt vmcnt(32) lgkmcnt(0)
    s_barrier
    ds_read_b64_tr_b16 a[112:113], v102 offset:49152
    ds_read_b64_tr_b16 a[114:115], v102 offset:53248
    ds_read_b64_tr_b16 a[116:117], v102 offset:57344
    ds_read_b64_tr_b16 a[118:119], v102 offset:61440
    ds_read_b64_tr_b16 a[120:121], v103 offset:49152
    ds_read_b64_tr_b16 a[122:123], v103 offset:53248
    ds_read_b64_tr_b16 a[124:125], v103 offset:57344
    ds_read_b64_tr_b16 a[126:127], v103 offset:61440
    s_mov_b32 m0, 139264
    s_add_u32 s34, s60, 2097152
    buffer_load_dwordx4 v96, s[92:95], s34 offen lds
    s_mov_b32 m0, 140288
    s_add_u32 s34, s60, 2113536
    buffer_load_dwordx4 v97, s[92:95], s34 offen lds
    s_mov_b32 m0, 141312
    s_add_u32 s34, s60, 2129920
    buffer_load_dwordx4 v96, s[92:95], s34 offen lds
    s_mov_b32 m0, 142336
    s_add_u32 s34, s60, 2146304
    buffer_load_dwordx4 v97, s[92:95], s34 offen lds
    s_waitcnt vmcnt(32) lgkmcnt(0)
    s_barrier
    ds_read_b64_tr_b16 a[128:129], v107 offset:0
    ds_read_b64_tr_b16 a[130:131], v107 offset:4096
    ds_read_b64_tr_b16 a[132:133], v107 offset:8192
    ds_read_b64_tr_b16 a[134:135], v107 offset:12288
    ds_read_b64_tr_b16 a[136:137], v108 offset:0
    ds_read_b64_tr_b16 a[138:139], v108 offset:4096
    ds_read_b64_tr_b16 a[140:141], v108 offset:8192
    ds_read_b64_tr_b16 a[142:143], v108 offset:12288
    s_mov_b32 m0, 155648
    s_add_u32 s34, s60, 2621440
    buffer_load_dwordx4 v96, s[92:95], s34 offen lds
    s_mov_b32 m0, 156672
    s_add_u32 s34, s60, 2637824
    buffer_load_dwordx4 v97, s[92:95], s34 offen lds
    s_mov_b32 m0, 157696
    s_add_u32 s34, s60, 2654208
    buffer_load_dwordx4 v96, s[92:95], s34 offen lds
    s_mov_b32 m0, 158720
    s_add_u32 s34, s60, 2670592
    buffer_load_dwordx4 v97, s[92:95], s34 offen lds
    s_waitcnt vmcnt(32) lgkmcnt(0)
    s_barrier
    ds_read_b64_tr_b16 a[144:145], v107 offset:16384
    ds_read_b64_tr_b16 a[146:147], v107 offset:20480
    ds_read_b64_tr_b16 a[148:149], v107 offset:24576
    ds_read_b64_tr_b16 a[150:151], v107 offset:28672
    ds_read_b64_tr_b16 a[152:153], v108 offset:16384
    ds_read_b64_tr_b16 a[154:155], v108 offset:20480
    ds_read_b64_tr_b16 a[156:157], v108 offset:24576
    ds_read_b64_tr_b16 a[158:159], v108 offset:28672
    s_mov_b32 m0, 8192
    s_add_u32 s34, s60, 3145728
    buffer_load_dwordx4 v96, s[92:95], s34 offen lds
    s_mov_b32 m0, 9216
    s_add_u32 s34, s60, 3162112
    buffer_load_dwordx4 v97, s[92:95], s34 offen lds
    s_mov_b32 m0, 10240
    s_add_u32 s34, s60, 3178496
    buffer_load_dwordx4 v96, s[92:95], s34 offen lds
    s_mov_b32 m0, 11264
    s_add_u32 s34, s60, 3194880
    buffer_load_dwordx4 v97, s[92:95], s34 offen lds
    s_waitcnt vmcnt(32) lgkmcnt(0)
    s_barrier
    ds_read_b64_tr_b16 a[160:161], v100 offset:0
    ds_read_b64_tr_b16 a[162:163], v100 offset:4096
    ds_read_b64_tr_b16 a[164:165], v100 offset:8192
    ds_read_b64_tr_b16 a[166:167], v100 offset:12288
    ds_read_b64_tr_b16 a[168:169], v101 offset:0
    ds_read_b64_tr_b16 a[170:171], v101 offset:4096
    ds_read_b64_tr_b16 a[172:173], v101 offset:8192
    ds_read_b64_tr_b16 a[174:175], v101 offset:12288
    s_mov_b32 m0, 24576
    s_add_u32 s34, s60, 3670016
    buffer_load_dwordx4 v96, s[92:95], s34 offen lds
    s_mov_b32 m0, 25600
    s_add_u32 s34, s60, 3686400
    buffer_load_dwordx4 v97, s[92:95], s34 offen lds
    s_mov_b32 m0, 26624
    s_add_u32 s34, s60, 3702784
    buffer_load_dwordx4 v96, s[92:95], s34 offen lds
    s_mov_b32 m0, 27648
    s_add_u32 s34, s60, 3719168
    buffer_load_dwordx4 v97, s[92:95], s34 offen lds
    s_waitcnt vmcnt(32) lgkmcnt(0)
    s_barrier
    ds_read_b64_tr_b16 a[176:177], v100 offset:16384
    ds_read_b64_tr_b16 a[178:179], v100 offset:20480
    ds_read_b64_tr_b16 a[180:181], v100 offset:24576
    ds_read_b64_tr_b16 a[182:183], v100 offset:28672
    ds_read_b64_tr_b16 a[184:185], v101 offset:16384
    ds_read_b64_tr_b16 a[186:187], v101 offset:20480
    ds_read_b64_tr_b16 a[188:189], v101 offset:24576
    ds_read_b64_tr_b16 a[190:191], v101 offset:28672
    s_mov_b32 m0, 40960
    s_add_u32 s34, s61, 0
    buffer_load_dwordx4 v98, s[96:99], s34 offen lds
    s_mov_b32 m0, 41984
    s_add_u32 s34, s61, 16384
    buffer_load_dwordx4 v99, s[96:99], s34 offen lds
    s_mov_b32 m0, 43008
    s_add_u32 s34, s61, 8192
    buffer_load_dwordx4 v98, s[96:99], s34 offen lds
    s_mov_b32 m0, 44032
    s_add_u32 s34, s61, 24576
    buffer_load_dwordx4 v99, s[96:99], s34 offen lds
    s_waitcnt vmcnt(32) lgkmcnt(0)
    s_barrier
    ds_read_b64_tr_b16 v[128:129], v100 offset:32768
    ds_read_b64_tr_b16 v[130:131], v100 offset:36864
    ds_read_b64_tr_b16 v[132:133], v100 offset:40960
    ds_read_b64_tr_b16 v[134:135], v100 offset:45056
    ds_read_b64_tr_b16 v[136:137], v101 offset:32768
    ds_read_b64_tr_b16 v[138:139], v101 offset:36864
    ds_read_b64_tr_b16 v[140:141], v101 offset:40960
    ds_read_b64_tr_b16 v[142:143], v101 offset:45056
    s_mov_b32 m0, 57344
    s_add_u32 s34, s61, 256
    buffer_load_dwordx4 v98, s[96:99], s34 offen lds
    s_mov_b32 m0, 58368
    s_add_u32 s34, s61, 16640
    buffer_load_dwordx4 v99, s[96:99], s34 offen lds
    s_mov_b32 m0, 59392
    s_add_u32 s34, s61, 8448
    buffer_load_dwordx4 v98, s[96:99], s34 offen lds
    s_mov_b32 m0, 60416
    s_add_u32 s34, s61, 24832
    buffer_load_dwordx4 v99, s[96:99], s34 offen lds
    s_waitcnt vmcnt(32) lgkmcnt(0)
    s_barrier
    ds_read_b64_tr_b16 v[144:145], v100 offset:49152
    ds_read_b64_tr_b16 v[146:147], v100 offset:53248
    ds_read_b64_tr_b16 v[148:149], v100 offset:57344
    ds_read_b64_tr_b16 v[150:151], v100 offset:61440
    ds_read_b64_tr_b16 v[152:153], v101 offset:49152
    ds_read_b64_tr_b16 v[154:155], v101 offset:53248
    ds_read_b64_tr_b16 v[156:157], v101 offset:57344
    ds_read_b64_tr_b16 v[158:159], v101 offset:61440
    s_mov_b32 m0, 73728
    s_add_u32 s34, s61, 512
    buffer_load_dwordx4 v98, s[96:99], s34 offen lds
    s_mov_b32 m0, 74752
    s_add_u32 s34, s61, 16896
    buffer_load_dwordx4 v99, s[96:99], s34 offen lds
    s_mov_b32 m0, 75776
    s_add_u32 s34, s61, 8704
    buffer_load_dwordx4 v98, s[96:99], s34 offen lds
    s_mov_b32 m0, 76800
    s_add_u32 s34, s61, 25088
    buffer_load_dwordx4 v99, s[96:99], s34 offen lds
    s_waitcnt vmcnt(32) lgkmcnt(0)
    s_barrier
    ds_read_b64_tr_b16 v[160:161], v102 offset:0
    ds_read_b64_tr_b16 v[162:163], v102 offset:4096
    ds_read_b64_tr_b16 v[164:165], v102 offset:8192
    ds_read_b64_tr_b16 v[166:167], v102 offset:12288
    ds_read_b64_tr_b16 v[168:169], v103 offset:0
    ds_read_b64_tr_b16 v[170:171], v103 offset:4096
    ds_read_b64_tr_b16 v[172:173], v103 offset:8192
    ds_read_b64_tr_b16 v[174:175], v103 offset:12288
    s_mov_b32 m0, 90112
    s_add_u32 s34, s61, 768
    buffer_load_dwordx4 v98, s[96:99], s34 offen lds
    s_mov_b32 m0, 91136
    s_add_u32 s34, s61, 17152
    buffer_load_dwordx4 v99, s[96:99], s34 offen lds
    s_mov_b32 m0, 92160
    s_add_u32 s34, s61, 8960
    buffer_load_dwordx4 v98, s[96:99], s34 offen lds
    s_mov_b32 m0, 93184
    s_add_u32 s34, s61, 25344
    buffer_load_dwordx4 v99, s[96:99], s34 offen lds
    v_mov_b32 v19, 28
    global_load_dword v16, v19, s[16:17] sc1
    v_mov_b32 v20, 16
    global_load_dword v17, v20, s[16:17] sc1
    s_waitcnt vmcnt(32) lgkmcnt(0)
    s_barrier
    ds_read_b64_tr_b16 v[176:177], v102 offset:16384
    ds_read_b64_tr_b16 v[178:179], v102 offset:20480
    ds_read_b64_tr_b16 v[180:181], v102 offset:24576
    ds_read_b64_tr_b16 v[182:183], v102 offset:28672
    ds_read_b64_tr_b16 v[184:185], v103 offset:16384
    ds_read_b64_tr_b16 v[186:187], v103 offset:20480
    ds_read_b64_tr_b16 v[188:189], v103 offset:24576
    ds_read_b64_tr_b16 v[190:191], v103 offset:28672
    s_mov_b32 m0, 106496
    s_add_u32 s34, s60, 3145728
    buffer_load_dwordx4 v96, s[88:91], s34 offen lds
    s_mov_b32 m0, 107520
    s_add_u32 s34, s60, 3162112
    buffer_load_dwordx4 v97, s[88:91], s34 offen lds
    s_mov_b32 m0, 108544
    s_add_u32 s34, s60, 3178496
    buffer_load_dwordx4 v96, s[88:91], s34 offen lds
    s_mov_b32 m0, 109568
    s_add_u32 s34, s60, 3194880
    buffer_load_dwordx4 v97, s[88:91], s34 offen lds
    s_waitcnt vmcnt(32) lgkmcnt(0)
    s_barrier
    ds_read_b64_tr_b16 v[192:193], v102 offset:32768
    ds_read_b64_tr_b16 v[194:195], v102 offset:36864
    ds_read_b64_tr_b16 v[196:197], v102 offset:40960
    ds_read_b64_tr_b16 v[198:199], v102 offset:45056
    ds_read_b64_tr_b16 v[200:201], v103 offset:32768
    ds_read_b64_tr_b16 v[202:203], v103 offset:36864
    ds_read_b64_tr_b16 v[204:205], v103 offset:40960
    ds_read_b64_tr_b16 v[206:207], v103 offset:45056
    s_mov_b32 m0, 122880
    s_add_u32 s34, s61, 66048
    buffer_load_dwordx4 v98, s[96:99], s34 offen lds
    s_mov_b32 m0, 123904
    s_add_u32 s34, s61, 82432
    buffer_load_dwordx4 v99, s[96:99], s34 offen lds
    s_mov_b32 m0, 124928
    s_add_u32 s34, s61, 74240
    buffer_load_dwordx4 v98, s[96:99], s34 offen lds
    s_mov_b32 m0, 125952
    s_add_u32 s34, s61, 90624
    buffer_load_dwordx4 v99, s[96:99], s34 offen lds
    s_waitcnt vmcnt(32) lgkmcnt(0)
    s_barrier
    ds_read_b64_tr_b16 v[208:209], v102 offset:49152
    ds_read_b64_tr_b16 v[210:211], v102 offset:53248
    ds_read_b64_tr_b16 v[212:213], v102 offset:57344
    ds_read_b64_tr_b16 v[214:215], v102 offset:61440
    ds_read_b64_tr_b16 v[216:217], v103 offset:49152
    ds_read_b64_tr_b16 v[218:219], v103 offset:53248
    ds_read_b64_tr_b16 v[220:221], v103 offset:57344
    ds_read_b64_tr_b16 v[222:223], v103 offset:61440
    s_mov_b32 m0, 139264
    s_add_u32 s34, s60, 3670016
    buffer_load_dwordx4 v96, s[88:91], s34 offen lds
    s_mov_b32 m0, 140288
    s_add_u32 s34, s60, 3686400
    buffer_load_dwordx4 v97, s[88:91], s34 offen lds
    s_mov_b32 m0, 141312
    s_add_u32 s34, s60, 3702784
    buffer_load_dwordx4 v96, s[88:91], s34 offen lds
    s_mov_b32 m0, 142336
    s_add_u32 s34, s60, 3719168
    buffer_load_dwordx4 v97, s[88:91], s34 offen lds
    s_waitcnt vmcnt(32) lgkmcnt(0)
    s_barrier
    ds_read_b64_tr_b16 v[224:225], v107 offset:0
    ds_read_b64_tr_b16 v[226:227], v107 offset:4096
    ds_read_b64_tr_b16 v[228:229], v107 offset:8192
    ds_read_b64_tr_b16 v[230:231], v107 offset:12288
    ds_read_b64_tr_b16 v[232:233], v108 offset:0
    ds_read_b64_tr_b16 v[234:235], v108 offset:4096
    ds_read_b64_tr_b16 v[236:237], v108 offset:8192
    ds_read_b64_tr_b16 v[238:239], v108 offset:12288
    s_mov_b32 m0, 155648
    s_add_u32 s34, s61, 66304
    buffer_load_dwordx4 v98, s[96:99], s34 offen lds
    s_mov_b32 m0, 156672
    s_add_u32 s34, s61, 82688
    buffer_load_dwordx4 v99, s[96:99], s34 offen lds
    s_mov_b32 m0, 157696
    s_add_u32 s34, s61, 74496
    buffer_load_dwordx4 v98, s[96:99], s34 offen lds
    s_mov_b32 m0, 158720
    s_add_u32 s34, s61, 90880
    buffer_load_dwordx4 v99, s[96:99], s34 offen lds
    s_waitcnt vmcnt(32) lgkmcnt(0)
    s_barrier
    ds_read_b64_tr_b16 v[240:241], v107 offset:16384
    ds_read_b64_tr_b16 v[242:243], v107 offset:20480
    ds_read_b64_tr_b16 v[244:245], v107 offset:24576
    ds_read_b64_tr_b16 v[246:247], v107 offset:28672
    ds_read_b64_tr_b16 v[248:249], v108 offset:16384
    ds_read_b64_tr_b16 v[250:251], v108 offset:20480
    ds_read_b64_tr_b16 v[252:253], v108 offset:24576
    ds_read_b64_tr_b16 v[254:255], v108 offset:28672
    s_waitcnt vmcnt(28) lgkmcnt(0)
    s_barrier
    s_waitcnt vmcnt(24) lgkmcnt(0)
    s_barrier
    s_mov_b32 m0, 40960
    s_add_u32 s34, s60, 3145728
    buffer_load_dwordx4 v96, s[84:87], s34 offen lds
    s_mov_b32 m0, 41984
    s_add_u32 s34, s60, 3162112
    buffer_load_dwordx4 v97, s[84:87], s34 offen lds
    s_mov_b32 m0, 43008
    s_add_u32 s34, s60, 3178496
    buffer_load_dwordx4 v96, s[84:87], s34 offen lds
    s_mov_b32 m0, 44032
    s_add_u32 s34, s60, 3194880
    buffer_load_dwordx4 v97, s[84:87], s34 offen lds
    s_waitcnt vmcnt(24) lgkmcnt(0)
    s_barrier
    v_add_u32 v105, 32768, v104
    v_xor_b32 v106, 0, v105
    ds_read_b64_tr_b16 a[192:193], v106 offset:0
    ds_read_b64_tr_b16 a[194:195], v106 offset:4096
    ds_read_b64_tr_b16 a[196:197], v106 offset:8192
    ds_read_b64_tr_b16 a[198:199], v106 offset:12288
    v_xor_b32 v106, 32, v105
    ds_read_b64_tr_b16 a[200:201], v106 offset:0
    ds_read_b64_tr_b16 a[202:203], v106 offset:4096
    ds_read_b64_tr_b16 a[204:205], v106 offset:8192
    ds_read_b64_tr_b16 a[206:207], v106 offset:12288
    s_waitcnt lgkmcnt(0)
    v_xor_b32 v106, 64, v105
    ds_read_b64_tr_b16 a[208:209], v106 offset:0
    ds_read_b64_tr_b16 a[210:211], v106 offset:4096
    ds_read_b64_tr_b16 a[212:213], v106 offset:8192
    ds_read_b64_tr_b16 a[214:215], v106 offset:12288
    v_xor_b32 v106, 96, v105
    ds_read_b64_tr_b16 a[216:217], v106 offset:0
    ds_read_b64_tr_b16 a[218:219], v106 offset:4096
    ds_read_b64_tr_b16 a[220:221], v106 offset:8192
    ds_read_b64_tr_b16 a[222:223], v106 offset:12288
    s_waitcnt lgkmcnt(0)
    v_xor_b32 v106, 128, v105
    ds_read_b64_tr_b16 a[224:225], v106 offset:0
    ds_read_b64_tr_b16 a[226:227], v106 offset:4096
    ds_read_b64_tr_b16 a[228:229], v106 offset:8192
    ds_read_b64_tr_b16 a[230:231], v106 offset:12288
    v_xor_b32 v106, 160, v105
    ds_read_b64_tr_b16 a[232:233], v106 offset:0
    ds_read_b64_tr_b16 a[234:235], v106 offset:4096
    ds_read_b64_tr_b16 a[236:237], v106 offset:8192
    ds_read_b64_tr_b16 a[238:239], v106 offset:12288
    s_waitcnt lgkmcnt(0)
    v_xor_b32 v106, 192, v105
    ds_read_b64_tr_b16 a[240:241], v106 offset:0
    ds_read_b64_tr_b16 a[242:243], v106 offset:4096
    ds_read_b64_tr_b16 a[244:245], v106 offset:8192
    ds_read_b64_tr_b16 a[246:247], v106 offset:12288
    v_xor_b32 v106, 224, v105
    ds_read_b64_tr_b16 a[248:249], v106 offset:0
    ds_read_b64_tr_b16 a[250:251], v106 offset:4096
    ds_read_b64_tr_b16 a[252:253], v106 offset:8192
    ds_read_b64_tr_b16 a[254:255], v106 offset:12288
    s_waitcnt lgkmcnt(0)
    s_mov_b32 m0, 57344
    s_add_u32 s34, s61, 65536
    buffer_load_dwordx4 v98, s[96:99], s34 offen lds
    s_mov_b32 m0, 58368
    s_add_u32 s34, s61, 81920
    buffer_load_dwordx4 v99, s[96:99], s34 offen lds
    s_mov_b32 m0, 59392
    s_add_u32 s34, s61, 73728
    buffer_load_dwordx4 v98, s[96:99], s34 offen lds
    s_mov_b32 m0, 60416
    s_add_u32 s34, s61, 90112
    buffer_load_dwordx4 v99, s[96:99], s34 offen lds
    s_waitcnt vmcnt(24) lgkmcnt(0)
    s_barrier
    s_mov_b32 m0, 73728
    s_add_u32 s34, s60, 3670016
    buffer_load_dwordx4 v96, s[84:87], s34 offen lds
    s_mov_b32 m0, 74752
    s_add_u32 s34, s60, 3686400
    buffer_load_dwordx4 v97, s[84:87], s34 offen lds
    s_mov_b32 m0, 75776
    s_add_u32 s34, s60, 3702784
    buffer_load_dwordx4 v96, s[84:87], s34 offen lds
    s_mov_b32 m0, 76800
    s_add_u32 s34, s60, 3719168
    buffer_load_dwordx4 v97, s[84:87], s34 offen lds
    s_waitcnt lgkmcnt(0)
    s_barrier
    v_mov_b32 v21, 262144
    buffer_load_dword v18, v21, s[8:11], 0 offen sc1
    s_mov_b32 m0, 90112
    s_add_u32 s34, s61, 65792
    buffer_load_dwordx4 v98, s[96:99], s34 offen lds
    s_mov_b32 m0, 91136
    s_add_u32 s34, s61, 82176
    buffer_load_dwordx4 v99, s[96:99], s34 offen lds
    s_mov_b32 m0, 92160
    s_add_u32 s34, s61, 73984
    buffer_load_dwordx4 v98, s[96:99], s34 offen lds
    s_mov_b32 m0, 93184
    s_add_u32 s34, s61, 90368
    buffer_load_dwordx4 v99, s[96:99], s34 offen lds
    s_waitcnt vmcnt(0)
    s_barrier
    v_readfirstlane_b32 s33, v17
    s_lshr_b32 s71, s33, 16
    s_and_b32 s33, s33, 0xffff
    s_cmp_ge_u32 s33, 32
    s_cbranch_scc1 L_cbd2
    v_mov_b32 v26, 16
    s_mov_b32 s7, 0
L_cb2:
    global_load_dword v27, v26, s[16:17] sc1
    s_waitcnt vmcnt(0)
    v_readfirstlane_b32 s33, v27
    s_lshr_b32 s71, s33, 16
    s_and_b32 s33, s33, 0xffff
    s_cmp_ge_u32 s33, 32
    s_cbranch_scc1 L_cbd2
    s_add_u32 s7, s7, 1
    s_cmp_lt_u32 s7, s6
    s_cbranch_scc1 L_cb2
    s_mov_b32 s6, 0
L_cbd2:
    v_readfirstlane_b32 s33, v16
    v_readfirstlane_b32 s34, v18
    s_and_b32 s34, s34, 0xff
    s_cmp_eq_u32 s34, 128
    s_cselect_b32 s34, s33, 0
    s_cmp_lg_u32 s34, 0
    s_cbranch_scc1 L_kv0d_2
    v_mov_b32 v26, 28
    s_mov_b32 s7, 0
L_ini_2:
    global_load_dword v27, v26, s[16:17] sc1
    s_waitcnt vmcnt(0)
    v_readfirstlane_b32 s33, v27
    s_cmp_lg_u32 s33, 0
    s_cbranch_scc1 L_inid_2
    s_add_u32 s7, s7, 1
    s_cmp_lt_u32 s7, 100000
    s_cbranch_scc1 L_ini_2
L_inid_2:
    v_mov_b32 v26, 262144
    s_mov_b32 s7, 0
L_kv0_2:
    buffer_load_dword v27, v26, s[8:11], 0 offen sc1
    s_waitcnt vmcnt(0)
    v_readfirstlane_b32 s33, v27
    s_and_b32 s33, s33, 0xff
    s_cmp_eq_u32 s33, 128
    s_cbranch_scc1 L_kv0d_2
    s_sleep 2
    s_add_u32 s7, s7, 1
    s_cmp_lt_u32 s7, 400000
    s_cbranch_scc1 L_kv0_2
L_kv0d_2:
    s_lshl_b32 s33, s3, 13
    s_add_u32 s33, s33, 4096
    s_add_u32 s28, s33, 16777216
    s_mov_b32 s29, 20480
    s_mov_b32 m0, s29
    s_add_u32 s30, s33, 33554432
    buffer_load_dwordx4 v0, s[8:11], s28 offen lds
    buffer_load_dwordx4 v0, s[8:11], s28 offen offset:1024 lds
    buffer_load_dwordx4 v[16:19], v9, s[8:11], s30 offen
    buffer_load_dwordx4 v[20:23], v9, s[8:11], s30 offen offset:256
    s_add_u32 s28, s28, 0x40000
    s_xor_b32 s29, s29, 8192
    s_add_u32 s30, s30, 0x40000
    s_mov_b32 s5, 0
    s_mov_b32 s20, 1572864
    s_mov_b32 s21, 1581056
    s_mov_b32 s22, 1589248
    s_lshl_b32 s33, s3, 6
    s_add_u32 s23, s33, 1179648
    s_add_u32 s25, s23, 32768
    s_lshl_b32 s33, s3, 13
    s_add_u32 s24, s33, 1052672
    s_add_u32 s26, s24, 262144
    s_lshl_b32 s33, s3, 11
    s_add_u32 s31, s33, 83886080
    s_lshl_b32 s33, s3, 12
    s_add_u32 s32, s33, 92274688
    s_mov_b32 s45, 2097152
    s_mov_b32 s62, 0x0F000000
    s_mov_b32 s63, 0x0F000000
    s_mov_b32 s96, 0x3e0293ee
    s_mov_b32 s97, 0x3e0293ee
    s_mov_b32 s98, 0x3f803f80
    s_mov_b32 s99, 0x3f803f80
    s_mov_b32 s100, 0xaaaaaaaa
    s_mov_b32 s101, 0xaaaaaaaa
    ds_read_b64_tr_b16 v[32:33], v100 offset:0
    ds_read_b64_tr_b16 v[34:35], v100 offset:4096
    ds_read_b64_tr_b16 v[36:37], v100 offset:8192
    ds_read_b64_tr_b16 v[38:39], v100 offset:12288
    ds_read_b64_tr_b16 v[40:41], v101 offset:0
    ds_read_b64_tr_b16 v[42:43], v101 offset:4096
    ds_read_b64_tr_b16 v[44:45], v101 offset:8192
    ds_read_b64_tr_b16 v[46:47], v101 offset:12288
    s_waitcnt lgkmcnt(0)
    ds_read_b64_tr_b16 v[48:49], v100 offset:32768
    ds_read_b64_tr_b16 v[50:51], v100 offset:36864
    ds_read_b64_tr_b16 v[52:53], v100 offset:40960
    ds_read_b64_tr_b16 v[54:55], v100 offset:45056
    ds_read_b64_tr_b16 v[56:57], v101 offset:32768
    ds_read_b64_tr_b16 v[58:59], v101 offset:36864
    ds_read_b64_tr_b16 v[60:61], v101 offset:40960
    ds_read_b64_tr_b16 v[62:63], v101 offset:45056
    s_waitcnt lgkmcnt(0)
    ds_read_b64_tr_b16 v[64:65], v102 offset:0
    ds_read_b64_tr_b16 v[66:67], v102 offset:4096
    ds_read_b64_tr_b16 v[68:69], v102 offset:8192
    ds_read_b64_tr_b16 v[70:71], v102 offset:12288
    ds_read_b64_tr_b16 v[72:73], v103 offset:0
    ds_read_b64_tr_b16 v[74:75], v103 offset:4096
    ds_read_b64_tr_b16 v[76:77], v103 offset:8192
    ds_read_b64_tr_b16 v[78:79], v103 offset:12288
    s_waitcnt lgkmcnt(0)
    ds_read_b64_tr_b16 v[80:81], v102 offset:32768
    ds_read_b64_tr_b16 v[82:83], v102 offset:36864
    ds_read_b64_tr_b16 v[84:85], v102 offset:40960
    ds_read_b64_tr_b16 v[86:87], v102 offset:45056
    ds_read_b64_tr_b16 v[88:89], v103 offset:32768
    ds_read_b64_tr_b16 v[90:91], v103 offset:36864
    ds_read_b64_tr_b16 v[92:93], v103 offset:40960
    ds_read_b64_tr_b16 v[94:95], v103 offset:45056
    s_waitcnt lgkmcnt(0)
    s_barrier
    ds_write_b128 v11, v[32:35] offset:0
    ds_write_b128 v11, v[36:39] offset:1024
    ds_write_b128 v11, v[40:43] offset:2048
    ds_write_b128 v11, v[44:47] offset:3072
    ds_write_b128 v11, v[48:51] offset:4096
    ds_write_b128 v11, v[52:55] offset:5120
    ds_write_b128 v11, v[56:59] offset:6144
    ds_write_b128 v11, v[60:63] offset:7168
    ds_write_b128 v11, v[64:67] offset:8192
    ds_write_b128 v11, v[68:71] offset:9216
    ds_write_b128 v11, v[72:75] offset:10240
    ds_write_b128 v11, v[76:79] offset:11264
    ds_write_b128 v11, v[80:83] offset:12288
    ds_write_b128 v11, v[84:87] offset:13312
    ds_write_b128 v11, v[88:91] offset:14336
    ds_write_b128 v11, v[92:95] offset:15360
    s_waitcnt lgkmcnt(0)
    v_add_u32 v105, 81920, v104
    v_xor_b32 v106, 0, v105
    ds_read_b64_tr_b16 v[32:33], v106 offset:0
    ds_read_b64_tr_b16 v[34:35], v106 offset:4096
    ds_read_b64_tr_b16 v[36:37], v106 offset:8192
    ds_read_b64_tr_b16 v[38:39], v106 offset:12288
    v_xor_b32 v106, 32, v105
    ds_read_b64_tr_b16 v[40:41], v106 offset:0
    ds_read_b64_tr_b16 v[42:43], v106 offset:4096
    ds_read_b64_tr_b16 v[44:45], v106 offset:8192
    ds_read_b64_tr_b16 v[46:47], v106 offset:12288
    s_waitcnt lgkmcnt(0)
    v_xor_b32 v106, 64, v105
    ds_read_b64_tr_b16 v[48:49], v106 offset:0
    ds_read_b64_tr_b16 v[50:51], v106 offset:4096
    ds_read_b64_tr_b16 v[52:53], v106 offset:8192
    ds_read_b64_tr_b16 v[54:55], v106 offset:12288
    v_xor_b32 v106, 96, v105
    ds_read_b64_tr_b16 v[56:57], v106 offset:0
    ds_read_b64_tr_b16 v[58:59], v106 offset:4096
    ds_read_b64_tr_b16 v[60:61], v106 offset:8192
    ds_read_b64_tr_b16 v[62:63], v106 offset:12288
    s_waitcnt lgkmcnt(0)
    v_xor_b32 v106, 128, v105
    ds_read_b64_tr_b16 v[64:65], v106 offset:0
    ds_read_b64_tr_b16 v[66:67], v106 offset:4096
    ds_read_b64_tr_b16 v[68:69], v106 offset:8192
    ds_read_b64_tr_b16 v[70:71], v106 offset:12288
    v_xor_b32 v106, 160, v105
    ds_read_b64_tr_b16 v[72:73], v106 offset:0
    ds_read_b64_tr_b16 v[74:75], v106 offset:4096
    ds_read_b64_tr_b16 v[76:77], v106 offset:8192
    ds_read_b64_tr_b16 v[78:79], v106 offset:12288
    s_waitcnt lgkmcnt(0)
    v_xor_b32 v106, 192, v105
    ds_read_b64_tr_b16 v[80:81], v106 offset:0
    ds_read_b64_tr_b16 v[82:83], v106 offset:4096
    ds_read_b64_tr_b16 v[84:85], v106 offset:8192
    ds_read_b64_tr_b16 v[86:87], v106 offset:12288
    v_xor_b32 v106, 224, v105
    ds_read_b64_tr_b16 v[88:89], v106 offset:0
    ds_read_b64_tr_b16 v[90:91], v106 offset:4096
    ds_read_b64_tr_b16 v[92:93], v106 offset:8192
    ds_read_b64_tr_b16 v[94:95], v106 offset:12288
    s_waitcnt lgkmcnt(0)
    s_waitcnt lgkmcnt(0)
    ds_write_b128 v11, v[32:35] offset:16384
    ds_write_b128 v11, v[36:39] offset:17408
    ds_write_b128 v11, v[40:43] offset:18432
    ds_write_b128 v11, v[44:47] offset:19456
    ds_write_b128 v11, v[48:51] offset:20480
    ds_write_b128 v11, v[52:55] offset:21504
    ds_write_b128 v11, v[56:59] offset:22528
    ds_write_b128 v11, v[60:63] offset:23552
    ds_write_b128 v11, v[64:67] offset:24576
    ds_write_b128 v11, v[68:71] offset:25600
    ds_write_b128 v11, v[72:75] offset:26624
    ds_write_b128 v11, v[76:79] offset:27648
    ds_write_b128 v11, v[80:83] offset:28672
    ds_write_b128 v11, v[84:87] offset:29696
    ds_write_b128 v11, v[88:91] offset:30720
    ds_write_b128 v11, v[92:95] offset:31744
    s_waitcnt lgkmcnt(0)
    s_barrier
    s_mov_b32 s84, 0
    s_mov_b32 s85, 0
    s_mov_b32 s86, 0
    s_mov_b32 s87, 0
    s_mov_b32 s88, 0
    s_mov_b32 s89, 0
    s_mov_b32 s90, 0
    s_mov_b32 s91, 0
    s_mov_b32 s92, 0
    s_mov_b32 s93, 0
    s_waitcnt vmcnt(0)
    s_barrier
    ds_read_b128 v[64:67], v11 offset:0
    ds_read_b128 v[68:71], v11 offset:1024
    ds_read_b128 v[72:75], v11 offset:2048
    ds_read_b128 v[76:79], v11 offset:3072
    ds_read_b128 v[80:83], v11 offset:4096
    ds_read_b128 v[84:87], v11 offset:5120
    ds_read_b128 v[88:91], v11 offset:6144
    ds_read_b128 v[92:95], v11 offset:7168
    v_mov_b32 v112, 0
    v_mov_b32 v113, 0
    v_mov_b32 v114, 0
    v_mov_b32 v115, 0
    v_mov_b32 v116, 0
    v_mov_b32 v117, 0
    v_mov_b32 v118, 0
    v_mov_b32 v119, 0
    v_mov_b32 v120, 0
    v_mov_b32 v121, 0
    v_mov_b32 v122, 0
    v_mov_b32 v123, 0
    v_mov_b32 v124, 0
    v_mov_b32 v125, 0
    v_mov_b32 v126, 0
    v_mov_b32 v127, 0
    v_mov_b64 v[28:29], -1
    v_mov_b64 v[30:31], -1
    v_mov_b64 v[104:105], -1
    v_mov_b64 v[106:107], -1
    s_add_u32 s47, s20, 4096
    s_mov_b32 s7, 0
    s_sleep 2
    s_mov_b32 m0, 4096
    s_nop 0
    buffer_load_dwordx4 v0, s[8:11], s47 offen sc1 lds
    buffer_load_dwordx4 v0, s[8:11], s47 offen offset:1024 sc1 lds
    s_mov_b32 m0, 4096
    s_nop 0
    buffer_load_dwordx4 v0, s[8:11], s47 offen sc1 lds
    buffer_load_dwordx4 v0, s[8:11], s47 offen offset:1024 sc1 lds
    s_memtime s[56:57]
    s_memrealtime s[74:75]
    s_waitcnt vmcnt(0) lgkmcnt(0)
    s_mov_b32 s94, s56
    s_cmp_lg_u32 s71, 0
    s_cbranch_scc1 L_step2s
L_step2:
    s_waitcnt vmcnt(2)
    ds_read_b128 v[48:51], v0 offset:4096
    ds_read_b128 v[52:55], v0 offset:5120
    s_waitcnt lgkmcnt(0)
    v_max3_u32 v26, v48, v49, v50
    v_max3_u32 v27, v51, v52, v53
    v_max3_u32 v26, v26, v54, v55
    v_max_u32 v26, v26, v27
    v_cmp_eq_u32 vcc, -1, v26
    s_cbranch_vccnz L_p2r_2m
L_p2d_2m:
    s_barrier
    ds_read_b128 v[56:59], v0 offset:6144
    ds_read_b128 v[60:63], v0 offset:7168
    v_smfmac_f32_16x16x64_bf16 v[112:115], v[48:51], a[64:71], v10
    ds_read_b128 v[32:35], v0 offset:0
    v_smfmac_f32_16x16x64_bf16 v[116:119], v[48:51], a[72:79], v10
    ds_read_b128 v[36:39], v0 offset:1024
    s_mov_b32 m0, s29
    s_nop 0
    buffer_load_dwordx4 v0, s[8:11], s28 offen lds
    v_smfmac_f32_16x16x64_bf16 v[112:115], v[52:55], a[80:87], v10
    ds_read_b128 v[40:43], v0 offset:2048
    v_smfmac_f32_16x16x64_bf16 v[116:119], v[52:55], a[88:95], v10
    ds_read_b128 v[44:47], v0 offset:3072
    v_smfmac_f32_16x16x64_bf16 v[120:123], v[48:51], a[160:167], v10
    ds_read_b64_tr_b16 v[28:29], v4 offset:2304
    buffer_load_dwordx4 v0, s[8:11], s28 offen offset:1024 lds
    v_smfmac_f32_16x16x64_bf16 v[124:127], v[48:51], a[168:175], v10
    ds_read_b64_tr_b16 v[30:31], v4 offset:2432
    v_smfmac_f32_16x16x64_bf16 v[120:123], v[52:55], a[176:183], v10
    s_mov_b32 m0, 15360
    s_nop 0
    buffer_load_dword v9, s[8:11], s30 offen lds
    v_smfmac_f32_16x16x64_bf16 v[124:127], v[52:55], a[184:191], v10
    s_waitcnt lgkmcnt(7)
    v_smfmac_f32_16x16x64_bf16 v[112:115], v[56:59], v[64:71], v10
    v_smfmac_f32_16x16x64_bf16 v[116:119], v[56:59], v[72:79], v10
    buffer_load_dword v9, s[8:11], s30 offen offset:256 lds
    s_waitcnt lgkmcnt(6)
    v_smfmac_f32_16x16x64_bf16 v[112:115], v[60:63], v[80:87], v10
    v_smfmac_f32_16x16x64_bf16 v[116:119], v[60:63], v[88:95], v10
    ds_read_b128 v[64:67], v11 offset:8192
    s_waitcnt lgkmcnt(6)
    v_smfmac_f32_16x16x64_bf16 v[112:115], v[32:35], a[0:7], v10
    ds_read_b128 v[68:71], v11 offset:9216
    v_smfmac_f32_16x16x64_bf16 v[116:119], v[32:35], a[8:15], v10
    ds_read_b128 v[72:75], v11 offset:10240
    s_waitcnt lgkmcnt(7)
    v_smfmac_f32_16x16x64_bf16 v[112:115], v[36:39], a[16:23], v10
    ds_read_b128 v[76:79], v11 offset:11264
    v_smfmac_f32_16x16x64_bf16 v[116:119], v[36:39], a[24:31], v10
    ds_read_b128 v[80:83], v11 offset:12288
    s_waitcnt lgkmcnt(8)
    v_smfmac_f32_16x16x64_bf16 v[112:115], v[40:43], a[32:39], v10
    ds_read_b128 v[84:87], v11 offset:13312
    v_smfmac_f32_16x16x64_bf16 v[116:119], v[40:43], a[40:47], v10
    ds_read_b128 v[88:91], v11 offset:14336
    s_waitcnt lgkmcnt(9)
    v_smfmac_f32_16x16x64_bf16 v[112:115], v[44:47], a[48:55], v10
    ds_read_b128 v[92:95], v11 offset:15360
    v_smfmac_f32_16x16x64_bf16 v[116:119], v[44:47], a[56:63], v10
    s_waitcnt lgkmcnt(4)
    v_smfmac_f32_16x16x64_bf16 v[120:123], v[56:59], v[64:71], v10
    v_smfmac_f32_16x16x64_bf16 v[124:127], v[56:59], v[72:79], v10
    v_add_f32 v112, v112, v114
    v_smfmac_f32_16x16x64_bf16 v[120:123], v[32:35], a[96:103], v10
    ds_read_b128 v[64:67], v5 offset:0
    v_add_f32 v113, v113, v115
    v_add_f32 v116, v116, v118
    v_smfmac_f32_16x16x64_bf16 v[124:127], v[32:35], a[104:111], v10
    ds_read_b128 v[68:71], v5 offset:2048
    v_add_f32 v117, v117, v119
    v_cvt_pk_bf16_f32 v112, v112, v113
    s_waitcnt lgkmcnt(2)
    v_smfmac_f32_16x16x64_bf16 v[120:123], v[60:63], v[80:87], v10
    ds_read_b128 v[72:75], v5 offset:4096
    v_cvt_pk_bf16_f32 v116, v116, v117
    v_smfmac_f32_16x16x64_bf16 v[124:127], v[60:63], v[88:95], v10
    ds_write2_b32 v3, v112, v116 offset0:0 offset1:128
    ds_read_b128 v[76:79], v5 offset:6144
    v_smfmac_f32_16x16x64_bf16 v[120:123], v[36:39], a[112:119], v10
    ds_read_b128 v[80:83], v6 offset:0
    v_smfmac_f32_16x16x64_bf16 v[124:127], v[36:39], a[120:127], v10
    ds_read_b128 v[84:87], v6 offset:2048
    buffer_store_dwordx4 v[12:15], v0, s[8:11], s63 offen offset:2048 sc1
    v_smfmac_f32_16x16x64_bf16 v[120:123], v[40:43], a[128:135], v10
    ds_read_b128 v[88:91], v6 offset:4096
    s_waitcnt lgkmcnt(4)
    v_smfmac_f32_16x16x64_bf16 v[124:127], v[40:43], a[136:143], v10
    ds_read_b128 v[92:95], v6 offset:6144
    v_mov_b64 v[112:113], 0
    v_smfmac_f32_16x16x64_bf16 v[120:123], v[44:47], a[144:151], v10
    v_mov_b64 v[114:115], 0
    v_smfmac_f32_16x16x64_bf16 v[124:127], v[44:47], a[152:159], v10
    v_mov_b64 v[116:117], 0
    v_mov_b64 v[118:119], 0
    v_smfmac_f32_16x16x64_bf16 v[112:115], v[32:35], v[128:135], v10
    v_smfmac_f32_16x16x64_bf16 v[116:119], v[32:35], v[136:143], v10
    v_add_f32 v120, v120, v122
    v_add_f32 v121, v121, v123
    v_smfmac_f32_16x16x64_bf16 v[112:115], v[36:39], v[144:151], v10
    v_add_f32 v124, v124, v126
    v_add_f32 v125, v125, v127
    v_smfmac_f32_16x16x64_bf16 v[116:119], v[36:39], v[152:159], v10
    v_cvt_pk_bf16_f32 v120, v120, v121
    v_cvt_pk_bf16_f32 v124, v124, v125
    v_smfmac_f32_16x16x64_bf16 v[112:115], v[40:43], v[160:167], v10
    ds_write2_b32 v3, v120, v124 offset0:64 offset1:192
    v_smfmac_f32_16x16x64_bf16 v[116:119], v[40:43], v[168:175], v10
    v_smfmac_f32_16x16x64_bf16 v[112:115], v[44:47], v[176:183], v10
    v_smfmac_f32_16x16x64_bf16 v[116:119], v[44:47], v[184:191], v10
    v_smfmac_f32_16x16x64_bf16 v[112:115], v[48:51], v[192:199], v10
    s_mov_b64 exec, s[36:37]
    buffer_store_dwordx4 v[28:31], v7, s[8:11], s62 offen offset:1024 sc1
    s_mov_b64 exec, -1
    s_waitcnt lgkmcnt(0)
    s_barrier
    ds_read_b64_tr_b16 v[96:97], v4 offset:0
    ds_read_b64_tr_b16 v[98:99], v4 offset:128
    v_smfmac_f32_16x16x64_bf16 v[116:119], v[48:51], v[200:207], v10
    ds_read_b64_tr_b16 v[100:101], v4 offset:1024
    ds_read_b64_tr_b16 v[102:103], v4 offset:1152
    v_smfmac_f32_16x16x64_bf16 v[112:115], v[52:55], v[208:215], v10
    ds_read_b64_tr_b16 v[104:105], v4 offset:2048
    ds_read_b64_tr_b16 v[106:107], v4 offset:2176
    v_smfmac_f32_16x16x64_bf16 v[116:119], v[52:55], v[216:223], v10
    ds_read_b64_tr_b16 v[108:109], v4 offset:3072
    ds_read_b64_tr_b16 v[110:111], v4 offset:3200
    v_smfmac_f32_16x16x64_bf16 v[112:115], v[56:59], v[224:231], v10
    v_smfmac_f32_16x16x64_bf16 v[116:119], v[56:59], v[232:239], v10
    v_smfmac_f32_16x16x64_bf16 v[112:115], v[60:63], v[240:247], v10
    v_smfmac_f32_16x16x64_bf16 v[116:119], v[60:63], v[248:255], v10
    s_waitcnt vmcnt(6)
    ds_read_b64_tr_b16 v[32:33], v4 offset:256
    ds_read_b64_tr_b16 v[34:35], v4 offset:384
    ds_read_b64_tr_b16 v[36:37], v4 offset:1280
    ds_read_b64_tr_b16 v[38:39], v4 offset:1408
    s_waitcnt lgkmcnt(10)
    v_mfma_f32_16x16x32_bf16 v[120:123], v[64:67], v[96:99], 0
    ds_read_b64_tr_b16 v[40:41], v4 offset:2304
    s_waitcnt lgkmcnt(9)
    v_mfma_f32_16x16x32_bf16 v[120:123], v[68:71], v[100:103], v[120:123]
    ds_read_b64_tr_b16 v[42:43], v4 offset:2432
    v_add_f32 v112, v112, v114
    v_add_f32 v113, v113, v115
    s_waitcnt lgkmcnt(8)
    v_mfma_f32_16x16x32_bf16 v[120:123], v[72:75], v[104:107], v[120:123]
    ds_read_b64_tr_b16 v[44:45], v4 offset:3328
    v_add_f32 v116, v116, v118
    v_add_f32 v117, v117, v119
    s_waitcnt lgkmcnt(7)
    v_mfma_f32_16x16x32_bf16 v[120:123], v[76:79], v[108:111], v[120:123]
    ds_read_b64_tr_b16 v[46:47], v4 offset:3456
    v_mov_b64 v[52:53], s[98:99]
    v_mov_b64 v[54:55], s[98:99]
    v_mfma_f32_16x16x32_bf16 v[124:127], v[80:83], v[96:99], 0
    ds_read_b128 v[64:67], v11 offset:16384
    v_cvt_pk_bf16_f32 v12, v112, v113
    v_cvt_pk_bf16_f32 v14, v116, v117
    v_mfma_f32_16x16x32_bf16 v[124:127], v[84:87], v[100:103], v[124:127]
    ds_read_b128 v[68:71], v11 offset:17408
    v_mfma_f32_16x16x32_bf16 v[124:127], v[88:91], v[104:107], v[124:127]
    ds_read_b128 v[72:75], v11 offset:18432
    v_max3_f32 v26, v120, v121, v122
    v_mfma_f32_16x16x32_bf16 v[124:127], v[92:95], v[108:111], v[124:127]
    ds_read_b128 v[76:79], v11 offset:19456
    v_max_f32 v26, v26, v123
    s_waitcnt lgkmcnt(10)
    v_mfma_f32_16x16x32_bf16 v[48:51], v[32:35], v[96:99], 0
    ds_read_b128 v[80:83], v11 offset:20480
    s_waitcnt lgkmcnt(9)
    v_mfma_f32_16x16x32_bf16 v[48:51], v[36:39], v[100:103], v[48:51]
    ds_read_b128 v[84:87], v11 offset:21504
    v_max3_f32 v27, v124, v125, v126
    v_mov_b64 v[96:97], 0
    s_waitcnt lgkmcnt(8)
    v_mfma_f32_16x16x32_bf16 v[48:51], v[40:43], v[104:107], v[48:51]
    ds_read_b128 v[88:91], v11 offset:22528
    v_mov_b64 v[98:99], 0
    v_max3_f32 v26, v26, v127, v27
    s_waitcnt lgkmcnt(7)
    v_mfma_f32_16x16x32_bf16 v[48:51], v[44:47], v[108:111], v[48:51]
    ds_read_b128 v[92:95], v11 offset:23552
    v_mov_b64 v[100:101], 0
    v_mov_b64 v[102:103], 0
    v_mov_b64 v[104:105], 0
    v_mov_b64 v[106:107], 0
    v_mov_b64 v[108:109], 0
    v_mov_b64 v[110:111], 0
    s_nop 0
    v_max3_f32 v26, v26, v48, v49
    v_max3_f32 v26, v26, v50, v51
    v_cndmask_b32 v48, v48, v50, s[38:39]
    v_mov_b32 v27, v26
    v_cndmask_b32 v49, v49, v51, s[38:39]
    s_nop 0
    v_permlane16_swap_b32 v26, v27
    v_max_f32 v26, v26, v27
    v_mov_b32 v27, v26
    v_mov_b32 v61, 0
    s_nop 0
    v_permlane32_swap_b32 v26, v27
    v_max_f32 v26, v26, v27
    v_mul_f32 v28, s46, v26
    v_pk_fma_f32 v[120:121], v[120:121], s[96:97], v[28:29] op_sel_hi:[1,1,0] neg_lo:[0,0,1] neg_hi:[0,0,1]
    v_pk_fma_f32 v[122:123], v[122:123], s[96:97], v[28:29] op_sel_hi:[1,1,0] neg_lo:[0,0,1] neg_hi:[0,0,1]
    v_pk_fma_f32 v[124:125], v[124:125], s[96:97], v[28:29] op_sel_hi:[1,1,0] neg_lo:[0,0,1] neg_hi:[0,0,1]
    v_pk_fma_f32 v[126:127], v[126:127], s[96:97], v[28:29] op_sel_hi:[1,1,0] neg_lo:[0,0,1] neg_hi:[0,0,1]
    v_pk_fma_f32 v[48:49], v[48:49], s[96:97], v[28:29] op_sel_hi:[1,1,0] neg_lo:[0,0,1] neg_hi:[0,0,1]
    v_exp_f32 v120, v120
    v_exp_f32 v121, v121
    v_exp_f32 v122, v122
    v_exp_f32 v123, v123
    v_exp_f32 v124, v124
    v_exp_f32 v125, v125
    v_exp_f32 v126, v126
    v_exp_f32 v127, v127
    v_exp_f32 v48, v48
    v_exp_f32 v49, v49
    v_cvt_pk_bf16_f32 v56, v120, v121
    v_cvt_pk_bf16_f32 v57, v122, v123
    v_cvt_pk_bf16_f32 v58, v124, v125
    v_cvt_pk_bf16_f32 v59, v126, v127
    v_cvt_pk_bf16_f32 v60, v48, v49
    s_nop 0
    v_mfma_f32_16x16x32_bf16 v[26:29], v[52:55], v[56:59], 0
    v_mov_b64 v[120:121], 0
    v_mov_b64 v[122:123], 0
    v_mfma_f32_16x16x32_bf16 v[112:115], v[16:19], v[56:59], 0
    ds_read_b128 v[32:35], v11 offset:24576
    v_mov_b64 v[124:125], 0
    v_mfma_f32_16x16x32_bf16 v[116:119], v[20:23], v[56:59], 0
    ds_read_b128 v[36:39], v11 offset:25600
    buffer_load_dwordx4 v[16:19], v9, s[8:11], s30 offen
    v_mfma_f32_16x16x16_bf16 v[26:29], v[24:25], v[60:61], v[26:29]
    ds_read_b128 v[40:43], v11 offset:26624
    buffer_load_dwordx4 v[20:23], v9, s[8:11], s30 offen offset:256
    v_mfma_f32_16x16x16_bf16 v[112:115], v[12:13], v[60:61], v[112:115]
    ds_read_b128 v[44:47], v11 offset:27648
    v_mov_b64 v[126:127], 0
    v_mfma_f32_16x16x16_bf16 v[116:119], v[14:15], v[60:61], v[116:119]
    v_rcp_f32 v30, v26
    s_nop 2
    v_mul_f32 v112, v112, v30
    v_mul_f32 v113, v113, v30
    v_cvt_pk_bf16_f32 v56, v112, v113
    v_mul_f32 v114, v114, v30
    v_mul_f32 v115, v115, v30
    v_cvt_pk_bf16_f32 v57, v114, v115
    v_mul_f32 v116, v116, v30
    v_mul_f32 v117, v117, v30
    v_cvt_pk_bf16_f32 v58, v116, v117
    v_mul_f32 v118, v118, v30
    v_mul_f32 v119, v119, v30
    v_cvt_pk_bf16_f32 v59, v118, v119
    s_mov_b64 exec, s[36:37]
    ds_write_b128 v7, v[56:59] offset:13312
    s_mov_b64 exec, -1
    ds_read_b128 v[48:51], v11 offset:28672
    ds_read_b128 v[52:55], v11 offset:29696
    v_mov_b64 v[28:29], -1
    v_mov_b64 v[30:31], -1
    buffer_store_dwordx4 v[28:31], v0, s[8:11], s26 offen
    s_waitcnt lgkmcnt(2)
    s_barrier
    ds_read_b128 v[56:59], v8 offset:0
    ds_read_b128 v[60:63], v8 offset:1024
    buffer_store_dwordx4 v[28:31], v0, s[8:11], s26 offen offset:1024
    s_waitcnt lgkmcnt(1)
    v_smfmac_f32_16x16x64_bf16 v[96:99], v[56:59], a[192:199], v10
    v_mov_b64 v[112:113], 0
    v_smfmac_f32_16x16x64_bf16 v[100:103], v[56:59], a[200:207], v10
    v_mov_b64 v[114:115], 0
    v_smfmac_f32_16x16x64_bf16 v[104:107], v[56:59], a[208:215], v10
    v_mov_b64 v[116:117], 0
    v_smfmac_f32_16x16x64_bf16 v[108:111], v[56:59], a[216:223], v10
    v_mov_b64 v[118:119], 0
    s_waitcnt lgkmcnt(0)
    v_smfmac_f32_16x16x64_bf16 v[96:99], v[60:63], v[64:71], v10
    v_smfmac_f32_16x16x64_bf16 v[100:103], v[60:63], v[72:79], v10
    ds_read_b128 v[64:67], v11 offset:30720
    v_smfmac_f32_16x16x64_bf16 v[104:107], v[60:63], v[80:87], v10
    ds_read_b128 v[68:71], v11 offset:31744
    v_smfmac_f32_16x16x64_bf16 v[108:111], v[60:63], v[88:95], v10
    v_add_f32 v96, v96, v98
    v_add_f32 v97, v97, v99
    v_cvt_pk_bf16_f32 v96, v96, v97
    v_smfmac_f32_16x16x64_bf16 v[112:115], v[56:59], a[224:231], v10
    v_add_f32 v100, v100, v102
    v_add_f32 v101, v101, v103
    v_cvt_pk_bf16_f32 v97, v100, v101
    v_smfmac_f32_16x16x64_bf16 v[116:119], v[56:59], a[232:239], v10
    v_add_f32 v104, v104, v106
    v_add_f32 v105, v105, v107
    v_cvt_pk_bf16_f32 v98, v104, v105
    v_smfmac_f32_16x16x64_bf16 v[120:123], v[56:59], a[240:247], v10
    v_add_f32 v108, v108, v110
    v_add_f32 v109, v109, v111
    v_cvt_pk_bf16_f32 v99, v108, v109
    v_smfmac_f32_16x16x64_bf16 v[124:127], v[56:59], a[248:255], v10
    buffer_store_dwordx4 v[96:99], v1, s[8:11], s23 offen
    v_smfmac_f32_16x16x64_bf16 v[112:115], v[60:63], v[32:39], v10
    v_smfmac_f32_16x16x64_bf16 v[116:119], v[60:63], v[40:47], v10
    v_smfmac_f32_16x16x64_bf16 v[120:123], v[60:63], v[48:55], v10
    s_waitcnt lgkmcnt(0)
    v_smfmac_f32_16x16x64_bf16 v[124:127], v[60:63], v[64:71], v10
    v_add_f32 v112, v112, v114
    v_add_f32 v113, v113, v115
    v_cvt_pk_bf16_f32 v112, v112, v113
    v_add_f32 v116, v116, v118
    v_add_f32 v117, v117, v119
    v_cvt_pk_bf16_f32 v113, v116, v117
    v_add_f32 v120, v120, v122
    v_add_f32 v121, v121, v123
    v_cvt_pk_bf16_f32 v114, v120, v121
    v_add_f32 v124, v124, v126
    v_add_f32 v125, v125, v127
    v_cvt_pk_bf16_f32 v115, v124, v125
    buffer_store_dwordx4 v[112:115], v1, s[8:11], s25 offen
    v_mov_b32 v26, 0x3f80
    v_mov_b32 v27, 0x3f800000
    v_cndmask_b32 v26, v26, v27, s[100:101]
    v_cndmask_b32 v108, 0, v26, s[48:49]
    v_cndmask_b32 v109, 0, v26, s[50:51]
    v_cndmask_b32 v110, 0, v26, s[52:53]
    v_cndmask_b32 v111, 0, v26, s[54:55]
    ds_read_b128 v[64:67], v11 offset:0
    ds_read_b128 v[68:71], v11 offset:1024
    ds_read_b128 v[72:75], v11 offset:2048
    ds_read_b128 v[76:79], v11 offset:3072
    ds_read_b128 v[80:83], v11 offset:4096
    ds_read_b128 v[84:87], v11 offset:5120
    ds_read_b128 v[88:91], v11 offset:6144
    ds_read_b128 v[92:95], v11 offset:7168
    v_mov_b64 v[112:113], 0
    v_mov_b64 v[114:115], 0
    v_mov_b64 v[116:117], 0
    v_mov_b64 v[118:119], 0
    v_mov_b64 v[120:121], 0
    v_mov_b64 v[122:123], 0
    v_mov_b64 v[124:125], 0
    v_mov_b64 v[126:127], 0
    v_mov_b64 v[28:29], -1
    v_mov_b64 v[30:31], -1
    s_mov_b32 s7, 0
    s_sleep 2
    buffer_load_dwordx4 v[96:99], v0, s[8:11], s24 offen sc1
    buffer_load_dwordx4 v[100:103], v0, s[8:11], s24 offen offset:1024 sc1
    s_sleep 3
    buffer_load_dwordx4 v[96:99], v0, s[8:11], s24 offen sc1
    buffer_load_dwordx4 v[100:103], v0, s[8:11], s24 offen offset:1024 sc1
    s_and_b32 s33, s5, 7
    s_cmp_eq_u32 s33, 6
    s_cbranch_scc0 L_nkv_2m
    s_add_u32 s33, s5, 2
    s_lshr_b32 s33, s33, 3
    s_lshl_b32 s33, s33, 7
    s_add_u32 s33, s33, 262144
    v_mov_b32 v26, s33
    buffer_load_dword v27, v26, s[8:11], 0 offen sc1
    s_waitcnt vmcnt(0)
L_nkv_2m:
L_p1w_2m:
    s_waitcnt vmcnt(2)
    v_mfma_f32_16x16x32_bf16 v[104:107], v[108:111], v[96:99], 0
    v_mfma_f32_16x16x32_bf16 v[104:107], v[108:111], v[100:103], v[104:107]
    s_nop 7
    v_cmp_u_f32 vcc, v104, v104
    s_cbranch_vccnz L_p1r_2m
L_p1d_2m:
    v_add_f32_dpp v104, v104, v104 row_ror:8 row_mask:0xf bank_mask:0xf
    v_add_f32_dpp v105, v105, v105 row_ror:8 row_mask:0xf bank_mask:0xf
    v_add_f32_dpp v106, v106, v106 row_ror:8 row_mask:0xf bank_mask:0xf
    v_add_f32_dpp v107, v107, v107 row_ror:8 row_mask:0xf bank_mask:0xf
    v_add_f32_dpp v104, v104, v104 row_ror:4 row_mask:0xf bank_mask:0xf
    v_add_f32_dpp v105, v105, v105 row_ror:4 row_mask:0xf bank_mask:0xf
    v_add_f32_dpp v106, v106, v106 row_ror:4 row_mask:0xf bank_mask:0xf
    v_add_f32_dpp v107, v107, v107 row_ror:4 row_mask:0xf bank_mask:0xf
    v_cvt_pk_bf16_f32 v104, v104, v106
    v_cvt_pk_bf16_f32 v105, v105, v107
    s_mov_b64 exec, s[40:41]
    v_cndmask_b32 v104, v104, v105, s[42:43]
    v_min_u32 v104, -2, v104
    buffer_store_dword v104, v2, s[8:11], s21 offen
    buffer_store_dword v28, v2, s[8:11], s20 offen
    s_mov_b64 exec, -1
    s_add_u32 s47, s21, 4096
    s_mov_b32 s7, 0
    s_add_u32 s5, s5, 1
    s_and_b32 s33, s5, 7
    s_cmp_eq_u32 s33, 7
    s_cbranch_scc0 L_ckv_2m
    s_cmp_ge_u32 s5, 57
    s_cbranch_scc1 L_ckv_2m
L_ckvl_2m:
    v_readfirstlane_b32 s33, v27
    s_and_b32 s33, s33, 0xff
    s_cmp_eq_u32 s33, 128
    s_cbranch_scc1 L_ckv_2m
    s_add_u32 s7, s7, 1
    s_cmp_lt_u32 s7, 400000
    s_cbranch_scc0 L_ckv_2m
    s_sleep 2
    buffer_load_dword v27, v26, s[8:11], 0 offen sc1
    s_waitcnt vmcnt(0)
    s_branch L_ckvl_2m
L_ckv_2m:
    s_mov_b32 s7, 0
    s_sleep 2
    s_mov_b32 m0, 4096
    s_nop 0
    buffer_load_dwordx4 v0, s[8:11], s47 offen sc1 lds
    buffer_load_dwordx4 v0, s[8:11], s47 offen offset:1024 sc1 lds
    s_mov_b32 s33, s20
    s_mov_b32 s20, s21
    s_mov_b32 s21, s22
    s_mov_b32 s22, s33
    s_xor_b32 s23, s23, 0x40000
    s_mov_b32 s26, s24
    s_xor_b32 s24, s24, 0x40000
    s_xor_b32 s25, s25, 0x40000
    s_add_u32 s28, s28, 0x40000
    s_xor_b32 s29, s29, 8192
    s_add_u32 s30, s30, 0x40000
    s_mov_b32 s62, s31
    s_mov_b32 s63, s32
    s_add_u32 s31, s31, 65536
    s_add_u32 s32, s32, 131072
    v_xor_b32 v5, 0x2000, v5
    v_xor_b32 v6, 0x2000, v6
    s_sleep 2
    s_mov_b32 m0, 4096
    s_nop 0
    buffer_load_dwordx4 v0, s[8:11], s47 offen sc1 lds
    buffer_load_dwordx4 v0, s[8:11], s47 offen offset:1024 sc1 lds
    v_mov_b64 v[104:105], -1
    v_mov_b64 v[106:107], -1
    s_cmp_lt_u32 s5, 63
    s_cbranch_scc1 L_step2
    s_waitcnt vmcnt(2)
    ds_read_b128 v[48:51], v0 offset:4096
    ds_read_b128 v[52:55], v0 offset:5120
    s_waitcnt lgkmcnt(0)
    v_max3_u32 v26, v48, v49, v50
    v_max3_u32 v27, v51, v52, v53
    v_max3_u32 v26, v26, v54, v55
    v_max_u32 v26, v26, v27
    v_cmp_eq_u32 vcc, -1, v26
    s_cbranch_vccnz L_p2r_2l
L_p2d_2l:
    s_barrier
    ds_read_b128 v[56:59], v0 offset:6144
    ds_read_b128 v[60:63], v0 offset:7168
    ds_read_b128 v[32:35], v0 offset:0
    ds_read_b128 v[36:39], v0 offset:1024
    ds_read_b128 v[40:43], v0 offset:2048
    ds_read_b128 v[44:47], v0 offset:3072
    ds_read_b64_tr_b16 v[28:29], v4 offset:2304
    ds_read_b64_tr_b16 v[30:31], v4 offset:2432
    buffer_store_dwordx4 v[12:15], v0, s[8:11], s63 offen offset:2048 sc1
    s_waitcnt lgkmcnt(0)
    s_mov_b64 exec, s[36:37]
    buffer_store_dwordx4 v[28:31], v7, s[8:11], s62 offen offset:1024 sc1
    s_mov_b64 exec, -1
    v_smfmac_f32_16x16x64_bf16 v[120:123], v[48:51], a[160:167], v10
    v_smfmac_f32_16x16x64_bf16 v[124:127], v[48:51], a[168:175], v10
    v_smfmac_f32_16x16x64_bf16 v[120:123], v[52:55], a[176:183], v10
    v_smfmac_f32_16x16x64_bf16 v[124:127], v[52:55], a[184:191], v10
    ds_read_b128 v[64:67], v11 offset:8192
    ds_read_b128 v[68:71], v11 offset:9216
    ds_read_b128 v[72:75], v11 offset:10240
    ds_read_b128 v[76:79], v11 offset:11264
    ds_read_b128 v[80:83], v11 offset:12288
    ds_read_b128 v[84:87], v11 offset:13312
    ds_read_b128 v[88:91], v11 offset:14336
    ds_read_b128 v[92:95], v11 offset:15360
    s_waitcnt lgkmcnt(4)
    v_smfmac_f32_16x16x64_bf16 v[120:123], v[56:59], v[64:71], v10
    v_smfmac_f32_16x16x64_bf16 v[124:127], v[56:59], v[72:79], v10
    v_smfmac_f32_16x16x64_bf16 v[120:123], v[32:35], a[96:103], v10
    v_smfmac_f32_16x16x64_bf16 v[124:127], v[32:35], a[104:111], v10
    s_waitcnt lgkmcnt(0)
    v_smfmac_f32_16x16x64_bf16 v[120:123], v[60:63], v[80:87], v10
    v_smfmac_f32_16x16x64_bf16 v[124:127], v[60:63], v[88:95], v10
    v_smfmac_f32_16x16x64_bf16 v[120:123], v[36:39], a[112:119], v10
    v_smfmac_f32_16x16x64_bf16 v[124:127], v[36:39], a[120:127], v10
    v_smfmac_f32_16x16x64_bf16 v[120:123], v[40:43], a[128:135], v10
    v_smfmac_f32_16x16x64_bf16 v[124:127], v[40:43], a[136:143], v10
    v_smfmac_f32_16x16x64_bf16 v[120:123], v[44:47], a[144:151], v10
    v_smfmac_f32_16x16x64_bf16 v[124:127], v[44:47], a[152:159], v10
    v_mov_b64 v[112:113], 0
    v_mov_b64 v[114:115], 0
    v_mov_b64 v[116:117], 0
    v_mov_b64 v[118:119], 0
    v_smfmac_f32_16x16x64_bf16 v[112:115], v[32:35], v[128:135], v10
    v_smfmac_f32_16x16x64_bf16 v[116:119], v[32:35], v[136:143], v10
    v_add_f32 v120, v120, v122
    v_add_f32 v121, v121, v123
    v_smfmac_f32_16x16x64_bf16 v[112:115], v[36:39], v[144:151], v10
    v_add_f32 v124, v124, v126
    v_add_f32 v125, v125, v127
    v_smfmac_f32_16x16x64_bf16 v[116:119], v[36:39], v[152:159], v10
    v_cvt_pk_bf16_f32 v120, v120, v121
    v_cvt_pk_bf16_f32 v124, v124, v125
    v_smfmac_f32_16x16x64_bf16 v[112:115], v[40:43], v[160:167], v10
    ds_write2_b32 v3, v120, v124 offset0:64 offset1:192
    v_smfmac_f32_16x16x64_bf16 v[116:119], v[40:43], v[168:175], v10
    v_smfmac_f32_16x16x64_bf16 v[112:115], v[44:47], v[176:183], v10
    v_smfmac_f32_16x16x64_bf16 v[116:119], v[44:47], v[184:191], v10
    v_smfmac_f32_16x16x64_bf16 v[112:115], v[48:51], v[192:199], v10
    s_waitcnt lgkmcnt(0)
    s_barrier
    v_smfmac_f32_16x16x64_bf16 v[116:119], v[48:51], v[200:207], v10
    v_smfmac_f32_16x16x64_bf16 v[112:115], v[52:55], v[208:215], v10
    v_smfmac_f32_16x16x64_bf16 v[116:119], v[52:55], v[216:223], v10
    v_smfmac_f32_16x16x64_bf16 v[112:115], v[56:59], v[224:231], v10
    v_smfmac_f32_16x16x64_bf16 v[116:119], v[56:59], v[232:239], v10
    v_smfmac_f32_16x16x64_bf16 v[112:115], v[60:63], v[240:247], v10
    v_smfmac_f32_16x16x64_bf16 v[116:119], v[60:63], v[248:255], v10
    ds_read_b64_tr_b16 v[32:33], v4 offset:256
    ds_read_b64_tr_b16 v[34:35], v4 offset:384
    ds_read_b64_tr_b16 v[36:37], v4 offset:1280
    ds_read_b64_tr_b16 v[38:39], v4 offset:1408
    ds_read_b64_tr_b16 v[40:41], v4 offset:2304
    ds_read_b64_tr_b16 v[42:43], v4 offset:2432
    ds_read_b64_tr_b16 v[44:45], v4 offset:3328
    ds_read_b64_tr_b16 v[46:47], v4 offset:3456
    v_pk_add_f32 v[112:113], v[112:113], v[114:115]
    v_pk_add_f32 v[116:117], v[116:117], v[118:119]
    v_cvt_pk_bf16_f32 v12, v112, v113
    v_cvt_pk_bf16_f32 v14, v116, v117
    buffer_store_dwordx4 v[12:15], v0, s[8:11], s32 offen offset:2048 sc1
    s_waitcnt lgkmcnt(0)
    s_mov_b64 exec, s[36:37]
    buffer_store_dwordx4 v[40:43], v7, s[8:11], s31 offen offset:1024 sc1
    s_mov_b64 exec, -1
    s_branch L_cfin2
L_step2s:
    s_waitcnt vmcnt(2)
    ds_read_b128 v[48:51], v0 offset:4096
    ds_read_b128 v[52:55], v0 offset:5120
    s_waitcnt lgkmcnt(0)
    v_max3_u32 v26, v48, v49, v50
    v_max3_u32 v27, v51, v52, v53
    v_max3_u32 v26, v26, v54, v55
    v_max_u32 v26, v26, v27
    v_cmp_eq_u32 vcc, -1, v26
    s_cbranch_vccnz L_p2r_2ms
L_p2d_2ms:
    s_barrier
    ds_read_b128 v[56:59], v0 offset:6144
    ds_read_b128 v[60:63], v0 offset:7168
    v_smfmac_f32_16x16x64_bf16 v[112:115], v[48:51], a[64:71], v10
    ds_read_b128 v[32:35], v0 offset:0
    v_smfmac_f32_16x16x64_bf16 v[116:119], v[48:51], a[72:79], v10
    ds_read_b128 v[36:39], v0 offset:1024
    s_mov_b32 m0, s29
    s_nop 0
    buffer_load_dwordx4 v0, s[8:11], s28 offen lds
    v_smfmac_f32_16x16x64_bf16 v[112:115], v[52:55], a[80:87], v10
    ds_read_b128 v[40:43], v0 offset:2048
    v_smfmac_f32_16x16x64_bf16 v[116:119], v[52:55], a[88:95], v10
    ds_read_b128 v[44:47], v0 offset:3072
    v_smfmac_f32_16x16x64_bf16 v[120:123], v[48:51], a[160:167], v10
    ds_read_b64_tr_b16 v[28:29], v4 offset:2304
    buffer_load_dwordx4 v0, s[8:11], s28 offen offset:1024 lds
    v_smfmac_f32_16x16x64_bf16 v[124:127], v[48:51], a[168:175], v10
    ds_read_b64_tr_b16 v[30:31], v4 offset:2432
    v_smfmac_f32_16x16x64_bf16 v[120:123], v[52:55], a[176:183], v10
    s_mov_b32 m0, 15360
    s_nop 0
    buffer_load_dword v9, s[8:11], s30 offen lds
    v_smfmac_f32_16x16x64_bf16 v[124:127], v[52:55], a[184:191], v10
    s_waitcnt lgkmcnt(7)
    v_smfmac_f32_16x16x64_bf16 v[112:115], v[56:59], v[64:71], v10
    v_smfmac_f32_16x16x64_bf16 v[116:119], v[56:59], v[72:79], v10
    buffer_load_dword v9, s[8:11], s30 offen offset:256 lds
    s_waitcnt lgkmcnt(6)
    v_smfmac_f32_16x16x64_bf16 v[112:115], v[60:63], v[80:87], v10
    v_smfmac_f32_16x16x64_bf16 v[116:119], v[60:63], v[88:95], v10
    ds_read_b128 v[64:67], v11 offset:8192
    s_waitcnt lgkmcnt(6)
    v_smfmac_f32_16x16x64_bf16 v[112:115], v[32:35], a[0:7], v10
    ds_read_b128 v[68:71], v11 offset:9216
    v_smfmac_f32_16x16x64_bf16 v[116:119], v[32:35], a[8:15], v10
    ds_read_b128 v[72:75], v11 offset:10240
    s_waitcnt lgkmcnt(7)
    v_smfmac_f32_16x16x64_bf16 v[112:115], v[36:39], a[16:23], v10
    ds_read_b128 v[76:79], v11 offset:11264
    v_smfmac_f32_16x16x64_bf16 v[116:119], v[36:39], a[24:31], v10
    ds_read_b128 v[80:83], v11 offset:12288
    s_waitcnt lgkmcnt(8)
    v_smfmac_f32_16x16x64_bf16 v[112:115], v[40:43], a[32:39], v10
    ds_read_b128 v[84:87], v11 offset:13312
    v_smfmac_f32_16x16x64_bf16 v[116:119], v[40:43], a[40:47], v10
    ds_read_b128 v[88:91], v11 offset:14336
    s_waitcnt lgkmcnt(9)
    v_smfmac_f32_16x16x64_bf16 v[112:115], v[44:47], a[48:55], v10
    ds_read_b128 v[92:95], v11 offset:15360
    v_smfmac_f32_16x16x64_bf16 v[116:119], v[44:47], a[56:63], v10
    s_waitcnt lgkmcnt(4)
    v_smfmac_f32_16x16x64_bf16 v[120:123], v[56:59], v[64:71], v10
    v_smfmac_f32_16x16x64_bf16 v[124:127], v[56:59], v[72:79], v10
    v_add_f32 v112, v112, v114
    v_smfmac_f32_16x16x64_bf16 v[120:123], v[32:35], a[96:103], v10
    ds_read_b128 v[64:67], v5 offset:0
    v_add_f32 v113, v113, v115
    v_add_f32 v116, v116, v118
    v_smfmac_f32_16x16x64_bf16 v[124:127], v[32:35], a[104:111], v10
    ds_read_b128 v[68:71], v5 offset:2048
    v_add_f32 v117, v117, v119
    v_cvt_pk_bf16_f32 v112, v112, v113
    s_waitcnt lgkmcnt(2)
    v_smfmac_f32_16x16x64_bf16 v[120:123], v[60:63], v[80:87], v10
    ds_read_b128 v[72:75], v5 offset:4096
    v_cvt_pk_bf16_f32 v116, v116, v117
    v_smfmac_f32_16x16x64_bf16 v[124:127], v[60:63], v[88:95], v10
    ds_write2_b32 v3, v112, v116 offset0:0 offset1:128
    ds_read_b128 v[76:79], v5 offset:6144
    v_smfmac_f32_16x16x64_bf16 v[120:123], v[36:39], a[112:119], v10
    ds_read_b128 v[80:83], v6 offset:0
    v_smfmac_f32_16x16x64_bf16 v[124:127], v[36:39], a[120:127], v10
    ds_read_b128 v[84:87], v6 offset:2048
    buffer_store_dwordx4 v[12:15], v0, s[8:11], s63 offen offset:2048 sc1
    v_smfmac_f32_16x16x64_bf16 v[120:123], v[40:43], a[128:135], v10
    ds_read_b128 v[88:91], v6 offset:4096
    s_waitcnt lgkmcnt(4)
    v_smfmac_f32_16x16x64_bf16 v[124:127], v[40:43], a[136:143], v10
    ds_read_b128 v[92:95], v6 offset:6144
    v_mov_b64 v[112:113], 0
    v_smfmac_f32_16x16x64_bf16 v[120:123], v[44:47], a[144:151], v10
    v_mov_b64 v[114:115], 0
    v_smfmac_f32_16x16x64_bf16 v[124:127], v[44:47], a[152:159], v10
    v_mov_b64 v[116:117], 0
    v_mov_b64 v[118:119], 0
    v_smfmac_f32_16x16x64_bf16 v[112:115], v[32:35], v[128:135], v10
    v_smfmac_f32_16x16x64_bf16 v[116:119], v[32:35], v[136:143], v10
    v_add_f32 v120, v120, v122
    v_add_f32 v121, v121, v123
    v_smfmac_f32_16x16x64_bf16 v[112:115], v[36:39], v[144:151], v10
    v_add_f32 v124, v124, v126
    v_add_f32 v125, v125, v127
    v_smfmac_f32_16x16x64_bf16 v[116:119], v[36:39], v[152:159], v10
    v_cvt_pk_bf16_f32 v120, v120, v121
    v_cvt_pk_bf16_f32 v124, v124, v125
    v_smfmac_f32_16x16x64_bf16 v[112:115], v[40:43], v[160:167], v10
    ds_write2_b32 v3, v120, v124 offset0:64 offset1:192
    v_smfmac_f32_16x16x64_bf16 v[116:119], v[40:43], v[168:175], v10
    v_smfmac_f32_16x16x64_bf16 v[112:115], v[44:47], v[176:183], v10
    v_smfmac_f32_16x16x64_bf16 v[116:119], v[44:47], v[184:191], v10
    v_smfmac_f32_16x16x64_bf16 v[112:115], v[48:51], v[192:199], v10
    s_mov_b64 exec, s[36:37]
    buffer_store_dwordx4 v[28:31], v7, s[8:11], s62 offen offset:1024 sc1
    s_mov_b64 exec, -1
    s_waitcnt lgkmcnt(0)
    s_barrier
    ds_read_b64_tr_b16 v[96:97], v4 offset:0
    ds_read_b64_tr_b16 v[98:99], v4 offset:128
    v_smfmac_f32_16x16x64_bf16 v[116:119], v[48:51], v[200:207], v10
    ds_read_b64_tr_b16 v[100:101], v4 offset:1024
    ds_read_b64_tr_b16 v[102:103], v4 offset:1152
    v_smfmac_f32_16x16x64_bf16 v[112:115], v[52:55], v[208:215], v10
    ds_read_b64_tr_b16 v[104:105], v4 offset:2048
    ds_read_b64_tr_b16 v[106:107], v4 offset:2176
    v_smfmac_f32_16x16x64_bf16 v[116:119], v[52:55], v[216:223], v10
    ds_read_b64_tr_b16 v[108:109], v4 offset:3072
    ds_read_b64_tr_b16 v[110:111], v4 offset:3200
    v_smfmac_f32_16x16x64_bf16 v[112:115], v[56:59], v[224:231], v10
    v_smfmac_f32_16x16x64_bf16 v[116:119], v[56:59], v[232:239], v10
    v_smfmac_f32_16x16x64_bf16 v[112:115], v[60:63], v[240:247], v10
    v_smfmac_f32_16x16x64_bf16 v[116:119], v[60:63], v[248:255], v10
    s_waitcnt vmcnt(6)
    ds_read_b64_tr_b16 v[32:33], v4 offset:256
    ds_read_b64_tr_b16 v[34:35], v4 offset:384
    ds_read_b64_tr_b16 v[36:37], v4 offset:1280
    ds_read_b64_tr_b16 v[38:39], v4 offset:1408
    s_waitcnt lgkmcnt(10)
    v_mfma_f32_16x16x32_bf16 v[120:123], v[64:67], v[96:99], 0
    ds_read_b64_tr_b16 v[40:41], v4 offset:2304
    s_waitcnt lgkmcnt(9)
    v_mfma_f32_16x16x32_bf16 v[120:123], v[68:71], v[100:103], v[120:123]
    ds_read_b64_tr_b16 v[42:43], v4 offset:2432
    v_add_f32 v112, v112, v114
    v_add_f32 v113, v113, v115
    s_waitcnt lgkmcnt(8)
    v_mfma_f32_16x16x32_bf16 v[120:123], v[72:75], v[104:107], v[120:123]
    ds_read_b64_tr_b16 v[44:45], v4 offset:3328
    v_add_f32 v116, v116, v118
    v_add_f32 v117, v117, v119
    s_waitcnt lgkmcnt(7)
    v_mfma_f32_16x16x32_bf16 v[120:123], v[76:79], v[108:111], v[120:123]
    ds_read_b64_tr_b16 v[46:47], v4 offset:3456
    v_mov_b64 v[52:53], s[98:99]
    v_mov_b64 v[54:55], s[98:99]
    v_mfma_f32_16x16x32_bf16 v[124:127], v[80:83], v[96:99], 0
    ds_read_b128 v[64:67], v11 offset:16384
    v_cvt_pk_bf16_f32 v12, v112, v113
    v_cvt_pk_bf16_f32 v14, v116, v117
    v_mfma_f32_16x16x32_bf16 v[124:127], v[84:87], v[100:103], v[124:127]
    ds_read_b128 v[68:71], v11 offset:17408
    v_mfma_f32_16x16x32_bf16 v[124:127], v[88:91], v[104:107], v[124:127]
    ds_read_b128 v[72:75], v11 offset:18432
    v_max3_f32 v26, v120, v121, v122
    v_mfma_f32_16x16x32_bf16 v[124:127], v[92:95], v[108:111], v[124:127]
    ds_read_b128 v[76:79], v11 offset:19456
    v_max_f32 v26, v26, v123
    s_waitcnt lgkmcnt(10)
    v_mfma_f32_16x16x32_bf16 v[48:51], v[32:35], v[96:99], 0
    ds_read_b128 v[80:83], v11 offset:20480
    s_waitcnt lgkmcnt(9)
    v_mfma_f32_16x16x32_bf16 v[48:51], v[36:39], v[100:103], v[48:51]
    ds_read_b128 v[84:87], v11 offset:21504
    v_max3_f32 v27, v124, v125, v126
    v_mov_b64 v[96:97], 0
    s_waitcnt lgkmcnt(8)
    v_mfma_f32_16x16x32_bf16 v[48:51], v[40:43], v[104:107], v[48:51]
    ds_read_b128 v[88:91], v11 offset:22528
    v_mov_b64 v[98:99], 0
    v_max3_f32 v26, v26, v127, v27
    s_waitcnt lgkmcnt(7)
    v_mfma_f32_16x16x32_bf16 v[48:51], v[44:47], v[108:111], v[48:51]
    ds_read_b128 v[92:95], v11 offset:23552
    v_mov_b64 v[100:101], 0
    v_mov_b64 v[102:103], 0
    v_mov_b64 v[104:105], 0
    v_mov_b64 v[106:107], 0
    v_mov_b64 v[108:109], 0
    v_mov_b64 v[110:111], 0
    s_nop 0
    v_max3_f32 v26, v26, v48, v49
    v_max3_f32 v26, v26, v50, v51
    v_cndmask_b32 v48, v48, v50, s[38:39]
    v_mov_b32 v27, v26
    v_cndmask_b32 v49, v49, v51, s[38:39]
    s_nop 0
    v_permlane16_swap_b32 v26, v27
    v_max_f32 v26, v26, v27
    v_mov_b32 v27, v26
    v_mov_b32 v61, 0
    s_nop 0
    v_permlane32_swap_b32 v26, v27
    v_max_f32 v26, v26, v27
    v_mul_f32 v28, s46, v26
    v_pk_fma_f32 v[120:121], v[120:121], s[96:97], v[28:29] op_sel_hi:[1,1,0] neg_lo:[0,0,1] neg_hi:[0,0,1]
    v_pk_fma_f32 v[122:123], v[122:123], s[96:97], v[28:29] op_sel_hi:[1,1,0] neg_lo:[0,0,1] neg_hi:[0,0,1]
    v_pk_fma_f32 v[124:125], v[124:125], s[96:97], v[28:29] op_sel_hi:[1,1,0] neg_lo:[0,0,1] neg_hi:[0,0,1]
    v_pk_fma_f32 v[126:127], v[126:127], s[96:97], v[28:29] op_sel_hi:[1,1,0] neg_lo:[0,0,1] neg_hi:[0,0,1]
    v_pk_fma_f32 v[48:49], v[48:49], s[96:97], v[28:29] op_sel_hi:[1,1,0] neg_lo:[0,0,1] neg_hi:[0,0,1]
    v_exp_f32 v120, v120
    v_exp_f32 v121, v121
    v_exp_f32 v122, v122
    v_exp_f32 v123, v123
    v_exp_f32 v124, v124
    v_exp_f32 v125, v125
    v_exp_f32 v126, v126
    v_exp_f32 v127, v127
    v_exp_f32 v48, v48
    v_exp_f32 v49, v49
    v_cvt_pk_bf16_f32 v56, v120, v121
    v_cvt_pk_bf16_f32 v57, v122, v123
    v_cvt_pk_bf16_f32 v58, v124, v125
    v_cvt_pk_bf16_f32 v59, v126, v127
    v_cvt_pk_bf16_f32 v60, v48, v49
    s_nop 0
    v_mfma_f32_16x16x32_bf16 v[26:29], v[52:55], v[56:59], 0
    v_mov_b64 v[120:121], 0
    v_mov_b64 v[122:123], 0
    v_mfma_f32_16x16x32_bf16 v[112:115], v[16:19], v[56:59], 0
    ds_read_b128 v[32:35], v11 offset:24576
    v_mov_b64 v[124:125], 0
    v_mfma_f32_16x16x32_bf16 v[116:119], v[20:23], v[56:59], 0
    ds_read_b128 v[36:39], v11 offset:25600
    buffer_load_dwordx4 v[16:19], v9, s[8:11], s30 offen
    v_mfma_f32_16x16x16_bf16 v[26:29], v[24:25], v[60:61], v[26:29]
    ds_read_b128 v[40:43], v11 offset:26624
    buffer_load_dwordx4 v[20:23], v9, s[8:11], s30 offen offset:256
    v_mfma_f32_16x16x16_bf16 v[112:115], v[12:13], v[60:61], v[112:115]
    ds_read_b128 v[44:47], v11 offset:27648
    v_mov_b64 v[126:127], 0
    v_mfma_f32_16x16x16_bf16 v[116:119], v[14:15], v[60:61], v[116:119]
    v_rcp_f32 v30, v26
    s_nop 2
    v_mul_f32 v112, v112, v30
    v_mul_f32 v113, v113, v30
    v_cvt_pk_bf16_f32 v56, v112, v113
    v_mul_f32 v114, v114, v30
    v_mul_f32 v115, v115, v30
    v_cvt_pk_bf16_f32 v57, v114, v115
    v_mul_f32 v116, v116, v30
    v_mul_f32 v117, v117, v30
    v_cvt_pk_bf16_f32 v58, v116, v117
    v_mul_f32 v118, v118, v30
    v_mul_f32 v119, v119, v30
    v_cvt_pk_bf16_f32 v59, v118, v119
    s_mov_b64 exec, s[36:37]
    ds_write_b128 v7, v[56:59] offset:13312
    s_mov_b64 exec, -1
    ds_read_b128 v[48:51], v11 offset:28672
    ds_read_b128 v[52:55], v11 offset:29696
    v_mov_b64 v[28:29], -1
    v_mov_b64 v[30:31], -1
    buffer_store_dwordx4 v[28:31], v0, s[8:11], s26 offen sc1
    s_waitcnt lgkmcnt(2)
    s_barrier
    ds_read_b128 v[56:59], v8 offset:0
    ds_read_b128 v[60:63], v8 offset:1024
    buffer_store_dwordx4 v[28:31], v0, s[8:11], s26 offen offset:1024 sc1
    s_waitcnt lgkmcnt(1)
    v_smfmac_f32_16x16x64_bf16 v[96:99], v[56:59], a[192:199], v10
    v_mov_b64 v[112:113], 0
    v_smfmac_f32_16x16x64_bf16 v[100:103], v[56:59], a[200:207], v10
    v_mov_b64 v[114:115], 0
    v_smfmac_f32_16x16x64_bf16 v[104:107], v[56:59], a[208:215], v10
    v_mov_b64 v[116:117], 0
    v_smfmac_f32_16x16x64_bf16 v[108:111], v[56:59], a[216:223], v10
    v_mov_b64 v[118:119], 0
    s_waitcnt lgkmcnt(0)
    v_smfmac_f32_16x16x64_bf16 v[96:99], v[60:63], v[64:71], v10
    v_smfmac_f32_16x16x64_bf16 v[100:103], v[60:63], v[72:79], v10
    ds_read_b128 v[64:67], v11 offset:30720
    v_smfmac_f32_16x16x64_bf16 v[104:107], v[60:63], v[80:87], v10
    ds_read_b128 v[68:71], v11 offset:31744
    v_smfmac_f32_16x16x64_bf16 v[108:111], v[60:63], v[88:95], v10
    v_add_f32 v96, v96, v98
    v_add_f32 v97, v97, v99
    v_cvt_pk_bf16_f32 v96, v96, v97
    v_smfmac_f32_16x16x64_bf16 v[112:115], v[56:59], a[224:231], v10
    v_add_f32 v100, v100, v102
    v_add_f32 v101, v101, v103
    v_cvt_pk_bf16_f32 v97, v100, v101
    v_smfmac_f32_16x16x64_bf16 v[116:119], v[56:59], a[232:239], v10
    v_add_f32 v104, v104, v106
    v_add_f32 v105, v105, v107
    v_cvt_pk_bf16_f32 v98, v104, v105
    v_smfmac_f32_16x16x64_bf16 v[120:123], v[56:59], a[240:247], v10
    v_add_f32 v108, v108, v110
    v_add_f32 v109, v109, v111
    v_cvt_pk_bf16_f32 v99, v108, v109
    v_smfmac_f32_16x16x64_bf16 v[124:127], v[56:59], a[248:255], v10
    buffer_store_dwordx4 v[96:99], v1, s[8:11], s23 offen sc1
    v_smfmac_f32_16x16x64_bf16 v[112:115], v[60:63], v[32:39], v10
    v_smfmac_f32_16x16x64_bf16 v[116:119], v[60:63], v[40:47], v10
    v_smfmac_f32_16x16x64_bf16 v[120:123], v[60:63], v[48:55], v10
    s_waitcnt lgkmcnt(0)
    v_smfmac_f32_16x16x64_bf16 v[124:127], v[60:63], v[64:71], v10
    v_add_f32 v112, v112, v114
    v_add_f32 v113, v113, v115
    v_cvt_pk_bf16_f32 v112, v112, v113
    v_add_f32 v116, v116, v118
    v_add_f32 v117, v117, v119
    v_cvt_pk_bf16_f32 v113, v116, v117
    v_add_f32 v120, v120, v122
    v_add_f32 v121, v121, v123
    v_cvt_pk_bf16_f32 v114, v120, v121
    v_add_f32 v124, v124, v126
    v_add_f32 v125, v125, v127
    v_cvt_pk_bf16_f32 v115, v124, v125
    buffer_store_dwordx4 v[112:115], v1, s[8:11], s25 offen sc1
    v_mov_b32 v26, 0x3f80
    v_mov_b32 v27, 0x3f800000
    v_cndmask_b32 v26, v26, v27, s[100:101]
    v_cndmask_b32 v108, 0, v26, s[48:49]
    v_cndmask_b32 v109, 0, v26, s[50:51]
    v_cndmask_b32 v110, 0, v26, s[52:53]
    v_cndmask_b32 v111, 0, v26, s[54:55]
    ds_read_b128 v[64:67], v11 offset:0
    ds_read_b128 v[68:71], v11 offset:1024
    ds_read_b128 v[72:75], v11 offset:2048
    ds_read_b128 v[76:79], v11 offset:3072
    ds_read_b128 v[80:83], v11 offset:4096
    ds_read_b128 v[84:87], v11 offset:5120
    ds_read_b128 v[88:91], v11 offset:6144
    ds_read_b128 v[92:95], v11 offset:7168
    v_mov_b64 v[112:113], 0
    v_mov_b64 v[114:115], 0
    v_mov_b64 v[116:117], 0
    v_mov_b64 v[118:119], 0
    v_mov_b64 v[120:121], 0
    v_mov_b64 v[122:123], 0
    v_mov_b64 v[124:125], 0
    v_mov_b64 v[126:127], 0
    v_mov_b64 v[28:29], -1
    v_mov_b64 v[30:31], -1
    s_mov_b32 s7, 0
    s_sleep 2
    buffer_load_dwordx4 v[96:99], v0, s[8:11], s24 offen sc1
    buffer_load_dwordx4 v[100:103], v0, s[8:11], s24 offen offset:1024 sc1
    s_sleep 3
    buffer_load_dwordx4 v[96:99], v0, s[8:11], s24 offen sc1
    buffer_load_dwordx4 v[100:103], v0, s[8:11], s24 offen offset:1024 sc1
    s_and_b32 s33, s5, 7
    s_cmp_eq_u32 s33, 6
    s_cbranch_scc0 L_nkv_2ms
    s_add_u32 s33, s5, 2
    s_lshr_b32 s33, s33, 3
    s_lshl_b32 s33, s33, 7
    s_add_u32 s33, s33, 262144
    v_mov_b32 v26, s33
    buffer_load_dword v27, v26, s[8:11], 0 offen sc1
    s_waitcnt vmcnt(0)
L_nkv_2ms:
L_p1w_2ms:
    s_waitcnt vmcnt(2)
    v_mfma_f32_16x16x32_bf16 v[104:107], v[108:111], v[96:99], 0
    v_mfma_f32_16x16x32_bf16 v[104:107], v[108:111], v[100:103], v[104:107]
    s_nop 7
    v_cmp_u_f32 vcc, v104, v104
    s_cbranch_vccnz L_p1r_2ms
L_p1d_2ms:
    v_add_f32_dpp v104, v104, v104 row_ror:8 row_mask:0xf bank_mask:0xf
    v_add_f32_dpp v105, v105, v105 row_ror:8 row_mask:0xf bank_mask:0xf
    v_add_f32_dpp v106, v106, v106 row_ror:8 row_mask:0xf bank_mask:0xf
    v_add_f32_dpp v107, v107, v107 row_ror:8 row_mask:0xf bank_mask:0xf
    v_add_f32_dpp v104, v104, v104 row_ror:4 row_mask:0xf bank_mask:0xf
    v_add_f32_dpp v105, v105, v105 row_ror:4 row_mask:0xf bank_mask:0xf
    v_add_f32_dpp v106, v106, v106 row_ror:4 row_mask:0xf bank_mask:0xf
    v_add_f32_dpp v107, v107, v107 row_ror:4 row_mask:0xf bank_mask:0xf
    v_cvt_pk_bf16_f32 v104, v104, v106
    v_cvt_pk_bf16_f32 v105, v105, v107
    s_mov_b64 exec, s[40:41]
    v_cndmask_b32 v104, v104, v105, s[42:43]
    v_min_u32 v104, -2, v104
    buffer_store_dword v104, v2, s[8:11], s21 offen sc1
    buffer_store_dword v28, v2, s[8:11], s20 offen sc1
    s_mov_b64 exec, -1
    s_add_u32 s47, s21, 4096
    s_mov_b32 s7, 0
    s_add_u32 s5, s5, 1
    s_and_b32 s33, s5, 7
    s_cmp_eq_u32 s33, 7
    s_cbranch_scc0 L_ckv_2ms
    s_cmp_ge_u32 s5, 57
    s_cbranch_scc1 L_ckv_2ms
L_ckvl_2ms:
    v_readfirstlane_b32 s33, v27
    s_and_b32 s33, s33, 0xff
    s_cmp_eq_u32 s33, 128
    s_cbranch_scc1 L_ckv_2ms
    s_add_u32 s7, s7, 1
    s_cmp_lt_u32 s7, 400000
    s_cbranch_scc0 L_ckv_2ms
    s_sleep 2
    buffer_load_dword v27, v26, s[8:11], 0 offen sc1
    s_waitcnt vmcnt(0)
    s_branch L_ckvl_2ms
L_ckv_2ms:
    s_mov_b32 s7, 0
    s_sleep 2
    s_mov_b32 m0, 4096
    s_nop 0
    buffer_load_dwordx4 v0, s[8:11], s47 offen sc1 lds
    buffer_load_dwordx4 v0, s[8:11], s47 offen offset:1024 sc1 lds
    s_mov_b32 s33, s20
    s_mov_b32 s20, s21
    s_mov_b32 s21, s22
    s_mov_b32 s22, s33
    s_xor_b32 s23, s23, 0x40000
    s_mov_b32 s26, s24
    s_xor_b32 s24, s24, 0x40000
    s_xor_b32 s25, s25, 0x40000
    s_add_u32 s28, s28, 0x40000
    s_xor_b32 s29, s29, 8192
    s_add_u32 s30, s30, 0x40000
    s_mov_b32 s62, s31
    s_mov_b32 s63, s32
    s_add_u32 s31, s31, 65536
    s_add_u32 s32, s32, 131072
    v_xor_b32 v5, 0x2000, v5
    v_xor_b32 v6, 0x2000, v6
    s_sleep 2
    s_mov_b32 m0, 4096
    s_nop 0
    buffer_load_dwordx4 v0, s[8:11], s47 offen sc1 lds
    buffer_load_dwordx4 v0, s[8:11], s47 offen offset:1024 sc1 lds
    v_mov_b64 v[104:105], -1
    v_mov_b64 v[106:107], -1
    s_cmp_lt_u32 s5, 63
    s_cbranch_scc1 L_step2s
    s_waitcnt vmcnt(2)
    ds_read_b128 v[48:51], v0 offset:4096
    ds_read_b128 v[52:55], v0 offset:5120
    s_waitcnt lgkmcnt(0)
    v_max3_u32 v26, v48, v49, v50
    v_max3_u32 v27, v51, v52, v53
    v_max3_u32 v26, v26, v54, v55
    v_max_u32 v26, v26, v27
    v_cmp_eq_u32 vcc, -1, v26
    s_cbranch_vccnz L_p2r_2ls
L_p2d_2ls:
    s_barrier
    ds_read_b128 v[56:59], v0 offset:6144
    ds_read_b128 v[60:63], v0 offset:7168
    ds_read_b128 v[32:35], v0 offset:0
    ds_read_b128 v[36:39], v0 offset:1024
    ds_read_b128 v[40:43], v0 offset:2048
    ds_read_b128 v[44:47], v0 offset:3072
    ds_read_b64_tr_b16 v[28:29], v4 offset:2304
    ds_read_b64_tr_b16 v[30:31], v4 offset:2432
    buffer_store_dwordx4 v[12:15], v0, s[8:11], s63 offen offset:2048 sc1
    s_waitcnt lgkmcnt(0)
    s_mov_b64 exec, s[36:37]
    buffer_store_dwordx4 v[28:31], v7, s[8:11], s62 offen offset:1024 sc1
    s_mov_b64 exec, -1
    v_smfmac_f32_16x16x64_bf16 v[120:123], v[48:51], a[160:167], v10
    v_smfmac_f32_16x16x64_bf16 v[124:127], v[48:51], a[168:175], v10
    v_smfmac_f32_16x16x64_bf16 v[120:123], v[52:55], a[176:183], v10
    v_smfmac_f32_16x16x64_bf16 v[124:127], v[52:55], a[184:191], v10
    ds_read_b128 v[64:67], v11 offset:8192
    ds_read_b128 v[68:71], v11 offset:9216
    ds_read_b128 v[72:75], v11 offset:10240
    ds_read_b128 v[76:79], v11 offset:11264
    ds_read_b128 v[80:83], v11 offset:12288
    ds_read_b128 v[84:87], v11 offset:13312
    ds_read_b128 v[88:91], v11 offset:14336
    ds_read_b128 v[92:95], v11 offset:15360
    s_waitcnt lgkmcnt(4)
    v_smfmac_f32_16x16x64_bf16 v[120:123], v[56:59], v[64:71], v10
    v_smfmac_f32_16x16x64_bf16 v[124:127], v[56:59], v[72:79], v10
    v_smfmac_f32_16x16x64_bf16 v[120:123], v[32:35], a[96:103], v10
    v_smfmac_f32_16x16x64_bf16 v[124:127], v[32:35], a[104:111], v10
    s_waitcnt lgkmcnt(0)
    v_smfmac_f32_16x16x64_bf16 v[120:123], v[60:63], v[80:87], v10
    v_smfmac_f32_16x16x64_bf16 v[124:127], v[60:63], v[88:95], v10
    v_smfmac_f32_16x16x64_bf16 v[120:123], v[36:39], a[112:119], v10
    v_smfmac_f32_16x16x64_bf16 v[124:127], v[36:39], a[120:127], v10
    v_smfmac_f32_16x16x64_bf16 v[120:123], v[40:43], a[128:135], v10
    v_smfmac_f32_16x16x64_bf16 v[124:127], v[40:43], a[136:143], v10
    v_smfmac_f32_16x16x64_bf16 v[120:123], v[44:47], a[144:151], v10
    v_smfmac_f32_16x16x64_bf16 v[124:127], v[44:47], a[152:159], v10
    v_mov_b64 v[112:113], 0
    v_mov_b64 v[114:115], 0
    v_mov_b64 v[116:117], 0
    v_mov_b64 v[118:119], 0
    v_smfmac_f32_16x16x64_bf16 v[112:115], v[32:35], v[128:135], v10
    v_smfmac_f32_16x16x64_bf16 v[116:119], v[32:35], v[136:143], v10
    v_add_f32 v120, v120, v122
    v_add_f32 v121, v121, v123
    v_smfmac_f32_16x16x64_bf16 v[112:115], v[36:39], v[144:151], v10
    v_add_f32 v124, v124, v126
    v_add_f32 v125, v125, v127
    v_smfmac_f32_16x16x64_bf16 v[116:119], v[36:39], v[152:159], v10
    v_cvt_pk_bf16_f32 v120, v120, v121
    v_cvt_pk_bf16_f32 v124, v124, v125
    v_smfmac_f32_16x16x64_bf16 v[112:115], v[40:43], v[160:167], v10
    ds_write2_b32 v3, v120, v124 offset0:64 offset1:192
    v_smfmac_f32_16x16x64_bf16 v[116:119], v[40:43], v[168:175], v10
    v_smfmac_f32_16x16x64_bf16 v[112:115], v[44:47], v[176:183], v10
    v_smfmac_f32_16x16x64_bf16 v[116:119], v[44:47], v[184:191], v10
    v_smfmac_f32_16x16x64_bf16 v[112:115], v[48:51], v[192:199], v10
    s_waitcnt lgkmcnt(0)
    s_barrier
    v_smfmac_f32_16x16x64_bf16 v[116:119], v[48:51], v[200:207], v10
    v_smfmac_f32_16x16x64_bf16 v[112:115], v[52:55], v[208:215], v10
    v_smfmac_f32_16x16x64_bf16 v[116:119], v[52:55], v[216:223], v10
    v_smfmac_f32_16x16x64_bf16 v[112:115], v[56:59], v[224:231], v10
    v_smfmac_f32_16x16x64_bf16 v[116:119], v[56:59], v[232:239], v10
    v_smfmac_f32_16x16x64_bf16 v[112:115], v[60:63], v[240:247], v10
    v_smfmac_f32_16x16x64_bf16 v[116:119], v[60:63], v[248:255], v10
    ds_read_b64_tr_b16 v[32:33], v4 offset:256
    ds_read_b64_tr_b16 v[34:35], v4 offset:384
    ds_read_b64_tr_b16 v[36:37], v4 offset:1280
    ds_read_b64_tr_b16 v[38:39], v4 offset:1408
    ds_read_b64_tr_b16 v[40:41], v4 offset:2304
    ds_read_b64_tr_b16 v[42:43], v4 offset:2432
    ds_read_b64_tr_b16 v[44:45], v4 offset:3328
    ds_read_b64_tr_b16 v[46:47], v4 offset:3456
    v_pk_add_f32 v[112:113], v[112:113], v[114:115]
    v_pk_add_f32 v[116:117], v[116:117], v[118:119]
    v_cvt_pk_bf16_f32 v12, v112, v113
    v_cvt_pk_bf16_f32 v14, v116, v117
    buffer_store_dwordx4 v[12:15], v0, s[8:11], s32 offen offset:2048 sc1
    s_waitcnt lgkmcnt(0)
    s_mov_b64 exec, s[36:37]
    buffer_store_dwordx4 v[40:43], v7, s[8:11], s31 offen offset:1024 sc1
    s_mov_b64 exec, -1
L_cfin2:
    s_waitcnt vmcnt(0)
    s_barrier
    s_memtime s[58:59]
    s_memrealtime s[76:77]
    s_waitcnt lgkmcnt(0)
    s_branch L_chain_end
L_p2r_2m:
    s_add_u32 s7, s7, 1
    s_cmp_lt_u32 s7, s6
    s_cbranch_scc0 L_p2r_2m_to
    s_mov_b32 m0, 4096
    s_nop 0
    buffer_load_dwordx4 v0, s[8:11], s47 offen sc1 lds
    buffer_load_dwordx4 v0, s[8:11], s47 offen offset:1024 sc1 lds
    s_waitcnt vmcnt(2)
    ds_read_b128 v[48:51], v0 offset:4096
    ds_read_b128 v[52:55], v0 offset:5120
    s_waitcnt lgkmcnt(0)
    v_max3_u32 v26, v48, v49, v50
    v_max3_u32 v27, v51, v52, v53
    v_max3_u32 v26, v26, v54, v55
    v_max_u32 v26, v26, v27
    v_cmp_eq_u32 vcc, -1, v26
    s_cbranch_vccnz L_p2r_2m
    s_branch L_p2d_2m
L_p2r_2m_to:
    s_mov_b32 s6, 0
    s_branch L_p2d_2m
L_p1r_2m:
    s_add_u32 s7, s7, 1
    s_cmp_lt_u32 s7, s6
    s_cbranch_scc0 L_p1r_2m_to
    buffer_load_dwordx4 v[96:99], v0, s[8:11], s24 offen sc1
    buffer_load_dwordx4 v[100:103], v0, s[8:11], s24 offen offset:1024 sc1
    s_branch L_p1w_2m
L_p1r_2m_to:
    s_mov_b32 s6, 0
    s_branch L_p1d_2m
L_p2r_2l:
    s_add_u32 s7, s7, 1
    s_cmp_lt_u32 s7, s6
    s_cbranch_scc0 L_p2r_2l_to
    s_mov_b32 m0, 4096
    s_nop 0
    buffer_load_dwordx4 v0, s[8:11], s47 offen sc1 lds
    buffer_load_dwordx4 v0, s[8:11], s47 offen offset:1024 sc1 lds
    s_waitcnt vmcnt(2)
    ds_read_b128 v[48:51], v0 offset:4096
    ds_read_b128 v[52:55], v0 offset:5120
    s_waitcnt lgkmcnt(0)
    v_max3_u32 v26, v48, v49, v50
    v_max3_u32 v27, v51, v52, v53
    v_max3_u32 v26, v26, v54, v55
    v_max_u32 v26, v26, v27
    v_cmp_eq_u32 vcc, -1, v26
    s_cbranch_vccnz L_p2r_2l
    s_branch L_p2d_2l
L_p2r_2l_to:
    s_mov_b32 s6, 0
    s_branch L_p2d_2l
L_p2r_2ms:
    s_add_u32 s7, s7, 1
    s_cmp_lt_u32 s7, s6
    s_cbranch_scc0 L_p2r_2ms_to
    s_mov_b32 m0, 4096
    s_nop 0
    buffer_load_dwordx4 v0, s[8:11], s47 offen sc1 lds
    buffer_load_dwordx4 v0, s[8:11], s47 offen offset:1024 sc1 lds
    s_waitcnt vmcnt(2)
    ds_read_b128 v[48:51], v0 offset:4096
    ds_read_b128 v[52:55], v0 offset:5120
    s_waitcnt lgkmcnt(0)
    v_max3_u32 v26, v48, v49, v50
    v_max3_u32 v27, v51, v52, v53
    v_max3_u32 v26, v26, v54, v55
    v_max_u32 v26, v26, v27
    v_cmp_eq_u32 vcc, -1, v26
    s_cbranch_vccnz L_p2r_2ms
    s_branch L_p2d_2ms
L_p2r_2ms_to:
    s_mov_b32 s6, 0
    s_branch L_p2d_2ms
L_p1r_2ms:
    s_add_u32 s7, s7, 1
    s_cmp_lt_u32 s7, s6
    s_cbranch_scc0 L_p1r_2ms_to
    buffer_load_dwordx4 v[96:99], v0, s[8:11], s24 offen sc1
    buffer_load_dwordx4 v[100:103], v0, s[8:11], s24 offen offset:1024 sc1
    s_branch L_p1w_2ms
L_p1r_2ms_to:
    s_mov_b32 s6, 0
    s_branch L_p1d_2ms
L_p2r_2ls:
    s_add_u32 s7, s7, 1
    s_cmp_lt_u32 s7, s6
    s_cbranch_scc0 L_p2r_2ls_to
    s_mov_b32 m0, 4096
    s_nop 0
    buffer_load_dwordx4 v0, s[8:11], s47 offen sc1 lds
    buffer_load_dwordx4 v0, s[8:11], s47 offen offset:1024 sc1 lds
    s_waitcnt vmcnt(2)
    ds_read_b128 v[48:51], v0 offset:4096
    ds_read_b128 v[52:55], v0 offset:5120
    s_waitcnt lgkmcnt(0)
    v_max3_u32 v26, v48, v49, v50
    v_max3_u32 v27, v51, v52, v53
    v_max3_u32 v26, v26, v54, v55
    v_max_u32 v26, v26, v27
    v_cmp_eq_u32 vcc, -1, v26
    s_cbranch_vccnz L_p2r_2ls
    s_branch L_p2d_2ls
L_p2r_2ls_to:
    s_mov_b32 s6, 0
    s_branch L_p2d_2ls
L_wave3:
    v_and_b32 v31, 63, v0
    v_lshlrev_b32 v0, 4, v31
    s_lshl_b32 s33, s3, 2
    s_add_u32 s33, s33, 3
    v_lshrrev_b32 v26, 2, v31
    v_lshlrev_b32 v26, 11, v26
    v_and_b32 v27, 3, v31
    v_lshlrev_b32 v27, 4, v27
    v_add_u32 v1, v26, v27
    s_lshr_b32 s34, s33, 4
    s_lshl_b32 s34, s34, 10
    s_and_b32 s35, s33, 3
    s_lshl_b32 s35, s35, 8
    s_add_u32 s34, s34, s35
    s_and_b32 s35, s33, 12
    s_lshl_b32 s35, s35, 4
    s_add_u32 s34, s34, s35
    v_bfe_u32 v26, v31, 4, 1
    v_lshlrev_b32 v26, 5, v26
    v_bfe_u32 v27, v31, 2, 1
    v_lshlrev_b32 v27, 4, v27
    v_and_b32 v28, 3, v31
    v_lshlrev_b32 v28, 2, v28
    v_add3_u32 v26, v26, v27, v28
    v_add_u32 v2, s34, v26
    v_and_b32 v26, 15, v31
    v_lshlrev_b32 v26, 4, v26
    v_lshrrev_b32 v27, 4, v31
    v_lshlrev_b32 v27, 2, v27
    v_add_u32 v26, v26, v27
    v_add_u32 v3, 11264, v26
    v_lshrrev_b32 v26, 5, v31
    v_lshlrev_b32 v26, 9, v26
    v_bfe_u32 v27, v31, 4, 1
    v_lshlrev_b32 v27, 6, v27
    v_bfe_u32 v28, v31, 2, 2
    v_lshlrev_b32 v28, 4, v28
    v_add3_u32 v26, v26, v27, v28
    v_bfe_u32 v27, v31, 1, 1
    v_lshlrev_b32 v27, 3, v27
    v_add_u32 v26, v26, v27
    v_add_u32 v4, 8192, v26
    v_lshrrev_b32 v26, 4, v31
    v_lshlrev_b32 v26, 9, v26
    v_and_b32 v27, 15, v31
    v_lshlrev_b32 v27, 4, v27
    v_add_u32 v26, v26, v27
    v_bfe_u32 v28, v31, 3, 1
    v_lshlrev_b32 v28, 8, v28
    v_add_u32 v5, v26, v28
    v_add_u32 v5, 16384, v5
    v_add_u32 v6, 16512, v26
    v_lshrrev_b32 v26, 4, v31
    v_lshlrev_b32 v26, 7, v26
    v_bfe_u32 v27, v31, 3, 1
    v_lshlrev_b32 v27, 6, v27
    v_and_b32 v28, 3, v31
    v_lshlrev_b32 v28, 4, v28
    v_add3_u32 v7, v26, v27, v28
    v_lshrrev_b32 v26, 4, v31
    v_lshlrev_b32 v26, 8, v26
    v_bfe_u32 v27, v31, 1, 1
    v_lshlrev_b32 v27, 7, v27
    v_bfe_u32 v28, v31, 2, 2
    v_lshlrev_b32 v28, 5, v28
    v_add3_u32 v26, v26, v27, v28
    v_and_b32 v27, 1, v31
    v_lshlrev_b32 v27, 4, v27
    v_add_u32 v26, v26, v27
    v_add_u32 v8, 12288, v26
    v_lshrrev_b32 v26, 5, v31
    v_lshlrev_b32 v26, 10, v26
    v_bfe_u32 v27, v31, 4, 1
    v_lshlrev_b32 v27, 9, v27
    v_and_b32 v28, 15, v31
    v_lshlrev_b32 v28, 4, v28
    v_add3_u32 v9, v26, v27, v28
    v_bfe_u32 v26, v31, 1, 1
    v_mov_b32 v27, 0x4444
    v_mov_b32 v28, 0xeeee
    v_cmp_eq_u32 vcc, 1, v26
    s_nop 1
    v_cndmask_b32 v10, v27, v28, vcc
    v_add_u32 v11, 131072, v0
    v_mov_b32 v13, 0
    v_mov_b32 v15, 0
    v_mov_b32 v24, 0x3f803f80
    v_mov_b32 v25, 0
    v_bfe_u32 v26, v31, 1, 3
    v_cmp_eq_u32 s[48:49], 0, v26
    v_cmp_eq_u32 s[50:51], 1, v26
    v_cmp_eq_u32 s[52:53], 2, v26
    v_cmp_eq_u32 s[54:55], 3, v26
    s_mov_b32 s36, 0x0f0f0f0f
    s_mov_b32 s37, 0x0f0f0f0f
    s_mov_b32 s38, 0xffff0000
    s_mov_b32 s39, 0xffff0000
    s_mov_b32 s40, 0x00ff00ff
    s_mov_b32 s41, 0
    s_mov_b32 s42, 0xf0f0f0f0
    s_mov_b32 s43, 0xf0f0f0f0
    s_mov_b32 s46, 0x3e0293ee
    v_lshrrev_b32 v26, 4, v31
    v_bfe_u32 v27, v31, 1, 3
    v_add_u32 v28, 0, v26
    v_xor_b32 v27, v27, v28
    v_lshlrev_b32 v27, 5, v27
    v_and_b32 v28, 1, v31
    v_lshlrev_b32 v28, 4, v28
    v_add_u32 v27, v27, v28
    v_and_b32 v28, 1, v26
    v_lshlrev_b32 v28, 17, v28
    v_add_u32 v96, v27, v28
    v_lshrrev_b32 v28, 1, v26
    v_lshlrev_b32 v28, 18, v28
    v_add_u32 v96, v96, v28
    v_and_b32 v28, 1, v26
    v_lshlrev_b32 v28, 10, v28
    v_add_u32 v98, v27, v28
    v_lshrrev_b32 v28, 1, v26
    v_lshlrev_b32 v28, 12, v28
    v_add_u32 v98, v98, v28
    v_lshrrev_b32 v26, 4, v31
    v_bfe_u32 v27, v31, 1, 3
    v_add_u32 v28, 4, v26
    v_xor_b32 v27, v27, v28
    v_lshlrev_b32 v27, 5, v27
    v_and_b32 v28, 1, v31
    v_lshlrev_b32 v28, 4, v28
    v_add_u32 v27, v27, v28
    v_and_b32 v28, 1, v26
    v_lshlrev_b32 v28, 17, v28
    v_add_u32 v97, v27, v28
    v_lshrrev_b32 v28, 1, v26
    v_lshlrev_b32 v28, 18, v28
    v_add_u32 v97, v97, v28
    v_and_b32 v28, 1, v26
    v_lshlrev_b32 v28, 10, v28
    v_add_u32 v99, v27, v28
    v_lshrrev_b32 v28, 1, v26
    v_lshlrev_b32 v28, 12, v28
    v_add_u32 v99, v99, v28
    v_lshrrev_b32 v26, 2, v31
    v_lshlrev_b32 v27, 8, v26
    v_and_b32 v26, 7, v26
    v_lshlrev_b32 v26, 5, v26
    v_and_b32 v28, 3, v31
    v_lshlrev_b32 v28, 3, v28
    v_add3_u32 v26, v26, v27, v28
    v_add_u32 v104, 32768, v26
    v_xor_b32 v100, 192, v104
    v_xor_b32 v101, 32, v100
    v_add_u32 v102, 0x10000, v100
    v_add_u32 v103, 0x10000, v101
    s_lshl_b32 s60, s3, 8
    s_add_u32 s60, s60, 73728
    s_lshl_b32 s61, s3, 17
    s_add_u32 s61, s61, 34816
    v_add_u32 v107, 0xffff8000, v100
    v_add_u32 v108, 0xffff8000, v101
    s_mov_b32 m0, 45056
    s_add_u32 s34, s60, 0
    buffer_load_dwordx4 v96, s[84:87], s34 offen lds
    s_mov_b32 m0, 46080
    s_add_u32 s34, s60, 16384
    buffer_load_dwordx4 v97, s[84:87], s34 offen lds
    s_mov_b32 m0, 47104
    s_add_u32 s34, s60, 32768
    buffer_load_dwordx4 v96, s[84:87], s34 offen lds
    s_mov_b32 m0, 48128
    s_add_u32 s34, s60, 49152
    buffer_load_dwordx4 v97, s[84:87], s34 offen lds
    s_mov_b32 m0, 61440
    s_add_u32 s34, s60, 524288
    buffer_load_dwordx4 v96, s[84:87], s34 offen lds
    s_mov_b32 m0, 62464
    s_add_u32 s34, s60, 540672
    buffer_load_dwordx4 v97, s[84:87], s34 offen lds
    s_mov_b32 m0, 63488
    s_add_u32 s34, s60, 557056
    buffer_load_dwordx4 v96, s[84:87], s34 offen lds
    s_mov_b32 m0, 64512
    s_add_u32 s34, s60, 573440
    buffer_load_dwordx4 v97, s[84:87], s34 offen lds
    s_mov_b32 m0, 77824
    s_add_u32 s34, s60, 1048576
    buffer_load_dwordx4 v96, s[84:87], s34 offen lds
    s_mov_b32 m0, 78848
    s_add_u32 s34, s60, 1064960
    buffer_load_dwordx4 v97, s[84:87], s34 offen lds
    s_mov_b32 m0, 79872
    s_add_u32 s34, s60, 1081344
    buffer_load_dwordx4 v96, s[84:87], s34 offen lds
    s_mov_b32 m0, 80896
    s_add_u32 s34, s60, 1097728
    buffer_load_dwordx4 v97, s[84:87], s34 offen lds
    s_mov_b32 m0, 94208
    s_add_u32 s34, s60, 1572864
    buffer_load_dwordx4 v96, s[84:87], s34 offen lds
    s_mov_b32 m0, 95232
    s_add_u32 s34, s60, 1589248
    buffer_load_dwordx4 v97, s[84:87], s34 offen lds
    s_mov_b32 m0, 96256
    s_add_u32 s34, s60, 1605632
    buffer_load_dwordx4 v96, s[84:87], s34 offen lds
    s_mov_b32 m0, 97280
    s_add_u32 s34, s60, 1622016
    buffer_load_dwordx4 v97, s[84:87], s34 offen lds
    s_mov_b32 m0, 110592
    s_add_u32 s34, s60, 2097152
    buffer_load_dwordx4 v96, s[84:87], s34 offen lds
    s_mov_b32 m0, 111616
    s_add_u32 s34, s60, 2113536
    buffer_load_dwordx4 v97, s[84:87], s34 offen lds
    s_mov_b32 m0, 112640
    s_add_u32 s34, s60, 2129920
    buffer_load_dwordx4 v96, s[84:87], s34 offen lds
    s_mov_b32 m0, 113664
    s_add_u32 s34, s60, 2146304
    buffer_load_dwordx4 v97, s[84:87], s34 offen lds
    s_mov_b32 m0, 126976
    s_add_u32 s34, s60, 2621440
    buffer_load_dwordx4 v96, s[84:87], s34 offen lds
    s_mov_b32 m0, 128000
    s_add_u32 s34, s60, 2637824
    buffer_load_dwordx4 v97, s[84:87], s34 offen lds
    s_mov_b32 m0, 129024
    s_add_u32 s34, s60, 2654208
    buffer_load_dwordx4 v96, s[84:87], s34 offen lds
    s_mov_b32 m0, 130048
    s_add_u32 s34, s60, 2670592
    buffer_load_dwordx4 v97, s[84:87], s34 offen lds
    s_mov_b32 m0, 143360
    s_add_u32 s34, s60, 0
    buffer_load_dwordx4 v96, s[88:91], s34 offen lds
    s_mov_b32 m0, 144384
    s_add_u32 s34, s60, 16384
    buffer_load_dwordx4 v97, s[88:91], s34 offen lds
    s_mov_b32 m0, 145408
    s_add_u32 s34, s60, 32768
    buffer_load_dwordx4 v96, s[88:91], s34 offen lds
    s_mov_b32 m0, 146432
    s_add_u32 s34, s60, 49152
    buffer_load_dwordx4 v97, s[88:91], s34 offen lds
    s_mov_b32 m0, 159744
    s_add_u32 s34, s60, 524288
    buffer_load_dwordx4 v96, s[88:91], s34 offen lds
    s_mov_b32 m0, 160768
    s_add_u32 s34, s60, 540672
    buffer_load_dwordx4 v97, s[88:91], s34 offen lds
    s_mov_b32 m0, 161792
    s_add_u32 s34, s60, 557056
    buffer_load_dwordx4 v96, s[88:91], s34 offen lds
    s_mov_b32 m0, 162816
    s_add_u32 s34, s60, 573440
    buffer_load_dwordx4 v97, s[88:91], s34 offen lds
    s_mov_b32 m0, 12288
    s_add_u32 s34, s60, 1048576
    buffer_load_dwordx4 v96, s[88:91], s34 offen lds
    s_mov_b32 m0, 13312
    s_add_u32 s34, s60, 1064960
    buffer_load_dwordx4 v97, s[88:91], s34 offen lds
    s_mov_b32 m0, 14336
    s_add_u32 s34, s60, 1081344
    buffer_load_dwordx4 v96, s[88:91], s34 offen lds
    s_mov_b32 m0, 15360
    s_add_u32 s34, s60, 1097728
    buffer_load_dwordx4 v97, s[88:91], s34 offen lds
    s_mov_b32 m0, 28672
    s_add_u32 s34, s60, 1572864
    buffer_load_dwordx4 v96, s[88:91], s34 offen lds
    s_mov_b32 m0, 29696
    s_add_u32 s34, s60, 1589248
    buffer_load_dwordx4 v97, s[88:91], s34 offen lds
    s_mov_b32 m0, 30720
    s_add_u32 s34, s60, 1605632
    buffer_load_dwordx4 v96, s[88:91], s34 offen lds
    s_mov_b32 m0, 31744
    s_add_u32 s34, s60, 1622016
    buffer_load_dwordx4 v97, s[88:91], s34 offen lds
    s_cmp_lg_u32 s3, 0
    s_cbranch_scc1 L_nofi_3
    v_mov_b64 v[64:65], 0
    v_mov_b64 v[66:67], 0
    s_mov_b32 s33, 274432
    buffer_store_dwordx4 v[64:67], v0, s[8:11], s33 offen offset:0 sc1
    buffer_store_dwordx4 v[64:67], v0, s[8:11], s33 offen offset:1024 sc1
    buffer_store_dwordx4 v[64:67], v0, s[8:11], s33 offen offset:2048 sc1
    buffer_store_dwordx4 v[64:67], v0, s[8:11], s33 offen offset:3072 sc1
L_nofi_3:
    s_nop 1
    v_mov_b32 v64, -1
    v_mov_b32 v65, -1
    v_mov_b32 v66, -1
    v_mov_b32 v67, -1
    s_lshl_b32 s33, s3, 13
    s_add_u32 s33, s33, 1054720
    buffer_store_dwordx4 v[64:67], v0, s[8:11], s33 offen sc1
    buffer_store_dwordx4 v[64:67], v0, s[8:11], s33 offen offset:1024 sc1
    s_add_u32 s33, s33, 262144
    buffer_store_dwordx4 v[64:67], v0, s[8:11], s33 offen sc1
    buffer_store_dwordx4 v[64:67], v0, s[8:11], s33 offen offset:1024 sc1
    s_lshl_b32 s33, s3, 2
    s_add_u32 s33, s33, 3
    s_lshr_b32 s34, s33, 4
    s_lshl_b32 s34, s34, 7
    s_and_b32 s35, s33, 3
    s_lshl_b32 s35, s35, 3
    s_add_u32 s34, s34, s35
    s_bfe_u32 s35, s33, 0x20002
    s_lshl_b32 s35, s35, 11
    s_add_u32 s34, s34, s35
    v_bfe_u32 v68, v31, 4, 1
    v_lshlrev_b32 v68, 6, v68
    v_bfe_u32 v69, v31, 2, 1
    v_lshlrev_b32 v69, 10, v69
    v_and_b32 v70, 3, v31
    v_lshlrev_b32 v70, 1, v70
    v_add3_u32 v68, v68, v69, v70
    v_add_u32 v68, s34, v68
    buffer_load_ushort v69, v68, s[12:15], 0 offen
    buffer_load_ushort v70, v68, s[12:15], 0 offen offset:32
    s_waitcnt vmcnt(0)
    v_lshl_or_b32 v69, v70, 16, v69
    v_min_u32 v69, -2, v69
    s_mov_b64 exec, s[40:41]
    s_mov_b32 s33, 1572864
    buffer_store_dword v69, v2, s[8:11], s33 offen sc1
    s_mov_b32 s33, 1581056
    buffer_store_dword v64, v2, s[8:11], s33 offen sc1
    s_mov_b32 s33, 1589248
    buffer_store_dword v64, v2, s[8:11], s33 offen sc1
    s_mov_b64 exec, -1
    s_waitcnt vmcnt(0)
    s_barrier
    s_waitcnt vmcnt(36) lgkmcnt(0)
    s_barrier
    ds_read_b64_tr_b16 a[0:1], v100 offset:0
    ds_read_b64_tr_b16 a[2:3], v100 offset:4096
    ds_read_b64_tr_b16 a[4:5], v100 offset:8192
    ds_read_b64_tr_b16 a[6:7], v100 offset:12288
    ds_read_b64_tr_b16 a[8:9], v101 offset:0
    ds_read_b64_tr_b16 a[10:11], v101 offset:4096
    ds_read_b64_tr_b16 a[12:13], v101 offset:8192
    ds_read_b64_tr_b16 a[14:15], v101 offset:12288
    s_waitcnt vmcnt(32) lgkmcnt(0)
    s_barrier
    ds_read_b64_tr_b16 a[16:17], v100 offset:16384
    ds_read_b64_tr_b16 a[18:19], v100 offset:20480
    ds_read_b64_tr_b16 a[20:21], v100 offset:24576
    ds_read_b64_tr_b16 a[22:23], v100 offset:28672
    ds_read_b64_tr_b16 a[24:25], v101 offset:16384
    ds_read_b64_tr_b16 a[26:27], v101 offset:20480
    ds_read_b64_tr_b16 a[28:29], v101 offset:24576
    ds_read_b64_tr_b16 a[30:31], v101 offset:28672
    s_mov_b32 m0, 45056
    s_add_u32 s34, s60, 2097152
    buffer_load_dwordx4 v96, s[88:91], s34 offen lds
    s_mov_b32 m0, 46080
    s_add_u32 s34, s60, 2113536
    buffer_load_dwordx4 v97, s[88:91], s34 offen lds
    s_mov_b32 m0, 47104
    s_add_u32 s34, s60, 2129920
    buffer_load_dwordx4 v96, s[88:91], s34 offen lds
    s_mov_b32 m0, 48128
    s_add_u32 s34, s60, 2146304
    buffer_load_dwordx4 v97, s[88:91], s34 offen lds
    s_waitcnt vmcnt(32) lgkmcnt(0)
    s_barrier
    ds_read_b64_tr_b16 a[32:33], v100 offset:32768
    ds_read_b64_tr_b16 a[34:35], v100 offset:36864
    ds_read_b64_tr_b16 a[36:37], v100 offset:40960
    ds_read_b64_tr_b16 a[38:39], v100 offset:45056
    ds_read_b64_tr_b16 a[40:41], v101 offset:32768
    ds_read_b64_tr_b16 a[42:43], v101 offset:36864
    ds_read_b64_tr_b16 a[44:45], v101 offset:40960
    ds_read_b64_tr_b16 a[46:47], v101 offset:45056
    s_mov_b32 m0, 61440
    s_add_u32 s34, s60, 2621440
    buffer_load_dwordx4 v96, s[88:91], s34 offen lds
    s_mov_b32 m0, 62464
    s_add_u32 s34, s60, 2637824
    buffer_load_dwordx4 v97, s[88:91], s34 offen lds
    s_mov_b32 m0, 63488
    s_add_u32 s34, s60, 2654208
    buffer_load_dwordx4 v96, s[88:91], s34 offen lds
    s_mov_b32 m0, 64512
    s_add_u32 s34, s60, 2670592
    buffer_load_dwordx4 v97, s[88:91], s34 offen lds
    s_waitcnt vmcnt(32) lgkmcnt(0)
    s_barrier
    ds_read_b64_tr_b16 a[48:49], v100 offset:49152
    ds_read_b64_tr_b16 a[50:51], v100 offset:53248
    ds_read_b64_tr_b16 a[52:53], v100 offset:57344
    ds_read_b64_tr_b16 a[54:55], v100 offset:61440
    ds_read_b64_tr_b16 a[56:57], v101 offset:49152
    ds_read_b64_tr_b16 a[58:59], v101 offset:53248
    ds_read_b64_tr_b16 a[60:61], v101 offset:57344
    ds_read_b64_tr_b16 a[62:63], v101 offset:61440
    s_mov_b32 m0, 77824
    s_add_u32 s34, s60, 0
    buffer_load_dwordx4 v96, s[92:95], s34 offen lds
    s_mov_b32 m0, 78848
    s_add_u32 s34, s60, 16384
    buffer_load_dwordx4 v97, s[92:95], s34 offen lds
    s_mov_b32 m0, 79872
    s_add_u32 s34, s60, 32768
    buffer_load_dwordx4 v96, s[92:95], s34 offen lds
    s_mov_b32 m0, 80896
    s_add_u32 s34, s60, 49152
    buffer_load_dwordx4 v97, s[92:95], s34 offen lds
    s_waitcnt vmcnt(32) lgkmcnt(0)
    s_barrier
    ds_read_b64_tr_b16 a[64:65], v102 offset:0
    ds_read_b64_tr_b16 a[66:67], v102 offset:4096
    ds_read_b64_tr_b16 a[68:69], v102 offset:8192
    ds_read_b64_tr_b16 a[70:71], v102 offset:12288
    ds_read_b64_tr_b16 a[72:73], v103 offset:0
    ds_read_b64_tr_b16 a[74:75], v103 offset:4096
    ds_read_b64_tr_b16 a[76:77], v103 offset:8192
    ds_read_b64_tr_b16 a[78:79], v103 offset:12288
    s_mov_b32 m0, 94208
    s_add_u32 s34, s60, 524288
    buffer_load_dwordx4 v96, s[92:95], s34 offen lds
    s_mov_b32 m0, 95232
    s_add_u32 s34, s60, 540672
    buffer_load_dwordx4 v97, s[92:95], s34 offen lds
    s_mov_b32 m0, 96256
    s_add_u32 s34, s60, 557056
    buffer_load_dwordx4 v96, s[92:95], s34 offen lds
    s_mov_b32 m0, 97280
    s_add_u32 s34, s60, 573440
    buffer_load_dwordx4 v97, s[92:95], s34 offen lds
    s_waitcnt vmcnt(32) lgkmcnt(0)
    s_barrier
    ds_read_b64_tr_b16 a[80:81], v102 offset:16384
    ds_read_b64_tr_b16 a[82:83], v102 offset:20480
    ds_read_b64_tr_b16 a[84:85], v102 offset:24576
    ds_read_b64_tr_b16 a[86:87], v102 offset:28672
    ds_read_b64_tr_b16 a[88:89], v103 offset:16384
    ds_read_b64_tr_b16 a[90:91], v103 offset:20480
    ds_read_b64_tr_b16 a[92:93], v103 offset:24576
    ds_read_b64_tr_b16 a[94:95], v103 offset:28672
    s_mov_b32 m0, 110592
    s_add_u32 s34, s60, 1048576
    buffer_load_dwordx4 v96, s[92:95], s34 offen lds
    s_mov_b32 m0, 111616
    s_add_u32 s34, s60, 1064960
    buffer_load_dwordx4 v97, s[92:95], s34 offen lds
    s_mov_b32 m0, 112640
    s_add_u32 s34, s60, 1081344
    buffer_load_dwordx4 v96, s[92:95], s34 offen lds
    s_mov_b32 m0, 113664
    s_add_u32 s34, s60, 1097728
    buffer_load_dwordx4 v97, s[92:95], s34 offen lds
    s_waitcnt vmcnt(32) lgkmcnt(0)
    s_barrier
    ds_read_b64_tr_b16 a[96:97], v102 offset:32768
    ds_read_b64_tr_b16 a[98:99], v102 offset:36864
    ds_read_b64_tr_b16 a[100:101], v102 offset:40960
    ds_read_b64_tr_b16 a[102:103], v102 offset:45056
    ds_read_b64_tr_b16 a[104:105], v103 offset:32768
    ds_read_b64_tr_b16 a[106:107], v103 offset:36864
    ds_read_b64_tr_b16 a[108:109], v103 offset:40960
    ds_read_b64_tr_b16 a[110:111], v103 offset:45056
    s_mov_b32 m0, 126976
    s_add_u32 s34, s60, 1572864
    buffer_load_dwordx4 v96, s[92:95], s34 offen lds
    s_mov_b32 m0, 128000
    s_add_u32 s34, s60, 1589248
    buffer_load_dwordx4 v97, s[92:95], s34 offen lds
    s_mov_b32 m0, 129024
    s_add_u32 s34, s60, 1605632
    buffer_load_dwordx4 v96, s[92:95], s34 offen lds
    s_mov_b32 m0, 130048
    s_add_u32 s34, s60, 1622016
    buffer_load_dwordx4 v97, s[92:95], s34 offen lds
    s_waitcnt vmcnt(32) lgkmcnt(0)
    s_barrier
    ds_read_b64_tr_b16 a[112:113], v102 offset:49152
    ds_read_b64_tr_b16 a[114:115], v102 offset:53248
    ds_read_b64_tr_b16 a[116:117], v102 offset:57344
    ds_read_b64_tr_b16 a[118:119], v102 offset:61440
    ds_read_b64_tr_b16 a[120:121], v103 offset:49152
    ds_read_b64_tr_b16 a[122:123], v103 offset:53248
    ds_read_b64_tr_b16 a[124:125], v103 offset:57344
    ds_read_b64_tr_b16 a[126:127], v103 offset:61440
    s_mov_b32 m0, 143360
    s_add_u32 s34, s60, 2097152
    buffer_load_dwordx4 v96, s[92:95], s34 offen lds
    s_mov_b32 m0, 144384
    s_add_u32 s34, s60, 2113536
    buffer_load_dwordx4 v97, s[92:95], s34 offen lds
    s_mov_b32 m0, 145408
    s_add_u32 s34, s60, 2129920
    buffer_load_dwordx4 v96, s[92:95], s34 offen lds
    s_mov_b32 m0, 146432
    s_add_u32 s34, s60, 2146304
    buffer_load_dwordx4 v97, s[92:95], s34 offen lds
    s_waitcnt vmcnt(32) lgkmcnt(0)
    s_barrier
    ds_read_b64_tr_b16 a[128:129], v107 offset:0
    ds_read_b64_tr_b16 a[130:131], v107 offset:4096
    ds_read_b64_tr_b16 a[132:133], v107 offset:8192
    ds_read_b64_tr_b16 a[134:135], v107 offset:12288
    ds_read_b64_tr_b16 a[136:137], v108 offset:0
    ds_read_b64_tr_b16 a[138:139], v108 offset:4096
    ds_read_b64_tr_b16 a[140:141], v108 offset:8192
    ds_read_b64_tr_b16 a[142:143], v108 offset:12288
    s_mov_b32 m0, 159744
    s_add_u32 s34, s60, 2621440
    buffer_load_dwordx4 v96, s[92:95], s34 offen lds
    s_mov_b32 m0, 160768
    s_add_u32 s34, s60, 2637824
    buffer_load_dwordx4 v97, s[92:95], s34 offen lds
    s_mov_b32 m0, 161792
    s_add_u32 s34, s60, 2654208
    buffer_load_dwordx4 v96, s[92:95], s34 offen lds
    s_mov_b32 m0, 162816
    s_add_u32 s34, s60, 2670592
    buffer_load_dwordx4 v97, s[92:95], s34 offen lds
    s_waitcnt vmcnt(32) lgkmcnt(0)
    s_barrier
    ds_read_b64_tr_b16 a[144:145], v107 offset:16384
    ds_read_b64_tr_b16 a[146:147], v107 offset:20480
    ds_read_b64_tr_b16 a[148:149], v107 offset:24576
    ds_read_b64_tr_b16 a[150:151], v107 offset:28672
    ds_read_b64_tr_b16 a[152:153], v108 offset:16384
    ds_read_b64_tr_b16 a[154:155], v108 offset:20480
    ds_read_b64_tr_b16 a[156:157], v108 offset:24576
    ds_read_b64_tr_b16 a[158:159], v108 offset:28672
    s_mov_b32 m0, 12288
    s_add_u32 s34, s60, 3145728
    buffer_load_dwordx4 v96, s[92:95], s34 offen lds
    s_mov_b32 m0, 13312
    s_add_u32 s34, s60, 3162112
    buffer_load_dwordx4 v97, s[92:95], s34 offen lds
    s_mov_b32 m0, 14336
    s_add_u32 s34, s60, 3178496
    buffer_load_dwordx4 v96, s[92:95], s34 offen lds
    s_mov_b32 m0, 15360
    s_add_u32 s34, s60, 3194880
    buffer_load_dwordx4 v97, s[92:95], s34 offen lds
    s_waitcnt vmcnt(32) lgkmcnt(0)
    s_barrier
    ds_read_b64_tr_b16 a[160:161], v100 offset:0
    ds_read_b64_tr_b16 a[162:163], v100 offset:4096
    ds_read_b64_tr_b16 a[164:165], v100 offset:8192
    ds_read_b64_tr_b16 a[166:167], v100 offset:12288
    ds_read_b64_tr_b16 a[168:169], v101 offset:0
    ds_read_b64_tr_b16 a[170:171], v101 offset:4096
    ds_read_b64_tr_b16 a[172:173], v101 offset:8192
    ds_read_b64_tr_b16 a[174:175], v101 offset:12288
    s_mov_b32 m0, 28672
    s_add_u32 s34, s60, 3670016
    buffer_load_dwordx4 v96, s[92:95], s34 offen lds
    s_mov_b32 m0, 29696
    s_add_u32 s34, s60, 3686400
    buffer_load_dwordx4 v97, s[92:95], s34 offen lds
    s_mov_b32 m0, 30720
    s_add_u32 s34, s60, 3702784
    buffer_load_dwordx4 v96, s[92:95], s34 offen lds
    s_mov_b32 m0, 31744
    s_add_u32 s34, s60, 3719168
    buffer_load_dwordx4 v97, s[92:95], s34 offen lds
    s_waitcnt vmcnt(32) lgkmcnt(0)
    s_barrier
    ds_read_b64_tr_b16 a[176:177], v100 offset:16384
    ds_read_b64_tr_b16 a[178:179], v100 offset:20480
    ds_read_b64_tr_b16 a[180:181], v100 offset:24576
    ds_read_b64_tr_b16 a[182:183], v100 offset:28672
    ds_read_b64_tr_b16 a[184:185], v101 offset:16384
    ds_read_b64_tr_b16 a[186:187], v101 offset:20480
    ds_read_b64_tr_b16 a[188:189], v101 offset:24576
    ds_read_b64_tr_b16 a[190:191], v101 offset:28672
    s_mov_b32 m0, 45056
    s_add_u32 s34, s61, 0
    buffer_load_dwordx4 v98, s[96:99], s34 offen lds
    s_mov_b32 m0, 46080
    s_add_u32 s34, s61, 16384
    buffer_load_dwordx4 v99, s[96:99], s34 offen lds
    s_mov_b32 m0, 47104
    s_add_u32 s34, s61, 8192
    buffer_load_dwordx4 v98, s[96:99], s34 offen lds
    s_mov_b32 m0, 48128
    s_add_u32 s34, s61, 24576
    buffer_load_dwordx4 v99, s[96:99], s34 offen lds
    s_waitcnt vmcnt(32) lgkmcnt(0)
    s_barrier
    ds_read_b64_tr_b16 v[128:129], v100 offset:32768
    ds_read_b64_tr_b16 v[130:131], v100 offset:36864
    ds_read_b64_tr_b16 v[132:133], v100 offset:40960
    ds_read_b64_tr_b16 v[134:135], v100 offset:45056
    ds_read_b64_tr_b16 v[136:137], v101 offset:32768
    ds_read_b64_tr_b16 v[138:139], v101 offset:36864
    ds_read_b64_tr_b16 v[140:141], v101 offset:40960
    ds_read_b64_tr_b16 v[142:143], v101 offset:45056
    s_mov_b32 m0, 61440
    s_add_u32 s34, s61, 256
    buffer_load_dwordx4 v98, s[96:99], s34 offen lds
    s_mov_b32 m0, 62464
    s_add_u32 s34, s61, 16640
    buffer_load_dwordx4 v99, s[96:99], s34 offen lds
    s_mov_b32 m0, 63488
    s_add_u32 s34, s61, 8448
    buffer_load_dwordx4 v98, s[96:99], s34 offen lds
    s_mov_b32 m0, 64512
    s_add_u32 s34, s61, 24832
    buffer_load_dwordx4 v99, s[96:99], s34 offen lds
    s_waitcnt vmcnt(32) lgkmcnt(0)
    s_barrier
    ds_read_b64_tr_b16 v[144:145], v100 offset:49152
    ds_read_b64_tr_b16 v[146:147], v100 offset:53248
    ds_read_b64_tr_b16 v[148:149], v100 offset:57344
    ds_read_b64_tr_b16 v[150:151], v100 offset:61440
    ds_read_b64_tr_b16 v[152:153], v101 offset:49152
    ds_read_b64_tr_b16 v[154:155], v101 offset:53248
    ds_read_b64_tr_b16 v[156:157], v101 offset:57344
    ds_read_b64_tr_b16 v[158:159], v101 offset:61440
    s_mov_b32 m0, 77824
    s_add_u32 s34, s61, 512
    buffer_load_dwordx4 v98, s[96:99], s34 offen lds
    s_mov_b32 m0, 78848
    s_add_u32 s34, s61, 16896
    buffer_load_dwordx4 v99, s[96:99], s34 offen lds
    s_mov_b32 m0, 79872
    s_add_u32 s34, s61, 8704
    buffer_load_dwordx4 v98, s[96:99], s34 offen lds
    s_mov_b32 m0, 80896
    s_add_u32 s34, s61, 25088
    buffer_load_dwordx4 v99, s[96:99], s34 offen lds
    s_waitcnt vmcnt(32) lgkmcnt(0)
    s_barrier
    ds_read_b64_tr_b16 v[160:161], v102 offset:0
    ds_read_b64_tr_b16 v[162:163], v102 offset:4096
    ds_read_b64_tr_b16 v[164:165], v102 offset:8192
    ds_read_b64_tr_b16 v[166:167], v102 offset:12288
    ds_read_b64_tr_b16 v[168:169], v103 offset:0
    ds_read_b64_tr_b16 v[170:171], v103 offset:4096
    ds_read_b64_tr_b16 v[172:173], v103 offset:8192
    ds_read_b64_tr_b16 v[174:175], v103 offset:12288
    s_mov_b32 m0, 94208
    s_add_u32 s34, s61, 768
    buffer_load_dwordx4 v98, s[96:99], s34 offen lds
    s_mov_b32 m0, 95232
    s_add_u32 s34, s61, 17152
    buffer_load_dwordx4 v99, s[96:99], s34 offen lds
    s_mov_b32 m0, 96256
    s_add_u32 s34, s61, 8960
    buffer_load_dwordx4 v98, s[96:99], s34 offen lds
    s_mov_b32 m0, 97280
    s_add_u32 s34, s61, 25344
    buffer_load_dwordx4 v99, s[96:99], s34 offen lds
    v_mov_b32 v19, 28
    global_load_dword v16, v19, s[16:17] sc1
    v_mov_b32 v20, 16
    global_load_dword v17, v20, s[16:17] sc1
    s_waitcnt vmcnt(32) lgkmcnt(0)
    s_barrier
    ds_read_b64_tr_b16 v[176:177], v102 offset:16384
    ds_read_b64_tr_b16 v[178:179], v102 offset:20480
    ds_read_b64_tr_b16 v[180:181], v102 offset:24576
    ds_read_b64_tr_b16 v[182:183], v102 offset:28672
    ds_read_b64_tr_b16 v[184:185], v103 offset:16384
    ds_read_b64_tr_b16 v[186:187], v103 offset:20480
    ds_read_b64_tr_b16 v[188:189], v103 offset:24576
    ds_read_b64_tr_b16 v[190:191], v103 offset:28672
    s_mov_b32 m0, 110592
    s_add_u32 s34, s60, 3145728
    buffer_load_dwordx4 v96, s[88:91], s34 offen lds
    s_mov_b32 m0, 111616
    s_add_u32 s34, s60, 3162112
    buffer_load_dwordx4 v97, s[88:91], s34 offen lds
    s_mov_b32 m0, 112640
    s_add_u32 s34, s60, 3178496
    buffer_load_dwordx4 v96, s[88:91], s34 offen lds
    s_mov_b32 m0, 113664
    s_add_u32 s34, s60, 3194880
    buffer_load_dwordx4 v97, s[88:91], s34 offen lds
    s_waitcnt vmcnt(32) lgkmcnt(0)
    s_barrier
    ds_read_b64_tr_b16 v[192:193], v102 offset:32768
    ds_read_b64_tr_b16 v[194:195], v102 offset:36864
    ds_read_b64_tr_b16 v[196:197], v102 offset:40960
    ds_read_b64_tr_b16 v[198:199], v102 offset:45056
    ds_read_b64_tr_b16 v[200:201], v103 offset:32768
    ds_read_b64_tr_b16 v[202:203], v103 offset:36864
    ds_read_b64_tr_b16 v[204:205], v103 offset:40960
    ds_read_b64_tr_b16 v[206:207], v103 offset:45056
    s_mov_b32 m0, 126976
    s_add_u32 s34, s61, 66048
    buffer_load_dwordx4 v98, s[96:99], s34 offen lds
    s_mov_b32 m0, 128000
    s_add_u32 s34, s61, 82432
    buffer_load_dwordx4 v99, s[96:99], s34 offen lds
    s_mov_b32 m0, 129024
    s_add_u32 s34, s61, 74240
    buffer_load_dwordx4 v98, s[96:99], s34 offen lds
    s_mov_b32 m0, 130048
    s_add_u32 s34, s61, 90624
    buffer_load_dwordx4 v99, s[96:99], s34 offen lds
    s_waitcnt vmcnt(32) lgkmcnt(0)
    s_barrier
    ds_read_b64_tr_b16 v[208:209], v102 offset:49152
    ds_read_b64_tr_b16 v[210:211], v102 offset:53248
    ds_read_b64_tr_b16 v[212:213], v102 offset:57344
    ds_read_b64_tr_b16 v[214:215], v102 offset:61440
    ds_read_b64_tr_b16 v[216:217], v103 offset:49152
    ds_read_b64_tr_b16 v[218:219], v103 offset:53248
    ds_read_b64_tr_b16 v[220:221], v103 offset:57344
    ds_read_b64_tr_b16 v[222:223], v103 offset:61440
    s_mov_b32 m0, 143360
    s_add_u32 s34, s60, 3670016
    buffer_load_dwordx4 v96, s[88:91], s34 offen lds
    s_mov_b32 m0, 144384
    s_add_u32 s34, s60, 3686400
    buffer_load_dwordx4 v97, s[88:91], s34 offen lds
    s_mov_b32 m0, 145408
    s_add_u32 s34, s60, 3702784
    buffer_load_dwordx4 v96, s[88:91], s34 offen lds
    s_mov_b32 m0, 146432
    s_add_u32 s34, s60, 3719168
    buffer_load_dwordx4 v97, s[88:91], s34 offen lds
    s_waitcnt vmcnt(32) lgkmcnt(0)
    s_barrier
    ds_read_b64_tr_b16 v[224:225], v107 offset:0
    ds_read_b64_tr_b16 v[226:227], v107 offset:4096
    ds_read_b64_tr_b16 v[228:229], v107 offset:8192
    ds_read_b64_tr_b16 v[230:231], v107 offset:12288
    ds_read_b64_tr_b16 v[232:233], v108 offset:0
    ds_read_b64_tr_b16 v[234:235], v108 offset:4096
    ds_read_b64_tr_b16 v[236:237], v108 offset:8192
    ds_read_b64_tr_b16 v[238:239], v108 offset:12288
    s_mov_b32 m0, 159744
    s_add_u32 s34, s61, 66304
    buffer_load_dwordx4 v98, s[96:99], s34 offen lds
    s_mov_b32 m0, 160768
    s_add_u32 s34, s61, 82688
    buffer_load_dwordx4 v99, s[96:99], s34 offen lds
    s_mov_b32 m0, 161792
    s_add_u32 s34, s61, 74496
    buffer_load_dwordx4 v98, s[96:99], s34 offen lds
    s_mov_b32 m0, 162816
    s_add_u32 s34, s61, 90880
    buffer_load_dwordx4 v99, s[96:99], s34 offen lds
    s_waitcnt vmcnt(32) lgkmcnt(0)
    s_barrier
    ds_read_b64_tr_b16 v[240:241], v107 offset:16384
    ds_read_b64_tr_b16 v[242:243], v107 offset:20480
    ds_read_b64_tr_b16 v[244:245], v107 offset:24576
    ds_read_b64_tr_b16 v[246:247], v107 offset:28672
    ds_read_b64_tr_b16 v[248:249], v108 offset:16384
    ds_read_b64_tr_b16 v[250:251], v108 offset:20480
    ds_read_b64_tr_b16 v[252:253], v108 offset:24576
    ds_read_b64_tr_b16 v[254:255], v108 offset:28672
    s_waitcnt vmcnt(28) lgkmcnt(0)
    s_barrier
    s_waitcnt vmcnt(24) lgkmcnt(0)
    s_barrier
    s_mov_b32 m0, 45056
    s_add_u32 s34, s60, 3145728
    buffer_load_dwordx4 v96, s[84:87], s34 offen lds
    s_mov_b32 m0, 46080
    s_add_u32 s34, s60, 3162112
    buffer_load_dwordx4 v97, s[84:87], s34 offen lds
    s_mov_b32 m0, 47104
    s_add_u32 s34, s60, 3178496
    buffer_load_dwordx4 v96, s[84:87], s34 offen lds
    s_mov_b32 m0, 48128
    s_add_u32 s34, s60, 3194880
    buffer_load_dwordx4 v97, s[84:87], s34 offen lds
    s_waitcnt vmcnt(24) lgkmcnt(0)
    s_barrier
    s_mov_b32 m0, 61440
    s_add_u32 s34, s61, 65536
    buffer_load_dwordx4 v98, s[96:99], s34 offen lds
    s_mov_b32 m0, 62464
    s_add_u32 s34, s61, 81920
    buffer_load_dwordx4 v99, s[96:99], s34 offen lds
    s_mov_b32 m0, 63488
    s_add_u32 s34, s61, 73728
    buffer_load_dwordx4 v98, s[96:99], s34 offen lds
    s_mov_b32 m0, 64512
    s_add_u32 s34, s61, 90112
    buffer_load_dwordx4 v99, s[96:99], s34 offen lds
    s_waitcnt vmcnt(24) lgkmcnt(0)
    s_barrier
    v_add_u32 v105, 49152, v104
    v_xor_b32 v106, 0, v105
    ds_read_b64_tr_b16 a[192:193], v106 offset:0
    ds_read_b64_tr_b16 a[194:195], v106 offset:4096
    ds_read_b64_tr_b16 a[196:197], v106 offset:8192
    ds_read_b64_tr_b16 a[198:199], v106 offset:12288
    v_xor_b32 v106, 32, v105
    ds_read_b64_tr_b16 a[200:201], v106 offset:0
    ds_read_b64_tr_b16 a[202:203], v106 offset:4096
    ds_read_b64_tr_b16 a[204:205], v106 offset:8192
    ds_read_b64_tr_b16 a[206:207], v106 offset:12288
    s_waitcnt lgkmcnt(0)
    v_xor_b32 v106, 64, v105
    ds_read_b64_tr_b16 a[208:209], v106 offset:0
    ds_read_b64_tr_b16 a[210:211], v106 offset:4096
    ds_read_b64_tr_b16 a[212:213], v106 offset:8192
    ds_read_b64_tr_b16 a[214:215], v106 offset:12288
    v_xor_b32 v106, 96, v105
    ds_read_b64_tr_b16 a[216:217], v106 offset:0
    ds_read_b64_tr_b16 a[218:219], v106 offset:4096
    ds_read_b64_tr_b16 a[220:221], v106 offset:8192
    ds_read_b64_tr_b16 a[222:223], v106 offset:12288
    s_waitcnt lgkmcnt(0)
    v_xor_b32 v106, 128, v105
    ds_read_b64_tr_b16 a[224:225], v106 offset:0
    ds_read_b64_tr_b16 a[226:227], v106 offset:4096
    ds_read_b64_tr_b16 a[228:229], v106 offset:8192
    ds_read_b64_tr_b16 a[230:231], v106 offset:12288
    v_xor_b32 v106, 160, v105
    ds_read_b64_tr_b16 a[232:233], v106 offset:0
    ds_read_b64_tr_b16 a[234:235], v106 offset:4096
    ds_read_b64_tr_b16 a[236:237], v106 offset:8192
    ds_read_b64_tr_b16 a[238:239], v106 offset:12288
    s_waitcnt lgkmcnt(0)
    v_xor_b32 v106, 192, v105
    ds_read_b64_tr_b16 a[240:241], v106 offset:0
    ds_read_b64_tr_b16 a[242:243], v106 offset:4096
    ds_read_b64_tr_b16 a[244:245], v106 offset:8192
    ds_read_b64_tr_b16 a[246:247], v106 offset:12288
    v_xor_b32 v106, 224, v105
    ds_read_b64_tr_b16 a[248:249], v106 offset:0
    ds_read_b64_tr_b16 a[250:251], v106 offset:4096
    ds_read_b64_tr_b16 a[252:253], v106 offset:8192
    ds_read_b64_tr_b16 a[254:255], v106 offset:12288
    s_waitcnt lgkmcnt(0)
    s_mov_b32 m0, 77824
    s_add_u32 s34, s60, 3670016
    buffer_load_dwordx4 v96, s[84:87], s34 offen lds
    s_mov_b32 m0, 78848
    s_add_u32 s34, s60, 3686400
    buffer_load_dwordx4 v97, s[84:87], s34 offen lds
    s_mov_b32 m0, 79872
    s_add_u32 s34, s60, 3702784
    buffer_load_dwordx4 v96, s[84:87], s34 offen lds
    s_mov_b32 m0, 80896
    s_add_u32 s34, s60, 3719168
    buffer_load_dwordx4 v97, s[84:87], s34 offen lds
    s_waitcnt lgkmcnt(0)
    s_barrier
    v_mov_b32 v21, 262144
    buffer_load_dword v18, v21, s[8:11], 0 offen sc1
    s_mov_b32 m0, 94208
    s_add_u32 s34, s61, 65792
    buffer_load_dwordx4 v98, s[96:99], s34 offen lds
    s_mov_b32 m0, 95232
    s_add_u32 s34, s61, 82176
    buffer_load_dwordx4 v99, s[96:99], s34 offen lds
    s_mov_b32 m0, 96256
    s_add_u32 s34, s61, 73984
    buffer_load_dwordx4 v98, s[96:99], s34 offen lds
    s_mov_b32 m0, 97280
    s_add_u32 s34, s61, 90368
    buffer_load_dwordx4 v99, s[96:99], s34 offen lds
    s_waitcnt vmcnt(0)
    s_barrier
    v_readfirstlane_b32 s33, v17
    s_lshr_b32 s71, s33, 16
    s_and_b32 s33, s33, 0xffff
    s_cmp_ge_u32 s33, 32
    s_cbranch_scc1 L_cbd3
    v_mov_b32 v26, 16
    s_mov_b32 s7, 0
L_cb3:
    global_load_dword v27, v26, s[16:17] sc1
    s_waitcnt vmcnt(0)
    v_readfirstlane_b32 s33, v27
    s_lshr_b32 s71, s33, 16
    s_and_b32 s33, s33, 0xffff
    s_cmp_ge_u32 s33, 32
    s_cbranch_scc1 L_cbd3
    s_add_u32 s7, s7, 1
    s_cmp_lt_u32 s7, s6
    s_cbranch_scc1 L_cb3
    s_mov_b32 s6, 0
L_cbd3:
    v_readfirstlane_b32 s33, v16
    v_readfirstlane_b32 s34, v18
    s_and_b32 s34, s34, 0xff
    s_cmp_eq_u32 s34, 128
    s_cselect_b32 s34, s33, 0
    s_cmp_lg_u32 s34, 0
    s_cbranch_scc1 L_kv0d_3
    v_mov_b32 v26, 28
    s_mov_b32 s7, 0
L_ini_3:
    global_load_dword v27, v26, s[16:17] sc1
    s_waitcnt vmcnt(0)
    v_readfirstlane_b32 s33, v27
    s_cmp_lg_u32 s33, 0
    s_cbranch_scc1 L_inid_3
    s_add_u32 s7, s7, 1
    s_cmp_lt_u32 s7, 100000
    s_cbranch_scc1 L_ini_3
L_inid_3:
    v_mov_b32 v26, 262144
    s_mov_b32 s7, 0
L_kv0_3:
    buffer_load_dword v27, v26, s[8:11], 0 offen sc1
    s_waitcnt vmcnt(0)
    v_readfirstlane_b32 s33, v27
    s_and_b32 s33, s33, 0xff
    s_cmp_eq_u32 s33, 128
    s_cbranch_scc1 L_kv0d_3
    s_sleep 2
    s_add_u32 s7, s7, 1
    s_cmp_lt_u32 s7, 400000
    s_cbranch_scc1 L_kv0_3
L_kv0d_3:
    s_lshl_b32 s33, s3, 13
    s_add_u32 s33, s33, 6144
    s_add_u32 s28, s33, 16777216
    s_mov_b32 s29, 22528
    s_mov_b32 m0, s29
    s_add_u32 s30, s33, 33554432
    buffer_load_dwordx4 v0, s[8:11], s28 offen lds
    buffer_load_dwordx4 v0, s[8:11], s28 offen offset:1024 lds
    buffer_load_dwordx4 v[16:19], v9, s[8:11], s30 offen
    buffer_load_dwordx4 v[20:23], v9, s[8:11], s30 offen offset:256
    s_add_u32 s28, s28, 0x40000
    s_xor_b32 s29, s29, 8192
    s_add_u32 s30, s30, 0x40000
    s_mov_b32 s5, 0
    s_mov_b32 s20, 1572864
    s_mov_b32 s21, 1581056
    s_mov_b32 s22, 1589248
    s_lshl_b32 s33, s3, 6
    s_add_u32 s23, s33, 1245184
    s_add_u32 s25, s23, 32768
    s_lshl_b32 s33, s3, 13
    s_add_u32 s24, s33, 1054720
    s_add_u32 s26, s24, 262144
    s_lshl_b32 s33, s3, 11
    s_add_u32 s31, s33, 83886080
    s_lshl_b32 s33, s3, 12
    s_add_u32 s32, s33, 92274688
    s_mov_b32 s45, 2097152
    s_mov_b32 s62, 0x0F000000
    s_mov_b32 s63, 0x0F000000
    s_mov_b32 s96, 0x3e0293ee
    s_mov_b32 s97, 0x3e0293ee
    s_mov_b32 s98, 0x3f803f80
    s_mov_b32 s99, 0x3f803f80
    s_mov_b32 s100, 0xaaaaaaaa
    s_mov_b32 s101, 0xaaaaaaaa
    ds_read_b64_tr_b16 v[32:33], v100 offset:0
    ds_read_b64_tr_b16 v[34:35], v100 offset:4096
    ds_read_b64_tr_b16 v[36:37], v100 offset:8192
    ds_read_b64_tr_b16 v[38:39], v100 offset:12288
    ds_read_b64_tr_b16 v[40:41], v101 offset:0
    ds_read_b64_tr_b16 v[42:43], v101 offset:4096
    ds_read_b64_tr_b16 v[44:45], v101 offset:8192
    ds_read_b64_tr_b16 v[46:47], v101 offset:12288
    s_waitcnt lgkmcnt(0)
    ds_read_b64_tr_b16 v[48:49], v100 offset:32768
    ds_read_b64_tr_b16 v[50:51], v100 offset:36864
    ds_read_b64_tr_b16 v[52:53], v100 offset:40960
    ds_read_b64_tr_b16 v[54:55], v100 offset:45056
    ds_read_b64_tr_b16 v[56:57], v101 offset:32768
    ds_read_b64_tr_b16 v[58:59], v101 offset:36864
    ds_read_b64_tr_b16 v[60:61], v101 offset:40960
    ds_read_b64_tr_b16 v[62:63], v101 offset:45056
    s_waitcnt lgkmcnt(0)
    ds_read_b64_tr_b16 v[64:65], v102 offset:0
    ds_read_b64_tr_b16 v[66:67], v102 offset:4096
    ds_read_b64_tr_b16 v[68:69], v102 offset:8192
    ds_read_b64_tr_b16 v[70:71], v102 offset:12288
    ds_read_b64_tr_b16 v[72:73], v103 offset:0
    ds_read_b64_tr_b16 v[74:75], v103 offset:4096
    ds_read_b64_tr_b16 v[76:77], v103 offset:8192
    ds_read_b64_tr_b16 v[78:79], v103 offset:12288
    s_waitcnt lgkmcnt(0)
    ds_read_b64_tr_b16 v[80:81], v102 offset:32768
    ds_read_b64_tr_b16 v[82:83], v102 offset:36864
    ds_read_b64_tr_b16 v[84:85], v102 offset:40960
    ds_read_b64_tr_b16 v[86:87], v102 offset:45056
    ds_read_b64_tr_b16 v[88:89], v103 offset:32768
    ds_read_b64_tr_b16 v[90:91], v103 offset:36864
    ds_read_b64_tr_b16 v[92:93], v103 offset:40960
    ds_read_b64_tr_b16 v[94:95], v103 offset:45056
    s_waitcnt lgkmcnt(0)
    s_barrier
    ds_write_b128 v11, v[32:35] offset:0
    ds_write_b128 v11, v[36:39] offset:1024
    ds_write_b128 v11, v[40:43] offset:2048
    ds_write_b128 v11, v[44:47] offset:3072
    ds_write_b128 v11, v[48:51] offset:4096
    ds_write_b128 v11, v[52:55] offset:5120
    ds_write_b128 v11, v[56:59] offset:6144
    ds_write_b128 v11, v[60:63] offset:7168
    ds_write_b128 v11, v[64:67] offset:8192
    ds_write_b128 v11, v[68:71] offset:9216
    ds_write_b128 v11, v[72:75] offset:10240
    ds_write_b128 v11, v[76:79] offset:11264
    ds_write_b128 v11, v[80:83] offset:12288
    ds_write_b128 v11, v[84:87] offset:13312
    ds_write_b128 v11, v[88:91] offset:14336
    ds_write_b128 v11, v[92:95] offset:15360
    s_waitcnt lgkmcnt(0)
    v_add_u32 v105, 114688, v104
    v_xor_b32 v106, 0, v105
    ds_read_b64_tr_b16 v[32:33], v106 offset:0
    ds_read_b64_tr_b16 v[34:35], v106 offset:4096
    ds_read_b64_tr_b16 v[36:37], v106 offset:8192
    ds_read_b64_tr_b16 v[38:39], v106 offset:12288
    v_xor_b32 v106, 32, v105
    ds_read_b64_tr_b16 v[40:41], v106 offset:0
    ds_read_b64_tr_b16 v[42:43], v106 offset:4096
    ds_read_b64_tr_b16 v[44:45], v106 offset:8192
    ds_read_b64_tr_b16 v[46:47], v106 offset:12288
    s_waitcnt lgkmcnt(0)
    v_xor_b32 v106, 64, v105
    ds_read_b64_tr_b16 v[48:49], v106 offset:0
    ds_read_b64_tr_b16 v[50:51], v106 offset:4096
    ds_read_b64_tr_b16 v[52:53], v106 offset:8192
    ds_read_b64_tr_b16 v[54:55], v106 offset:12288
    v_xor_b32 v106, 96, v105
    ds_read_b64_tr_b16 v[56:57], v106 offset:0
    ds_read_b64_tr_b16 v[58:59], v106 offset:4096
    ds_read_b64_tr_b16 v[60:61], v106 offset:8192
    ds_read_b64_tr_b16 v[62:63], v106 offset:12288
    s_waitcnt lgkmcnt(0)
    v_xor_b32 v106, 128, v105
    ds_read_b64_tr_b16 v[64:65], v106 offset:0
    ds_read_b64_tr_b16 v[66:67], v106 offset:4096
    ds_read_b64_tr_b16 v[68:69], v106 offset:8192
    ds_read_b64_tr_b16 v[70:71], v106 offset:12288
    v_xor_b32 v106, 160, v105
    ds_read_b64_tr_b16 v[72:73], v106 offset:0
    ds_read_b64_tr_b16 v[74:75], v106 offset:4096
    ds_read_b64_tr_b16 v[76:77], v106 offset:8192
    ds_read_b64_tr_b16 v[78:79], v106 offset:12288
    s_waitcnt lgkmcnt(0)
    v_xor_b32 v106, 192, v105
    ds_read_b64_tr_b16 v[80:81], v106 offset:0
    ds_read_b64_tr_b16 v[82:83], v106 offset:4096
    ds_read_b64_tr_b16 v[84:85], v106 offset:8192
    ds_read_b64_tr_b16 v[86:87], v106 offset:12288
    v_xor_b32 v106, 224, v105
    ds_read_b64_tr_b16 v[88:89], v106 offset:0
    ds_read_b64_tr_b16 v[90:91], v106 offset:4096
    ds_read_b64_tr_b16 v[92:93], v106 offset:8192
    ds_read_b64_tr_b16 v[94:95], v106 offset:12288
    s_waitcnt lgkmcnt(0)
    s_waitcnt lgkmcnt(0)
    ds_write_b128 v11, v[32:35] offset:16384
    ds_write_b128 v11, v[36:39] offset:17408
    ds_write_b128 v11, v[40:43] offset:18432
    ds_write_b128 v11, v[44:47] offset:19456
    ds_write_b128 v11, v[48:51] offset:20480
    ds_write_b128 v11, v[52:55] offset:21504
    ds_write_b128 v11, v[56:59] offset:22528
    ds_write_b128 v11, v[60:63] offset:23552
    ds_write_b128 v11, v[64:67] offset:24576
    ds_write_b128 v11, v[68:71] offset:25600
    ds_write_b128 v11, v[72:75] offset:26624
    ds_write_b128 v11, v[76:79] offset:27648
    ds_write_b128 v11, v[80:83] offset:28672
    ds_write_b128 v11, v[84:87] offset:29696
    ds_write_b128 v11, v[88:91] offset:30720
    ds_write_b128 v11, v[92:95] offset:31744
    s_waitcnt lgkmcnt(0)
    s_barrier
    s_mov_b32 s84, 0
    s_mov_b32 s85, 0
    s_mov_b32 s86, 0
    s_mov_b32 s87, 0
    s_mov_b32 s88, 0
    s_mov_b32 s89, 0
    s_mov_b32 s90, 0
    s_mov_b32 s91, 0
    s_mov_b32 s92, 0
    s_mov_b32 s93, 0
    s_waitcnt vmcnt(0)
    s_barrier
    ds_read_b128 v[64:67], v11 offset:0
    ds_read_b128 v[68:71], v11 offset:1024
    ds_read_b128 v[72:75], v11 offset:2048
    ds_read_b128 v[76:79], v11 offset:3072
    ds_read_b128 v[80:83], v11 offset:4096
    ds_read_b128 v[84:87], v11 offset:5120
    ds_read_b128 v[88:91], v11 offset:6144
    ds_read_b128 v[92:95], v11 offset:7168
    v_mov_b32 v112, 0
    v_mov_b32 v113, 0
    v_mov_b32 v114, 0
    v_mov_b32 v115, 0
    v_mov_b32 v116, 0
    v_mov_b32 v117, 0
    v_mov_b32 v118, 0
    v_mov_b32 v119, 0
    v_mov_b32 v120, 0
    v_mov_b32 v121, 0
    v_mov_b32 v122, 0
    v_mov_b32 v123, 0
    v_mov_b32 v124, 0
    v_mov_b32 v125, 0
    v_mov_b32 v126, 0
    v_mov_b32 v127, 0
    v_mov_b64 v[28:29], -1
    v_mov_b64 v[30:31], -1
    v_mov_b64 v[104:105], -1
    v_mov_b64 v[106:107], -1
    s_add_u32 s47, s20, 6144
    s_mov_b32 s7, 0
    s_sleep 2
    s_mov_b32 m0, 6144
    s_nop 0
    buffer_load_dwordx4 v0, s[8:11], s47 offen sc1 lds
    buffer_load_dwordx4 v0, s[8:11], s47 offen offset:1024 sc1 lds
    s_mov_b32 m0, 6144
    s_nop 0
    buffer_load_dwordx4 v0, s[8:11], s47 offen sc1 lds
    buffer_load_dwordx4 v0, s[8:11], s47 offen offset:1024 sc1 lds
    s_memtime s[56:57]
    s_memrealtime s[74:75]
    s_waitcnt vmcnt(0) lgkmcnt(0)
    s_mov_b32 s94, s56
    s_cmp_lg_u32 s71, 0
    s_cbranch_scc1 L_step3s
L_step3:
    s_waitcnt vmcnt(2)
    ds_read_b128 v[56:59], v0 offset:6144
    ds_read_b128 v[60:63], v0 offset:7168
    s_waitcnt lgkmcnt(0)
    v_max3_u32 v26, v56, v57, v58
    v_max3_u32 v27, v59, v60, v61
    v_max3_u32 v26, v26, v62, v63
    v_max_u32 v26, v26, v27
    v_cmp_eq_u32 vcc, -1, v26
    s_cbranch_vccnz L_p2r_3m
L_p2d_3m:
    s_barrier
    ds_read_b128 v[32:35], v0 offset:0
    ds_read_b128 v[36:39], v0 offset:1024
    v_smfmac_f32_16x16x64_bf16 v[112:115], v[56:59], v[64:71], v10
    ds_read_b128 v[40:43], v0 offset:2048
    v_smfmac_f32_16x16x64_bf16 v[116:119], v[56:59], v[72:79], v10
    ds_read_b128 v[44:47], v0 offset:3072
    s_mov_b32 m0, s29
    s_nop 0
    buffer_load_dwordx4 v0, s[8:11], s28 offen lds
    v_smfmac_f32_16x16x64_bf16 v[112:115], v[60:63], v[80:87], v10
    ds_read_b128 v[48:51], v0 offset:4096
    v_smfmac_f32_16x16x64_bf16 v[116:119], v[60:63], v[88:95], v10
    ds_read_b128 v[52:55], v0 offset:5120
    s_waitcnt lgkmcnt(5)
    v_smfmac_f32_16x16x64_bf16 v[112:115], v[32:35], a[0:7], v10
    ds_read_b64_tr_b16 v[28:29], v4 offset:3328
    buffer_load_dwordx4 v0, s[8:11], s28 offen offset:1024 lds
    v_smfmac_f32_16x16x64_bf16 v[116:119], v[32:35], a[8:15], v10
    ds_read_b64_tr_b16 v[30:31], v4 offset:3456
    s_waitcnt lgkmcnt(6)
    v_smfmac_f32_16x16x64_bf16 v[112:115], v[36:39], a[16:23], v10
    ds_read_b128 v[64:67], v11 offset:8192
    s_mov_b32 m0, 15872
    s_nop 0
    buffer_load_dword v9, s[8:11], s30 offen lds
    v_smfmac_f32_16x16x64_bf16 v[116:119], v[36:39], a[24:31], v10
    ds_read_b128 v[68:71], v11 offset:9216
    s_waitcnt lgkmcnt(7)
    v_smfmac_f32_16x16x64_bf16 v[112:115], v[40:43], a[32:39], v10
    ds_read_b128 v[72:75], v11 offset:10240
    v_smfmac_f32_16x16x64_bf16 v[116:119], v[40:43], a[40:47], v10
    ds_read_b128 v[76:79], v11 offset:11264
    buffer_load_dword v9, s[8:11], s30 offen offset:256 lds
    s_waitcnt lgkmcnt(8)
    v_smfmac_f32_16x16x64_bf16 v[112:115], v[44:47], a[48:55], v10
    ds_read_b128 v[80:83], v11 offset:12288
    v_smfmac_f32_16x16x64_bf16 v[116:119], v[44:47], a[56:63], v10
    ds_read_b128 v[84:87], v11 offset:13312
    s_waitcnt lgkmcnt(9)
    v_smfmac_f32_16x16x64_bf16 v[112:115], v[48:51], a[64:71], v10
    ds_read_b128 v[88:91], v11 offset:14336
    v_smfmac_f32_16x16x64_bf16 v[116:119], v[48:51], a[72:79], v10
    ds_read_b128 v[92:95], v11 offset:15360
    s_waitcnt lgkmcnt(10)
    v_smfmac_f32_16x16x64_bf16 v[112:115], v[52:55], a[80:87], v10
    v_smfmac_f32_16x16x64_bf16 v[116:119], v[52:55], a[88:95], v10
    v_smfmac_f32_16x16x64_bf16 v[120:123], v[32:35], a[96:103], v10
    v_smfmac_f32_16x16x64_bf16 v[124:127], v[32:35], a[104:111], v10
    v_add_f32 v112, v112, v114
    s_waitcnt lgkmcnt(4)
    v_smfmac_f32_16x16x64_bf16 v[120:123], v[56:59], v[64:71], v10
    v_add_f32 v113, v113, v115
    v_add_f32 v116, v116, v118
    v_smfmac_f32_16x16x64_bf16 v[124:127], v[56:59], v[72:79], v10
    v_add_f32 v117, v117, v119
    v_cvt_pk_bf16_f32 v112, v112, v113
    v_smfmac_f32_16x16x64_bf16 v[120:123], v[36:39], a[112:119], v10
    ds_read_b128 v[64:67], v5 offset:0
    v_cvt_pk_bf16_f32 v116, v116, v117
    v_smfmac_f32_16x16x64_bf16 v[124:127], v[36:39], a[120:127], v10
    ds_write2_b32 v3, v112, v116 offset0:0 offset1:128
    ds_read_b128 v[68:71], v5 offset:2048
    s_waitcnt lgkmcnt(3)
    v_smfmac_f32_16x16x64_bf16 v[120:123], v[60:63], v[80:87], v10
    ds_read_b128 v[72:75], v5 offset:4096
    v_smfmac_f32_16x16x64_bf16 v[124:127], v[60:63], v[88:95], v10
    ds_read_b128 v[76:79], v5 offset:6144
    buffer_store_dwordx4 v[12:15], v0, s[8:11], s63 offen offset:3072 sc1
    v_smfmac_f32_16x16x64_bf16 v[120:123], v[40:43], a[128:135], v10
    ds_read_b128 v[80:83], v6 offset:0
    v_smfmac_f32_16x16x64_bf16 v[124:127], v[40:43], a[136:143], v10
    ds_read_b128 v[84:87], v6 offset:2048
    v_smfmac_f32_16x16x64_bf16 v[120:123], v[44:47], a[144:151], v10
    ds_read_b128 v[88:91], v6 offset:4096
    v_smfmac_f32_16x16x64_bf16 v[124:127], v[44:47], a[152:159], v10
    ds_read_b128 v[92:95], v6 offset:6144
    v_smfmac_f32_16x16x64_bf16 v[120:123], v[48:51], a[160:167], v10
    s_waitcnt lgkmcnt(7)
    v_smfmac_f32_16x16x64_bf16 v[124:127], v[48:51], a[168:175], v10
    v_mov_b64 v[112:113], 0
    v_smfmac_f32_16x16x64_bf16 v[120:123], v[52:55], a[176:183], v10
    v_mov_b64 v[114:115], 0
    v_smfmac_f32_16x16x64_bf16 v[124:127], v[52:55], a[184:191], v10
    v_mov_b64 v[116:117], 0
    v_mov_b64 v[118:119], 0
    v_smfmac_f32_16x16x64_bf16 v[112:115], v[32:35], v[128:135], v10
    v_smfmac_f32_16x16x64_bf16 v[116:119], v[32:35], v[136:143], v10
    v_add_f32 v120, v120, v122
    v_add_f32 v121, v121, v123
    v_smfmac_f32_16x16x64_bf16 v[112:115], v[36:39], v[144:151], v10
    v_add_f32 v124, v124, v126
    v_add_f32 v125, v125, v127
    v_smfmac_f32_16x16x64_bf16 v[116:119], v[36:39], v[152:159], v10
    v_cvt_pk_bf16_f32 v120, v120, v121
    v_cvt_pk_bf16_f32 v124, v124, v125
    v_smfmac_f32_16x16x64_bf16 v[112:115], v[40:43], v[160:167], v10
    ds_write2_b32 v3, v120, v124 offset0:64 offset1:192
    v_smfmac_f32_16x16x64_bf16 v[116:119], v[40:43], v[168:175], v10
    v_smfmac_f32_16x16x64_bf16 v[112:115], v[44:47], v[176:183], v10
    v_smfmac_f32_16x16x64_bf16 v[116:119], v[44:47], v[184:191], v10
    v_smfmac_f32_16x16x64_bf16 v[112:115], v[48:51], v[192:199], v10
    s_mov_b64 exec, s[36:37]
    buffer_store_dwordx4 v[28:31], v7, s[8:11], s62 offen offset:1536 sc1
    s_mov_b64 exec, -1
    s_waitcnt lgkmcnt(0)
    s_barrier
    ds_read_b64_tr_b16 v[96:97], v4 offset:0
    ds_read_b64_tr_b16 v[98:99], v4 offset:128
    v_smfmac_f32_16x16x64_bf16 v[116:119], v[48:51], v[200:207], v10
    ds_read_b64_tr_b16 v[100:101], v4 offset:1024
    ds_read_b64_tr_b16 v[102:103], v4 offset:1152
    v_smfmac_f32_16x16x64_bf16 v[112:115], v[52:55], v[208:215], v10
    ds_read_b64_tr_b16 v[104:105], v4 offset:2048
    ds_read_b64_tr_b16 v[106:107], v4 offset:2176
    v_smfmac_f32_16x16x64_bf16 v[116:119], v[52:55], v[216:223], v10
    ds_read_b64_tr_b16 v[108:109], v4 offset:3072
    ds_read_b64_tr_b16 v[110:111], v4 offset:3200
    v_smfmac_f32_16x16x64_bf16 v[112:115], v[56:59], v[224:231], v10
    v_smfmac_f32_16x16x64_bf16 v[116:119], v[56:59], v[232:239], v10
    v_smfmac_f32_16x16x64_bf16 v[112:115], v[60:63], v[240:247], v10
    v_smfmac_f32_16x16x64_bf16 v[116:119], v[60:63], v[248:255], v10
    s_waitcnt vmcnt(6)
    ds_read_b64_tr_b16 v[32:33], v4 offset:256
    ds_read_b64_tr_b16 v[34:35], v4 offset:384
    ds_read_b64_tr_b16 v[36:37], v4 offset:1280
    ds_read_b64_tr_b16 v[38:39], v4 offset:1408
    s_waitcnt lgkmcnt(10)
    v_mfma_f32_16x16x32_bf16 v[120:123], v[64:67], v[96:99], 0
    ds_read_b64_tr_b16 v[40:41], v4 offset:2304
    s_waitcnt lgkmcnt(9)
    v_mfma_f32_16x16x32_bf16 v[120:123], v[68:71], v[100:103], v[120:123]
    ds_read_b64_tr_b16 v[42:43], v4 offset:2432
    v_add_f32 v112, v112, v114
    v_add_f32 v113, v113, v115
    s_waitcnt lgkmcnt(8)
    v_mfma_f32_16x16x32_bf16 v[120:123], v[72:75], v[104:107], v[120:123]
    ds_read_b64_tr_b16 v[44:45], v4 offset:3328
    v_add_f32 v116, v116, v118
    v_add_f32 v117, v117, v119
    s_waitcnt lgkmcnt(7)
    v_mfma_f32_16x16x32_bf16 v[120:123], v[76:79], v[108:111], v[120:123]
    ds_read_b64_tr_b16 v[46:47], v4 offset:3456
    v_mov_b64 v[52:53], s[98:99]
    v_mov_b64 v[54:55], s[98:99]
    v_mfma_f32_16x16x32_bf16 v[124:127], v[80:83], v[96:99], 0
    ds_read_b128 v[64:67], v11 offset:16384
    v_cvt_pk_bf16_f32 v12, v112, v113
    v_cvt_pk_bf16_f32 v14, v116, v117
    v_mfma_f32_16x16x32_bf16 v[124:127], v[84:87], v[100:103], v[124:127]
    ds_read_b128 v[68:71], v11 offset:17408
    v_mfma_f32_16x16x32_bf16 v[124:127], v[88:91], v[104:107], v[124:127]
    ds_read_b128 v[72:75], v11 offset:18432
    v_max3_f32 v26, v120, v121, v122
    v_mfma_f32_16x16x32_bf16 v[124:127], v[92:95], v[108:111], v[124:127]
    ds_read_b128 v[76:79], v11 offset:19456
    v_max_f32 v26, v26, v123
    s_waitcnt lgkmcnt(10)
    v_mfma_f32_16x16x32_bf16 v[48:51], v[32:35], v[96:99], 0
    ds_read_b128 v[80:83], v11 offset:20480
    s_waitcnt lgkmcnt(9)
    v_mfma_f32_16x16x32_bf16 v[48:51], v[36:39], v[100:103], v[48:51]
    ds_read_b128 v[84:87], v11 offset:21504
    v_max3_f32 v27, v124, v125, v126
    v_mov_b64 v[96:97], 0
    s_waitcnt lgkmcnt(8)
    v_mfma_f32_16x16x32_bf16 v[48:51], v[40:43], v[104:107], v[48:51]
    ds_read_b128 v[88:91], v11 offset:22528
    v_mov_b64 v[98:99], 0
    v_max3_f32 v26, v26, v127, v27
    s_waitcnt lgkmcnt(7)
    v_mfma_f32_16x16x32_bf16 v[48:51], v[44:47], v[108:111], v[48:51]
    ds_read_b128 v[92:95], v11 offset:23552
    v_mov_b64 v[100:101], 0
    v_mov_b64 v[102:103], 0
    v_mov_b64 v[104:105], 0
    v_mov_b64 v[106:107], 0
    v_mov_b64 v[108:109], 0
    v_mov_b64 v[110:111], 0
    s_nop 0
    v_max3_f32 v26, v26, v48, v49
    v_max3_f32 v26, v26, v50, v51
    v_cndmask_b32 v48, v48, v50, s[38:39]
    v_mov_b32 v27, v26
    v_cndmask_b32 v49, v49, v51, s[38:39]
    s_nop 0
    v_permlane16_swap_b32 v26, v27
    v_max_f32 v26, v26, v27
    v_mov_b32 v27, v26
    v_mov_b32 v61, 0
    s_nop 0
    v_permlane32_swap_b32 v26, v27
    v_max_f32 v26, v26, v27
    v_mul_f32 v28, s46, v26
    v_pk_fma_f32 v[120:121], v[120:121], s[96:97], v[28:29] op_sel_hi:[1,1,0] neg_lo:[0,0,1] neg_hi:[0,0,1]
    v_pk_fma_f32 v[122:123], v[122:123], s[96:97], v[28:29] op_sel_hi:[1,1,0] neg_lo:[0,0,1] neg_hi:[0,0,1]
    v_pk_fma_f32 v[124:125], v[124:125], s[96:97], v[28:29] op_sel_hi:[1,1,0] neg_lo:[0,0,1] neg_hi:[0,0,1]
    v_pk_fma_f32 v[126:127], v[126:127], s[96:97], v[28:29] op_sel_hi:[1,1,0] neg_lo:[0,0,1] neg_hi:[0,0,1]
    v_pk_fma_f32 v[48:49], v[48:49], s[96:97], v[28:29] op_sel_hi:[1,1,0] neg_lo:[0,0,1] neg_hi:[0,0,1]
    v_exp_f32 v120, v120
    v_exp_f32 v121, v121
    v_exp_f32 v122, v122
    v_exp_f32 v123, v123
    v_exp_f32 v124, v124
    v_exp_f32 v125, v125
    v_exp_f32 v126, v126
    v_exp_f32 v127, v127
    v_exp_f32 v48, v48
    v_exp_f32 v49, v49
    v_cvt_pk_bf16_f32 v56, v120, v121
    v_cvt_pk_bf16_f32 v57, v122, v123
    v_cvt_pk_bf16_f32 v58, v124, v125
    v_cvt_pk_bf16_f32 v59, v126, v127
    v_cvt_pk_bf16_f32 v60, v48, v49
    s_nop 0
    v_mfma_f32_16x16x32_bf16 v[26:29], v[52:55], v[56:59], 0
    v_mov_b64 v[120:121], 0
    v_mov_b64 v[122:123], 0
    v_mfma_f32_16x16x32_bf16 v[112:115], v[16:19], v[56:59], 0
    ds_read_b128 v[32:35], v11 offset:24576
    v_mov_b64 v[124:125], 0
    v_mfma_f32_16x16x32_bf16 v[116:119], v[20:23], v[56:59], 0
    ds_read_b128 v[36:39], v11 offset:25600
    buffer_load_dwordx4 v[16:19], v9, s[8:11], s30 offen
    v_mfma_f32_16x16x16_bf16 v[26:29], v[24:25], v[60:61], v[26:29]
    ds_read_b128 v[40:43], v11 offset:26624
    buffer_load_dwordx4 v[20:23], v9, s[8:11], s30 offen offset:256
    v_mfma_f32_16x16x16_bf16 v[112:115], v[12:13], v[60:61], v[112:115]
    ds_read_b128 v[44:47], v11 offset:27648
    v_mov_b64 v[126:127], 0
    v_mfma_f32_16x16x16_bf16 v[116:119], v[14:15], v[60:61], v[116:119]
    v_rcp_f32 v30, v26
    s_nop 2
    v_mul_f32 v112, v112, v30
    v_mul_f32 v113, v113, v30
    v_cvt_pk_bf16_f32 v56, v112, v113
    v_mul_f32 v114, v114, v30
    v_mul_f32 v115, v115, v30
    v_cvt_pk_bf16_f32 v57, v114, v115
    v_mul_f32 v116, v116, v30
    v_mul_f32 v117, v117, v30
    v_cvt_pk_bf16_f32 v58, v116, v117
    v_mul_f32 v118, v118, v30
    v_mul_f32 v119, v119, v30
    v_cvt_pk_bf16_f32 v59, v118, v119
    s_mov_b64 exec, s[36:37]
    ds_write_b128 v7, v[56:59] offset:13824
    s_mov_b64 exec, -1
    ds_read_b128 v[48:51], v11 offset:28672
    ds_read_b128 v[52:55], v11 offset:29696
    v_mov_b64 v[28:29], -1
    v_mov_b64 v[30:31], -1
    buffer_store_dwordx4 v[28:31], v0, s[8:11], s26 offen
    s_waitcnt lgkmcnt(2)
    s_barrier
    ds_read_b128 v[56:59], v8 offset:0
    ds_read_b128 v[60:63], v8 offset:1024
    buffer_store_dwordx4 v[28:31], v0, s[8:11], s26 offen offset:1024
    s_waitcnt lgkmcnt(1)
    v_smfmac_f32_16x16x64_bf16 v[96:99], v[56:59], a[192:199], v10
    v_mov_b64 v[112:113], 0
    v_smfmac_f32_16x16x64_bf16 v[100:103], v[56:59], a[200:207], v10
    v_mov_b64 v[114:115], 0
    v_smfmac_f32_16x16x64_bf16 v[104:107], v[56:59], a[208:215], v10
    v_mov_b64 v[116:117], 0
    v_smfmac_f32_16x16x64_bf16 v[108:111], v[56:59], a[216:223], v10
    v_mov_b64 v[118:119], 0
    s_waitcnt lgkmcnt(0)
    v_smfmac_f32_16x16x64_bf16 v[96:99], v[60:63], v[64:71], v10
    v_smfmac_f32_16x16x64_bf16 v[100:103], v[60:63], v[72:79], v10
    ds_read_b128 v[64:67], v11 offset:30720
    v_smfmac_f32_16x16x64_bf16 v[104:107], v[60:63], v[80:87], v10
    ds_read_b128 v[68:71], v11 offset:31744
    v_smfmac_f32_16x16x64_bf16 v[108:111], v[60:63], v[88:95], v10
    v_add_f32 v96, v96, v98
    v_add_f32 v97, v97, v99
    v_cvt_pk_bf16_f32 v96, v96, v97
    v_smfmac_f32_16x16x64_bf16 v[112:115], v[56:59], a[224:231], v10
    v_add_f32 v100, v100, v102
    v_add_f32 v101, v101, v103
    v_cvt_pk_bf16_f32 v97, v100, v101
    v_smfmac_f32_16x16x64_bf16 v[116:119], v[56:59], a[232:239], v10
    v_add_f32 v104, v104, v106
    v_add_f32 v105, v105, v107
    v_cvt_pk_bf16_f32 v98, v104, v105
    v_smfmac_f32_16x16x64_bf16 v[120:123], v[56:59], a[240:247], v10
    v_add_f32 v108, v108, v110
    v_add_f32 v109, v109, v111
    v_cvt_pk_bf16_f32 v99, v108, v109
    v_smfmac_f32_16x16x64_bf16 v[124:127], v[56:59], a[248:255], v10
    buffer_store_dwordx4 v[96:99], v1, s[8:11], s23 offen
    v_smfmac_f32_16x16x64_bf16 v[112:115], v[60:63], v[32:39], v10
    v_smfmac_f32_16x16x64_bf16 v[116:119], v[60:63], v[40:47], v10
    v_smfmac_f32_16x16x64_bf16 v[120:123], v[60:63], v[48:55], v10
    s_waitcnt lgkmcnt(0)
    v_smfmac_f32_16x16x64_bf16 v[124:127], v[60:63], v[64:71], v10
    v_add_f32 v112, v112, v114
    v_add_f32 v113, v113, v115
    v_cvt_pk_bf16_f32 v112, v112, v113
    v_add_f32 v116, v116, v118
    v_add_f32 v117, v117, v119
    v_cvt_pk_bf16_f32 v113, v116, v117
    v_add_f32 v120, v120, v122
    v_add_f32 v121, v121, v123
    v_cvt_pk_bf16_f32 v114, v120, v121
    v_add_f32 v124, v124, v126
    v_add_f32 v125, v125, v127
    v_cvt_pk_bf16_f32 v115, v124, v125
    buffer_store_dwordx4 v[112:115], v1, s[8:11], s25 offen
    v_mov_b32 v26, 0x3f80
    v_mov_b32 v27, 0x3f800000
    v_cndmask_b32 v26, v26, v27, s[100:101]
    v_cndmask_b32 v108, 0, v26, s[48:49]
    v_cndmask_b32 v109, 0, v26, s[50:51]
    v_cndmask_b32 v110, 0, v26, s[52:53]
    v_cndmask_b32 v111, 0, v26, s[54:55]
    ds_read_b128 v[64:67], v11 offset:0
    ds_read_b128 v[68:71], v11 offset:1024
    ds_read_b128 v[72:75], v11 offset:2048
    ds_read_b128 v[76:79], v11 offset:3072
    ds_read_b128 v[80:83], v11 offset:4096
    ds_read_b128 v[84:87], v11 offset:5120
    ds_read_b128 v[88:91], v11 offset:6144
    ds_read_b128 v[92:95], v11 offset:7168
    v_mov_b64 v[112:113], 0
    v_mov_b64 v[114:115], 0
    v_mov_b64 v[116:117], 0
    v_mov_b64 v[118:119], 0
    v_mov_b64 v[120:121], 0
    v_mov_b64 v[122:123], 0
    v_mov_b64 v[124:125], 0
    v_mov_b64 v[126:127], 0
    v_mov_b64 v[28:29], -1
    v_mov_b64 v[30:31], -1
    s_mov_b32 s7, 0
    s_sleep 2
    buffer_load_dwordx4 v[96:99], v0, s[8:11], s24 offen sc1
    buffer_load_dwordx4 v[100:103], v0, s[8:11], s24 offen offset:1024 sc1
    s_sleep 3
    buffer_load_dwordx4 v[96:99], v0, s[8:11], s24 offen sc1
    buffer_load_dwordx4 v[100:103], v0, s[8:11], s24 offen offset:1024 sc1
    s_and_b32 s33, s5, 7
    s_cmp_eq_u32 s33, 6
    s_cbranch_scc0 L_nkv_3m
    s_add_u32 s33, s5, 2
    s_lshr_b32 s33, s33, 3
    s_lshl_b32 s33, s33, 7
    s_add_u32 s33, s33, 262144
    v_mov_b32 v26, s33
    buffer_load_dword v27, v26, s[8:11], 0 offen sc1
    s_waitcnt vmcnt(0)
L_nkv_3m:
L_p1w_3m:
    s_waitcnt vmcnt(2)
    v_mfma_f32_16x16x32_bf16 v[104:107], v[108:111], v[96:99], 0
    v_mfma_f32_16x16x32_bf16 v[104:107], v[108:111], v[100:103], v[104:107]
    s_nop 7
    v_cmp_u_f32 vcc, v104, v104
    s_cbranch_vccnz L_p1r_3m
L_p1d_3m:
    v_add_f32_dpp v104, v104, v104 row_ror:8 row_mask:0xf bank_mask:0xf
    v_add_f32_dpp v105, v105, v105 row_ror:8 row_mask:0xf bank_mask:0xf
    v_add_f32_dpp v106, v106, v106 row_ror:8 row_mask:0xf bank_mask:0xf
    v_add_f32_dpp v107, v107, v107 row_ror:8 row_mask:0xf bank_mask:0xf
    v_add_f32_dpp v104, v104, v104 row_ror:4 row_mask:0xf bank_mask:0xf
    v_add_f32_dpp v105, v105, v105 row_ror:4 row_mask:0xf bank_mask:0xf
    v_add_f32_dpp v106, v106, v106 row_ror:4 row_mask:0xf bank_mask:0xf
    v_add_f32_dpp v107, v107, v107 row_ror:4 row_mask:0xf bank_mask:0xf
    v_cvt_pk_bf16_f32 v104, v104, v106
    v_cvt_pk_bf16_f32 v105, v105, v107
    s_mov_b64 exec, s[40:41]
    v_cndmask_b32 v104, v104, v105, s[42:43]
    v_min_u32 v104, -2, v104
    buffer_store_dword v104, v2, s[8:11], s21 offen
    buffer_store_dword v28, v2, s[8:11], s20 offen
    s_mov_b64 exec, -1
    s_add_u32 s47, s21, 6144
    s_mov_b32 s7, 0
    s_add_u32 s5, s5, 1
    s_and_b32 s33, s5, 7
    s_cmp_eq_u32 s33, 7
    s_cbranch_scc0 L_ckv_3m
    s_cmp_ge_u32 s5, 57
    s_cbranch_scc1 L_ckv_3m
L_ckvl_3m:
    v_readfirstlane_b32 s33, v27
    s_and_b32 s33, s33, 0xff
    s_cmp_eq_u32 s33, 128
    s_cbranch_scc1 L_ckv_3m
    s_add_u32 s7, s7, 1
    s_cmp_lt_u32 s7, 400000
    s_cbranch_scc0 L_ckv_3m
    s_sleep 2
    buffer_load_dword v27, v26, s[8:11], 0 offen sc1
    s_waitcnt vmcnt(0)
    s_branch L_ckvl_3m
L_ckv_3m:
    s_mov_b32 s7, 0
    s_sleep 2
    s_mov_b32 m0, 6144
    s_nop 0
    buffer_load_dwordx4 v0, s[8:11], s47 offen sc1 lds
    buffer_load_dwordx4 v0, s[8:11], s47 offen offset:1024 sc1 lds
    s_mov_b32 s33, s20
    s_mov_b32 s20, s21
    s_mov_b32 s21, s22
    s_mov_b32 s22, s33
    s_xor_b32 s23, s23, 0x40000
    s_mov_b32 s26, s24
    s_xor_b32 s24, s24, 0x40000
    s_xor_b32 s25, s25, 0x40000
    s_add_u32 s28, s28, 0x40000
    s_xor_b32 s29, s29, 8192
    s_add_u32 s30, s30, 0x40000
    s_mov_b32 s62, s31
    s_mov_b32 s63, s32
    s_add_u32 s31, s31, 65536
    s_add_u32 s32, s32, 131072
    v_xor_b32 v5, 0x2000, v5
    v_xor_b32 v6, 0x2000, v6
    s_sleep 2
    s_mov_b32 m0, 6144
    s_nop 0
    buffer_load_dwordx4 v0, s[8:11], s47 offen sc1 lds
    buffer_load_dwordx4 v0, s[8:11], s47 offen offset:1024 sc1 lds
    v_mov_b64 v[104:105], -1
    v_mov_b64 v[106:107], -1
    s_cmp_lt_u32 s5, 63
    s_cbranch_scc1 L_step3
    s_waitcnt vmcnt(2)
    ds_read_b128 v[56:59], v0 offset:6144
    ds_read_b128 v[60:63], v0 offset:7168
    s_waitcnt lgkmcnt(0)
    v_max3_u32 v26, v56, v57, v58
    v_max3_u32 v27, v59, v60, v61
    v_max3_u32 v26, v26, v62, v63
    v_max_u32 v26, v26, v27
    v_cmp_eq_u32 vcc, -1, v26
    s_cbranch_vccnz L_p2r_3l
L_p2d_3l:
    s_barrier
    ds_read_b128 v[32:35], v0 offset:0
    ds_read_b128 v[36:39], v0 offset:1024
    ds_read_b128 v[40:43], v0 offset:2048
    ds_read_b128 v[44:47], v0 offset:3072
    ds_read_b128 v[48:51], v0 offset:4096
    ds_read_b128 v[52:55], v0 offset:5120
    ds_read_b64_tr_b16 v[28:29], v4 offset:3328
    ds_read_b64_tr_b16 v[30:31], v4 offset:3456
    buffer_store_dwordx4 v[12:15], v0, s[8:11], s63 offen offset:3072 sc1
    s_waitcnt lgkmcnt(0)
    s_mov_b64 exec, s[36:37]
    buffer_store_dwordx4 v[28:31], v7, s[8:11], s62 offen offset:1536 sc1
    s_mov_b64 exec, -1
    ds_read_b128 v[64:67], v11 offset:8192
    ds_read_b128 v[68:71], v11 offset:9216
    ds_read_b128 v[72:75], v11 offset:10240
    ds_read_b128 v[76:79], v11 offset:11264
    ds_read_b128 v[80:83], v11 offset:12288
    ds_read_b128 v[84:87], v11 offset:13312
    ds_read_b128 v[88:91], v11 offset:14336
    ds_read_b128 v[92:95], v11 offset:15360
    v_smfmac_f32_16x16x64_bf16 v[120:123], v[32:35], a[96:103], v10
    v_smfmac_f32_16x16x64_bf16 v[124:127], v[32:35], a[104:111], v10
    s_waitcnt lgkmcnt(4)
    v_smfmac_f32_16x16x64_bf16 v[120:123], v[56:59], v[64:71], v10
    v_smfmac_f32_16x16x64_bf16 v[124:127], v[56:59], v[72:79], v10
    v_smfmac_f32_16x16x64_bf16 v[120:123], v[36:39], a[112:119], v10
    v_smfmac_f32_16x16x64_bf16 v[124:127], v[36:39], a[120:127], v10
    s_waitcnt lgkmcnt(0)
    v_smfmac_f32_16x16x64_bf16 v[120:123], v[60:63], v[80:87], v10
    v_smfmac_f32_16x16x64_bf16 v[124:127], v[60:63], v[88:95], v10
    v_smfmac_f32_16x16x64_bf16 v[120:123], v[40:43], a[128:135], v10
    v_smfmac_f32_16x16x64_bf16 v[124:127], v[40:43], a[136:143], v10
    v_smfmac_f32_16x16x64_bf16 v[120:123], v[44:47], a[144:151], v10
    v_smfmac_f32_16x16x64_bf16 v[124:127], v[44:47], a[152:159], v10
    v_smfmac_f32_16x16x64_bf16 v[120:123], v[48:51], a[160:167], v10
    v_smfmac_f32_16x16x64_bf16 v[124:127], v[48:51], a[168:175], v10
    v_smfmac_f32_16x16x64_bf16 v[120:123], v[52:55], a[176:183], v10
    v_smfmac_f32_16x16x64_bf16 v[124:127], v[52:55], a[184:191], v10
    v_mov_b64 v[112:113], 0
    v_mov_b64 v[114:115], 0
    v_mov_b64 v[116:117], 0
    v_mov_b64 v[118:119], 0
    v_smfmac_f32_16x16x64_bf16 v[112:115], v[32:35], v[128:135], v10
    v_smfmac_f32_16x16x64_bf16 v[116:119], v[32:35], v[136:143], v10
    v_add_f32 v120, v120, v122
    v_add_f32 v121, v121, v123
    v_smfmac_f32_16x16x64_bf16 v[112:115], v[36:39], v[144:151], v10
    v_add_f32 v124, v124, v126
    v_add_f32 v125, v125, v127
    v_smfmac_f32_16x16x64_bf16 v[116:119], v[36:39], v[152:159], v10
    v_cvt_pk_bf16_f32 v120, v120, v121
    v_cvt_pk_bf16_f32 v124, v124, v125
    v_smfmac_f32_16x16x64_bf16 v[112:115], v[40:43], v[160:167], v10
    ds_write2_b32 v3, v120, v124 offset0:64 offset1:192
    v_smfmac_f32_16x16x64_bf16 v[116:119], v[40:43], v[168:175], v10
    v_smfmac_f32_16x16x64_bf16 v[112:115], v[44:47], v[176:183], v10
    v_smfmac_f32_16x16x64_bf16 v[116:119], v[44:47], v[184:191], v10
    v_smfmac_f32_16x16x64_bf16 v[112:115], v[48:51], v[192:199], v10
    s_waitcnt lgkmcnt(0)
    s_barrier
    v_smfmac_f32_16x16x64_bf16 v[116:119], v[48:51], v[200:207], v10
    v_smfmac_f32_16x16x64_bf16 v[112:115], v[52:55], v[208:215], v10
    v_smfmac_f32_16x16x64_bf16 v[116:119], v[52:55], v[216:223], v10
    v_smfmac_f32_16x16x64_bf16 v[112:115], v[56:59], v[224:231], v10
    v_smfmac_f32_16x16x64_bf16 v[116:119], v[56:59], v[232:239], v10
    v_smfmac_f32_16x16x64_bf16 v[112:115], v[60:63], v[240:247], v10
    v_smfmac_f32_16x16x64_bf16 v[116:119], v[60:63], v[248:255], v10
    ds_read_b64_tr_b16 v[32:33], v4 offset:256
    ds_read_b64_tr_b16 v[34:35], v4 offset:384
    ds_read_b64_tr_b16 v[36:37], v4 offset:1280
    ds_read_b64_tr_b16 v[38:39], v4 offset:1408
    ds_read_b64_tr_b16 v[40:41], v4 offset:2304
    ds_read_b64_tr_b16 v[42:43], v4 offset:2432
    ds_read_b64_tr_b16 v[44:45], v4 offset:3328
    ds_read_b64_tr_b16 v[46:47], v4 offset:3456
    v_pk_add_f32 v[112:113], v[112:113], v[114:115]
    v_pk_add_f32 v[116:117], v[116:117], v[118:119]
    v_cvt_pk_bf16_f32 v12, v112, v113
    v_cvt_pk_bf16_f32 v14, v116, v117
    buffer_store_dwordx4 v[12:15], v0, s[8:11], s32 offen offset:3072 sc1
    s_waitcnt lgkmcnt(0)
    s_mov_b64 exec, s[36:37]
    buffer_store_dwordx4 v[44:47], v7, s[8:11], s31 offen offset:1536 sc1
    s_mov_b64 exec, -1
    s_branch L_cfin3
L_step3s:
    s_waitcnt vmcnt(2)
    ds_read_b128 v[56:59], v0 offset:6144
    ds_read_b128 v[60:63], v0 offset:7168
    s_waitcnt lgkmcnt(0)
    v_max3_u32 v26, v56, v57, v58
    v_max3_u32 v27, v59, v60, v61
    v_max3_u32 v26, v26, v62, v63
    v_max_u32 v26, v26, v27
    v_cmp_eq_u32 vcc, -1, v26
    s_cbranch_vccnz L_p2r_3ms
L_p2d_3ms:
    s_barrier
    ds_read_b128 v[32:35], v0 offset:0
    ds_read_b128 v[36:39], v0 offset:1024
    v_smfmac_f32_16x16x64_bf16 v[112:115], v[56:59], v[64:71], v10
    ds_read_b128 v[40:43], v0 offset:2048
    v_smfmac_f32_16x16x64_bf16 v[116:119], v[56:59], v[72:79], v10
    ds_read_b128 v[44:47], v0 offset:3072
    s_mov_b32 m0, s29
    s_nop 0
    buffer_load_dwordx4 v0, s[8:11], s28 offen lds
    v_smfmac_f32_16x16x64_bf16 v[112:115], v[60:63], v[80:87], v10
    ds_read_b128 v[48:51], v0 offset:4096
    v_smfmac_f32_16x16x64_bf16 v[116:119], v[60:63], v[88:95], v10
    ds_read_b128 v[52:55], v0 offset:5120
    s_waitcnt lgkmcnt(5)
    v_smfmac_f32_16x16x64_bf16 v[112:115], v[32:35], a[0:7], v10
    ds_read_b64_tr_b16 v[28:29], v4 offset:3328
    buffer_load_dwordx4 v0, s[8:11], s28 offen offset:1024 lds
    v_smfmac_f32_16x16x64_bf16 v[116:119], v[32:35], a[8:15], v10
    ds_read_b64_tr_b16 v[30:31], v4 offset:3456
    s_waitcnt lgkmcnt(6)
    v_smfmac_f32_16x16x64_bf16 v[112:115], v[36:39], a[16:23], v10
    ds_read_b128 v[64:67], v11 offset:8192
    s_mov_b32 m0, 15872
    s_nop 0
    buffer_load_dword v9, s[8:11], s30 offen lds
    v_smfmac_f32_16x16x64_bf16 v[116:119], v[36:39], a[24:31], v10
    ds_read_b128 v[68:71], v11 offset:9216
    s_waitcnt lgkmcnt(7)
    v_smfmac_f32_16x16x64_bf16 v[112:115], v[40:43], a[32:39], v10
    ds_read_b128 v[72:75], v11 offset:10240
    v_smfmac_f32_16x16x64_bf16 v[116:119], v[40:43], a[40:47], v10
    ds_read_b128 v[76:79], v11 offset:11264
    buffer_load_dword v9, s[8:11], s30 offen offset:256 lds
    s_waitcnt lgkmcnt(8)
    v_smfmac_f32_16x16x64_bf16 v[112:115], v[44:47], a[48:55], v10
    ds_read_b128 v[80:83], v11 offset:12288
    v_smfmac_f32_16x16x64_bf16 v[116:119], v[44:47], a[56:63], v10
    ds_read_b128 v[84:87], v11 offset:13312
    s_waitcnt lgkmcnt(9)
    v_smfmac_f32_16x16x64_bf16 v[112:115], v[48:51], a[64:71], v10
    ds_read_b128 v[88:91], v11 offset:14336
    v_smfmac_f32_16x16x64_bf16 v[116:119], v[48:51], a[72:79], v10
    ds_read_b128 v[92:95], v11 offset:15360
    s_waitcnt lgkmcnt(10)
    v_smfmac_f32_16x16x64_bf16 v[112:115], v[52:55], a[80:87], v10
    v_smfmac_f32_16x16x64_bf16 v[116:119], v[52:55], a[88:95], v10
    v_smfmac_f32_16x16x64_bf16 v[120:123], v[32:35], a[96:103], v10
    v_smfmac_f32_16x16x64_bf16 v[124:127], v[32:35], a[104:111], v10
    v_add_f32 v112, v112, v114
    s_waitcnt lgkmcnt(4)
    v_smfmac_f32_16x16x64_bf16 v[120:123], v[56:59], v[64:71], v10
    v_add_f32 v113, v113, v115
    v_add_f32 v116, v116, v118
    v_smfmac_f32_16x16x64_bf16 v[124:127], v[56:59], v[72:79], v10
    v_add_f32 v117, v117, v119
    v_cvt_pk_bf16_f32 v112, v112, v113
    v_smfmac_f32_16x16x64_bf16 v[120:123], v[36:39], a[112:119], v10
    ds_read_b128 v[64:67], v5 offset:0
    v_cvt_pk_bf16_f32 v116, v116, v117
    v_smfmac_f32_16x16x64_bf16 v[124:127], v[36:39], a[120:127], v10
    ds_write2_b32 v3, v112, v116 offset0:0 offset1:128
    ds_read_b128 v[68:71], v5 offset:2048
    s_waitcnt lgkmcnt(3)
    v_smfmac_f32_16x16x64_bf16 v[120:123], v[60:63], v[80:87], v10
    ds_read_b128 v[72:75], v5 offset:4096
    v_smfmac_f32_16x16x64_bf16 v[124:127], v[60:63], v[88:95], v10
    ds_read_b128 v[76:79], v5 offset:6144
    buffer_store_dwordx4 v[12:15], v0, s[8:11], s63 offen offset:3072 sc1
    v_smfmac_f32_16x16x64_bf16 v[120:123], v[40:43], a[128:135], v10
    ds_read_b128 v[80:83], v6 offset:0
    v_smfmac_f32_16x16x64_bf16 v[124:127], v[40:43], a[136:143], v10
    ds_read_b128 v[84:87], v6 offset:2048
    v_smfmac_f32_16x16x64_bf16 v[120:123], v[44:47], a[144:151], v10
    ds_read_b128 v[88:91], v6 offset:4096
    v_smfmac_f32_16x16x64_bf16 v[124:127], v[44:47], a[152:159], v10
    ds_read_b128 v[92:95], v6 offset:6144
    v_smfmac_f32_16x16x64_bf16 v[120:123], v[48:51], a[160:167], v10
    s_waitcnt lgkmcnt(7)
    v_smfmac_f32_16x16x64_bf16 v[124:127], v[48:51], a[168:175], v10
    v_mov_b64 v[112:113], 0
    v_smfmac_f32_16x16x64_bf16 v[120:123], v[52:55], a[176:183], v10
    v_mov_b64 v[114:115], 0
    v_smfmac_f32_16x16x64_bf16 v[124:127], v[52:55], a[184:191], v10
    v_mov_b64 v[116:117], 0
    v_mov_b64 v[118:119], 0
    v_smfmac_f32_16x16x64_bf16 v[112:115], v[32:35], v[128:135], v10
    v_smfmac_f32_16x16x64_bf16 v[116:119], v[32:35], v[136:143], v10
    v_add_f32 v120, v120, v122
    v_add_f32 v121, v121, v123
    v_smfmac_f32_16x16x64_bf16 v[112:115], v[36:39], v[144:151], v10
    v_add_f32 v124, v124, v126
    v_add_f32 v125, v125, v127
    v_smfmac_f32_16x16x64_bf16 v[116:119], v[36:39], v[152:159], v10
    v_cvt_pk_bf16_f32 v120, v120, v121
    v_cvt_pk_bf16_f32 v124, v124, v125
    v_smfmac_f32_16x16x64_bf16 v[112:115], v[40:43], v[160:167], v10
    ds_write2_b32 v3, v120, v124 offset0:64 offset1:192
    v_smfmac_f32_16x16x64_bf16 v[116:119], v[40:43], v[168:175], v10
    v_smfmac_f32_16x16x64_bf16 v[112:115], v[44:47], v[176:183], v10
    v_smfmac_f32_16x16x64_bf16 v[116:119], v[44:47], v[184:191], v10
    v_smfmac_f32_16x16x64_bf16 v[112:115], v[48:51], v[192:199], v10
    s_mov_b64 exec, s[36:37]
    buffer_store_dwordx4 v[28:31], v7, s[8:11], s62 offen offset:1536 sc1
    s_mov_b64 exec, -1
    s_waitcnt lgkmcnt(0)
    s_barrier
    ds_read_b64_tr_b16 v[96:97], v4 offset:0
    ds_read_b64_tr_b16 v[98:99], v4 offset:128
    v_smfmac_f32_16x16x64_bf16 v[116:119], v[48:51], v[200:207], v10
    ds_read_b64_tr_b16 v[100:101], v4 offset:1024
    ds_read_b64_tr_b16 v[102:103], v4 offset:1152
    v_smfmac_f32_16x16x64_bf16 v[112:115], v[52:55], v[208:215], v10
    ds_read_b64_tr_b16 v[104:105], v4 offset:2048
    ds_read_b64_tr_b16 v[106:107], v4 offset:2176
    v_smfmac_f32_16x16x64_bf16 v[116:119], v[52:55], v[216:223], v10
    ds_read_b64_tr_b16 v[108:109], v4 offset:3072
    ds_read_b64_tr_b16 v[110:111], v4 offset:3200
    v_smfmac_f32_16x16x64_bf16 v[112:115], v[56:59], v[224:231], v10
    v_smfmac_f32_16x16x64_bf16 v[116:119], v[56:59], v[232:239], v10
    v_smfmac_f32_16x16x64_bf16 v[112:115], v[60:63], v[240:247], v10
    v_smfmac_f32_16x16x64_bf16 v[116:119], v[60:63], v[248:255], v10
    s_waitcnt vmcnt(6)
    ds_read_b64_tr_b16 v[32:33], v4 offset:256
    ds_read_b64_tr_b16 v[34:35], v4 offset:384
    ds_read_b64_tr_b16 v[36:37], v4 offset:1280
    ds_read_b64_tr_b16 v[38:39], v4 offset:1408
    s_waitcnt lgkmcnt(10)
    v_mfma_f32_16x16x32_bf16 v[120:123], v[64:67], v[96:99], 0
    ds_read_b64_tr_b16 v[40:41], v4 offset:2304
    s_waitcnt lgkmcnt(9)
    v_mfma_f32_16x16x32_bf16 v[120:123], v[68:71], v[100:103], v[120:123]
    ds_read_b64_tr_b16 v[42:43], v4 offset:2432
    v_add_f32 v112, v112, v114
    v_add_f32 v113, v113, v115
    s_waitcnt lgkmcnt(8)
    v_mfma_f32_16x16x32_bf16 v[120:123], v[72:75], v[104:107], v[120:123]
    ds_read_b64_tr_b16 v[44:45], v4 offset:3328
    v_add_f32 v116, v116, v118
    v_add_f32 v117, v117, v119
    s_waitcnt lgkmcnt(7)
    v_mfma_f32_16x16x32_bf16 v[120:123], v[76:79], v[108:111], v[120:123]
    ds_read_b64_tr_b16 v[46:47], v4 offset:3456
    v_mov_b64 v[52:53], s[98:99]
    v_mov_b64 v[54:55], s[98:99]
    v_mfma_f32_16x16x32_bf16 v[124:127], v[80:83], v[96:99], 0
    ds_read_b128 v[64:67], v11 offset:16384
    v_cvt_pk_bf16_f32 v12, v112, v113
    v_cvt_pk_bf16_f32 v14, v116, v117
    v_mfma_f32_16x16x32_bf16 v[124:127], v[84:87], v[100:103], v[124:127]
    ds_read_b128 v[68:71], v11 offset:17408
    v_mfma_f32_16x16x32_bf16 v[124:127], v[88:91], v[104:107], v[124:127]
    ds_read_b128 v[72:75], v11 offset:18432
    v_max3_f32 v26, v120, v121, v122
    v_mfma_f32_16x16x32_bf16 v[124:127], v[92:95], v[108:111], v[124:127]
    ds_read_b128 v[76:79], v11 offset:19456
    v_max_f32 v26, v26, v123
    s_waitcnt lgkmcnt(10)
    v_mfma_f32_16x16x32_bf16 v[48:51], v[32:35], v[96:99], 0
    ds_read_b128 v[80:83], v11 offset:20480
    s_waitcnt lgkmcnt(9)
    v_mfma_f32_16x16x32_bf16 v[48:51], v[36:39], v[100:103], v[48:51]
    ds_read_b128 v[84:87], v11 offset:21504
    v_max3_f32 v27, v124, v125, v126
    v_mov_b64 v[96:97], 0
    s_waitcnt lgkmcnt(8)
    v_mfma_f32_16x16x32_bf16 v[48:51], v[40:43], v[104:107], v[48:51]
    ds_read_b128 v[88:91], v11 offset:22528
    v_mov_b64 v[98:99], 0
    v_max3_f32 v26, v26, v127, v27
    s_waitcnt lgkmcnt(7)
    v_mfma_f32_16x16x32_bf16 v[48:51], v[44:47], v[108:111], v[48:51]
    ds_read_b128 v[92:95], v11 offset:23552
    v_mov_b64 v[100:101], 0
    v_mov_b64 v[102:103], 0
    v_mov_b64 v[104:105], 0
    v_mov_b64 v[106:107], 0
    v_mov_b64 v[108:109], 0
    v_mov_b64 v[110:111], 0
    s_nop 0
    v_max3_f32 v26, v26, v48, v49
    v_max3_f32 v26, v26, v50, v51
    v_cndmask_b32 v48, v48, v50, s[38:39]
    v_mov_b32 v27, v26
    v_cndmask_b32 v49, v49, v51, s[38:39]
    s_nop 0
    v_permlane16_swap_b32 v26, v27
    v_max_f32 v26, v26, v27
    v_mov_b32 v27, v26
    v_mov_b32 v61, 0
    s_nop 0
    v_permlane32_swap_b32 v26, v27
    v_max_f32 v26, v26, v27
    v_mul_f32 v28, s46, v26
    v_pk_fma_f32 v[120:121], v[120:121], s[96:97], v[28:29] op_sel_hi:[1,1,0] neg_lo:[0,0,1] neg_hi:[0,0,1]
    v_pk_fma_f32 v[122:123], v[122:123], s[96:97], v[28:29] op_sel_hi:[1,1,0] neg_lo:[0,0,1] neg_hi:[0,0,1]
    v_pk_fma_f32 v[124:125], v[124:125], s[96:97], v[28:29] op_sel_hi:[1,1,0] neg_lo:[0,0,1] neg_hi:[0,0,1]
    v_pk_fma_f32 v[126:127], v[126:127], s[96:97], v[28:29] op_sel_hi:[1,1,0] neg_lo:[0,0,1] neg_hi:[0,0,1]
    v_pk_fma_f32 v[48:49], v[48:49], s[96:97], v[28:29] op_sel_hi:[1,1,0] neg_lo:[0,0,1] neg_hi:[0,0,1]
    v_exp_f32 v120, v120
    v_exp_f32 v121, v121
    v_exp_f32 v122, v122
    v_exp_f32 v123, v123
    v_exp_f32 v124, v124
    v_exp_f32 v125, v125
    v_exp_f32 v126, v126
    v_exp_f32 v127, v127
    v_exp_f32 v48, v48
    v_exp_f32 v49, v49
    v_cvt_pk_bf16_f32 v56, v120, v121
    v_cvt_pk_bf16_f32 v57, v122, v123
    v_cvt_pk_bf16_f32 v58, v124, v125
    v_cvt_pk_bf16_f32 v59, v126, v127
    v_cvt_pk_bf16_f32 v60, v48, v49
    s_nop 0
    v_mfma_f32_16x16x32_bf16 v[26:29], v[52:55], v[56:59], 0
    v_mov_b64 v[120:121], 0
    v_mov_b64 v[122:123], 0
    v_mfma_f32_16x16x32_bf16 v[112:115], v[16:19], v[56:59], 0
    ds_read_b128 v[32:35], v11 offset:24576
    v_mov_b64 v[124:125], 0
    v_mfma_f32_16x16x32_bf16 v[116:119], v[20:23], v[56:59], 0
    ds_read_b128 v[36:39], v11 offset:25600
    buffer_load_dwordx4 v[16:19], v9, s[8:11], s30 offen
    v_mfma_f32_16x16x16_bf16 v[26:29], v[24:25], v[60:61], v[26:29]
    ds_read_b128 v[40:43], v11 offset:26624
    buffer_load_dwordx4 v[20:23], v9, s[8:11], s30 offen offset:256
    v_mfma_f32_16x16x16_bf16 v[112:115], v[12:13], v[60:61], v[112:115]
    ds_read_b128 v[44:47], v11 offset:27648
    v_mov_b64 v[126:127], 0
    v_mfma_f32_16x16x16_bf16 v[116:119], v[14:15], v[60:61], v[116:119]
    v_rcp_f32 v30, v26
    s_nop 2
    v_mul_f32 v112, v112, v30
    v_mul_f32 v113, v113, v30
    v_cvt_pk_bf16_f32 v56, v112, v113
    v_mul_f32 v114, v114, v30
    v_mul_f32 v115, v115, v30
    v_cvt_pk_bf16_f32 v57, v114, v115
    v_mul_f32 v116, v116, v30
    v_mul_f32 v117, v117, v30
    v_cvt_pk_bf16_f32 v58, v116, v117
    v_mul_f32 v118, v118, v30
    v_mul_f32 v119, v119, v30
    v_cvt_pk_bf16_f32 v59, v118, v119
    s_mov_b64 exec, s[36:37]
    ds_write_b128 v7, v[56:59] offset:13824
    s_mov_b64 exec, -1
    ds_read_b128 v[48:51], v11 offset:28672
    ds_read_b128 v[52:55], v11 offset:29696
    v_mov_b64 v[28:29], -1
    v_mov_b64 v[30:31], -1
    buffer_store_dwordx4 v[28:31], v0, s[8:11], s26 offen sc1
    s_waitcnt lgkmcnt(2)
    s_barrier
    ds_read_b128 v[56:59], v8 offset:0
    ds_read_b128 v[60:63], v8 offset:1024
    buffer_store_dwordx4 v[28:31], v0, s[8:11], s26 offen offset:1024 sc1
    s_waitcnt lgkmcnt(1)
    v_smfmac_f32_16x16x64_bf16 v[96:99], v[56:59], a[192:199], v10
    v_mov_b64 v[112:113], 0
    v_smfmac_f32_16x16x64_bf16 v[100:103], v[56:59], a[200:207], v10
    v_mov_b64 v[114:115], 0
    v_smfmac_f32_16x16x64_bf16 v[104:107], v[56:59], a[208:215], v10
    v_mov_b64 v[116:117], 0
    v_smfmac_f32_16x16x64_bf16 v[108:111], v[56:59], a[216:223], v10
    v_mov_b64 v[118:119], 0
    s_waitcnt lgkmcnt(0)
    v_smfmac_f32_16x16x64_bf16 v[96:99], v[60:63], v[64:71], v10
    v_smfmac_f32_16x16x64_bf16 v[100:103], v[60:63], v[72:79], v10
    ds_read_b128 v[64:67], v11 offset:30720
    v_smfmac_f32_16x16x64_bf16 v[104:107], v[60:63], v[80:87], v10
    ds_read_b128 v[68:71], v11 offset:31744
    v_smfmac_f32_16x16x64_bf16 v[108:111], v[60:63], v[88:95], v10
    v_add_f32 v96, v96, v98
    v_add_f32 v97, v97, v99
    v_cvt_pk_bf16_f32 v96, v96, v97
    v_smfmac_f32_16x16x64_bf16 v[112:115], v[56:59], a[224:231], v10
    v_add_f32 v100, v100, v102
    v_add_f32 v101, v101, v103
    v_cvt_pk_bf16_f32 v97, v100, v101
    v_smfmac_f32_16x16x64_bf16 v[116:119], v[56:59], a[232:239], v10
    v_add_f32 v104, v104, v106
    v_add_f32 v105, v105, v107
    v_cvt_pk_bf16_f32 v98, v104, v105
    v_smfmac_f32_16x16x64_bf16 v[120:123], v[56:59], a[240:247], v10
    v_add_f32 v108, v108, v110
    v_add_f32 v109, v109, v111
    v_cvt_pk_bf16_f32 v99, v108, v109
    v_smfmac_f32_16x16x64_bf16 v[124:127], v[56:59], a[248:255], v10
    buffer_store_dwordx4 v[96:99], v1, s[8:11], s23 offen sc1
    v_smfmac_f32_16x16x64_bf16 v[112:115], v[60:63], v[32:39], v10
    v_smfmac_f32_16x16x64_bf16 v[116:119], v[60:63], v[40:47], v10
    v_smfmac_f32_16x16x64_bf16 v[120:123], v[60:63], v[48:55], v10
    s_waitcnt lgkmcnt(0)
    v_smfmac_f32_16x16x64_bf16 v[124:127], v[60:63], v[64:71], v10
    v_add_f32 v112, v112, v114
    v_add_f32 v113, v113, v115
    v_cvt_pk_bf16_f32 v112, v112, v113
    v_add_f32 v116, v116, v118
    v_add_f32 v117, v117, v119
    v_cvt_pk_bf16_f32 v113, v116, v117
    v_add_f32 v120, v120, v122
    v_add_f32 v121, v121, v123
    v_cvt_pk_bf16_f32 v114, v120, v121
    v_add_f32 v124, v124, v126
    v_add_f32 v125, v125, v127
    v_cvt_pk_bf16_f32 v115, v124, v125
    buffer_store_dwordx4 v[112:115], v1, s[8:11], s25 offen sc1
    v_mov_b32 v26, 0x3f80
    v_mov_b32 v27, 0x3f800000
    v_cndmask_b32 v26, v26, v27, s[100:101]
    v_cndmask_b32 v108, 0, v26, s[48:49]
    v_cndmask_b32 v109, 0, v26, s[50:51]
    v_cndmask_b32 v110, 0, v26, s[52:53]
    v_cndmask_b32 v111, 0, v26, s[54:55]
    ds_read_b128 v[64:67], v11 offset:0
    ds_read_b128 v[68:71], v11 offset:1024
    ds_read_b128 v[72:75], v11 offset:2048
    ds_read_b128 v[76:79], v11 offset:3072
    ds_read_b128 v[80:83], v11 offset:4096
    ds_read_b128 v[84:87], v11 offset:5120
    ds_read_b128 v[88:91], v11 offset:6144
    ds_read_b128 v[92:95], v11 offset:7168
    v_mov_b64 v[112:113], 0
    v_mov_b64 v[114:115], 0
    v_mov_b64 v[116:117], 0
    v_mov_b64 v[118:119], 0
    v_mov_b64 v[120:121], 0
    v_mov_b64 v[122:123], 0
    v_mov_b64 v[124:125], 0
    v_mov_b64 v[126:127], 0
    v_mov_b64 v[28:29], -1
    v_mov_b64 v[30:31], -1
    s_mov_b32 s7, 0
    s_sleep 2
    buffer_load_dwordx4 v[96:99], v0, s[8:11], s24 offen sc1
    buffer_load_dwordx4 v[100:103], v0, s[8:11], s24 offen offset:1024 sc1
    s_sleep 3
    buffer_load_dwordx4 v[96:99], v0, s[8:11], s24 offen sc1
    buffer_load_dwordx4 v[100:103], v0, s[8:11], s24 offen offset:1024 sc1
    s_and_b32 s33, s5, 7
    s_cmp_eq_u32 s33, 6
    s_cbranch_scc0 L_nkv_3ms
    s_add_u32 s33, s5, 2
    s_lshr_b32 s33, s33, 3
    s_lshl_b32 s33, s33, 7
    s_add_u32 s33, s33, 262144
    v_mov_b32 v26, s33
    buffer_load_dword v27, v26, s[8:11], 0 offen sc1
    s_waitcnt vmcnt(0)
L_nkv_3ms:
L_p1w_3ms:
    s_waitcnt vmcnt(2)
    v_mfma_f32_16x16x32_bf16 v[104:107], v[108:111], v[96:99], 0
    v_mfma_f32_16x16x32_bf16 v[104:107], v[108:111], v[100:103], v[104:107]
    s_nop 7
    v_cmp_u_f32 vcc, v104, v104
    s_cbranch_vccnz L_p1r_3ms
L_p1d_3ms:
    v_add_f32_dpp v104, v104, v104 row_ror:8 row_mask:0xf bank_mask:0xf
    v_add_f32_dpp v105, v105, v105 row_ror:8 row_mask:0xf bank_mask:0xf
    v_add_f32_dpp v106, v106, v106 row_ror:8 row_mask:0xf bank_mask:0xf
    v_add_f32_dpp v107, v107, v107 row_ror:8 row_mask:0xf bank_mask:0xf
    v_add_f32_dpp v104, v104, v104 row_ror:4 row_mask:0xf bank_mask:0xf
    v_add_f32_dpp v105, v105, v105 row_ror:4 row_mask:0xf bank_mask:0xf
    v_add_f32_dpp v106, v106, v106 row_ror:4 row_mask:0xf bank_mask:0xf
    v_add_f32_dpp v107, v107, v107 row_ror:4 row_mask:0xf bank_mask:0xf
    v_cvt_pk_bf16_f32 v104, v104, v106
    v_cvt_pk_bf16_f32 v105, v105, v107
    s_mov_b64 exec, s[40:41]
    v_cndmask_b32 v104, v104, v105, s[42:43]
    v_min_u32 v104, -2, v104
    buffer_store_dword v104, v2, s[8:11], s21 offen sc1
    buffer_store_dword v28, v2, s[8:11], s20 offen sc1
    s_mov_b64 exec, -1
    s_add_u32 s47, s21, 6144
    s_mov_b32 s7, 0
    s_add_u32 s5, s5, 1
    s_and_b32 s33, s5, 7
    s_cmp_eq_u32 s33, 7
    s_cbranch_scc0 L_ckv_3ms
    s_cmp_ge_u32 s5, 57
    s_cbranch_scc1 L_ckv_3ms
L_ckvl_3ms:
    v_readfirstlane_b32 s33, v27
    s_and_b32 s33, s33, 0xff
    s_cmp_eq_u32 s33, 128
    s_cbranch_scc1 L_ckv_3ms
    s_add_u32 s7, s7, 1
    s_cmp_lt_u32 s7, 400000
    s_cbranch_scc0 L_ckv_3ms
    s_sleep 2
    buffer_load_dword v27, v26, s[8:11], 0 offen sc1
    s_waitcnt vmcnt(0)
    s_branch L_ckvl_3ms
L_ckv_3ms:
    s_mov_b32 s7, 0
    s_sleep 2
    s_mov_b32 m0, 6144
    s_nop 0
    buffer_load_dwordx4 v0, s[8:11], s47 offen sc1 lds
    buffer_load_dwordx4 v0, s[8:11], s47 offen offset:1024 sc1 lds
    s_mov_b32 s33, s20
    s_mov_b32 s20, s21
    s_mov_b32 s21, s22
    s_mov_b32 s22, s33
    s_xor_b32 s23, s23, 0x40000
    s_mov_b32 s26, s24
    s_xor_b32 s24, s24, 0x40000
    s_xor_b32 s25, s25, 0x40000
    s_add_u32 s28, s28, 0x40000
    s_xor_b32 s29, s29, 8192
    s_add_u32 s30, s30, 0x40000
    s_mov_b32 s62, s31
    s_mov_b32 s63, s32
    s_add_u32 s31, s31, 65536
    s_add_u32 s32, s32, 131072
    v_xor_b32 v5, 0x2000, v5
    v_xor_b32 v6, 0x2000, v6
    s_sleep 2
    s_mov_b32 m0, 6144
    s_nop 0
    buffer_load_dwordx4 v0, s[8:11], s47 offen sc1 lds
    buffer_load_dwordx4 v0, s[8:11], s47 offen offset:1024 sc1 lds
    v_mov_b64 v[104:105], -1
    v_mov_b64 v[106:107], -1
    s_cmp_lt_u32 s5, 63
    s_cbranch_scc1 L_step3s
    s_waitcnt vmcnt(2)
    ds_read_b128 v[56:59], v0 offset:6144
    ds_read_b128 v[60:63], v0 offset:7168
    s_waitcnt lgkmcnt(0)
    v_max3_u32 v26, v56, v57, v58
    v_max3_u32 v27, v59, v60, v61
    v_max3_u32 v26, v26, v62, v63
    v_max_u32 v26, v26, v27
    v_cmp_eq_u32 vcc, -1, v26
    s_cbranch_vccnz L_p2r_3ls
L_p2d_3ls:
    s_barrier
    ds_read_b128 v[32:35], v0 offset:0
    ds_read_b128 v[36:39], v0 offset:1024
    ds_read_b128 v[40:43], v0 offset:2048
    ds_read_b128 v[44:47], v0 offset:3072
    ds_read_b128 v[48:51], v0 offset:4096
    ds_read_b128 v[52:55], v0 offset:5120
    ds_read_b64_tr_b16 v[28:29], v4 offset:3328
    ds_read_b64_tr_b16 v[30:31], v4 offset:3456
    buffer_store_dwordx4 v[12:15], v0, s[8:11], s63 offen offset:3072 sc1
    s_waitcnt lgkmcnt(0)
    s_mov_b64 exec, s[36:37]
    buffer_store_dwordx4 v[28:31], v7, s[8:11], s62 offen offset:1536 sc1
    s_mov_b64 exec, -1
    ds_read_b128 v[64:67], v11 offset:8192
    ds_read_b128 v[68:71], v11 offset:9216
    ds_read_b128 v[72:75], v11 offset:10240
    ds_read_b128 v[76:79], v11 offset:11264
    ds_read_b128 v[80:83], v11 offset:12288
    ds_read_b128 v[84:87], v11 offset:13312
    ds_read_b128 v[88:91], v11 offset:14336
    ds_read_b128 v[92:95], v11 offset:15360
    v_smfmac_f32_16x16x64_bf16 v[120:123], v[32:35], a[96:103], v10
    v_smfmac_f32_16x16x64_bf16 v[124:127], v[32:35], a[104:111], v10
    s_waitcnt lgkmcnt(4)
    v_smfmac_f32_16x16x64_bf16 v[120:123], v[56:59], v[64:71], v10
    v_smfmac_f32_16x16x64_bf16 v[124:127], v[56:59], v[72:79], v10
    v_smfmac_f32_16x16x64_bf16 v[120:123], v[36:39], a[112:119], v10
    v_smfmac_f32_16x16x64_bf16 v[124:127], v[36:39], a[120:127], v10
    s_waitcnt lgkmcnt(0)
    v_smfmac_f32_16x16x64_bf16 v[120:123], v[60:63], v[80:87], v10
    v_smfmac_f32_16x16x64_bf16 v[124:127], v[60:63], v[88:95], v10
    v_smfmac_f32_16x16x64_bf16 v[120:123], v[40:43], a[128:135], v10
    v_smfmac_f32_16x16x64_bf16 v[124:127], v[40:43], a[136:143], v10
    v_smfmac_f32_16x16x64_bf16 v[120:123], v[44:47], a[144:151], v10
    v_smfmac_f32_16x16x64_bf16 v[124:127], v[44:47], a[152:159], v10
    v_smfmac_f32_16x16x64_bf16 v[120:123], v[48:51], a[160:167], v10
    v_smfmac_f32_16x16x64_bf16 v[124:127], v[48:51], a[168:175], v10
    v_smfmac_f32_16x16x64_bf16 v[120:123], v[52:55], a[176:183], v10
    v_smfmac_f32_16x16x64_bf16 v[124:127], v[52:55], a[184:191], v10
    v_mov_b64 v[112:113], 0
    v_mov_b64 v[114:115], 0
    v_mov_b64 v[116:117], 0
    v_mov_b64 v[118:119], 0
    v_smfmac_f32_16x16x64_bf16 v[112:115], v[32:35], v[128:135], v10
    v_smfmac_f32_16x16x64_bf16 v[116:119], v[32:35], v[136:143], v10
    v_add_f32 v120, v120, v122
    v_add_f32 v121, v121, v123
    v_smfmac_f32_16x16x64_bf16 v[112:115], v[36:39], v[144:151], v10
    v_add_f32 v124, v124, v126
    v_add_f32 v125, v125, v127
    v_smfmac_f32_16x16x64_bf16 v[116:119], v[36:39], v[152:159], v10
    v_cvt_pk_bf16_f32 v120, v120, v121
    v_cvt_pk_bf16_f32 v124, v124, v125
    v_smfmac_f32_16x16x64_bf16 v[112:115], v[40:43], v[160:167], v10
    ds_write2_b32 v3, v120, v124 offset0:64 offset1:192
    v_smfmac_f32_16x16x64_bf16 v[116:119], v[40:43], v[168:175], v10
    v_smfmac_f32_16x16x64_bf16 v[112:115], v[44:47], v[176:183], v10
    v_smfmac_f32_16x16x64_bf16 v[116:119], v[44:47], v[184:191], v10
    v_smfmac_f32_16x16x64_bf16 v[112:115], v[48:51], v[192:199], v10
    s_waitcnt lgkmcnt(0)
    s_barrier
    v_smfmac_f32_16x16x64_bf16 v[116:119], v[48:51], v[200:207], v10
    v_smfmac_f32_16x16x64_bf16 v[112:115], v[52:55], v[208:215], v10
    v_smfmac_f32_16x16x64_bf16 v[116:119], v[52:55], v[216:223], v10
    v_smfmac_f32_16x16x64_bf16 v[112:115], v[56:59], v[224:231], v10
    v_smfmac_f32_16x16x64_bf16 v[116:119], v[56:59], v[232:239], v10
    v_smfmac_f32_16x16x64_bf16 v[112:115], v[60:63], v[240:247], v10
    v_smfmac_f32_16x16x64_bf16 v[116:119], v[60:63], v[248:255], v10
    ds_read_b64_tr_b16 v[32:33], v4 offset:256
    ds_read_b64_tr_b16 v[34:35], v4 offset:384
    ds_read_b64_tr_b16 v[36:37], v4 offset:1280
    ds_read_b64_tr_b16 v[38:39], v4 offset:1408
    ds_read_b64_tr_b16 v[40:41], v4 offset:2304
    ds_read_b64_tr_b16 v[42:43], v4 offset:2432
    ds_read_b64_tr_b16 v[44:45], v4 offset:3328
    ds_read_b64_tr_b16 v[46:47], v4 offset:3456
    v_pk_add_f32 v[112:113], v[112:113], v[114:115]
    v_pk_add_f32 v[116:117], v[116:117], v[118:119]
    v_cvt_pk_bf16_f32 v12, v112, v113
    v_cvt_pk_bf16_f32 v14, v116, v117
    buffer_store_dwordx4 v[12:15], v0, s[8:11], s32 offen offset:3072 sc1
    s_waitcnt lgkmcnt(0)
    s_mov_b64 exec, s[36:37]
    buffer_store_dwordx4 v[44:47], v7, s[8:11], s31 offen offset:1536 sc1
    s_mov_b64 exec, -1
L_cfin3:
    s_waitcnt vmcnt(0)
    s_barrier
    s_memtime s[58:59]
    s_memrealtime s[76:77]
    s_waitcnt lgkmcnt(0)
    s_branch L_chain_end
L_p2r_3m:
    s_add_u32 s7, s7, 1
    s_cmp_lt_u32 s7, s6
    s_cbranch_scc0 L_p2r_3m_to
    s_mov_b32 m0, 6144
    s_nop 0
    buffer_load_dwordx4 v0, s[8:11], s47 offen sc1 lds
    buffer_load_dwordx4 v0, s[8:11], s47 offen offset:1024 sc1 lds
    s_waitcnt vmcnt(2)
    ds_read_b128 v[56:59], v0 offset:6144
    ds_read_b128 v[60:63], v0 offset:7168
    s_waitcnt lgkmcnt(0)
    v_max3_u32 v26, v56, v57, v58
    v_max3_u32 v27, v59, v60, v61
    v_max3_u32 v26, v26, v62, v63
    v_max_u32 v26, v26, v27
    v_cmp_eq_u32 vcc, -1, v26
    s_cbranch_vccnz L_p2r_3m
    s_branch L_p2d_3m
L_p2r_3m_to:
    s_mov_b32 s6, 0
    s_branch L_p2d_3m
L_p1r_3m:
    s_add_u32 s7, s7, 1
    s_cmp_lt_u32 s7, s6
    s_cbranch_scc0 L_p1r_3m_to
    buffer_load_dwordx4 v[96:99], v0, s[8:11], s24 offen sc1
    buffer_load_dwordx4 v[100:103], v0, s[8:11], s24 offen offset:1024 sc1
    s_branch L_p1w_3m
L_p1r_3m_to:
    s_mov_b32 s6, 0
    s_branch L_p1d_3m
L_p2r_3l:
    s_add_u32 s7, s7, 1
    s_cmp_lt_u32 s7, s6
    s_cbranch_scc0 L_p2r_3l_to
    s_mov_b32 m0, 6144
    s_nop 0
    buffer_load_dwordx4 v0, s[8:11], s47 offen sc1 lds
    buffer_load_dwordx4 v0, s[8:11], s47 offen offset:1024 sc1 lds
    s_waitcnt vmcnt(2)
    ds_read_b128 v[56:59], v0 offset:6144
    ds_read_b128 v[60:63], v0 offset:7168
    s_waitcnt lgkmcnt(0)
    v_max3_u32 v26, v56, v57, v58
    v_max3_u32 v27, v59, v60, v61
    v_max3_u32 v26, v26, v62, v63
    v_max_u32 v26, v26, v27
    v_cmp_eq_u32 vcc, -1, v26
    s_cbranch_vccnz L_p2r_3l
    s_branch L_p2d_3l
L_p2r_3l_to:
    s_mov_b32 s6, 0
    s_branch L_p2d_3l
L_p2r_3ms:
    s_add_u32 s7, s7, 1
    s_cmp_lt_u32 s7, s6
    s_cbranch_scc0 L_p2r_3ms_to
    s_mov_b32 m0, 6144
    s_nop 0
    buffer_load_dwordx4 v0, s[8:11], s47 offen sc1 lds
    buffer_load_dwordx4 v0, s[8:11], s47 offen offset:1024 sc1 lds
    s_waitcnt vmcnt(2)
    ds_read_b128 v[56:59], v0 offset:6144
    ds_read_b128 v[60:63], v0 offset:7168
    s_waitcnt lgkmcnt(0)
    v_max3_u32 v26, v56, v57, v58
    v_max3_u32 v27, v59, v60, v61
    v_max3_u32 v26, v26, v62, v63
    v_max_u32 v26, v26, v27
    v_cmp_eq_u32 vcc, -1, v26
    s_cbranch_vccnz L_p2r_3ms
    s_branch L_p2d_3ms
L_p2r_3ms_to:
    s_mov_b32 s6, 0
    s_branch L_p2d_3ms
L_p1r_3ms:
    s_add_u32 s7, s7, 1
    s_cmp_lt_u32 s7, s6
    s_cbranch_scc0 L_p1r_3ms_to
    buffer_load_dwordx4 v[96:99], v0, s[8:11], s24 offen sc1
    buffer_load_dwordx4 v[100:103], v0, s[8:11], s24 offen offset:1024 sc1
    s_branch L_p1w_3ms
L_p1r_3ms_to:
    s_mov_b32 s6, 0
    s_branch L_p1d_3ms
L_p2r_3ls:
    s_add_u32 s7, s7, 1
    s_cmp_lt_u32 s7, s6
    s_cbranch_scc0 L_p2r_3ls_to
    s_mov_b32 m0, 6144
    s_nop 0
    buffer_load_dwordx4 v0, s[8:11], s47 offen sc1 lds
    buffer_load_dwordx4 v0, s[8:11], s47 offen offset:1024 sc1 lds
    s_waitcnt vmcnt(2)
    ds_read_b128 v[56:59], v0 offset:6144
    ds_read_b128 v[60:63], v0 offset:7168
    s_waitcnt lgkmcnt(0)
    v_max3_u32 v26, v56, v57, v58
    v_max3_u32 v27, v59, v60, v61
    v_max3_u32 v26, v26, v62, v63
    v_max_u32 v26, v26, v27
    v_cmp_eq_u32 vcc, -1, v26
    s_cbranch_vccnz L_p2r_3ls
    s_branch L_p2d_3ls
L_p2r_3ls_to:
    s_mov_b32 s6, 0
    s_branch L_p2d_3ls
L_chain_end:
    s_branch L_all_end
L_worker:
    s_sub_u32 s90, s33, 1
    s_lshl_b32 s90, s90, 5
    s_add_u32 s90, s90, s3
    v_mov_b32 v15, v0
    s_load_dwordx2 s[8:9], s[0:1], 112
    s_load_dwordx2 s[12:13], s[0:1], 0
    s_load_dwordx2 s[24:25], s[0:1], 16
    s_load_dwordx2 s[28:29], s[0:1], 24
    s_load_dwordx2 s[32:33], s[0:1], 32
    s_load_dwordx2 s[36:37], s[0:1], 64
    s_load_dwordx2 s[40:41], s[0:1], 72
    s_load_dwordx2 s[60:61], s[0:1], 88
    s_load_dwordx2 s[68:69], s[0:1], 104
    s_waitcnt lgkmcnt(0)
    s_mov_b32 s10, 268435456
    s_mov_b32 s11, 0x20000
    s_mov_b32 s14, 2097152
    s_mov_b32 s15, 0x20000
    s_mov_b32 s62, 1024
    s_mov_b32 s63, 0x20000
    s_mov_b32 s54, 0xbfb8aa3b
    s_mov_b32 s55, 0xbfb8aa3b
    s_mov_b32 s58, 1.0
    s_mov_b32 s59, 1.0
    s_mov_b32 s72, 0
    s_mov_b32 s88, 0
    s_mov_b32 s89, 0
    s_mov_b32 s87, 0
    v_and_b32 v8, 63, v0
    v_lshlrev_b32 v0, 4, v8
    v_lshrrev_b32 v16, 3, v8
    v_bfe_u32 v17, v8, 1, 2
    v_and_b32 v18, 2, v16
    v_xor_b32 v17, v17, v18
    v_lshlrev_b32 v17, 5, v17
    v_and_b32 v18, 1, v8
    v_lshlrev_b32 v18, 4, v18
    v_add_u32 v17, v17, v18
    v_lshlrev_b32 v18, 13, v16
    v_add_u32 v1, v17, v18
    v_mul_u32_u24 v18, 3584, v16
    v_add_u32 v2, v17, v18
    v_lshrrev_b32 v16, 5, v8
    v_lshlrev_b32 v16, 10, v16
    v_bfe_u32 v17, v8, 2, 2
    v_lshlrev_b32 v18, 7, v17
    v_add_u32 v16, v16, v18
    v_and_b32 v17, 2, v17
    v_bfe_u32 v18, v8, 4, 1
    v_add_u32 v17, v17, v18
    v_lshlrev_b32 v17, 5, v17
    v_add_u32 v16, v16, v17
    v_and_b32 v17, 3, v8
    v_lshlrev_b32 v17, 3, v17
    v_add_u32 v4, v16, v17
    v_xor_b32 v5, 64, v4
    v_add_u32 v12, 0x10000, v4
    v_add_u32 v13, 0x10000, v5
    v_and_b32 v16, 31, v8
    v_bfe_u32 v17, v8, 4, 1
    v_lshlrev_b32 v17, 3, v17
    v_xor_b32 v16, v16, v17
    v_lshlrev_b32 v16, 4, v16
    v_lshrrev_b32 v17, 5, v8
    v_lshlrev_b32 v17, 9, v17
    v_add_u32 v6, v16, v17
    v_and_b32 v16, 31, v8
    v_lshlrev_b32 v17, 10, v16
    v_and_b32 v16, 15, v16
    v_lshrrev_b32 v18, 5, v8
    v_xor_b32 v16, v16, v18
    v_lshlrev_b32 v16, 4, v16
    v_add_u32 v16, v16, v17
    s_lshl_b32 s46, s4, 15
    s_add_u32 s46, s46, 32768
    v_add_u32 v7, s46, v16
    s_and_b32 s75, s90, 7
    s_lshr_b32 s76, s90, 3
    s_mov_b32 s71, 1
    s_cmp_ge_u32 s90, 192
    s_cbranch_scc1 L_g1w_own
    s_cmp_ge_u32 s90, 128
    s_cbranch_scc1 L_g1w_f1
    s_mov_b32 s5, 0
    s_lshr_b32 s6, s90, 1
    s_and_b32 s79, s90, 1
    s_lshr_b32 s46, s6, 5
    s_and_b32 s47, s6, 31
    s_mov_b32 s49, s46
    s_cmp_eq_u32 s46, 3
    s_cbranch_scc1 L_decF_u9606
    s_lshl_b32 s44, s47, 8
    s_mov_b32 s45, 65536
    v_mov_b32 v3, v1
    s_cmp_eq_u32 s46, 0
    s_cselect_b32 s16, s28, s32
    s_cselect_b32 s17, s29, s33
    s_mov_b32 s48, 33554432
    s_cselect_b32 s48, 16777216, s48
    s_cmp_eq_u32 s46, 2
    s_cselect_b32 s16, s24, s16
    s_cselect_b32 s17, s25, s17
    s_cselect_b32 s48, 50331648, s48
    s_mov_b32 s18, 0x400000
    s_mov_b32 s19, 0x20000
    s_add_u32 s20, s16, 128
    s_addc_u32 s21, s17, 0
    s_mov_b32 s22, 4194176
    s_mov_b32 s23, 0x20000
    s_lshl_b32 s50, s5, 3
    s_lshl_b32 s46, s4, 1
    s_add_u32 s50, s50, s46
    s_lshl_b32 s50, s50, 5
    s_add_u32 s50, s50, s47
    s_lshl_b32 s50, s50, 13
    s_add_u32 s50, s50, s48
    s_branch L_decD_u9606
L_decF_u9606:
    s_lshl_b32 s44, s47, 7
    s_mov_b32 s45, 28672
    v_mov_b32 v3, v2
    s_mov_b32 s16, s36
    s_mov_b32 s17, s37
    s_mov_b32 s18, 1835008
    s_mov_b32 s19, 0x20000
    s_mov_b32 s20, s40
    s_mov_b32 s21, s41
    s_mov_b32 s22, 1835008
    s_mov_b32 s23, 0x20000
    s_lshl_b32 s50, s5, 3
    s_lshl_b32 s46, s4, 1
    s_add_u32 s50, s50, s46
    s_mul_i32 s50, s50, 114688
    s_lshl_b32 s47, s47, 12
    s_add_u32 s50, s50, s47
    s_add_u32 s50, s50, 109051904
L_decD_u9606:
    s_mul_i32 s53, s45, s4
    s_lshl_b32 s53, s53, 1
    s_add_u32 s53, s53, s44
    s_lshl_b32 s46, s79, 2
    s_sub_u32 s46, s46, s4
    s_ashr_i32 s47, s46, 31
    s_lshl_b32 s46, s46, 18
    s_add_u32 s50, s50, s46
    s_lshl_b32 s46, s4, 11
    s_add_u32 m0, s46, 0
    s_nop 0
    buffer_load_dwordx4 v3, s[16:19], s53 offen lds
    s_lshl_b32 s46, s4, 11
    s_add_u32 m0, s46, 1024
    s_add_u32 s47, s53, s45
    buffer_load_dwordx4 v3, s[16:19], s47 offen lds
    s_lshl_b32 s46, s4, 11
    s_add_u32 m0, s46, 8192
    s_nop 0
    buffer_load_dwordx4 v3, s[20:23], s53 offen lds
    s_lshl_b32 s46, s4, 11
    s_add_u32 m0, s46, 9216
    s_add_u32 s47, s53, s45
    buffer_load_dwordx4 v3, s[20:23], s47 offen lds
    s_lshl_b32 s46, s45, 3
    s_add_u32 s53, s53, s46
    s_lshl_b32 s46, s4, 11
    s_add_u32 m0, s46, 16384
    s_nop 0
    buffer_load_dwordx4 v3, s[16:19], s53 offen lds
    s_lshl_b32 s46, s4, 11
    s_add_u32 m0, s46, 17408
    s_add_u32 s47, s53, s45
    buffer_load_dwordx4 v3, s[16:19], s47 offen lds
    s_lshl_b32 s46, s4, 11
    s_add_u32 m0, s46, 24576
    s_nop 0
    buffer_load_dwordx4 v3, s[20:23], s53 offen lds
    s_lshl_b32 s46, s4, 11
    s_add_u32 m0, s46, 25600
    s_add_u32 s47, s53, s45
    buffer_load_dwordx4 v3, s[20:23], s47 offen lds
    s_lshl_b32 s46, s45, 3
    s_add_u32 s53, s53, s46
    s_lshl_b32 s46, s5, 8
    s_lshl_b32 s47, s79, 7
    s_add_u32 s46, s46, s47
    s_lshl_b32 s47, s4, 5
    s_add_u32 s46, s46, s47
    s_lshl_b32 s46, s46, 10
    s_lshl_b32 s47, s4, 15
    s_add_u32 s47, s47, 32768
    v_xor_b32 v9, 0, v0
    s_mov_b32 m0, s47
    s_nop 0
    buffer_load_dwordx4 v9, s[12:15], s46 offen lds
    s_add_u32 s46, s46, 1024
    s_add_u32 s47, s47, 1024
    v_xor_b32 v9, 16, v0
    s_mov_b32 m0, s47
    s_nop 0
    buffer_load_dwordx4 v9, s[12:15], s46 offen lds
    s_add_u32 s46, s46, 1024
    s_add_u32 s47, s47, 1024
    v_xor_b32 v9, 32, v0
    s_mov_b32 m0, s47
    s_nop 0
    buffer_load_dwordx4 v9, s[12:15], s46 offen lds
    s_add_u32 s46, s46, 1024
    s_add_u32 s47, s47, 1024
    v_xor_b32 v9, 48, v0
    s_mov_b32 m0, s47
    s_nop 0
    buffer_load_dwordx4 v9, s[12:15], s46 offen lds
    s_add_u32 s46, s46, 1024
    s_add_u32 s47, s47, 1024
    v_xor_b32 v9, 64, v0
    s_mov_b32 m0, s47
    s_nop 0
    buffer_load_dwordx4 v9, s[12:15], s46 offen lds
    s_add_u32 s46, s46, 1024
    s_add_u32 s47, s47, 1024
    v_xor_b32 v9, 80, v0
    s_mov_b32 m0, s47
    s_nop 0
    buffer_load_dwordx4 v9, s[12:15], s46 offen lds
    s_add_u32 s46, s46, 1024
    s_add_u32 s47, s47, 1024
    v_xor_b32 v9, 96, v0
    s_mov_b32 m0, s47
    s_nop 0
    buffer_load_dwordx4 v9, s[12:15], s46 offen lds
    s_add_u32 s46, s46, 1024
    s_add_u32 s47, s47, 1024
    v_xor_b32 v9, 112, v0
    s_mov_b32 m0, s47
    s_nop 0
    buffer_load_dwordx4 v9, s[12:15], s46 offen lds
    s_add_u32 s46, s46, 1024
    s_add_u32 s47, s47, 1024
    v_xor_b32 v9, 128, v0
    s_mov_b32 m0, s47
    s_nop 0
    buffer_load_dwordx4 v9, s[12:15], s46 offen lds
    s_add_u32 s46, s46, 1024
    s_add_u32 s47, s47, 1024
    v_xor_b32 v9, 144, v0
    s_mov_b32 m0, s47
    s_nop 0
    buffer_load_dwordx4 v9, s[12:15], s46 offen lds
    s_add_u32 s46, s46, 1024
    s_add_u32 s47, s47, 1024
    v_xor_b32 v9, 160, v0
    s_mov_b32 m0, s47
    s_nop 0
    buffer_load_dwordx4 v9, s[12:15], s46 offen lds
    s_add_u32 s46, s46, 1024
    s_add_u32 s47, s47, 1024
    v_xor_b32 v9, 176, v0
    s_mov_b32 m0, s47
    s_nop 0
    buffer_load_dwordx4 v9, s[12:15], s46 offen lds
    s_add_u32 s46, s46, 1024
    s_add_u32 s47, s47, 1024
    v_xor_b32 v9, 192, v0
    s_mov_b32 m0, s47
    s_nop 0
    buffer_load_dwordx4 v9, s[12:15], s46 offen lds
    s_add_u32 s46, s46, 1024
    s_add_u32 s47, s47, 1024
    v_xor_b32 v9, 208, v0
    s_mov_b32 m0, s47
    s_nop 0
    buffer_load_dwordx4 v9, s[12:15], s46 offen lds
    s_add_u32 s46, s46, 1024
    s_add_u32 s47, s47, 1024
    v_xor_b32 v9, 224, v0
    s_mov_b32 m0, s47
    s_nop 0
    buffer_load_dwordx4 v9, s[12:15], s46 offen lds
    s_add_u32 s46, s46, 1024
    s_add_u32 s47, s47, 1024
    v_xor_b32 v9, 240, v0
    s_mov_b32 m0, s47
    s_nop 0
    buffer_load_dwordx4 v9, s[12:15], s46 offen lds
    s_add_u32 s46, s46, 1024
    s_add_u32 s47, s47, 1024
    v_xor_b32 v9, 0, v0
    s_mov_b32 m0, s47
    s_nop 0
    buffer_load_dwordx4 v9, s[12:15], s46 offen lds
    s_add_u32 s46, s46, 1024
    s_add_u32 s47, s47, 1024
    v_xor_b32 v9, 16, v0
    s_mov_b32 m0, s47
    s_nop 0
    buffer_load_dwordx4 v9, s[12:15], s46 offen lds
    s_add_u32 s46, s46, 1024
    s_add_u32 s47, s47, 1024
    v_xor_b32 v9, 32, v0
    s_mov_b32 m0, s47
    s_nop 0
    buffer_load_dwordx4 v9, s[12:15], s46 offen lds
    s_add_u32 s46, s46, 1024
    s_add_u32 s47, s47, 1024
    v_xor_b32 v9, 48, v0
    s_mov_b32 m0, s47
    s_nop 0
    buffer_load_dwordx4 v9, s[12:15], s46 offen lds
    s_add_u32 s46, s46, 1024
    s_add_u32 s47, s47, 1024
    v_xor_b32 v9, 64, v0
    s_mov_b32 m0, s47
    s_nop 0
    buffer_load_dwordx4 v9, s[12:15], s46 offen lds
    s_add_u32 s46, s46, 1024
    s_add_u32 s47, s47, 1024
    v_xor_b32 v9, 80, v0
    s_mov_b32 m0, s47
    s_nop 0
    buffer_load_dwordx4 v9, s[12:15], s46 offen lds
    s_add_u32 s46, s46, 1024
    s_add_u32 s47, s47, 1024
    v_xor_b32 v9, 96, v0
    s_mov_b32 m0, s47
    s_nop 0
    buffer_load_dwordx4 v9, s[12:15], s46 offen lds
    s_add_u32 s46, s46, 1024
    s_add_u32 s47, s47, 1024
    v_xor_b32 v9, 112, v0
    s_mov_b32 m0, s47
    s_nop 0
    buffer_load_dwordx4 v9, s[12:15], s46 offen lds
    s_add_u32 s46, s46, 1024
    s_add_u32 s47, s47, 1024
    v_xor_b32 v9, 128, v0
    s_mov_b32 m0, s47
    s_nop 0
    buffer_load_dwordx4 v9, s[12:15], s46 offen lds
    s_add_u32 s46, s46, 1024
    s_add_u32 s47, s47, 1024
    v_xor_b32 v9, 144, v0
    s_mov_b32 m0, s47
    s_nop 0
    buffer_load_dwordx4 v9, s[12:15], s46 offen lds
    s_add_u32 s46, s46, 1024
    s_add_u32 s47, s47, 1024
    v_xor_b32 v9, 160, v0
    s_mov_b32 m0, s47
    s_nop 0
    buffer_load_dwordx4 v9, s[12:15], s46 offen lds
    s_add_u32 s46, s46, 1024
    s_add_u32 s47, s47, 1024
    v_xor_b32 v9, 176, v0
    s_mov_b32 m0, s47
    s_nop 0
    buffer_load_dwordx4 v9, s[12:15], s46 offen lds
    s_add_u32 s46, s46, 1024
    s_add_u32 s47, s47, 1024
    v_xor_b32 v9, 192, v0
    s_mov_b32 m0, s47
    s_nop 0
    buffer_load_dwordx4 v9, s[12:15], s46 offen lds
    s_add_u32 s46, s46, 1024
    s_add_u32 s47, s47, 1024
    v_xor_b32 v9, 208, v0
    s_mov_b32 m0, s47
    s_nop 0
    buffer_load_dwordx4 v9, s[12:15], s46 offen lds
    s_add_u32 s46, s46, 1024
    s_add_u32 s47, s47, 1024
    v_xor_b32 v9, 224, v0
    s_mov_b32 m0, s47
    s_nop 0
    buffer_load_dwordx4 v9, s[12:15], s46 offen lds
    s_add_u32 s46, s46, 1024
    s_add_u32 s47, s47, 1024
    v_xor_b32 v9, 240, v0
    s_mov_b32 m0, s47
    s_nop 0
    buffer_load_dwordx4 v9, s[12:15], s46 offen lds
    s_add_u32 s46, s46, 1024
    s_add_u32 s47, s47, 1024
    s_waitcnt vmcnt(0)
    v_xor_b32 v9, 0, v7
    ds_read_b128 a[0:3], v9
    v_xor_b32 v10, 32, v7
    ds_read_b128 a[4:7], v10
    v_xor_b32 v9, 64, v7
    ds_read_b128 a[8:11], v9
    v_xor_b32 v10, 96, v7
    ds_read_b128 a[12:15], v10
    v_xor_b32 v9, 128, v7
    ds_read_b128 a[16:19], v9
    v_xor_b32 v10, 160, v7
    ds_read_b128 a[20:23], v10
    v_xor_b32 v9, 192, v7
    ds_read_b128 a[24:27], v9
    v_xor_b32 v10, 224, v7
    ds_read_b128 a[28:31], v10
    v_xor_b32 v9, 256, v7
    ds_read_b128 a[32:35], v9
    v_xor_b32 v10, 288, v7
    ds_read_b128 a[36:39], v10
    v_xor_b32 v9, 320, v7
    ds_read_b128 a[40:43], v9
    v_xor_b32 v10, 352, v7
    ds_read_b128 a[44:47], v10
    v_xor_b32 v9, 384, v7
    ds_read_b128 a[48:51], v9
    v_xor_b32 v10, 416, v7
    ds_read_b128 a[52:55], v10
    v_xor_b32 v9, 448, v7
    ds_read_b128 a[56:59], v9
    v_xor_b32 v10, 480, v7
    ds_read_b128 a[60:63], v10
    v_xor_b32 v9, 512, v7
    ds_read_b128 a[64:67], v9
    v_xor_b32 v10, 544, v7
    ds_read_b128 a[68:71], v10
    v_xor_b32 v9, 576, v7
    ds_read_b128 a[72:75], v9
    v_xor_b32 v10, 608, v7
    ds_read_b128 a[76:79], v10
    v_xor_b32 v9, 640, v7
    ds_read_b128 a[80:83], v9
    v_xor_b32 v10, 672, v7
    ds_read_b128 a[84:87], v10
    v_xor_b32 v9, 704, v7
    ds_read_b128 a[88:91], v9
    v_xor_b32 v10, 736, v7
    ds_read_b128 a[92:95], v10
    v_xor_b32 v9, 768, v7
    ds_read_b128 a[96:99], v9
    v_xor_b32 v10, 800, v7
    ds_read_b128 a[100:103], v10
    v_xor_b32 v9, 832, v7
    ds_read_b128 a[104:107], v9
    v_xor_b32 v10, 864, v7
    ds_read_b128 a[108:111], v10
    v_xor_b32 v9, 896, v7
    ds_read_b128 a[112:115], v9
    v_xor_b32 v10, 928, v7
    ds_read_b128 a[116:119], v10
    v_xor_b32 v9, 960, v7
    ds_read_b128 a[120:123], v9
    v_xor_b32 v10, 992, v7
    ds_read_b128 a[124:127], v10
    s_waitcnt lgkmcnt(0)
    s_barrier
    s_lshl_b32 s46, s4, 11
    s_add_u32 m0, s46, 32768
    s_nop 0
    buffer_load_dwordx4 v3, s[16:19], s53 offen lds
    s_lshl_b32 s46, s4, 11
    s_add_u32 m0, s46, 33792
    s_add_u32 s47, s53, s45
    buffer_load_dwordx4 v3, s[16:19], s47 offen lds
    s_lshl_b32 s46, s4, 11
    s_add_u32 m0, s46, 40960
    s_nop 0
    buffer_load_dwordx4 v3, s[20:23], s53 offen lds
    s_lshl_b32 s46, s4, 11
    s_add_u32 m0, s46, 41984
    s_add_u32 s47, s53, s45
    buffer_load_dwordx4 v3, s[20:23], s47 offen lds
    s_lshl_b32 s46, s45, 3
    s_add_u32 s53, s53, s46
    s_lshl_b32 s46, s4, 11
    s_add_u32 m0, s46, 49152
    s_nop 0
    buffer_load_dwordx4 v3, s[16:19], s53 offen lds
    s_lshl_b32 s46, s4, 11
    s_add_u32 m0, s46, 50176
    s_add_u32 s47, s53, s45
    buffer_load_dwordx4 v3, s[16:19], s47 offen lds
    s_lshl_b32 s46, s4, 11
    s_add_u32 m0, s46, 57344
    s_nop 0
    buffer_load_dwordx4 v3, s[20:23], s53 offen lds
    s_lshl_b32 s46, s4, 11
    s_add_u32 m0, s46, 58368
    s_add_u32 s47, s53, s45
    buffer_load_dwordx4 v3, s[20:23], s47 offen lds
    s_lshl_b32 s46, s45, 3
    s_add_u32 s53, s53, s46
    s_lshl_b32 s46, s4, 11
    s_add_u32 m0, s46, 65536
    s_nop 0
    buffer_load_dwordx4 v3, s[16:19], s53 offen lds
    s_lshl_b32 s46, s4, 11
    s_add_u32 m0, s46, 66560
    s_add_u32 s47, s53, s45
    buffer_load_dwordx4 v3, s[16:19], s47 offen lds
    s_lshl_b32 s46, s4, 11
    s_add_u32 m0, s46, 73728
    s_nop 0
    buffer_load_dwordx4 v3, s[20:23], s53 offen lds
    s_lshl_b32 s46, s4, 11
    s_add_u32 m0, s46, 74752
    s_add_u32 s47, s53, s45
    buffer_load_dwordx4 v3, s[20:23], s47 offen lds
    s_lshl_b32 s46, s45, 3
    s_add_u32 s53, s53, s46
    s_lshl_b32 s46, s4, 11
    s_add_u32 m0, s46, 81920
    s_nop 0
    buffer_load_dwordx4 v3, s[16:19], s53 offen lds
    s_lshl_b32 s46, s4, 11
    s_add_u32 m0, s46, 82944
    s_add_u32 s47, s53, s45
    buffer_load_dwordx4 v3, s[16:19], s47 offen lds
    s_lshl_b32 s46, s4, 11
    s_add_u32 m0, s46, 90112
    s_nop 0
    buffer_load_dwordx4 v3, s[20:23], s53 offen lds
    s_lshl_b32 s46, s4, 11
    s_add_u32 m0, s46, 91136
    s_add_u32 s47, s53, s45
    buffer_load_dwordx4 v3, s[20:23], s47 offen lds
    s_lshl_b32 s46, s45, 3
    s_add_u32 s53, s53, s46
    buffer_load_dword v14, v0, s[12:15], 0 offen
    buffer_load_dword v14, v0, s[12:15], 0 offen
    buffer_load_dword v14, v0, s[12:15], 0 offen
    buffer_load_dword v14, v0, s[12:15], 0 offen
    buffer_load_dword v14, v0, s[12:15], 0 offen
    buffer_load_dword v14, v0, s[12:15], 0 offen
    buffer_load_dword v14, v0, s[12:15], 0 offen
    buffer_load_dword v14, v0, s[12:15], 0 offen
    buffer_load_dword v14, v0, s[12:15], 0 offen
    buffer_load_dword v14, v0, s[12:15], 0 offen
    buffer_load_dword v14, v0, s[12:15], 0 offen
    buffer_load_dword v14, v0, s[12:15], 0 offen
    buffer_load_dword v14, v0, s[12:15], 0 offen
    buffer_load_dword v14, v0, s[12:15], 0 offen
    buffer_load_dword v14, v0, s[12:15], 0 offen
    buffer_load_dword v14, v0, s[12:15], 0 offen
    s_cmp_eq_u32 s49, 1
    s_cbranch_scc1 L_g1h_v
    s_waitcnt vmcnt(36)
    s_barrier
    ds_read_b64_tr_b16 v[64:65], v4 offset:0
    ds_read_b64_tr_b16 v[66:67], v4 offset:512
    ds_read_b64_tr_b16 v[68:69], v5 offset:0
    ds_read_b64_tr_b16 v[70:71], v5 offset:512
    ds_read_b64_tr_b16 v[72:73], v4 offset:8192
    ds_read_b64_tr_b16 v[74:75], v4 offset:8704
    ds_read_b64_tr_b16 v[76:77], v5 offset:8192
    ds_read_b64_tr_b16 v[78:79], v5 offset:8704
    s_waitcnt lgkmcnt(0)
    v_mfma_f32_32x32x16_bf16 v[128:143], v[64:67], a[0:3], 0
    ds_read_b64_tr_b16 v[80:81], v4 offset:2048
    ds_read_b64_tr_b16 v[82:83], v4 offset:2560
    v_mfma_f32_32x32x16_bf16 v[160:175], v[68:71], a[0:3], 0
    ds_read_b64_tr_b16 v[84:85], v5 offset:2048
    ds_read_b64_tr_b16 v[86:87], v5 offset:2560
    v_mfma_f32_32x32x16_bf16 v[192:207], v[72:75], a[0:3], 0
    ds_read_b64_tr_b16 v[88:89], v4 offset:10240
    ds_read_b64_tr_b16 v[90:91], v4 offset:10752
    v_mfma_f32_32x32x16_bf16 v[224:239], v[76:79], a[0:3], 0
    ds_read_b64_tr_b16 v[92:93], v5 offset:10240
    ds_read_b64_tr_b16 v[94:95], v5 offset:10752
    s_lshl_b32 s46, s4, 11
    s_add_u32 m0, s46, 98304
    s_nop 0
    buffer_load_dwordx4 v3, s[16:19], s53 offen lds
    s_lshl_b32 s46, s4, 11
    s_add_u32 m0, s46, 99328
    s_add_u32 s47, s53, s45
    buffer_load_dwordx4 v3, s[16:19], s47 offen lds
    s_lshl_b32 s46, s4, 11
    s_add_u32 m0, s46, 106496
    s_nop 0
    buffer_load_dwordx4 v3, s[20:23], s53 offen lds
    s_lshl_b32 s46, s4, 11
    s_add_u32 m0, s46, 107520
    s_add_u32 s47, s53, s45
    buffer_load_dwordx4 v3, s[20:23], s47 offen lds
    s_lshl_b32 s46, s45, 3
    s_add_u32 s53, s53, s46
    s_waitcnt lgkmcnt(0)
    v_mfma_f32_32x32x16_bf16 v[128:143], v[80:83], a[4:7], v[128:143]
    ds_read_b64_tr_b16 v[64:65], v4 offset:4096
    ds_read_b64_tr_b16 v[66:67], v4 offset:4608
    v_mfma_f32_32x32x16_bf16 v[160:175], v[84:87], a[4:7], v[160:175]
    ds_read_b64_tr_b16 v[68:69], v5 offset:4096
    ds_read_b64_tr_b16 v[70:71], v5 offset:4608
    v_mfma_f32_32x32x16_bf16 v[192:207], v[88:91], a[4:7], v[192:207]
    ds_read_b64_tr_b16 v[72:73], v4 offset:12288
    ds_read_b64_tr_b16 v[74:75], v4 offset:12800
    v_mfma_f32_32x32x16_bf16 v[224:239], v[92:95], a[4:7], v[224:239]
    ds_read_b64_tr_b16 v[76:77], v5 offset:12288
    ds_read_b64_tr_b16 v[78:79], v5 offset:12800
    s_waitcnt lgkmcnt(0)
    v_mfma_f32_32x32x16_bf16 v[128:143], v[64:67], a[8:11], v[128:143]
    ds_read_b64_tr_b16 v[80:81], v4 offset:6144
    ds_read_b64_tr_b16 v[82:83], v4 offset:6656
    v_mfma_f32_32x32x16_bf16 v[160:175], v[68:71], a[8:11], v[160:175]
    ds_read_b64_tr_b16 v[84:85], v5 offset:6144
    ds_read_b64_tr_b16 v[86:87], v5 offset:6656
    v_mfma_f32_32x32x16_bf16 v[192:207], v[72:75], a[8:11], v[192:207]
    ds_read_b64_tr_b16 v[88:89], v4 offset:14336
    ds_read_b64_tr_b16 v[90:91], v4 offset:14848
    v_mfma_f32_32x32x16_bf16 v[224:239], v[76:79], a[8:11], v[224:239]
    ds_read_b64_tr_b16 v[92:93], v5 offset:14336
    ds_read_b64_tr_b16 v[94:95], v5 offset:14848
    s_waitcnt lgkmcnt(0)
    s_waitcnt vmcnt(36)
    s_barrier
    v_mfma_f32_32x32x16_bf16 v[128:143], v[80:83], a[12:15], v[128:143]
    ds_read_b64_tr_b16 v[64:65], v4 offset:16384
    ds_read_b64_tr_b16 v[66:67], v4 offset:16896
    v_mfma_f32_32x32x16_bf16 v[160:175], v[84:87], a[12:15], v[160:175]
    ds_read_b64_tr_b16 v[68:69], v5 offset:16384
    ds_read_b64_tr_b16 v[70:71], v5 offset:16896
    v_mfma_f32_32x32x16_bf16 v[192:207], v[88:91], a[12:15], v[192:207]
    ds_read_b64_tr_b16 v[72:73], v4 offset:24576
    ds_read_b64_tr_b16 v[74:75], v4 offset:25088
    v_mfma_f32_32x32x16_bf16 v[224:239], v[92:95], a[12:15], v[224:239]
    ds_read_b64_tr_b16 v[76:77], v5 offset:24576
    ds_read_b64_tr_b16 v[78:79], v5 offset:25088
    s_waitcnt lgkmcnt(0)
    v_mfma_f32_32x32x16_bf16 v[128:143], v[64:67], a[16:19], v[128:143]
    ds_read_b64_tr_b16 v[80:81], v4 offset:18432
    ds_read_b64_tr_b16 v[82:83], v4 offset:18944
    v_mfma_f32_32x32x16_bf16 v[160:175], v[68:71], a[16:19], v[160:175]
    ds_read_b64_tr_b16 v[84:85], v5 offset:18432
    ds_read_b64_tr_b16 v[86:87], v5 offset:18944
    v_mfma_f32_32x32x16_bf16 v[192:207], v[72:75], a[16:19], v[192:207]
    ds_read_b64_tr_b16 v[88:89], v4 offset:26624
    ds_read_b64_tr_b16 v[90:91], v4 offset:27136
    v_mfma_f32_32x32x16_bf16 v[224:239], v[76:79], a[16:19], v[224:239]
    ds_read_b64_tr_b16 v[92:93], v5 offset:26624
    ds_read_b64_tr_b16 v[94:95], v5 offset:27136
    s_lshl_b32 s46, s4, 11
    s_add_u32 m0, s46, 114688
    s_nop 0
    buffer_load_dwordx4 v3, s[16:19], s53 offen lds
    s_lshl_b32 s46, s4, 11
    s_add_u32 m0, s46, 115712
    s_add_u32 s47, s53, s45
    buffer_load_dwordx4 v3, s[16:19], s47 offen lds
    s_lshl_b32 s46, s4, 11
    s_add_u32 m0, s46, 122880
    s_nop 0
    buffer_load_dwordx4 v3, s[20:23], s53 offen lds
    s_lshl_b32 s46, s4, 11
    s_add_u32 m0, s46, 123904
    s_add_u32 s47, s53, s45
    buffer_load_dwordx4 v3, s[20:23], s47 offen lds
    s_lshl_b32 s46, s45, 3
    s_add_u32 s53, s53, s46
    s_waitcnt lgkmcnt(0)
    v_mfma_f32_32x32x16_bf16 v[128:143], v[80:83], a[20:23], v[128:143]
    ds_read_b64_tr_b16 v[64:65], v4 offset:20480
    ds_read_b64_tr_b16 v[66:67], v4 offset:20992
    v_mfma_f32_32x32x16_bf16 v[160:175], v[84:87], a[20:23], v[160:175]
    ds_read_b64_tr_b16 v[68:69], v5 offset:20480
    ds_read_b64_tr_b16 v[70:71], v5 offset:20992
    v_mfma_f32_32x32x16_bf16 v[192:207], v[88:91], a[20:23], v[192:207]
    ds_read_b64_tr_b16 v[72:73], v4 offset:28672
    ds_read_b64_tr_b16 v[74:75], v4 offset:29184
    v_mfma_f32_32x32x16_bf16 v[224:239], v[92:95], a[20:23], v[224:239]
    ds_read_b64_tr_b16 v[76:77], v5 offset:28672
    ds_read_b64_tr_b16 v[78:79], v5 offset:29184
    s_waitcnt lgkmcnt(0)
    v_mfma_f32_32x32x16_bf16 v[128:143], v[64:67], a[24:27], v[128:143]
    ds_read_b64_tr_b16 v[80:81], v4 offset:22528
    ds_read_b64_tr_b16 v[82:83], v4 offset:23040
    v_mfma_f32_32x32x16_bf16 v[160:175], v[68:71], a[24:27], v[160:175]
    ds_read_b64_tr_b16 v[84:85], v5 offset:22528
    ds_read_b64_tr_b16 v[86:87], v5 offset:23040
    v_mfma_f32_32x32x16_bf16 v[192:207], v[72:75], a[24:27], v[192:207]
    ds_read_b64_tr_b16 v[88:89], v4 offset:30720
    ds_read_b64_tr_b16 v[90:91], v4 offset:31232
    v_mfma_f32_32x32x16_bf16 v[224:239], v[76:79], a[24:27], v[224:239]
    ds_read_b64_tr_b16 v[92:93], v5 offset:30720
    ds_read_b64_tr_b16 v[94:95], v5 offset:31232
    s_waitcnt lgkmcnt(0)
    s_waitcnt vmcnt(36)
    s_barrier
    v_mfma_f32_32x32x16_bf16 v[128:143], v[80:83], a[28:31], v[128:143]
    ds_read_b64_tr_b16 v[64:65], v4 offset:32768
    ds_read_b64_tr_b16 v[66:67], v4 offset:33280
    v_mfma_f32_32x32x16_bf16 v[160:175], v[84:87], a[28:31], v[160:175]
    ds_read_b64_tr_b16 v[68:69], v5 offset:32768
    ds_read_b64_tr_b16 v[70:71], v5 offset:33280
    v_mfma_f32_32x32x16_bf16 v[192:207], v[88:91], a[28:31], v[192:207]
    ds_read_b64_tr_b16 v[72:73], v4 offset:40960
    ds_read_b64_tr_b16 v[74:75], v4 offset:41472
    v_mfma_f32_32x32x16_bf16 v[224:239], v[92:95], a[28:31], v[224:239]
    ds_read_b64_tr_b16 v[76:77], v5 offset:40960
    ds_read_b64_tr_b16 v[78:79], v5 offset:41472
    s_waitcnt lgkmcnt(0)
    v_mfma_f32_32x32x16_bf16 v[128:143], v[64:67], a[32:35], v[128:143]
    ds_read_b64_tr_b16 v[80:81], v4 offset:34816
    ds_read_b64_tr_b16 v[82:83], v4 offset:35328
    v_mfma_f32_32x32x16_bf16 v[160:175], v[68:71], a[32:35], v[160:175]
    ds_read_b64_tr_b16 v[84:85], v5 offset:34816
    ds_read_b64_tr_b16 v[86:87], v5 offset:35328
    v_mfma_f32_32x32x16_bf16 v[192:207], v[72:75], a[32:35], v[192:207]
    ds_read_b64_tr_b16 v[88:89], v4 offset:43008
    ds_read_b64_tr_b16 v[90:91], v4 offset:43520
    v_mfma_f32_32x32x16_bf16 v[224:239], v[76:79], a[32:35], v[224:239]
    ds_read_b64_tr_b16 v[92:93], v5 offset:43008
    ds_read_b64_tr_b16 v[94:95], v5 offset:43520
    s_mov_b32 s67, s6
    s_lshr_b32 s46, s67, 5
    s_and_b32 s47, s67, 31
    s_mov_b32 s51, s46
    s_cmp_eq_u32 s46, 3
    s_cbranch_scc1 L_decF_u10182
    s_lshl_b32 s44, s47, 8
    s_mov_b32 s45, 65536
    v_mov_b32 v3, v1
    s_cmp_eq_u32 s46, 0
    s_cselect_b32 s16, s28, s32
    s_cselect_b32 s17, s29, s33
    s_mov_b32 s48, 33554432
    s_cselect_b32 s48, 16777216, s48
    s_cmp_eq_u32 s46, 2
    s_cselect_b32 s16, s24, s16
    s_cselect_b32 s17, s25, s17
    s_cselect_b32 s48, 50331648, s48
    s_mov_b32 s18, 0x400000
    s_mov_b32 s19, 0x20000
    s_add_u32 s20, s16, 128
    s_addc_u32 s21, s17, 0
    s_mov_b32 s22, 4194176
    s_mov_b32 s23, 0x20000
    s_lshl_b32 s52, s5, 3
    s_lshl_b32 s46, s4, 1
    s_add_u32 s52, s52, s46
    s_lshl_b32 s52, s52, 5
    s_add_u32 s52, s52, s47
    s_lshl_b32 s52, s52, 13
    s_add_u32 s52, s52, s48
    s_branch L_decD_u10182
L_decF_u10182:
    s_lshl_b32 s44, s47, 7
    s_mov_b32 s45, 28672
    v_mov_b32 v3, v2
    s_mov_b32 s16, s36
    s_mov_b32 s17, s37
    s_mov_b32 s18, 1835008
    s_mov_b32 s19, 0x20000
    s_mov_b32 s20, s40
    s_mov_b32 s21, s41
    s_mov_b32 s22, 1835008
    s_mov_b32 s23, 0x20000
    s_lshl_b32 s52, s5, 3
    s_lshl_b32 s46, s4, 1
    s_add_u32 s52, s52, s46
    s_mul_i32 s52, s52, 114688
    s_lshl_b32 s47, s47, 12
    s_add_u32 s52, s52, s47
    s_add_u32 s52, s52, 109051904
L_decD_u10182:
    s_mul_i32 s53, s45, s4
    s_lshl_b32 s53, s53, 1
    s_add_u32 s53, s53, s44
    s_lshl_b32 s46, s4, 11
    s_add_u32 m0, s46, 0
    s_nop 0
    buffer_load_dwordx4 v3, s[16:19], s53 offen lds
    s_lshl_b32 s46, s4, 11
    s_add_u32 m0, s46, 1024
    s_add_u32 s47, s53, s45
    buffer_load_dwordx4 v3, s[16:19], s47 offen lds
    s_lshl_b32 s46, s4, 11
    s_add_u32 m0, s46, 8192
    s_nop 0
    buffer_load_dwordx4 v3, s[20:23], s53 offen lds
    s_lshl_b32 s46, s4, 11
    s_add_u32 m0, s46, 9216
    s_add_u32 s47, s53, s45
    buffer_load_dwordx4 v3, s[20:23], s47 offen lds
    s_lshl_b32 s46, s45, 3
    s_add_u32 s53, s53, s46
    s_waitcnt lgkmcnt(0)
    v_mfma_f32_32x32x16_bf16 v[128:143], v[80:83], a[36:39], v[128:143]
    ds_read_b64_tr_b16 v[64:65], v4 offset:36864
    ds_read_b64_tr_b16 v[66:67], v4 offset:37376
    v_mfma_f32_32x32x16_bf16 v[160:175], v[84:87], a[36:39], v[160:175]
    ds_read_b64_tr_b16 v[68:69], v5 offset:36864
    ds_read_b64_tr_b16 v[70:71], v5 offset:37376
    v_mfma_f32_32x32x16_bf16 v[192:207], v[88:91], a[36:39], v[192:207]
    ds_read_b64_tr_b16 v[72:73], v4 offset:45056
    ds_read_b64_tr_b16 v[74:75], v4 offset:45568
    v_mfma_f32_32x32x16_bf16 v[224:239], v[92:95], a[36:39], v[224:239]
    ds_read_b64_tr_b16 v[76:77], v5 offset:45056
    ds_read_b64_tr_b16 v[78:79], v5 offset:45568
    s_waitcnt lgkmcnt(0)
    v_mfma_f32_32x32x16_bf16 v[128:143], v[64:67], a[40:43], v[128:143]
    ds_read_b64_tr_b16 v[80:81], v4 offset:38912
    ds_read_b64_tr_b16 v[82:83], v4 offset:39424
    v_mfma_f32_32x32x16_bf16 v[160:175], v[68:71], a[40:43], v[160:175]
    ds_read_b64_tr_b16 v[84:85], v5 offset:38912
    ds_read_b64_tr_b16 v[86:87], v5 offset:39424
    v_mfma_f32_32x32x16_bf16 v[192:207], v[72:75], a[40:43], v[192:207]
    ds_read_b64_tr_b16 v[88:89], v4 offset:47104
    ds_read_b64_tr_b16 v[90:91], v4 offset:47616
    v_mfma_f32_32x32x16_bf16 v[224:239], v[76:79], a[40:43], v[224:239]
    ds_read_b64_tr_b16 v[92:93], v5 offset:47104
    ds_read_b64_tr_b16 v[94:95], v5 offset:47616
    s_waitcnt lgkmcnt(0)
    s_waitcnt vmcnt(36)
    s_barrier
    v_mfma_f32_32x32x16_bf16 v[128:143], v[80:83], a[44:47], v[128:143]
    ds_read_b64_tr_b16 v[64:65], v4 offset:49152
    ds_read_b64_tr_b16 v[66:67], v4 offset:49664
    v_mfma_f32_32x32x16_bf16 v[160:175], v[84:87], a[44:47], v[160:175]
    ds_read_b64_tr_b16 v[68:69], v5 offset:49152
    ds_read_b64_tr_b16 v[70:71], v5 offset:49664
    v_mfma_f32_32x32x16_bf16 v[192:207], v[88:91], a[44:47], v[192:207]
    ds_read_b64_tr_b16 v[72:73], v4 offset:57344
    ds_read_b64_tr_b16 v[74:75], v4 offset:57856
    v_mfma_f32_32x32x16_bf16 v[224:239], v[92:95], a[44:47], v[224:239]
    ds_read_b64_tr_b16 v[76:77], v5 offset:57344
    ds_read_b64_tr_b16 v[78:79], v5 offset:57856
    s_waitcnt lgkmcnt(0)
    v_mfma_f32_32x32x16_bf16 v[128:143], v[64:67], a[48:51], v[128:143]
    ds_read_b64_tr_b16 v[80:81], v4 offset:51200
    ds_read_b64_tr_b16 v[82:83], v4 offset:51712
    v_mfma_f32_32x32x16_bf16 v[160:175], v[68:71], a[48:51], v[160:175]
    ds_read_b64_tr_b16 v[84:85], v5 offset:51200
    ds_read_b64_tr_b16 v[86:87], v5 offset:51712
    v_mfma_f32_32x32x16_bf16 v[192:207], v[72:75], a[48:51], v[192:207]
    ds_read_b64_tr_b16 v[88:89], v4 offset:59392
    ds_read_b64_tr_b16 v[90:91], v4 offset:59904
    v_mfma_f32_32x32x16_bf16 v[224:239], v[76:79], a[48:51], v[224:239]
    ds_read_b64_tr_b16 v[92:93], v5 offset:59392
    ds_read_b64_tr_b16 v[94:95], v5 offset:59904
    s_lshl_b32 s46, s4, 11
    s_add_u32 m0, s46, 16384
    s_nop 0
    buffer_load_dwordx4 v3, s[16:19], s53 offen lds
    s_lshl_b32 s46, s4, 11
    s_add_u32 m0, s46, 17408
    s_add_u32 s47, s53, s45
    buffer_load_dwordx4 v3, s[16:19], s47 offen lds
    s_lshl_b32 s46, s4, 11
    s_add_u32 m0, s46, 24576
    s_nop 0
    buffer_load_dwordx4 v3, s[20:23], s53 offen lds
    s_lshl_b32 s46, s4, 11
    s_add_u32 m0, s46, 25600
    s_add_u32 s47, s53, s45
    buffer_load_dwordx4 v3, s[20:23], s47 offen lds
    s_lshl_b32 s46, s45, 3
    s_add_u32 s53, s53, s46
    s_waitcnt lgkmcnt(0)
    v_mfma_f32_32x32x16_bf16 v[128:143], v[80:83], a[52:55], v[128:143]
    ds_read_b64_tr_b16 v[64:65], v4 offset:53248
    ds_read_b64_tr_b16 v[66:67], v4 offset:53760
    v_mfma_f32_32x32x16_bf16 v[160:175], v[84:87], a[52:55], v[160:175]
    ds_read_b64_tr_b16 v[68:69], v5 offset:53248
    ds_read_b64_tr_b16 v[70:71], v5 offset:53760
    v_mfma_f32_32x32x16_bf16 v[192:207], v[88:91], a[52:55], v[192:207]
    ds_read_b64_tr_b16 v[72:73], v4 offset:61440
    ds_read_b64_tr_b16 v[74:75], v4 offset:61952
    v_mfma_f32_32x32x16_bf16 v[224:239], v[92:95], a[52:55], v[224:239]
    ds_read_b64_tr_b16 v[76:77], v5 offset:61440
    ds_read_b64_tr_b16 v[78:79], v5 offset:61952
    s_waitcnt lgkmcnt(0)
    v_mfma_f32_32x32x16_bf16 v[128:143], v[64:67], a[56:59], v[128:143]
    ds_read_b64_tr_b16 v[80:81], v4 offset:55296
    ds_read_b64_tr_b16 v[82:83], v4 offset:55808
    v_mfma_f32_32x32x16_bf16 v[160:175], v[68:71], a[56:59], v[160:175]
    ds_read_b64_tr_b16 v[84:85], v5 offset:55296
    ds_read_b64_tr_b16 v[86:87], v5 offset:55808
    v_mfma_f32_32x32x16_bf16 v[192:207], v[72:75], a[56:59], v[192:207]
    ds_read_b64_tr_b16 v[88:89], v4 offset:63488
    ds_read_b64_tr_b16 v[90:91], v4 offset:64000
    v_mfma_f32_32x32x16_bf16 v[224:239], v[76:79], a[56:59], v[224:239]
    ds_read_b64_tr_b16 v[92:93], v5 offset:63488
    ds_read_b64_tr_b16 v[94:95], v5 offset:64000
    s_waitcnt lgkmcnt(0)
    s_waitcnt vmcnt(36)
    s_barrier
    v_mfma_f32_32x32x16_bf16 v[128:143], v[80:83], a[60:63], v[128:143]
    ds_read_b64_tr_b16 v[64:65], v12 offset:0
    ds_read_b64_tr_b16 v[66:67], v12 offset:512
    v_mfma_f32_32x32x16_bf16 v[160:175], v[84:87], a[60:63], v[160:175]
    ds_read_b64_tr_b16 v[68:69], v13 offset:0
    ds_read_b64_tr_b16 v[70:71], v13 offset:512
    v_mfma_f32_32x32x16_bf16 v[192:207], v[88:91], a[60:63], v[192:207]
    ds_read_b64_tr_b16 v[72:73], v12 offset:8192
    ds_read_b64_tr_b16 v[74:75], v12 offset:8704
    v_mfma_f32_32x32x16_bf16 v[224:239], v[92:95], a[60:63], v[224:239]
    ds_read_b64_tr_b16 v[76:77], v13 offset:8192
    ds_read_b64_tr_b16 v[78:79], v13 offset:8704
    s_waitcnt lgkmcnt(0)
    v_mfma_f32_32x32x16_bf16 v[128:143], v[64:67], a[64:67], v[128:143]
    ds_read_b64_tr_b16 v[80:81], v12 offset:2048
    ds_read_b64_tr_b16 v[82:83], v12 offset:2560
    v_mfma_f32_32x32x16_bf16 v[160:175], v[68:71], a[64:67], v[160:175]
    ds_read_b64_tr_b16 v[84:85], v13 offset:2048
    ds_read_b64_tr_b16 v[86:87], v13 offset:2560
    v_mfma_f32_32x32x16_bf16 v[192:207], v[72:75], a[64:67], v[192:207]
    ds_read_b64_tr_b16 v[88:89], v12 offset:10240
    ds_read_b64_tr_b16 v[90:91], v12 offset:10752
    v_mfma_f32_32x32x16_bf16 v[224:239], v[76:79], a[64:67], v[224:239]
    ds_read_b64_tr_b16 v[92:93], v13 offset:10240
    ds_read_b64_tr_b16 v[94:95], v13 offset:10752
    s_lshl_b32 s46, s4, 11
    s_add_u32 m0, s46, 32768
    s_nop 0
    buffer_load_dwordx4 v3, s[16:19], s53 offen lds
    s_lshl_b32 s46, s4, 11
    s_add_u32 m0, s46, 33792
    s_add_u32 s47, s53, s45
    buffer_load_dwordx4 v3, s[16:19], s47 offen lds
    s_lshl_b32 s46, s4, 11
    s_add_u32 m0, s46, 40960
    s_nop 0
    buffer_load_dwordx4 v3, s[20:23], s53 offen lds
    s_lshl_b32 s46, s4, 11
    s_add_u32 m0, s46, 41984
    s_add_u32 s47, s53, s45
    buffer_load_dwordx4 v3, s[20:23], s47 offen lds
    s_lshl_b32 s46, s45, 3
    s_add_u32 s53, s53, s46
    s_waitcnt lgkmcnt(0)
    v_mfma_f32_32x32x16_bf16 v[128:143], v[80:83], a[68:71], v[128:143]
    ds_read_b64_tr_b16 v[64:65], v12 offset:4096
    ds_read_b64_tr_b16 v[66:67], v12 offset:4608
    v_mfma_f32_32x32x16_bf16 v[160:175], v[84:87], a[68:71], v[160:175]
    ds_read_b64_tr_b16 v[68:69], v13 offset:4096
    ds_read_b64_tr_b16 v[70:71], v13 offset:4608
    v_mfma_f32_32x32x16_bf16 v[192:207], v[88:91], a[68:71], v[192:207]
    ds_read_b64_tr_b16 v[72:73], v12 offset:12288
    ds_read_b64_tr_b16 v[74:75], v12 offset:12800
    v_mfma_f32_32x32x16_bf16 v[224:239], v[92:95], a[68:71], v[224:239]
    ds_read_b64_tr_b16 v[76:77], v13 offset:12288
    ds_read_b64_tr_b16 v[78:79], v13 offset:12800
    s_waitcnt lgkmcnt(0)
    v_mfma_f32_32x32x16_bf16 v[128:143], v[64:67], a[72:75], v[128:143]
    ds_read_b64_tr_b16 v[80:81], v12 offset:6144
    ds_read_b64_tr_b16 v[82:83], v12 offset:6656
    v_mfma_f32_32x32x16_bf16 v[160:175], v[68:71], a[72:75], v[160:175]
    ds_read_b64_tr_b16 v[84:85], v13 offset:6144
    ds_read_b64_tr_b16 v[86:87], v13 offset:6656
    v_mfma_f32_32x32x16_bf16 v[192:207], v[72:75], a[72:75], v[192:207]
    ds_read_b64_tr_b16 v[88:89], v12 offset:14336
    ds_read_b64_tr_b16 v[90:91], v12 offset:14848
    v_mfma_f32_32x32x16_bf16 v[224:239], v[76:79], a[72:75], v[224:239]
    ds_read_b64_tr_b16 v[92:93], v13 offset:14336
    ds_read_b64_tr_b16 v[94:95], v13 offset:14848
    s_waitcnt lgkmcnt(0)
    s_waitcnt vmcnt(36)
    s_barrier
    v_mfma_f32_32x32x16_bf16 v[128:143], v[80:83], a[76:79], v[128:143]
    ds_read_b64_tr_b16 v[64:65], v12 offset:16384
    ds_read_b64_tr_b16 v[66:67], v12 offset:16896
    v_mfma_f32_32x32x16_bf16 v[160:175], v[84:87], a[76:79], v[160:175]
    ds_read_b64_tr_b16 v[68:69], v13 offset:16384
    ds_read_b64_tr_b16 v[70:71], v13 offset:16896
    v_mfma_f32_32x32x16_bf16 v[192:207], v[88:91], a[76:79], v[192:207]
    ds_read_b64_tr_b16 v[72:73], v12 offset:24576
    ds_read_b64_tr_b16 v[74:75], v12 offset:25088
    v_mfma_f32_32x32x16_bf16 v[224:239], v[92:95], a[76:79], v[224:239]
    ds_read_b64_tr_b16 v[76:77], v13 offset:24576
    ds_read_b64_tr_b16 v[78:79], v13 offset:25088
    s_waitcnt lgkmcnt(0)
    v_mfma_f32_32x32x16_bf16 v[128:143], v[64:67], a[80:83], v[128:143]
    ds_read_b64_tr_b16 v[80:81], v12 offset:18432
    ds_read_b64_tr_b16 v[82:83], v12 offset:18944
    v_mfma_f32_32x32x16_bf16 v[160:175], v[68:71], a[80:83], v[160:175]
    ds_read_b64_tr_b16 v[84:85], v13 offset:18432
    ds_read_b64_tr_b16 v[86:87], v13 offset:18944
    v_mfma_f32_32x32x16_bf16 v[192:207], v[72:75], a[80:83], v[192:207]
    ds_read_b64_tr_b16 v[88:89], v12 offset:26624
    ds_read_b64_tr_b16 v[90:91], v12 offset:27136
    v_mfma_f32_32x32x16_bf16 v[224:239], v[76:79], a[80:83], v[224:239]
    ds_read_b64_tr_b16 v[92:93], v13 offset:26624
    ds_read_b64_tr_b16 v[94:95], v13 offset:27136
    s_lshl_b32 s46, s4, 11
    s_add_u32 m0, s46, 49152
    s_nop 0
    buffer_load_dwordx4 v3, s[16:19], s53 offen lds
    s_lshl_b32 s46, s4, 11
    s_add_u32 m0, s46, 50176
    s_add_u32 s47, s53, s45
    buffer_load_dwordx4 v3, s[16:19], s47 offen lds
    s_lshl_b32 s46, s4, 11
    s_add_u32 m0, s46, 57344
    s_nop 0
    buffer_load_dwordx4 v3, s[20:23], s53 offen lds
    s_lshl_b32 s46, s4, 11
    s_add_u32 m0, s46, 58368
    s_add_u32 s47, s53, s45
    buffer_load_dwordx4 v3, s[20:23], s47 offen lds
    s_lshl_b32 s46, s45, 3
    s_add_u32 s53, s53, s46
    s_waitcnt lgkmcnt(0)
    v_mfma_f32_32x32x16_bf16 v[128:143], v[80:83], a[84:87], v[128:143]
    ds_read_b64_tr_b16 v[64:65], v12 offset:20480
    ds_read_b64_tr_b16 v[66:67], v12 offset:20992
    v_mfma_f32_32x32x16_bf16 v[160:175], v[84:87], a[84:87], v[160:175]
    ds_read_b64_tr_b16 v[68:69], v13 offset:20480
    ds_read_b64_tr_b16 v[70:71], v13 offset:20992
    v_mfma_f32_32x32x16_bf16 v[192:207], v[88:91], a[84:87], v[192:207]
    ds_read_b64_tr_b16 v[72:73], v12 offset:28672
    ds_read_b64_tr_b16 v[74:75], v12 offset:29184
    v_mfma_f32_32x32x16_bf16 v[224:239], v[92:95], a[84:87], v[224:239]
    ds_read_b64_tr_b16 v[76:77], v13 offset:28672
    ds_read_b64_tr_b16 v[78:79], v13 offset:29184
    s_waitcnt lgkmcnt(0)
    v_mfma_f32_32x32x16_bf16 v[128:143], v[64:67], a[88:91], v[128:143]
    ds_read_b64_tr_b16 v[80:81], v12 offset:22528
    ds_read_b64_tr_b16 v[82:83], v12 offset:23040
    v_mfma_f32_32x32x16_bf16 v[160:175], v[68:71], a[88:91], v[160:175]
    ds_read_b64_tr_b16 v[84:85], v13 offset:22528
    ds_read_b64_tr_b16 v[86:87], v13 offset:23040
    v_mfma_f32_32x32x16_bf16 v[192:207], v[72:75], a[88:91], v[192:207]
    ds_read_b64_tr_b16 v[88:89], v12 offset:30720
    ds_read_b64_tr_b16 v[90:91], v12 offset:31232
    v_mfma_f32_32x32x16_bf16 v[224:239], v[76:79], a[88:91], v[224:239]
    ds_read_b64_tr_b16 v[92:93], v13 offset:30720
    ds_read_b64_tr_b16 v[94:95], v13 offset:31232
    s_waitcnt lgkmcnt(0)
    s_waitcnt vmcnt(20)
    s_barrier
    v_mfma_f32_32x32x16_bf16 v[128:143], v[80:83], a[92:95], v[128:143]
    ds_read_b64_tr_b16 v[64:65], v12 offset:32768
    ds_read_b64_tr_b16 v[66:67], v12 offset:33280
    v_mfma_f32_32x32x16_bf16 v[160:175], v[84:87], a[92:95], v[160:175]
    ds_read_b64_tr_b16 v[68:69], v13 offset:32768
    ds_read_b64_tr_b16 v[70:71], v13 offset:33280
    v_mfma_f32_32x32x16_bf16 v[192:207], v[88:91], a[92:95], v[192:207]
    ds_read_b64_tr_b16 v[72:73], v12 offset:40960
    ds_read_b64_tr_b16 v[74:75], v12 offset:41472
    v_mfma_f32_32x32x16_bf16 v[224:239], v[92:95], a[92:95], v[224:239]
    ds_read_b64_tr_b16 v[76:77], v13 offset:40960
    ds_read_b64_tr_b16 v[78:79], v13 offset:41472
    s_waitcnt lgkmcnt(0)
    v_mfma_f32_32x32x16_bf16 v[128:143], v[64:67], a[96:99], v[128:143]
    ds_read_b64_tr_b16 v[80:81], v12 offset:34816
    ds_read_b64_tr_b16 v[82:83], v12 offset:35328
    v_mfma_f32_32x32x16_bf16 v[160:175], v[68:71], a[96:99], v[160:175]
    ds_read_b64_tr_b16 v[84:85], v13 offset:34816
    ds_read_b64_tr_b16 v[86:87], v13 offset:35328
    v_mfma_f32_32x32x16_bf16 v[192:207], v[72:75], a[96:99], v[192:207]
    ds_read_b64_tr_b16 v[88:89], v12 offset:43008
    ds_read_b64_tr_b16 v[90:91], v12 offset:43520
    v_mfma_f32_32x32x16_bf16 v[224:239], v[76:79], a[96:99], v[224:239]
    ds_read_b64_tr_b16 v[92:93], v13 offset:43008
    ds_read_b64_tr_b16 v[94:95], v13 offset:43520
    s_lshl_b32 s46, s4, 11
    s_add_u32 m0, s46, 65536
    s_nop 0
    buffer_load_dwordx4 v3, s[16:19], s53 offen lds
    s_lshl_b32 s46, s4, 11
    s_add_u32 m0, s46, 66560
    s_add_u32 s47, s53, s45
    buffer_load_dwordx4 v3, s[16:19], s47 offen lds
    s_lshl_b32 s46, s4, 11
    s_add_u32 m0, s46, 73728
    s_nop 0
    buffer_load_dwordx4 v3, s[20:23], s53 offen lds
    s_lshl_b32 s46, s4, 11
    s_add_u32 m0, s46, 74752
    s_add_u32 s47, s53, s45
    buffer_load_dwordx4 v3, s[20:23], s47 offen lds
    s_lshl_b32 s46, s45, 3
    s_add_u32 s53, s53, s46
    s_waitcnt lgkmcnt(0)
    v_mfma_f32_32x32x16_bf16 v[128:143], v[80:83], a[100:103], v[128:143]
    ds_read_b64_tr_b16 v[64:65], v12 offset:36864
    ds_read_b64_tr_b16 v[66:67], v12 offset:37376
    v_mfma_f32_32x32x16_bf16 v[160:175], v[84:87], a[100:103], v[160:175]
    ds_read_b64_tr_b16 v[68:69], v13 offset:36864
    ds_read_b64_tr_b16 v[70:71], v13 offset:37376
    v_mfma_f32_32x32x16_bf16 v[192:207], v[88:91], a[100:103], v[192:207]
    ds_read_b64_tr_b16 v[72:73], v12 offset:45056
    ds_read_b64_tr_b16 v[74:75], v12 offset:45568
    v_mfma_f32_32x32x16_bf16 v[224:239], v[92:95], a[100:103], v[224:239]
    ds_read_b64_tr_b16 v[76:77], v13 offset:45056
    ds_read_b64_tr_b16 v[78:79], v13 offset:45568
    s_waitcnt lgkmcnt(0)
    v_mfma_f32_32x32x16_bf16 v[128:143], v[64:67], a[104:107], v[128:143]
    ds_read_b64_tr_b16 v[80:81], v12 offset:38912
    ds_read_b64_tr_b16 v[82:83], v12 offset:39424
    v_mfma_f32_32x32x16_bf16 v[160:175], v[68:71], a[104:107], v[160:175]
    ds_read_b64_tr_b16 v[84:85], v13 offset:38912
    ds_read_b64_tr_b16 v[86:87], v13 offset:39424
    v_mfma_f32_32x32x16_bf16 v[192:207], v[72:75], a[104:107], v[192:207]
    ds_read_b64_tr_b16 v[88:89], v12 offset:47104
    ds_read_b64_tr_b16 v[90:91], v12 offset:47616
    v_mfma_f32_32x32x16_bf16 v[224:239], v[76:79], a[104:107], v[224:239]
    ds_read_b64_tr_b16 v[92:93], v13 offset:47104
    ds_read_b64_tr_b16 v[94:95], v13 offset:47616
    s_waitcnt lgkmcnt(0)
    s_waitcnt vmcnt(20)
    s_barrier
    v_mfma_f32_32x32x16_bf16 v[128:143], v[80:83], a[108:111], v[128:143]
    ds_read_b64_tr_b16 v[64:65], v12 offset:49152
    ds_read_b64_tr_b16 v[66:67], v12 offset:49664
    v_mfma_f32_32x32x16_bf16 v[160:175], v[84:87], a[108:111], v[160:175]
    ds_read_b64_tr_b16 v[68:69], v13 offset:49152
    ds_read_b64_tr_b16 v[70:71], v13 offset:49664
    v_mfma_f32_32x32x16_bf16 v[192:207], v[88:91], a[108:111], v[192:207]
    ds_read_b64_tr_b16 v[72:73], v12 offset:57344
    ds_read_b64_tr_b16 v[74:75], v12 offset:57856
    v_mfma_f32_32x32x16_bf16 v[224:239], v[92:95], a[108:111], v[224:239]
    ds_read_b64_tr_b16 v[76:77], v13 offset:57344
    ds_read_b64_tr_b16 v[78:79], v13 offset:57856
    s_waitcnt lgkmcnt(0)
    v_mfma_f32_32x32x16_bf16 v[128:143], v[64:67], a[112:115], v[128:143]
    ds_read_b64_tr_b16 v[80:81], v12 offset:51200
    ds_read_b64_tr_b16 v[82:83], v12 offset:51712
    v_mfma_f32_32x32x16_bf16 v[160:175], v[68:71], a[112:115], v[160:175]
    ds_read_b64_tr_b16 v[84:85], v13 offset:51200
    ds_read_b64_tr_b16 v[86:87], v13 offset:51712
    v_mfma_f32_32x32x16_bf16 v[192:207], v[72:75], a[112:115], v[192:207]
    ds_read_b64_tr_b16 v[88:89], v12 offset:59392
    ds_read_b64_tr_b16 v[90:91], v12 offset:59904
    v_mfma_f32_32x32x16_bf16 v[224:239], v[76:79], a[112:115], v[224:239]
    ds_read_b64_tr_b16 v[92:93], v13 offset:59392
    ds_read_b64_tr_b16 v[94:95], v13 offset:59904
    s_lshl_b32 s46, s4, 11
    s_add_u32 m0, s46, 81920
    s_nop 0
    buffer_load_dwordx4 v3, s[16:19], s53 offen lds
    s_lshl_b32 s46, s4, 11
    s_add_u32 m0, s46, 82944
    s_add_u32 s47, s53, s45
    buffer_load_dwordx4 v3, s[16:19], s47 offen lds
    s_lshl_b32 s46, s4, 11
    s_add_u32 m0, s46, 90112
    s_nop 0
    buffer_load_dwordx4 v3, s[20:23], s53 offen lds
    s_lshl_b32 s46, s4, 11
    s_add_u32 m0, s46, 91136
    s_add_u32 s47, s53, s45
    buffer_load_dwordx4 v3, s[20:23], s47 offen lds
    s_lshl_b32 s46, s45, 3
    s_add_u32 s53, s53, s46
    s_waitcnt lgkmcnt(0)
    v_mfma_f32_32x32x16_bf16 v[128:143], v[80:83], a[116:119], v[128:143]
    ds_read_b64_tr_b16 v[64:65], v12 offset:53248
    ds_read_b64_tr_b16 v[66:67], v12 offset:53760
    v_mfma_f32_32x32x16_bf16 v[160:175], v[84:87], a[116:119], v[160:175]
    ds_read_b64_tr_b16 v[68:69], v13 offset:53248
    ds_read_b64_tr_b16 v[70:71], v13 offset:53760
    v_mfma_f32_32x32x16_bf16 v[192:207], v[88:91], a[116:119], v[192:207]
    ds_read_b64_tr_b16 v[72:73], v12 offset:61440
    ds_read_b64_tr_b16 v[74:75], v12 offset:61952
    v_mfma_f32_32x32x16_bf16 v[224:239], v[92:95], a[116:119], v[224:239]
    ds_read_b64_tr_b16 v[76:77], v13 offset:61440
    ds_read_b64_tr_b16 v[78:79], v13 offset:61952
    s_waitcnt lgkmcnt(0)
    v_mfma_f32_32x32x16_bf16 v[128:143], v[64:67], a[120:123], v[128:143]
    ds_read_b64_tr_b16 v[80:81], v12 offset:55296
    ds_read_b64_tr_b16 v[82:83], v12 offset:55808
    v_mfma_f32_32x32x16_bf16 v[160:175], v[68:71], a[120:123], v[160:175]
    ds_read_b64_tr_b16 v[84:85], v13 offset:55296
    ds_read_b64_tr_b16 v[86:87], v13 offset:55808
    v_mfma_f32_32x32x16_bf16 v[192:207], v[72:75], a[120:123], v[192:207]
    ds_read_b64_tr_b16 v[88:89], v12 offset:63488
    ds_read_b64_tr_b16 v[90:91], v12 offset:64000
    v_mfma_f32_32x32x16_bf16 v[224:239], v[76:79], a[120:123], v[224:239]
    ds_read_b64_tr_b16 v[92:93], v13 offset:63488
    ds_read_b64_tr_b16 v[94:95], v13 offset:64000
    s_waitcnt lgkmcnt(0)
    v_mfma_f32_32x32x16_bf16 v[128:143], v[80:83], a[124:127], v[128:143]
    v_mfma_f32_32x32x16_bf16 v[160:175], v[84:87], a[124:127], v[160:175]
    v_mfma_f32_32x32x16_bf16 v[192:207], v[88:91], a[124:127], v[192:207]
    v_mfma_f32_32x32x16_bf16 v[224:239], v[92:95], a[124:127], v[224:239]
    s_add_u32 s64, s50, 0
    s_add_u32 s65, s64, 4096
    v_cvt_pk_bf16_f32 v16, v128, v129
    v_cvt_pk_bf16_f32 v17, v130, v131
    v_cvt_pk_bf16_f32 v18, v132, v133
    v_cvt_pk_bf16_f32 v19, v134, v135
    buffer_store_dwordx4 v[16:19], v6, s[8:11], s64 offen offset:0 sc1
    v_cvt_pk_bf16_f32 v20, v136, v137
    v_cvt_pk_bf16_f32 v21, v138, v139
    v_cvt_pk_bf16_f32 v22, v140, v141
    v_cvt_pk_bf16_f32 v23, v142, v143
    buffer_store_dwordx4 v[20:23], v6, s[8:11], s64 offen offset:1024 sc1
    v_cvt_pk_bf16_f32 v24, v160, v161
    v_cvt_pk_bf16_f32 v25, v162, v163
    v_cvt_pk_bf16_f32 v26, v164, v165
    v_cvt_pk_bf16_f32 v27, v166, v167
    buffer_store_dwordx4 v[24:27], v6, s[8:11], s64 offen offset:2048 sc1
    v_cvt_pk_bf16_f32 v28, v168, v169
    v_cvt_pk_bf16_f32 v29, v170, v171
    v_cvt_pk_bf16_f32 v30, v172, v173
    v_cvt_pk_bf16_f32 v31, v174, v175
    buffer_store_dwordx4 v[28:31], v6, s[8:11], s64 offen offset:3072 sc1
    v_cvt_pk_bf16_f32 v16, v192, v193
    v_cvt_pk_bf16_f32 v17, v194, v195
    v_cvt_pk_bf16_f32 v18, v196, v197
    v_cvt_pk_bf16_f32 v19, v198, v199
    buffer_store_dwordx4 v[16:19], v6, s[8:11], s65 offen offset:0 sc1
    v_cvt_pk_bf16_f32 v20, v200, v201
    v_cvt_pk_bf16_f32 v21, v202, v203
    v_cvt_pk_bf16_f32 v22, v204, v205
    v_cvt_pk_bf16_f32 v23, v206, v207
    buffer_store_dwordx4 v[20:23], v6, s[8:11], s65 offen offset:1024 sc1
    v_cvt_pk_bf16_f32 v24, v224, v225
    v_cvt_pk_bf16_f32 v25, v226, v227
    v_cvt_pk_bf16_f32 v26, v228, v229
    v_cvt_pk_bf16_f32 v27, v230, v231
    buffer_store_dwordx4 v[24:27], v6, s[8:11], s65 offen offset:2048 sc1
    v_cvt_pk_bf16_f32 v28, v232, v233
    v_cvt_pk_bf16_f32 v29, v234, v235
    v_cvt_pk_bf16_f32 v30, v236, v237
    v_cvt_pk_bf16_f32 v31, v238, v239
    buffer_store_dwordx4 v[28:31], v6, s[8:11], s65 offen offset:3072 sc1
    s_branch L_g1h_d
L_g1h_v:
    s_waitcnt vmcnt(36)
    s_barrier
    ds_read_b64_tr_b16 v[64:65], v4 offset:0
    ds_read_b64_tr_b16 v[66:67], v4 offset:512
    ds_read_b64_tr_b16 v[68:69], v5 offset:0
    ds_read_b64_tr_b16 v[70:71], v5 offset:512
    ds_read_b64_tr_b16 v[72:73], v4 offset:8192
    ds_read_b64_tr_b16 v[74:75], v4 offset:8704
    ds_read_b64_tr_b16 v[76:77], v5 offset:8192
    ds_read_b64_tr_b16 v[78:79], v5 offset:8704
    s_waitcnt lgkmcnt(0)
    v_mfma_f32_32x32x16_bf16 v[128:143], a[0:3], v[64:67], 0
    ds_read_b64_tr_b16 v[80:81], v4 offset:2048
    ds_read_b64_tr_b16 v[82:83], v4 offset:2560
    v_mfma_f32_32x32x16_bf16 v[160:175], a[0:3], v[68:71], 0
    ds_read_b64_tr_b16 v[84:85], v5 offset:2048
    ds_read_b64_tr_b16 v[86:87], v5 offset:2560
    v_mfma_f32_32x32x16_bf16 v[192:207], a[0:3], v[72:75], 0
    ds_read_b64_tr_b16 v[88:89], v4 offset:10240
    ds_read_b64_tr_b16 v[90:91], v4 offset:10752
    v_mfma_f32_32x32x16_bf16 v[224:239], a[0:3], v[76:79], 0
    ds_read_b64_tr_b16 v[92:93], v5 offset:10240
    ds_read_b64_tr_b16 v[94:95], v5 offset:10752
    s_lshl_b32 s46, s4, 11
    s_add_u32 m0, s46, 98304
    s_nop 0
    buffer_load_dwordx4 v3, s[16:19], s53 offen lds
    s_lshl_b32 s46, s4, 11
    s_add_u32 m0, s46, 99328
    s_add_u32 s47, s53, s45
    buffer_load_dwordx4 v3, s[16:19], s47 offen lds
    s_lshl_b32 s46, s4, 11
    s_add_u32 m0, s46, 106496
    s_nop 0
    buffer_load_dwordx4 v3, s[20:23], s53 offen lds
    s_lshl_b32 s46, s4, 11
    s_add_u32 m0, s46, 107520
    s_add_u32 s47, s53, s45
    buffer_load_dwordx4 v3, s[20:23], s47 offen lds
    s_lshl_b32 s46, s45, 3
    s_add_u32 s53, s53, s46
    s_waitcnt lgkmcnt(0)
    v_mfma_f32_32x32x16_bf16 v[128:143], a[4:7], v[80:83], v[128:143]
    ds_read_b64_tr_b16 v[64:65], v4 offset:4096
    ds_read_b64_tr_b16 v[66:67], v4 offset:4608
    v_mfma_f32_32x32x16_bf16 v[160:175], a[4:7], v[84:87], v[160:175]
    ds_read_b64_tr_b16 v[68:69], v5 offset:4096
    ds_read_b64_tr_b16 v[70:71], v5 offset:4608
    v_mfma_f32_32x32x16_bf16 v[192:207], a[4:7], v[88:91], v[192:207]
    ds_read_b64_tr_b16 v[72:73], v4 offset:12288
    ds_read_b64_tr_b16 v[74:75], v4 offset:12800
    v_mfma_f32_32x32x16_bf16 v[224:239], a[4:7], v[92:95], v[224:239]
    ds_read_b64_tr_b16 v[76:77], v5 offset:12288
    ds_read_b64_tr_b16 v[78:79], v5 offset:12800
    s_waitcnt lgkmcnt(0)
    v_mfma_f32_32x32x16_bf16 v[128:143], a[8:11], v[64:67], v[128:143]
    ds_read_b64_tr_b16 v[80:81], v4 offset:6144
    ds_read_b64_tr_b16 v[82:83], v4 offset:6656
    v_mfma_f32_32x32x16_bf16 v[160:175], a[8:11], v[68:71], v[160:175]
    ds_read_b64_tr_b16 v[84:85], v5 offset:6144
    ds_read_b64_tr_b16 v[86:87], v5 offset:6656
    v_mfma_f32_32x32x16_bf16 v[192:207], a[8:11], v[72:75], v[192:207]
    ds_read_b64_tr_b16 v[88:89], v4 offset:14336
    ds_read_b64_tr_b16 v[90:91], v4 offset:14848
    v_mfma_f32_32x32x16_bf16 v[224:239], a[8:11], v[76:79], v[224:239]
    ds_read_b64_tr_b16 v[92:93], v5 offset:14336
    ds_read_b64_tr_b16 v[94:95], v5 offset:14848
    s_waitcnt lgkmcnt(0)
    s_waitcnt vmcnt(36)
    s_barrier
    v_mfma_f32_32x32x16_bf16 v[128:143], a[12:15], v[80:83], v[128:143]
    ds_read_b64_tr_b16 v[64:65], v4 offset:16384
    ds_read_b64_tr_b16 v[66:67], v4 offset:16896
    v_mfma_f32_32x32x16_bf16 v[160:175], a[12:15], v[84:87], v[160:175]
    ds_read_b64_tr_b16 v[68:69], v5 offset:16384
    ds_read_b64_tr_b16 v[70:71], v5 offset:16896
    v_mfma_f32_32x32x16_bf16 v[192:207], a[12:15], v[88:91], v[192:207]
    ds_read_b64_tr_b16 v[72:73], v4 offset:24576
    ds_read_b64_tr_b16 v[74:75], v4 offset:25088
    v_mfma_f32_32x32x16_bf16 v[224:239], a[12:15], v[92:95], v[224:239]
    ds_read_b64_tr_b16 v[76:77], v5 offset:24576
    ds_read_b64_tr_b16 v[78:79], v5 offset:25088
    s_waitcnt lgkmcnt(0)
    v_mfma_f32_32x32x16_bf16 v[128:143], a[16:19], v[64:67], v[128:143]
    ds_read_b64_tr_b16 v[80:81], v4 offset:18432
    ds_read_b64_tr_b16 v[82:83], v4 offset:18944
    v_mfma_f32_32x32x16_bf16 v[160:175], a[16:19], v[68:71], v[160:175]
    ds_read_b64_tr_b16 v[84:85], v5 offset:18432
    ds_read_b64_tr_b16 v[86:87], v5 offset:18944
    v_mfma_f32_32x32x16_bf16 v[192:207], a[16:19], v[72:75], v[192:207]
    ds_read_b64_tr_b16 v[88:89], v4 offset:26624
    ds_read_b64_tr_b16 v[90:91], v4 offset:27136
    v_mfma_f32_32x32x16_bf16 v[224:239], a[16:19], v[76:79], v[224:239]
    ds_read_b64_tr_b16 v[92:93], v5 offset:26624
    ds_read_b64_tr_b16 v[94:95], v5 offset:27136
    s_lshl_b32 s46, s4, 11
    s_add_u32 m0, s46, 114688
    s_nop 0
    buffer_load_dwordx4 v3, s[16:19], s53 offen lds
    s_lshl_b32 s46, s4, 11
    s_add_u32 m0, s46, 115712
    s_add_u32 s47, s53, s45
    buffer_load_dwordx4 v3, s[16:19], s47 offen lds
    s_lshl_b32 s46, s4, 11
    s_add_u32 m0, s46, 122880
    s_nop 0
    buffer_load_dwordx4 v3, s[20:23], s53 offen lds
    s_lshl_b32 s46, s4, 11
    s_add_u32 m0, s46, 123904
    s_add_u32 s47, s53, s45
    buffer_load_dwordx4 v3, s[20:23], s47 offen lds
    s_lshl_b32 s46, s45, 3
    s_add_u32 s53, s53, s46
    s_waitcnt lgkmcnt(0)
    v_mfma_f32_32x32x16_bf16 v[128:143], a[20:23], v[80:83], v[128:143]
    ds_read_b64_tr_b16 v[64:65], v4 offset:20480
    ds_read_b64_tr_b16 v[66:67], v4 offset:20992
    v_mfma_f32_32x32x16_bf16 v[160:175], a[20:23], v[84:87], v[160:175]
    ds_read_b64_tr_b16 v[68:69], v5 offset:20480
    ds_read_b64_tr_b16 v[70:71], v5 offset:20992
    v_mfma_f32_32x32x16_bf16 v[192:207], a[20:23], v[88:91], v[192:207]
    ds_read_b64_tr_b16 v[72:73], v4 offset:28672
    ds_read_b64_tr_b16 v[74:75], v4 offset:29184
    v_mfma_f32_32x32x16_bf16 v[224:239], a[20:23], v[92:95], v[224:239]
    ds_read_b64_tr_b16 v[76:77], v5 offset:28672
    ds_read_b64_tr_b16 v[78:79], v5 offset:29184
    s_waitcnt lgkmcnt(0)
    v_mfma_f32_32x32x16_bf16 v[128:143], a[24:27], v[64:67], v[128:143]
    ds_read_b64_tr_b16 v[80:81], v4 offset:22528
    ds_read_b64_tr_b16 v[82:83], v4 offset:23040
    v_mfma_f32_32x32x16_bf16 v[160:175], a[24:27], v[68:71], v[160:175]
    ds_read_b64_tr_b16 v[84:85], v5 offset:22528
    ds_read_b64_tr_b16 v[86:87], v5 offset:23040
    v_mfma_f32_32x32x16_bf16 v[192:207], a[24:27], v[72:75], v[192:207]
    ds_read_b64_tr_b16 v[88:89], v4 offset:30720
    ds_read_b64_tr_b16 v[90:91], v4 offset:31232
    v_mfma_f32_32x32x16_bf16 v[224:239], a[24:27], v[76:79], v[224:239]
    ds_read_b64_tr_b16 v[92:93], v5 offset:30720
    ds_read_b64_tr_b16 v[94:95], v5 offset:31232
    s_waitcnt lgkmcnt(0)
    s_waitcnt vmcnt(36)
    s_barrier
    v_mfma_f32_32x32x16_bf16 v[128:143], a[28:31], v[80:83], v[128:143]
    ds_read_b64_tr_b16 v[64:65], v4 offset:32768
    ds_read_b64_tr_b16 v[66:67], v4 offset:33280
    v_mfma_f32_32x32x16_bf16 v[160:175], a[28:31], v[84:87], v[160:175]
    ds_read_b64_tr_b16 v[68:69], v5 offset:32768
    ds_read_b64_tr_b16 v[70:71], v5 offset:33280
    v_mfma_f32_32x32x16_bf16 v[192:207], a[28:31], v[88:91], v[192:207]
    ds_read_b64_tr_b16 v[72:73], v4 offset:40960
    ds_read_b64_tr_b16 v[74:75], v4 offset:41472
    v_mfma_f32_32x32x16_bf16 v[224:239], a[28:31], v[92:95], v[224:239]
    ds_read_b64_tr_b16 v[76:77], v5 offset:40960
    ds_read_b64_tr_b16 v[78:79], v5 offset:41472
    s_waitcnt lgkmcnt(0)
    v_mfma_f32_32x32x16_bf16 v[128:143], a[32:35], v[64:67], v[128:143]
    ds_read_b64_tr_b16 v[80:81], v4 offset:34816
    ds_read_b64_tr_b16 v[82:83], v4 offset:35328
    v_mfma_f32_32x32x16_bf16 v[160:175], a[32:35], v[68:71], v[160:175]
    ds_read_b64_tr_b16 v[84:85], v5 offset:34816
    ds_read_b64_tr_b16 v[86:87], v5 offset:35328
    v_mfma_f32_32x32x16_bf16 v[192:207], a[32:35], v[72:75], v[192:207]
    ds_read_b64_tr_b16 v[88:89], v4 offset:43008
    ds_read_b64_tr_b16 v[90:91], v4 offset:43520
    v_mfma_f32_32x32x16_bf16 v[224:239], a[32:35], v[76:79], v[224:239]
    ds_read_b64_tr_b16 v[92:93], v5 offset:43008
    ds_read_b64_tr_b16 v[94:95], v5 offset:43520
    s_mov_b32 s67, s6
    s_lshr_b32 s46, s67, 5
    s_and_b32 s47, s67, 31
    s_mov_b32 s51, s46
    s_cmp_eq_u32 s46, 3
    s_cbranch_scc1 L_decF_u10845
    s_lshl_b32 s44, s47, 8
    s_mov_b32 s45, 65536
    v_mov_b32 v3, v1
    s_cmp_eq_u32 s46, 0
    s_cselect_b32 s16, s28, s32
    s_cselect_b32 s17, s29, s33
    s_mov_b32 s48, 33554432
    s_cselect_b32 s48, 16777216, s48
    s_cmp_eq_u32 s46, 2
    s_cselect_b32 s16, s24, s16
    s_cselect_b32 s17, s25, s17
    s_cselect_b32 s48, 50331648, s48
    s_mov_b32 s18, 0x400000
    s_mov_b32 s19, 0x20000
    s_add_u32 s20, s16, 128
    s_addc_u32 s21, s17, 0
    s_mov_b32 s22, 4194176
    s_mov_b32 s23, 0x20000
    s_lshl_b32 s52, s5, 3
    s_lshl_b32 s46, s4, 1
    s_add_u32 s52, s52, s46
    s_lshl_b32 s52, s52, 5
    s_add_u32 s52, s52, s47
    s_lshl_b32 s52, s52, 13
    s_add_u32 s52, s52, s48
    s_branch L_decD_u10845
L_decF_u10845:
    s_lshl_b32 s44, s47, 7
    s_mov_b32 s45, 28672
    v_mov_b32 v3, v2
    s_mov_b32 s16, s36
    s_mov_b32 s17, s37
    s_mov_b32 s18, 1835008
    s_mov_b32 s19, 0x20000
    s_mov_b32 s20, s40
    s_mov_b32 s21, s41
    s_mov_b32 s22, 1835008
    s_mov_b32 s23, 0x20000
    s_lshl_b32 s52, s5, 3
    s_lshl_b32 s46, s4, 1
    s_add_u32 s52, s52, s46
    s_mul_i32 s52, s52, 114688
    s_lshl_b32 s47, s47, 12
    s_add_u32 s52, s52, s47
    s_add_u32 s52, s52, 109051904
L_decD_u10845:
    s_mul_i32 s53, s45, s4
    s_lshl_b32 s53, s53, 1
    s_add_u32 s53, s53, s44
    s_lshl_b32 s46, s4, 11
    s_add_u32 m0, s46, 0
    s_nop 0
    buffer_load_dwordx4 v3, s[16:19], s53 offen lds
    s_lshl_b32 s46, s4, 11
    s_add_u32 m0, s46, 1024
    s_add_u32 s47, s53, s45
    buffer_load_dwordx4 v3, s[16:19], s47 offen lds
    s_lshl_b32 s46, s4, 11
    s_add_u32 m0, s46, 8192
    s_nop 0
    buffer_load_dwordx4 v3, s[20:23], s53 offen lds
    s_lshl_b32 s46, s4, 11
    s_add_u32 m0, s46, 9216
    s_add_u32 s47, s53, s45
    buffer_load_dwordx4 v3, s[20:23], s47 offen lds
    s_lshl_b32 s46, s45, 3
    s_add_u32 s53, s53, s46
    s_waitcnt lgkmcnt(0)
    v_mfma_f32_32x32x16_bf16 v[128:143], a[36:39], v[80:83], v[128:143]
    ds_read_b64_tr_b16 v[64:65], v4 offset:36864
    ds_read_b64_tr_b16 v[66:67], v4 offset:37376
    v_mfma_f32_32x32x16_bf16 v[160:175], a[36:39], v[84:87], v[160:175]
    ds_read_b64_tr_b16 v[68:69], v5 offset:36864
    ds_read_b64_tr_b16 v[70:71], v5 offset:37376
    v_mfma_f32_32x32x16_bf16 v[192:207], a[36:39], v[88:91], v[192:207]
    ds_read_b64_tr_b16 v[72:73], v4 offset:45056
    ds_read_b64_tr_b16 v[74:75], v4 offset:45568
    v_mfma_f32_32x32x16_bf16 v[224:239], a[36:39], v[92:95], v[224:239]
    ds_read_b64_tr_b16 v[76:77], v5 offset:45056
    ds_read_b64_tr_b16 v[78:79], v5 offset:45568
    s_waitcnt lgkmcnt(0)
    v_mfma_f32_32x32x16_bf16 v[128:143], a[40:43], v[64:67], v[128:143]
    ds_read_b64_tr_b16 v[80:81], v4 offset:38912
    ds_read_b64_tr_b16 v[82:83], v4 offset:39424
    v_mfma_f32_32x32x16_bf16 v[160:175], a[40:43], v[68:71], v[160:175]
    ds_read_b64_tr_b16 v[84:85], v5 offset:38912
    ds_read_b64_tr_b16 v[86:87], v5 offset:39424
    v_mfma_f32_32x32x16_bf16 v[192:207], a[40:43], v[72:75], v[192:207]
    ds_read_b64_tr_b16 v[88:89], v4 offset:47104
    ds_read_b64_tr_b16 v[90:91], v4 offset:47616
    v_mfma_f32_32x32x16_bf16 v[224:239], a[40:43], v[76:79], v[224:239]
    ds_read_b64_tr_b16 v[92:93], v5 offset:47104
    ds_read_b64_tr_b16 v[94:95], v5 offset:47616
    s_waitcnt lgkmcnt(0)
    s_waitcnt vmcnt(36)
    s_barrier
    v_mfma_f32_32x32x16_bf16 v[128:143], a[44:47], v[80:83], v[128:143]
    ds_read_b64_tr_b16 v[64:65], v4 offset:49152
    ds_read_b64_tr_b16 v[66:67], v4 offset:49664
    v_mfma_f32_32x32x16_bf16 v[160:175], a[44:47], v[84:87], v[160:175]
    ds_read_b64_tr_b16 v[68:69], v5 offset:49152
    ds_read_b64_tr_b16 v[70:71], v5 offset:49664
    v_mfma_f32_32x32x16_bf16 v[192:207], a[44:47], v[88:91], v[192:207]
    ds_read_b64_tr_b16 v[72:73], v4 offset:57344
    ds_read_b64_tr_b16 v[74:75], v4 offset:57856
    v_mfma_f32_32x32x16_bf16 v[224:239], a[44:47], v[92:95], v[224:239]
    ds_read_b64_tr_b16 v[76:77], v5 offset:57344
    ds_read_b64_tr_b16 v[78:79], v5 offset:57856
    s_waitcnt lgkmcnt(0)
    v_mfma_f32_32x32x16_bf16 v[128:143], a[48:51], v[64:67], v[128:143]
    ds_read_b64_tr_b16 v[80:81], v4 offset:51200
    ds_read_b64_tr_b16 v[82:83], v4 offset:51712
    v_mfma_f32_32x32x16_bf16 v[160:175], a[48:51], v[68:71], v[160:175]
    ds_read_b64_tr_b16 v[84:85], v5 offset:51200
    ds_read_b64_tr_b16 v[86:87], v5 offset:51712
    v_mfma_f32_32x32x16_bf16 v[192:207], a[48:51], v[72:75], v[192:207]
    ds_read_b64_tr_b16 v[88:89], v4 offset:59392
    ds_read_b64_tr_b16 v[90:91], v4 offset:59904
    v_mfma_f32_32x32x16_bf16 v[224:239], a[48:51], v[76:79], v[224:239]
    ds_read_b64_tr_b16 v[92:93], v5 offset:59392
    ds_read_b64_tr_b16 v[94:95], v5 offset:59904
    s_lshl_b32 s46, s4, 11
    s_add_u32 m0, s46, 16384
    s_nop 0
    buffer_load_dwordx4 v3, s[16:19], s53 offen lds
    s_lshl_b32 s46, s4, 11
    s_add_u32 m0, s46, 17408
    s_add_u32 s47, s53, s45
    buffer_load_dwordx4 v3, s[16:19], s47 offen lds
    s_lshl_b32 s46, s4, 11
    s_add_u32 m0, s46, 24576
    s_nop 0
    buffer_load_dwordx4 v3, s[20:23], s53 offen lds
    s_lshl_b32 s46, s4, 11
    s_add_u32 m0, s46, 25600
    s_add_u32 s47, s53, s45
    buffer_load_dwordx4 v3, s[20:23], s47 offen lds
    s_lshl_b32 s46, s45, 3
    s_add_u32 s53, s53, s46
    s_waitcnt lgkmcnt(0)
    v_mfma_f32_32x32x16_bf16 v[128:143], a[52:55], v[80:83], v[128:143]
    ds_read_b64_tr_b16 v[64:65], v4 offset:53248
    ds_read_b64_tr_b16 v[66:67], v4 offset:53760
    v_mfma_f32_32x32x16_bf16 v[160:175], a[52:55], v[84:87], v[160:175]
    ds_read_b64_tr_b16 v[68:69], v5 offset:53248
    ds_read_b64_tr_b16 v[70:71], v5 offset:53760
    v_mfma_f32_32x32x16_bf16 v[192:207], a[52:55], v[88:91], v[192:207]
    ds_read_b64_tr_b16 v[72:73], v4 offset:61440
    ds_read_b64_tr_b16 v[74:75], v4 offset:61952
    v_mfma_f32_32x32x16_bf16 v[224:239], a[52:55], v[92:95], v[224:239]
    ds_read_b64_tr_b16 v[76:77], v5 offset:61440
    ds_read_b64_tr_b16 v[78:79], v5 offset:61952
    s_waitcnt lgkmcnt(0)
    v_mfma_f32_32x32x16_bf16 v[128:143], a[56:59], v[64:67], v[128:143]
    ds_read_b64_tr_b16 v[80:81], v4 offset:55296
    ds_read_b64_tr_b16 v[82:83], v4 offset:55808
    v_mfma_f32_32x32x16_bf16 v[160:175], a[56:59], v[68:71], v[160:175]
    ds_read_b64_tr_b16 v[84:85], v5 offset:55296
    ds_read_b64_tr_b16 v[86:87], v5 offset:55808
    v_mfma_f32_32x32x16_bf16 v[192:207], a[56:59], v[72:75], v[192:207]
    ds_read_b64_tr_b16 v[88:89], v4 offset:63488
    ds_read_b64_tr_b16 v[90:91], v4 offset:64000
    v_mfma_f32_32x32x16_bf16 v[224:239], a[56:59], v[76:79], v[224:239]
    ds_read_b64_tr_b16 v[92:93], v5 offset:63488
    ds_read_b64_tr_b16 v[94:95], v5 offset:64000
    s_waitcnt lgkmcnt(0)
    s_waitcnt vmcnt(36)
    s_barrier
    v_mfma_f32_32x32x16_bf16 v[128:143], a[60:63], v[80:83], v[128:143]
    ds_read_b64_tr_b16 v[64:65], v12 offset:0
    ds_read_b64_tr_b16 v[66:67], v12 offset:512
    v_mfma_f32_32x32x16_bf16 v[160:175], a[60:63], v[84:87], v[160:175]
    ds_read_b64_tr_b16 v[68:69], v13 offset:0
    ds_read_b64_tr_b16 v[70:71], v13 offset:512
    v_mfma_f32_32x32x16_bf16 v[192:207], a[60:63], v[88:91], v[192:207]
    ds_read_b64_tr_b16 v[72:73], v12 offset:8192
    ds_read_b64_tr_b16 v[74:75], v12 offset:8704
    v_mfma_f32_32x32x16_bf16 v[224:239], a[60:63], v[92:95], v[224:239]
    ds_read_b64_tr_b16 v[76:77], v13 offset:8192
    ds_read_b64_tr_b16 v[78:79], v13 offset:8704
    s_waitcnt lgkmcnt(0)
    v_mfma_f32_32x32x16_bf16 v[128:143], a[64:67], v[64:67], v[128:143]
    ds_read_b64_tr_b16 v[80:81], v12 offset:2048
    ds_read_b64_tr_b16 v[82:83], v12 offset:2560
    v_mfma_f32_32x32x16_bf16 v[160:175], a[64:67], v[68:71], v[160:175]
    ds_read_b64_tr_b16 v[84:85], v13 offset:2048
    ds_read_b64_tr_b16 v[86:87], v13 offset:2560
    v_mfma_f32_32x32x16_bf16 v[192:207], a[64:67], v[72:75], v[192:207]
    ds_read_b64_tr_b16 v[88:89], v12 offset:10240
    ds_read_b64_tr_b16 v[90:91], v12 offset:10752
    v_mfma_f32_32x32x16_bf16 v[224:239], a[64:67], v[76:79], v[224:239]
    ds_read_b64_tr_b16 v[92:93], v13 offset:10240
    ds_read_b64_tr_b16 v[94:95], v13 offset:10752
    s_lshl_b32 s46, s4, 11
    s_add_u32 m0, s46, 32768
    s_nop 0
    buffer_load_dwordx4 v3, s[16:19], s53 offen lds
    s_lshl_b32 s46, s4, 11
    s_add_u32 m0, s46, 33792
    s_add_u32 s47, s53, s45
    buffer_load_dwordx4 v3, s[16:19], s47 offen lds
    s_lshl_b32 s46, s4, 11
    s_add_u32 m0, s46, 40960
    s_nop 0
    buffer_load_dwordx4 v3, s[20:23], s53 offen lds
    s_lshl_b32 s46, s4, 11
    s_add_u32 m0, s46, 41984
    s_add_u32 s47, s53, s45
    buffer_load_dwordx4 v3, s[20:23], s47 offen lds
    s_lshl_b32 s46, s45, 3
    s_add_u32 s53, s53, s46
    s_waitcnt lgkmcnt(0)
    v_mfma_f32_32x32x16_bf16 v[128:143], a[68:71], v[80:83], v[128:143]
    ds_read_b64_tr_b16 v[64:65], v12 offset:4096
    ds_read_b64_tr_b16 v[66:67], v12 offset:4608
    v_mfma_f32_32x32x16_bf16 v[160:175], a[68:71], v[84:87], v[160:175]
    ds_read_b64_tr_b16 v[68:69], v13 offset:4096
    ds_read_b64_tr_b16 v[70:71], v13 offset:4608
    v_mfma_f32_32x32x16_bf16 v[192:207], a[68:71], v[88:91], v[192:207]
    ds_read_b64_tr_b16 v[72:73], v12 offset:12288
    ds_read_b64_tr_b16 v[74:75], v12 offset:12800
    v_mfma_f32_32x32x16_bf16 v[224:239], a[68:71], v[92:95], v[224:239]
    ds_read_b64_tr_b16 v[76:77], v13 offset:12288
    ds_read_b64_tr_b16 v[78:79], v13 offset:12800
    s_waitcnt lgkmcnt(0)
    v_mfma_f32_32x32x16_bf16 v[128:143], a[72:75], v[64:67], v[128:143]
    ds_read_b64_tr_b16 v[80:81], v12 offset:6144
    ds_read_b64_tr_b16 v[82:83], v12 offset:6656
    v_mfma_f32_32x32x16_bf16 v[160:175], a[72:75], v[68:71], v[160:175]
    ds_read_b64_tr_b16 v[84:85], v13 offset:6144
    ds_read_b64_tr_b16 v[86:87], v13 offset:6656
    v_mfma_f32_32x32x16_bf16 v[192:207], a[72:75], v[72:75], v[192:207]
    ds_read_b64_tr_b16 v[88:89], v12 offset:14336
    ds_read_b64_tr_b16 v[90:91], v12 offset:14848
    v_mfma_f32_32x32x16_bf16 v[224:239], a[72:75], v[76:79], v[224:239]
    ds_read_b64_tr_b16 v[92:93], v13 offset:14336
    ds_read_b64_tr_b16 v[94:95], v13 offset:14848
    s_waitcnt lgkmcnt(0)
    s_waitcnt vmcnt(36)
    s_barrier
    v_mfma_f32_32x32x16_bf16 v[128:143], a[76:79], v[80:83], v[128:143]
    ds_read_b64_tr_b16 v[64:65], v12 offset:16384
    ds_read_b64_tr_b16 v[66:67], v12 offset:16896
    v_mfma_f32_32x32x16_bf16 v[160:175], a[76:79], v[84:87], v[160:175]
    ds_read_b64_tr_b16 v[68:69], v13 offset:16384
    ds_read_b64_tr_b16 v[70:71], v13 offset:16896
    v_mfma_f32_32x32x16_bf16 v[192:207], a[76:79], v[88:91], v[192:207]
    ds_read_b64_tr_b16 v[72:73], v12 offset:24576
    ds_read_b64_tr_b16 v[74:75], v12 offset:25088
    v_mfma_f32_32x32x16_bf16 v[224:239], a[76:79], v[92:95], v[224:239]
    ds_read_b64_tr_b16 v[76:77], v13 offset:24576
    ds_read_b64_tr_b16 v[78:79], v13 offset:25088
    s_waitcnt lgkmcnt(0)
    v_mfma_f32_32x32x16_bf16 v[128:143], a[80:83], v[64:67], v[128:143]
    ds_read_b64_tr_b16 v[80:81], v12 offset:18432
    ds_read_b64_tr_b16 v[82:83], v12 offset:18944
    v_mfma_f32_32x32x16_bf16 v[160:175], a[80:83], v[68:71], v[160:175]
    ds_read_b64_tr_b16 v[84:85], v13 offset:18432
    ds_read_b64_tr_b16 v[86:87], v13 offset:18944
    v_mfma_f32_32x32x16_bf16 v[192:207], a[80:83], v[72:75], v[192:207]
    ds_read_b64_tr_b16 v[88:89], v12 offset:26624
    ds_read_b64_tr_b16 v[90:91], v12 offset:27136
    v_mfma_f32_32x32x16_bf16 v[224:239], a[80:83], v[76:79], v[224:239]
    ds_read_b64_tr_b16 v[92:93], v13 offset:26624
    ds_read_b64_tr_b16 v[94:95], v13 offset:27136
    s_lshl_b32 s46, s4, 11
    s_add_u32 m0, s46, 49152
    s_nop 0
    buffer_load_dwordx4 v3, s[16:19], s53 offen lds
    s_lshl_b32 s46, s4, 11
    s_add_u32 m0, s46, 50176
    s_add_u32 s47, s53, s45
    buffer_load_dwordx4 v3, s[16:19], s47 offen lds
    s_lshl_b32 s46, s4, 11
    s_add_u32 m0, s46, 57344
    s_nop 0
    buffer_load_dwordx4 v3, s[20:23], s53 offen lds
    s_lshl_b32 s46, s4, 11
    s_add_u32 m0, s46, 58368
    s_add_u32 s47, s53, s45
    buffer_load_dwordx4 v3, s[20:23], s47 offen lds
    s_lshl_b32 s46, s45, 3
    s_add_u32 s53, s53, s46
    s_waitcnt lgkmcnt(0)
    v_mfma_f32_32x32x16_bf16 v[128:143], a[84:87], v[80:83], v[128:143]
    ds_read_b64_tr_b16 v[64:65], v12 offset:20480
    ds_read_b64_tr_b16 v[66:67], v12 offset:20992
    v_mfma_f32_32x32x16_bf16 v[160:175], a[84:87], v[84:87], v[160:175]
    ds_read_b64_tr_b16 v[68:69], v13 offset:20480
    ds_read_b64_tr_b16 v[70:71], v13 offset:20992
    v_mfma_f32_32x32x16_bf16 v[192:207], a[84:87], v[88:91], v[192:207]
    ds_read_b64_tr_b16 v[72:73], v12 offset:28672
    ds_read_b64_tr_b16 v[74:75], v12 offset:29184
    v_mfma_f32_32x32x16_bf16 v[224:239], a[84:87], v[92:95], v[224:239]
    ds_read_b64_tr_b16 v[76:77], v13 offset:28672
    ds_read_b64_tr_b16 v[78:79], v13 offset:29184
    s_waitcnt lgkmcnt(0)
    v_mfma_f32_32x32x16_bf16 v[128:143], a[88:91], v[64:67], v[128:143]
    ds_read_b64_tr_b16 v[80:81], v12 offset:22528
    ds_read_b64_tr_b16 v[82:83], v12 offset:23040
    v_mfma_f32_32x32x16_bf16 v[160:175], a[88:91], v[68:71], v[160:175]
    ds_read_b64_tr_b16 v[84:85], v13 offset:22528
    ds_read_b64_tr_b16 v[86:87], v13 offset:23040
    v_mfma_f32_32x32x16_bf16 v[192:207], a[88:91], v[72:75], v[192:207]
    ds_read_b64_tr_b16 v[88:89], v12 offset:30720
    ds_read_b64_tr_b16 v[90:91], v12 offset:31232
    v_mfma_f32_32x32x16_bf16 v[224:239], a[88:91], v[76:79], v[224:239]
    ds_read_b64_tr_b16 v[92:93], v13 offset:30720
    ds_read_b64_tr_b16 v[94:95], v13 offset:31232
    s_waitcnt lgkmcnt(0)
    s_waitcnt vmcnt(20)
    s_barrier
    v_mfma_f32_32x32x16_bf16 v[128:143], a[92:95], v[80:83], v[128:143]
    ds_read_b64_tr_b16 v[64:65], v12 offset:32768
    ds_read_b64_tr_b16 v[66:67], v12 offset:33280
    v_mfma_f32_32x32x16_bf16 v[160:175], a[92:95], v[84:87], v[160:175]
    ds_read_b64_tr_b16 v[68:69], v13 offset:32768
    ds_read_b64_tr_b16 v[70:71], v13 offset:33280
    v_mfma_f32_32x32x16_bf16 v[192:207], a[92:95], v[88:91], v[192:207]
    ds_read_b64_tr_b16 v[72:73], v12 offset:40960
    ds_read_b64_tr_b16 v[74:75], v12 offset:41472
    v_mfma_f32_32x32x16_bf16 v[224:239], a[92:95], v[92:95], v[224:239]
    ds_read_b64_tr_b16 v[76:77], v13 offset:40960
    ds_read_b64_tr_b16 v[78:79], v13 offset:41472
    s_waitcnt lgkmcnt(0)
    v_mfma_f32_32x32x16_bf16 v[128:143], a[96:99], v[64:67], v[128:143]
    ds_read_b64_tr_b16 v[80:81], v12 offset:34816
    ds_read_b64_tr_b16 v[82:83], v12 offset:35328
    v_mfma_f32_32x32x16_bf16 v[160:175], a[96:99], v[68:71], v[160:175]
    ds_read_b64_tr_b16 v[84:85], v13 offset:34816
    ds_read_b64_tr_b16 v[86:87], v13 offset:35328
    v_mfma_f32_32x32x16_bf16 v[192:207], a[96:99], v[72:75], v[192:207]
    ds_read_b64_tr_b16 v[88:89], v12 offset:43008
    ds_read_b64_tr_b16 v[90:91], v12 offset:43520
    v_mfma_f32_32x32x16_bf16 v[224:239], a[96:99], v[76:79], v[224:239]
    ds_read_b64_tr_b16 v[92:93], v13 offset:43008
    ds_read_b64_tr_b16 v[94:95], v13 offset:43520
    s_lshl_b32 s46, s4, 11
    s_add_u32 m0, s46, 65536
    s_nop 0
    buffer_load_dwordx4 v3, s[16:19], s53 offen lds
    s_lshl_b32 s46, s4, 11
    s_add_u32 m0, s46, 66560
    s_add_u32 s47, s53, s45
    buffer_load_dwordx4 v3, s[16:19], s47 offen lds
    s_lshl_b32 s46, s4, 11
    s_add_u32 m0, s46, 73728
    s_nop 0
    buffer_load_dwordx4 v3, s[20:23], s53 offen lds
    s_lshl_b32 s46, s4, 11
    s_add_u32 m0, s46, 74752
    s_add_u32 s47, s53, s45
    buffer_load_dwordx4 v3, s[20:23], s47 offen lds
    s_lshl_b32 s46, s45, 3
    s_add_u32 s53, s53, s46
    s_waitcnt lgkmcnt(0)
    v_mfma_f32_32x32x16_bf16 v[128:143], a[100:103], v[80:83], v[128:143]
    ds_read_b64_tr_b16 v[64:65], v12 offset:36864
    ds_read_b64_tr_b16 v[66:67], v12 offset:37376
    v_mfma_f32_32x32x16_bf16 v[160:175], a[100:103], v[84:87], v[160:175]
    ds_read_b64_tr_b16 v[68:69], v13 offset:36864
    ds_read_b64_tr_b16 v[70:71], v13 offset:37376
    v_mfma_f32_32x32x16_bf16 v[192:207], a[100:103], v[88:91], v[192:207]
    ds_read_b64_tr_b16 v[72:73], v12 offset:45056
    ds_read_b64_tr_b16 v[74:75], v12 offset:45568
    v_mfma_f32_32x32x16_bf16 v[224:239], a[100:103], v[92:95], v[224:239]
    ds_read_b64_tr_b16 v[76:77], v13 offset:45056
    ds_read_b64_tr_b16 v[78:79], v13 offset:45568
    s_waitcnt lgkmcnt(0)
    v_mfma_f32_32x32x16_bf16 v[128:143], a[104:107], v[64:67], v[128:143]
    ds_read_b64_tr_b16 v[80:81], v12 offset:38912
    ds_read_b64_tr_b16 v[82:83], v12 offset:39424
    v_mfma_f32_32x32x16_bf16 v[160:175], a[104:107], v[68:71], v[160:175]
    ds_read_b64_tr_b16 v[84:85], v13 offset:38912
    ds_read_b64_tr_b16 v[86:87], v13 offset:39424
    v_mfma_f32_32x32x16_bf16 v[192:207], a[104:107], v[72:75], v[192:207]
    ds_read_b64_tr_b16 v[88:89], v12 offset:47104
    ds_read_b64_tr_b16 v[90:91], v12 offset:47616
    v_mfma_f32_32x32x16_bf16 v[224:239], a[104:107], v[76:79], v[224:239]
    ds_read_b64_tr_b16 v[92:93], v13 offset:47104
    ds_read_b64_tr_b16 v[94:95], v13 offset:47616
    s_waitcnt lgkmcnt(0)
    s_waitcnt vmcnt(20)
    s_barrier
    v_mfma_f32_32x32x16_bf16 v[128:143], a[108:111], v[80:83], v[128:143]
    ds_read_b64_tr_b16 v[64:65], v12 offset:49152
    ds_read_b64_tr_b16 v[66:67], v12 offset:49664
    v_mfma_f32_32x32x16_bf16 v[160:175], a[108:111], v[84:87], v[160:175]
    ds_read_b64_tr_b16 v[68:69], v13 offset:49152
    ds_read_b64_tr_b16 v[70:71], v13 offset:49664
    v_mfma_f32_32x32x16_bf16 v[192:207], a[108:111], v[88:91], v[192:207]
    ds_read_b64_tr_b16 v[72:73], v12 offset:57344
    ds_read_b64_tr_b16 v[74:75], v12 offset:57856
    v_mfma_f32_32x32x16_bf16 v[224:239], a[108:111], v[92:95], v[224:239]
    ds_read_b64_tr_b16 v[76:77], v13 offset:57344
    ds_read_b64_tr_b16 v[78:79], v13 offset:57856
    s_waitcnt lgkmcnt(0)
    v_mfma_f32_32x32x16_bf16 v[128:143], a[112:115], v[64:67], v[128:143]
    ds_read_b64_tr_b16 v[80:81], v12 offset:51200
    ds_read_b64_tr_b16 v[82:83], v12 offset:51712
    v_mfma_f32_32x32x16_bf16 v[160:175], a[112:115], v[68:71], v[160:175]
    ds_read_b64_tr_b16 v[84:85], v13 offset:51200
    ds_read_b64_tr_b16 v[86:87], v13 offset:51712
    v_mfma_f32_32x32x16_bf16 v[192:207], a[112:115], v[72:75], v[192:207]
    ds_read_b64_tr_b16 v[88:89], v12 offset:59392
    ds_read_b64_tr_b16 v[90:91], v12 offset:59904
    v_mfma_f32_32x32x16_bf16 v[224:239], a[112:115], v[76:79], v[224:239]
    ds_read_b64_tr_b16 v[92:93], v13 offset:59392
    ds_read_b64_tr_b16 v[94:95], v13 offset:59904
    s_lshl_b32 s46, s4, 11
    s_add_u32 m0, s46, 81920
    s_nop 0
    buffer_load_dwordx4 v3, s[16:19], s53 offen lds
    s_lshl_b32 s46, s4, 11
    s_add_u32 m0, s46, 82944
    s_add_u32 s47, s53, s45
    buffer_load_dwordx4 v3, s[16:19], s47 offen lds
    s_lshl_b32 s46, s4, 11
    s_add_u32 m0, s46, 90112
    s_nop 0
    buffer_load_dwordx4 v3, s[20:23], s53 offen lds
    s_lshl_b32 s46, s4, 11
    s_add_u32 m0, s46, 91136
    s_add_u32 s47, s53, s45
    buffer_load_dwordx4 v3, s[20:23], s47 offen lds
    s_lshl_b32 s46, s45, 3
    s_add_u32 s53, s53, s46
    s_waitcnt lgkmcnt(0)
    v_mfma_f32_32x32x16_bf16 v[128:143], a[116:119], v[80:83], v[128:143]
    ds_read_b64_tr_b16 v[64:65], v12 offset:53248
    ds_read_b64_tr_b16 v[66:67], v12 offset:53760
    v_mfma_f32_32x32x16_bf16 v[160:175], a[116:119], v[84:87], v[160:175]
    ds_read_b64_tr_b16 v[68:69], v13 offset:53248
    ds_read_b64_tr_b16 v[70:71], v13 offset:53760
    v_mfma_f32_32x32x16_bf16 v[192:207], a[116:119], v[88:91], v[192:207]
    ds_read_b64_tr_b16 v[72:73], v12 offset:61440
    ds_read_b64_tr_b16 v[74:75], v12 offset:61952
    v_mfma_f32_32x32x16_bf16 v[224:239], a[116:119], v[92:95], v[224:239]
    ds_read_b64_tr_b16 v[76:77], v13 offset:61440
    ds_read_b64_tr_b16 v[78:79], v13 offset:61952
    s_waitcnt lgkmcnt(0)
    v_mfma_f32_32x32x16_bf16 v[128:143], a[120:123], v[64:67], v[128:143]
    ds_read_b64_tr_b16 v[80:81], v12 offset:55296
    ds_read_b64_tr_b16 v[82:83], v12 offset:55808
    v_mfma_f32_32x32x16_bf16 v[160:175], a[120:123], v[68:71], v[160:175]
    ds_read_b64_tr_b16 v[84:85], v13 offset:55296
    ds_read_b64_tr_b16 v[86:87], v13 offset:55808
    v_mfma_f32_32x32x16_bf16 v[192:207], a[120:123], v[72:75], v[192:207]
    ds_read_b64_tr_b16 v[88:89], v12 offset:63488
    ds_read_b64_tr_b16 v[90:91], v12 offset:64000
    v_mfma_f32_32x32x16_bf16 v[224:239], a[120:123], v[76:79], v[224:239]
    ds_read_b64_tr_b16 v[92:93], v13 offset:63488
    ds_read_b64_tr_b16 v[94:95], v13 offset:64000
    s_waitcnt lgkmcnt(0)
    v_mfma_f32_32x32x16_bf16 v[128:143], a[124:127], v[80:83], v[128:143]
    v_mfma_f32_32x32x16_bf16 v[160:175], a[124:127], v[84:87], v[160:175]
    v_mfma_f32_32x32x16_bf16 v[192:207], a[124:127], v[88:91], v[192:207]
    v_mfma_f32_32x32x16_bf16 v[224:239], a[124:127], v[92:95], v[224:239]
    s_add_u32 s64, s50, 0
    s_add_u32 s65, s64, 4096
    v_cvt_pk_bf16_f32 v16, v128, v129
    v_cvt_pk_bf16_f32 v17, v130, v131
    v_cvt_pk_bf16_f32 v18, v132, v133
    v_cvt_pk_bf16_f32 v19, v134, v135
    buffer_store_dwordx4 v[16:19], v0, s[8:11], s64 offen offset:0 sc1
    v_cvt_pk_bf16_f32 v20, v136, v137
    v_cvt_pk_bf16_f32 v21, v138, v139
    v_cvt_pk_bf16_f32 v22, v140, v141
    v_cvt_pk_bf16_f32 v23, v142, v143
    buffer_store_dwordx4 v[20:23], v0, s[8:11], s64 offen offset:1024 sc1
    v_cvt_pk_bf16_f32 v24, v160, v161
    v_cvt_pk_bf16_f32 v25, v162, v163
    v_cvt_pk_bf16_f32 v26, v164, v165
    v_cvt_pk_bf16_f32 v27, v166, v167
    buffer_store_dwordx4 v[24:27], v0, s[8:11], s64 offen offset:2048 sc1
    v_cvt_pk_bf16_f32 v28, v168, v169
    v_cvt_pk_bf16_f32 v29, v170, v171
    v_cvt_pk_bf16_f32 v30, v172, v173
    v_cvt_pk_bf16_f32 v31, v174, v175
    buffer_store_dwordx4 v[28:31], v0, s[8:11], s64 offen offset:3072 sc1
    v_cvt_pk_bf16_f32 v16, v192, v193
    v_cvt_pk_bf16_f32 v17, v194, v195
    v_cvt_pk_bf16_f32 v18, v196, v197
    v_cvt_pk_bf16_f32 v19, v198, v199
    buffer_store_dwordx4 v[16:19], v0, s[8:11], s65 offen offset:0 sc1
    v_cvt_pk_bf16_f32 v20, v200, v201
    v_cvt_pk_bf16_f32 v21, v202, v203
    v_cvt_pk_bf16_f32 v22, v204, v205
    v_cvt_pk_bf16_f32 v23, v206, v207
    buffer_store_dwordx4 v[20:23], v0, s[8:11], s65 offen offset:1024 sc1
    v_cvt_pk_bf16_f32 v24, v224, v225
    v_cvt_pk_bf16_f32 v25, v226, v227
    v_cvt_pk_bf16_f32 v26, v228, v229
    v_cvt_pk_bf16_f32 v27, v230, v231
    buffer_store_dwordx4 v[24:27], v0, s[8:11], s65 offen offset:2048 sc1
    v_cvt_pk_bf16_f32 v28, v232, v233
    v_cvt_pk_bf16_f32 v29, v234, v235
    v_cvt_pk_bf16_f32 v30, v236, v237
    v_cvt_pk_bf16_f32 v31, v238, v239
    buffer_store_dwordx4 v[28:31], v0, s[8:11], s65 offen offset:3072 sc1
L_g1h_d:
    s_waitcnt vmcnt(0)
    s_barrier
    s_mov_b32 s72, 1
    s_mov_b32 s74, 0
    s_cmp_eq_u32 s72, 0
    s_cbranch_scc1 L_flh
    s_cmp_lg_u32 s4, 0
    s_cbranch_scc1 L_flh_c
    s_cmp_lg_u32 s89, 0
    s_cbranch_scc1 L_flh_i
    v_mov_b32 v9, 28
    s_mov_b32 s78, 0
L_flh_w:
    global_load_dword v10, v9, s[68:69] sc1
    s_waitcnt vmcnt(0)
    v_readfirstlane_b32 s89, v10
    s_cmp_lg_u32 s89, 0
    s_cbranch_scc1 L_flh_i
    s_sleep 8
    s_add_u32 s78, s78, 1
    s_cmp_lt_u32 s78, 100000
    s_cbranch_scc1 L_flh_w
L_flh_i:
    s_lshl_b32 s46, s74, 7
    s_add_u32 s46, s46, 262144
    v_mov_b32 v9, 0
    v_mov_b32 v10, s72
    s_mov_b64 exec, 1
    buffer_atomic_add v10, v9, s[8:11], s46 offen sc1
    s_mov_b64 exec, -1
L_flh_c:
    s_mov_b32 s72, 0
L_flh:
    s_branch L_g1w_own
L_g1w_f1:
    s_mov_b32 s73, 0
    s_mov_b32 s5, 1
    s_sub_u32 s6, s90, 128
    s_mov_b32 s77, s6
    s_mov_b32 s71, 1
    s_branch L_g1w_go
L_g1w_own:
    s_mov_b32 s73, 1
    s_mov_b32 s5, s75
    s_mov_b32 s6, s76
    s_cmp_lt_u32 s75, 2
    s_cselect_b32 s46, 64, 0
    s_add_u32 s6, s6, s46
    s_add_u32 s77, s6, 28
    s_mov_b32 s71, 0
L_g1w_go:
    s_lshr_b32 s46, s6, 5
    s_and_b32 s47, s6, 31
    s_mov_b32 s49, s46
    s_cmp_eq_u32 s46, 3
    s_cbranch_scc1 L_decF_u11395
    s_lshl_b32 s44, s47, 8
    s_mov_b32 s45, 65536
    v_mov_b32 v3, v1
    s_cmp_eq_u32 s46, 0
    s_cselect_b32 s16, s28, s32
    s_cselect_b32 s17, s29, s33
    s_mov_b32 s48, 33554432
    s_cselect_b32 s48, 16777216, s48
    s_cmp_eq_u32 s46, 2
    s_cselect_b32 s16, s24, s16
    s_cselect_b32 s17, s25, s17
    s_cselect_b32 s48, 50331648, s48
    s_mov_b32 s18, 0x400000
    s_mov_b32 s19, 0x20000
    s_add_u32 s20, s16, 128
    s_addc_u32 s21, s17, 0
    s_mov_b32 s22, 4194176
    s_mov_b32 s23, 0x20000
    s_lshl_b32 s50, s5, 3
    s_lshl_b32 s46, s4, 1
    s_add_u32 s50, s50, s46
    s_lshl_b32 s50, s50, 5
    s_add_u32 s50, s50, s47
    s_lshl_b32 s50, s50, 13
    s_add_u32 s50, s50, s48
    s_branch L_decD_u11395
L_decF_u11395:
    s_lshl_b32 s44, s47, 7
    s_mov_b32 s45, 28672
    v_mov_b32 v3, v2
    s_mov_b32 s16, s36
    s_mov_b32 s17, s37
    s_mov_b32 s18, 1835008
    s_mov_b32 s19, 0x20000
    s_mov_b32 s20, s40
    s_mov_b32 s21, s41
    s_mov_b32 s22, 1835008
    s_mov_b32 s23, 0x20000
    s_lshl_b32 s50, s5, 3
    s_lshl_b32 s46, s4, 1
    s_add_u32 s50, s50, s46
    s_mul_i32 s50, s50, 114688
    s_lshl_b32 s47, s47, 12
    s_add_u32 s50, s50, s47
    s_add_u32 s50, s50, 109051904
L_decD_u11395:
    s_mul_i32 s53, s45, s4
    s_lshl_b32 s53, s53, 1
    s_add_u32 s53, s53, s44
    s_lshl_b32 s46, s4, 11
    s_add_u32 m0, s46, 0
    s_nop 0
    buffer_load_dwordx4 v3, s[16:19], s53 offen lds
    s_lshl_b32 s46, s4, 11
    s_add_u32 m0, s46, 1024
    s_add_u32 s47, s53, s45
    buffer_load_dwordx4 v3, s[16:19], s47 offen lds
    s_lshl_b32 s46, s4, 11
    s_add_u32 m0, s46, 8192
    s_nop 0
    buffer_load_dwordx4 v3, s[20:23], s53 offen lds
    s_lshl_b32 s46, s4, 11
    s_add_u32 m0, s46, 9216
    s_add_u32 s47, s53, s45
    buffer_load_dwordx4 v3, s[20:23], s47 offen lds
    s_lshl_b32 s46, s45, 3
    s_add_u32 s53, s53, s46
    s_lshl_b32 s46, s4, 11
    s_add_u32 m0, s46, 16384
    s_nop 0
    buffer_load_dwordx4 v3, s[16:19], s53 offen lds
    s_lshl_b32 s46, s4, 11
    s_add_u32 m0, s46, 17408
    s_add_u32 s47, s53, s45
    buffer_load_dwordx4 v3, s[16:19], s47 offen lds
    s_lshl_b32 s46, s4, 11
    s_add_u32 m0, s46, 24576
    s_nop 0
    buffer_load_dwordx4 v3, s[20:23], s53 offen lds
    s_lshl_b32 s46, s4, 11
    s_add_u32 m0, s46, 25600
    s_add_u32 s47, s53, s45
    buffer_load_dwordx4 v3, s[20:23], s47 offen lds
    s_lshl_b32 s46, s45, 3
    s_add_u32 s53, s53, s46
    s_lshl_b32 s46, s5, 8
    s_lshl_b32 s47, s4, 6
    s_add_u32 s46, s46, s47
    s_add_u32 s46, s46, 0
    s_lshl_b32 s46, s46, 10
    s_lshl_b32 s47, s4, 15
    s_add_u32 s47, s47, 32768
    v_xor_b32 v9, 0, v0
    s_mov_b32 m0, s47
    s_nop 0
    buffer_load_dwordx4 v9, s[12:15], s46 offen lds
    s_add_u32 s46, s46, 1024
    s_add_u32 s47, s47, 1024
    v_xor_b32 v9, 16, v0
    s_mov_b32 m0, s47
    s_nop 0
    buffer_load_dwordx4 v9, s[12:15], s46 offen lds
    s_add_u32 s46, s46, 1024
    s_add_u32 s47, s47, 1024
    v_xor_b32 v9, 32, v0
    s_mov_b32 m0, s47
    s_nop 0
    buffer_load_dwordx4 v9, s[12:15], s46 offen lds
    s_add_u32 s46, s46, 1024
    s_add_u32 s47, s47, 1024
    v_xor_b32 v9, 48, v0
    s_mov_b32 m0, s47
    s_nop 0
    buffer_load_dwordx4 v9, s[12:15], s46 offen lds
    s_add_u32 s46, s46, 1024
    s_add_u32 s47, s47, 1024
    v_xor_b32 v9, 64, v0
    s_mov_b32 m0, s47
    s_nop 0
    buffer_load_dwordx4 v9, s[12:15], s46 offen lds
    s_add_u32 s46, s46, 1024
    s_add_u32 s47, s47, 1024
    v_xor_b32 v9, 80, v0
    s_mov_b32 m0, s47
    s_nop 0
    buffer_load_dwordx4 v9, s[12:15], s46 offen lds
    s_add_u32 s46, s46, 1024
    s_add_u32 s47, s47, 1024
    v_xor_b32 v9, 96, v0
    s_mov_b32 m0, s47
    s_nop 0
    buffer_load_dwordx4 v9, s[12:15], s46 offen lds
    s_add_u32 s46, s46, 1024
    s_add_u32 s47, s47, 1024
    v_xor_b32 v9, 112, v0
    s_mov_b32 m0, s47
    s_nop 0
    buffer_load_dwordx4 v9, s[12:15], s46 offen lds
    s_add_u32 s46, s46, 1024
    s_add_u32 s47, s47, 1024
    v_xor_b32 v9, 128, v0
    s_mov_b32 m0, s47
    s_nop 0
    buffer_load_dwordx4 v9, s[12:15], s46 offen lds
    s_add_u32 s46, s46, 1024
    s_add_u32 s47, s47, 1024
    v_xor_b32 v9, 144, v0
    s_mov_b32 m0, s47
    s_nop 0
    buffer_load_dwordx4 v9, s[12:15], s46 offen lds
    s_add_u32 s46, s46, 1024
    s_add_u32 s47, s47, 1024
    v_xor_b32 v9, 160, v0
    s_mov_b32 m0, s47
    s_nop 0
    buffer_load_dwordx4 v9, s[12:15], s46 offen lds
    s_add_u32 s46, s46, 1024
    s_add_u32 s47, s47, 1024
    v_xor_b32 v9, 176, v0
    s_mov_b32 m0, s47
    s_nop 0
    buffer_load_dwordx4 v9, s[12:15], s46 offen lds
    s_add_u32 s46, s46, 1024
    s_add_u32 s47, s47, 1024
    v_xor_b32 v9, 192, v0
    s_mov_b32 m0, s47
    s_nop 0
    buffer_load_dwordx4 v9, s[12:15], s46 offen lds
    s_add_u32 s46, s46, 1024
    s_add_u32 s47, s47, 1024
    v_xor_b32 v9, 208, v0
    s_mov_b32 m0, s47
    s_nop 0
    buffer_load_dwordx4 v9, s[12:15], s46 offen lds
    s_add_u32 s46, s46, 1024
    s_add_u32 s47, s47, 1024
    v_xor_b32 v9, 224, v0
    s_mov_b32 m0, s47
    s_nop 0
    buffer_load_dwordx4 v9, s[12:15], s46 offen lds
    s_add_u32 s46, s46, 1024
    s_add_u32 s47, s47, 1024
    v_xor_b32 v9, 240, v0
    s_mov_b32 m0, s47
    s_nop 0
    buffer_load_dwordx4 v9, s[12:15], s46 offen lds
    s_add_u32 s46, s46, 1024
    s_add_u32 s47, s47, 1024
    v_xor_b32 v9, 0, v0
    s_mov_b32 m0, s47
    s_nop 0
    buffer_load_dwordx4 v9, s[12:15], s46 offen lds
    s_add_u32 s46, s46, 1024
    s_add_u32 s47, s47, 1024
    v_xor_b32 v9, 16, v0
    s_mov_b32 m0, s47
    s_nop 0
    buffer_load_dwordx4 v9, s[12:15], s46 offen lds
    s_add_u32 s46, s46, 1024
    s_add_u32 s47, s47, 1024
    v_xor_b32 v9, 32, v0
    s_mov_b32 m0, s47
    s_nop 0
    buffer_load_dwordx4 v9, s[12:15], s46 offen lds
    s_add_u32 s46, s46, 1024
    s_add_u32 s47, s47, 1024
    v_xor_b32 v9, 48, v0
    s_mov_b32 m0, s47
    s_nop 0
    buffer_load_dwordx4 v9, s[12:15], s46 offen lds
    s_add_u32 s46, s46, 1024
    s_add_u32 s47, s47, 1024
    v_xor_b32 v9, 64, v0
    s_mov_b32 m0, s47
    s_nop 0
    buffer_load_dwordx4 v9, s[12:15], s46 offen lds
    s_add_u32 s46, s46, 1024
    s_add_u32 s47, s47, 1024
    v_xor_b32 v9, 80, v0
    s_mov_b32 m0, s47
    s_nop 0
    buffer_load_dwordx4 v9, s[12:15], s46 offen lds
    s_add_u32 s46, s46, 1024
    s_add_u32 s47, s47, 1024
    v_xor_b32 v9, 96, v0
    s_mov_b32 m0, s47
    s_nop 0
    buffer_load_dwordx4 v9, s[12:15], s46 offen lds
    s_add_u32 s46, s46, 1024
    s_add_u32 s47, s47, 1024
    v_xor_b32 v9, 112, v0
    s_mov_b32 m0, s47
    s_nop 0
    buffer_load_dwordx4 v9, s[12:15], s46 offen lds
    s_add_u32 s46, s46, 1024
    s_add_u32 s47, s47, 1024
    v_xor_b32 v9, 128, v0
    s_mov_b32 m0, s47
    s_nop 0
    buffer_load_dwordx4 v9, s[12:15], s46 offen lds
    s_add_u32 s46, s46, 1024
    s_add_u32 s47, s47, 1024
    v_xor_b32 v9, 144, v0
    s_mov_b32 m0, s47
    s_nop 0
    buffer_load_dwordx4 v9, s[12:15], s46 offen lds
    s_add_u32 s46, s46, 1024
    s_add_u32 s47, s47, 1024
    v_xor_b32 v9, 160, v0
    s_mov_b32 m0, s47
    s_nop 0
    buffer_load_dwordx4 v9, s[12:15], s46 offen lds
    s_add_u32 s46, s46, 1024
    s_add_u32 s47, s47, 1024
    v_xor_b32 v9, 176, v0
    s_mov_b32 m0, s47
    s_nop 0
    buffer_load_dwordx4 v9, s[12:15], s46 offen lds
    s_add_u32 s46, s46, 1024
    s_add_u32 s47, s47, 1024
    v_xor_b32 v9, 192, v0
    s_mov_b32 m0, s47
    s_nop 0
    buffer_load_dwordx4 v9, s[12:15], s46 offen lds
    s_add_u32 s46, s46, 1024
    s_add_u32 s47, s47, 1024
    v_xor_b32 v9, 208, v0
    s_mov_b32 m0, s47
    s_nop 0
    buffer_load_dwordx4 v9, s[12:15], s46 offen lds
    s_add_u32 s46, s46, 1024
    s_add_u32 s47, s47, 1024
    v_xor_b32 v9, 224, v0
    s_mov_b32 m0, s47
    s_nop 0
    buffer_load_dwordx4 v9, s[12:15], s46 offen lds
    s_add_u32 s46, s46, 1024
    s_add_u32 s47, s47, 1024
    v_xor_b32 v9, 240, v0
    s_mov_b32 m0, s47
    s_nop 0
    buffer_load_dwordx4 v9, s[12:15], s46 offen lds
    s_add_u32 s46, s46, 1024
    s_add_u32 s47, s47, 1024
    s_waitcnt vmcnt(0)
    v_xor_b32 v9, 0, v7
    ds_read_b128 a[0:3], v9
    v_xor_b32 v10, 32, v7
    ds_read_b128 a[4:7], v10
    v_xor_b32 v9, 64, v7
    ds_read_b128 a[8:11], v9
    v_xor_b32 v10, 96, v7
    ds_read_b128 a[12:15], v10
    v_xor_b32 v9, 128, v7
    ds_read_b128 a[16:19], v9
    v_xor_b32 v10, 160, v7
    ds_read_b128 a[20:23], v10
    v_xor_b32 v9, 192, v7
    ds_read_b128 a[24:27], v9
    v_xor_b32 v10, 224, v7
    ds_read_b128 a[28:31], v10
    v_xor_b32 v9, 256, v7
    ds_read_b128 a[32:35], v9
    v_xor_b32 v10, 288, v7
    ds_read_b128 a[36:39], v10
    v_xor_b32 v9, 320, v7
    ds_read_b128 a[40:43], v9
    v_xor_b32 v10, 352, v7
    ds_read_b128 a[44:47], v10
    v_xor_b32 v9, 384, v7
    ds_read_b128 a[48:51], v9
    v_xor_b32 v10, 416, v7
    ds_read_b128 a[52:55], v10
    v_xor_b32 v9, 448, v7
    ds_read_b128 a[56:59], v9
    v_xor_b32 v10, 480, v7
    ds_read_b128 a[60:63], v10
    v_xor_b32 v9, 512, v7
    ds_read_b128 a[64:67], v9
    v_xor_b32 v10, 544, v7
    ds_read_b128 a[68:71], v10
    v_xor_b32 v9, 576, v7
    ds_read_b128 a[72:75], v9
    v_xor_b32 v10, 608, v7
    ds_read_b128 a[76:79], v10
    v_xor_b32 v9, 640, v7
    ds_read_b128 a[80:83], v9
    v_xor_b32 v10, 672, v7
    ds_read_b128 a[84:87], v10
    v_xor_b32 v9, 704, v7
    ds_read_b128 a[88:91], v9
    v_xor_b32 v10, 736, v7
    ds_read_b128 a[92:95], v10
    v_xor_b32 v9, 768, v7
    ds_read_b128 a[96:99], v9
    v_xor_b32 v10, 800, v7
    ds_read_b128 a[100:103], v10
    v_xor_b32 v9, 832, v7
    ds_read_b128 a[104:107], v9
    v_xor_b32 v10, 864, v7
    ds_read_b128 a[108:111], v10
    v_xor_b32 v9, 896, v7
    ds_read_b128 a[112:115], v9
    v_xor_b32 v10, 928, v7
    ds_read_b128 a[116:119], v10
    v_xor_b32 v9, 960, v7
    ds_read_b128 a[120:123], v9
    v_xor_b32 v10, 992, v7
    ds_read_b128 a[124:127], v10
    s_waitcnt lgkmcnt(0)
    s_lshl_b32 s46, s5, 8
    s_lshl_b32 s47, s4, 6
    s_add_u32 s46, s46, s47
    s_add_u32 s46, s46, 32
    s_lshl_b32 s46, s46, 10
    s_lshl_b32 s47, s4, 15
    s_add_u32 s47, s47, 32768
    v_xor_b32 v9, 0, v0
    s_mov_b32 m0, s47
    s_nop 0
    buffer_load_dwordx4 v9, s[12:15], s46 offen lds
    s_add_u32 s46, s46, 1024
    s_add_u32 s47, s47, 1024
    v_xor_b32 v9, 16, v0
    s_mov_b32 m0, s47
    s_nop 0
    buffer_load_dwordx4 v9, s[12:15], s46 offen lds
    s_add_u32 s46, s46, 1024
    s_add_u32 s47, s47, 1024
    v_xor_b32 v9, 32, v0
    s_mov_b32 m0, s47
    s_nop 0
    buffer_load_dwordx4 v9, s[12:15], s46 offen lds
    s_add_u32 s46, s46, 1024
    s_add_u32 s47, s47, 1024
    v_xor_b32 v9, 48, v0
    s_mov_b32 m0, s47
    s_nop 0
    buffer_load_dwordx4 v9, s[12:15], s46 offen lds
    s_add_u32 s46, s46, 1024
    s_add_u32 s47, s47, 1024
    v_xor_b32 v9, 64, v0
    s_mov_b32 m0, s47
    s_nop 0
    buffer_load_dwordx4 v9, s[12:15], s46 offen lds
    s_add_u32 s46, s46, 1024
    s_add_u32 s47, s47, 1024
    v_xor_b32 v9, 80, v0
    s_mov_b32 m0, s47
    s_nop 0
    buffer_load_dwordx4 v9, s[12:15], s46 offen lds
    s_add_u32 s46, s46, 1024
    s_add_u32 s47, s47, 1024
    v_xor_b32 v9, 96, v0
    s_mov_b32 m0, s47
    s_nop 0
    buffer_load_dwordx4 v9, s[12:15], s46 offen lds
    s_add_u32 s46, s46, 1024
    s_add_u32 s47, s47, 1024
    v_xor_b32 v9, 112, v0
    s_mov_b32 m0, s47
    s_nop 0
    buffer_load_dwordx4 v9, s[12:15], s46 offen lds
    s_add_u32 s46, s46, 1024
    s_add_u32 s47, s47, 1024
    v_xor_b32 v9, 128, v0
    s_mov_b32 m0, s47
    s_nop 0
    buffer_load_dwordx4 v9, s[12:15], s46 offen lds
    s_add_u32 s46, s46, 1024
    s_add_u32 s47, s47, 1024
    v_xor_b32 v9, 144, v0
    s_mov_b32 m0, s47
    s_nop 0
    buffer_load_dwordx4 v9, s[12:15], s46 offen lds
    s_add_u32 s46, s46, 1024
    s_add_u32 s47, s47, 1024
    v_xor_b32 v9, 160, v0
    s_mov_b32 m0, s47
    s_nop 0
    buffer_load_dwordx4 v9, s[12:15], s46 offen lds
    s_add_u32 s46, s46, 1024
    s_add_u32 s47, s47, 1024
    v_xor_b32 v9, 176, v0
    s_mov_b32 m0, s47
    s_nop 0
    buffer_load_dwordx4 v9, s[12:15], s46 offen lds
    s_add_u32 s46, s46, 1024
    s_add_u32 s47, s47, 1024
    v_xor_b32 v9, 192, v0
    s_mov_b32 m0, s47
    s_nop 0
    buffer_load_dwordx4 v9, s[12:15], s46 offen lds
    s_add_u32 s46, s46, 1024
    s_add_u32 s47, s47, 1024
    v_xor_b32 v9, 208, v0
    s_mov_b32 m0, s47
    s_nop 0
    buffer_load_dwordx4 v9, s[12:15], s46 offen lds
    s_add_u32 s46, s46, 1024
    s_add_u32 s47, s47, 1024
    v_xor_b32 v9, 224, v0
    s_mov_b32 m0, s47
    s_nop 0
    buffer_load_dwordx4 v9, s[12:15], s46 offen lds
    s_add_u32 s46, s46, 1024
    s_add_u32 s47, s47, 1024
    v_xor_b32 v9, 240, v0
    s_mov_b32 m0, s47
    s_nop 0
    buffer_load_dwordx4 v9, s[12:15], s46 offen lds
    s_add_u32 s46, s46, 1024
    s_add_u32 s47, s47, 1024
    v_xor_b32 v9, 0, v0
    s_mov_b32 m0, s47
    s_nop 0
    buffer_load_dwordx4 v9, s[12:15], s46 offen lds
    s_add_u32 s46, s46, 1024
    s_add_u32 s47, s47, 1024
    v_xor_b32 v9, 16, v0
    s_mov_b32 m0, s47
    s_nop 0
    buffer_load_dwordx4 v9, s[12:15], s46 offen lds
    s_add_u32 s46, s46, 1024
    s_add_u32 s47, s47, 1024
    v_xor_b32 v9, 32, v0
    s_mov_b32 m0, s47
    s_nop 0
    buffer_load_dwordx4 v9, s[12:15], s46 offen lds
    s_add_u32 s46, s46, 1024
    s_add_u32 s47, s47, 1024
    v_xor_b32 v9, 48, v0
    s_mov_b32 m0, s47
    s_nop 0
    buffer_load_dwordx4 v9, s[12:15], s46 offen lds
    s_add_u32 s46, s46, 1024
    s_add_u32 s47, s47, 1024
    v_xor_b32 v9, 64, v0
    s_mov_b32 m0, s47
    s_nop 0
    buffer_load_dwordx4 v9, s[12:15], s46 offen lds
    s_add_u32 s46, s46, 1024
    s_add_u32 s47, s47, 1024
    v_xor_b32 v9, 80, v0
    s_mov_b32 m0, s47
    s_nop 0
    buffer_load_dwordx4 v9, s[12:15], s46 offen lds
    s_add_u32 s46, s46, 1024
    s_add_u32 s47, s47, 1024
    v_xor_b32 v9, 96, v0
    s_mov_b32 m0, s47
    s_nop 0
    buffer_load_dwordx4 v9, s[12:15], s46 offen lds
    s_add_u32 s46, s46, 1024
    s_add_u32 s47, s47, 1024
    v_xor_b32 v9, 112, v0
    s_mov_b32 m0, s47
    s_nop 0
    buffer_load_dwordx4 v9, s[12:15], s46 offen lds
    s_add_u32 s46, s46, 1024
    s_add_u32 s47, s47, 1024
    v_xor_b32 v9, 128, v0
    s_mov_b32 m0, s47
    s_nop 0
    buffer_load_dwordx4 v9, s[12:15], s46 offen lds
    s_add_u32 s46, s46, 1024
    s_add_u32 s47, s47, 1024
    v_xor_b32 v9, 144, v0
    s_mov_b32 m0, s47
    s_nop 0
    buffer_load_dwordx4 v9, s[12:15], s46 offen lds
    s_add_u32 s46, s46, 1024
    s_add_u32 s47, s47, 1024
    v_xor_b32 v9, 160, v0
    s_mov_b32 m0, s47
    s_nop 0
    buffer_load_dwordx4 v9, s[12:15], s46 offen lds
    s_add_u32 s46, s46, 1024
    s_add_u32 s47, s47, 1024
    v_xor_b32 v9, 176, v0
    s_mov_b32 m0, s47
    s_nop 0
    buffer_load_dwordx4 v9, s[12:15], s46 offen lds
    s_add_u32 s46, s46, 1024
    s_add_u32 s47, s47, 1024
    v_xor_b32 v9, 192, v0
    s_mov_b32 m0, s47
    s_nop 0
    buffer_load_dwordx4 v9, s[12:15], s46 offen lds
    s_add_u32 s46, s46, 1024
    s_add_u32 s47, s47, 1024
    v_xor_b32 v9, 208, v0
    s_mov_b32 m0, s47
    s_nop 0
    buffer_load_dwordx4 v9, s[12:15], s46 offen lds
    s_add_u32 s46, s46, 1024
    s_add_u32 s47, s47, 1024
    v_xor_b32 v9, 224, v0
    s_mov_b32 m0, s47
    s_nop 0
    buffer_load_dwordx4 v9, s[12:15], s46 offen lds
    s_add_u32 s46, s46, 1024
    s_add_u32 s47, s47, 1024
    v_xor_b32 v9, 240, v0
    s_mov_b32 m0, s47
    s_nop 0
    buffer_load_dwordx4 v9, s[12:15], s46 offen lds
    s_add_u32 s46, s46, 1024
    s_add_u32 s47, s47, 1024
    s_waitcnt vmcnt(0)
    v_xor_b32 v9, 0, v7
    ds_read_b128 a[128:131], v9
    v_xor_b32 v10, 32, v7
    ds_read_b128 a[132:135], v10
    v_xor_b32 v9, 64, v7
    ds_read_b128 a[136:139], v9
    v_xor_b32 v10, 96, v7
    ds_read_b128 a[140:143], v10
    v_xor_b32 v9, 128, v7
    ds_read_b128 a[144:147], v9
    v_xor_b32 v10, 160, v7
    ds_read_b128 a[148:151], v10
    v_xor_b32 v9, 192, v7
    ds_read_b128 a[152:155], v9
    v_xor_b32 v10, 224, v7
    ds_read_b128 a[156:159], v10
    v_xor_b32 v9, 256, v7
    ds_read_b128 a[160:163], v9
    v_xor_b32 v10, 288, v7
    ds_read_b128 a[164:167], v10
    v_xor_b32 v9, 320, v7
    ds_read_b128 a[168:171], v9
    v_xor_b32 v10, 352, v7
    ds_read_b128 a[172:175], v10
    v_xor_b32 v9, 384, v7
    ds_read_b128 a[176:179], v9
    v_xor_b32 v10, 416, v7
    ds_read_b128 a[180:183], v10
    v_xor_b32 v9, 448, v7
    ds_read_b128 a[184:187], v9
    v_xor_b32 v10, 480, v7
    ds_read_b128 a[188:191], v10
    v_xor_b32 v9, 512, v7
    ds_read_b128 a[192:195], v9
    v_xor_b32 v10, 544, v7
    ds_read_b128 a[196:199], v10
    v_xor_b32 v9, 576, v7
    ds_read_b128 a[200:203], v9
    v_xor_b32 v10, 608, v7
    ds_read_b128 a[204:207], v10
    v_xor_b32 v9, 640, v7
    ds_read_b128 a[208:211], v9
    v_xor_b32 v10, 672, v7
    ds_read_b128 a[212:215], v10
    v_xor_b32 v9, 704, v7
    ds_read_b128 a[216:219], v9
    v_xor_b32 v10, 736, v7
    ds_read_b128 a[220:223], v10
    v_xor_b32 v9, 768, v7
    ds_read_b128 a[224:227], v9
    v_xor_b32 v10, 800, v7
    ds_read_b128 a[228:231], v10
    v_xor_b32 v9, 832, v7
    ds_read_b128 a[232:235], v9
    v_xor_b32 v10, 864, v7
    ds_read_b128 a[236:239], v10
    v_xor_b32 v9, 896, v7
    ds_read_b128 a[240:243], v9
    v_xor_b32 v10, 928, v7
    ds_read_b128 a[244:247], v10
    v_xor_b32 v9, 960, v7
    ds_read_b128 a[248:251], v9
    v_xor_b32 v10, 992, v7
    ds_read_b128 a[252:255], v10
    s_waitcnt lgkmcnt(0)
    s_barrier
    s_cmp_eq_u32 s73, 1
    s_cbranch_scc0 L_g1w_nog
    s_cmp_eq_u32 s76, 27
    s_cbranch_scc0 L_g1w_nog
    v_lshrrev_b32 v9, 5, v8
    v_lshlrev_b32 v9, 4, v9
    buffer_load_dwordx4 v[64:67], v9, s[60:63], 0 offen offset:0
    buffer_load_dwordx4 v[68:71], v9, s[60:63], 0 offen offset:32
    buffer_load_dwordx4 v[72:75], v9, s[60:63], 0 offen offset:64
    buffer_load_dwordx4 v[76:79], v9, s[60:63], 0 offen offset:96
    buffer_load_dwordx4 v[80:83], v9, s[60:63], 0 offen offset:128
    buffer_load_dwordx4 v[84:87], v9, s[60:63], 0 offen offset:160
    buffer_load_dwordx4 v[88:91], v9, s[60:63], 0 offen offset:192
    buffer_load_dwordx4 v[92:95], v9, s[60:63], 0 offen offset:224
    s_waitcnt vmcnt(7)
    v_mfma_f32_32x32x16_bf16 v[128:143], v[64:67], a[0:3], 0
    s_waitcnt vmcnt(6)
    v_mfma_f32_32x32x16_bf16 v[128:143], v[68:71], a[4:7], v[128:143]
    s_waitcnt vmcnt(5)
    v_mfma_f32_32x32x16_bf16 v[128:143], v[72:75], a[8:11], v[128:143]
    s_waitcnt vmcnt(4)
    v_mfma_f32_32x32x16_bf16 v[128:143], v[76:79], a[12:15], v[128:143]
    s_waitcnt vmcnt(3)
    v_mfma_f32_32x32x16_bf16 v[128:143], v[80:83], a[16:19], v[128:143]
    s_waitcnt vmcnt(2)
    v_mfma_f32_32x32x16_bf16 v[128:143], v[84:87], a[20:23], v[128:143]
    s_waitcnt vmcnt(1)
    v_mfma_f32_32x32x16_bf16 v[128:143], v[88:91], a[24:27], v[128:143]
    s_waitcnt vmcnt(0)
    v_mfma_f32_32x32x16_bf16 v[128:143], v[92:95], a[28:31], v[128:143]
    buffer_load_dwordx4 v[64:67], v9, s[60:63], 0 offen offset:256
    buffer_load_dwordx4 v[68:71], v9, s[60:63], 0 offen offset:288
    buffer_load_dwordx4 v[72:75], v9, s[60:63], 0 offen offset:320
    buffer_load_dwordx4 v[76:79], v9, s[60:63], 0 offen offset:352
    buffer_load_dwordx4 v[80:83], v9, s[60:63], 0 offen offset:384
    buffer_load_dwordx4 v[84:87], v9, s[60:63], 0 offen offset:416
    buffer_load_dwordx4 v[88:91], v9, s[60:63], 0 offen offset:448
    buffer_load_dwordx4 v[92:95], v9, s[60:63], 0 offen offset:480
    s_waitcnt vmcnt(7)
    v_mfma_f32_32x32x16_bf16 v[128:143], v[64:67], a[32:35], v[128:143]
    s_waitcnt vmcnt(6)
    v_mfma_f32_32x32x16_bf16 v[128:143], v[68:71], a[36:39], v[128:143]
    s_waitcnt vmcnt(5)
    v_mfma_f32_32x32x16_bf16 v[128:143], v[72:75], a[40:43], v[128:143]
    s_waitcnt vmcnt(4)
    v_mfma_f32_32x32x16_bf16 v[128:143], v[76:79], a[44:47], v[128:143]
    s_waitcnt vmcnt(3)
    v_mfma_f32_32x32x16_bf16 v[128:143], v[80:83], a[48:51], v[128:143]
    s_waitcnt vmcnt(2)
    v_mfma_f32_32x32x16_bf16 v[128:143], v[84:87], a[52:55], v[128:143]
    s_waitcnt vmcnt(1)
    v_mfma_f32_32x32x16_bf16 v[128:143], v[88:91], a[56:59], v[128:143]
    s_waitcnt vmcnt(0)
    v_mfma_f32_32x32x16_bf16 v[128:143], v[92:95], a[60:63], v[128:143]
    buffer_load_dwordx4 v[64:67], v9, s[60:63], 0 offen offset:512
    buffer_load_dwordx4 v[68:71], v9, s[60:63], 0 offen offset:544
    buffer_load_dwordx4 v[72:75], v9, s[60:63], 0 offen offset:576
    buffer_load_dwordx4 v[76:79], v9, s[60:63], 0 offen offset:608
    buffer_load_dwordx4 v[80:83], v9, s[60:63], 0 offen offset:640
    buffer_load_dwordx4 v[84:87], v9, s[60:63], 0 offen offset:672
    buffer_load_dwordx4 v[88:91], v9, s[60:63], 0 offen offset:704
    buffer_load_dwordx4 v[92:95], v9, s[60:63], 0 offen offset:736
    s_waitcnt vmcnt(7)
    v_mfma_f32_32x32x16_bf16 v[128:143], v[64:67], a[64:67], v[128:143]
    s_waitcnt vmcnt(6)
    v_mfma_f32_32x32x16_bf16 v[128:143], v[68:71], a[68:71], v[128:143]
    s_waitcnt vmcnt(5)
    v_mfma_f32_32x32x16_bf16 v[128:143], v[72:75], a[72:75], v[128:143]
    s_waitcnt vmcnt(4)
    v_mfma_f32_32x32x16_bf16 v[128:143], v[76:79], a[76:79], v[128:143]
    s_waitcnt vmcnt(3)
    v_mfma_f32_32x32x16_bf16 v[128:143], v[80:83], a[80:83], v[128:143]
    s_waitcnt vmcnt(2)
    v_mfma_f32_32x32x16_bf16 v[128:143], v[84:87], a[84:87], v[128:143]
    s_waitcnt vmcnt(1)
    v_mfma_f32_32x32x16_bf16 v[128:143], v[88:91], a[88:91], v[128:143]
    s_waitcnt vmcnt(0)
    v_mfma_f32_32x32x16_bf16 v[128:143], v[92:95], a[92:95], v[128:143]
    buffer_load_dwordx4 v[64:67], v9, s[60:63], 0 offen offset:768
    buffer_load_dwordx4 v[68:71], v9, s[60:63], 0 offen offset:800
    buffer_load_dwordx4 v[72:75], v9, s[60:63], 0 offen offset:832
    buffer_load_dwordx4 v[76:79], v9, s[60:63], 0 offen offset:864
    buffer_load_dwordx4 v[80:83], v9, s[60:63], 0 offen offset:896
    buffer_load_dwordx4 v[84:87], v9, s[60:63], 0 offen offset:928
    buffer_load_dwordx4 v[88:91], v9, s[60:63], 0 offen offset:960
    buffer_load_dwordx4 v[92:95], v9, s[60:63], 0 offen offset:992
    s_waitcnt vmcnt(7)
    v_mfma_f32_32x32x16_bf16 v[128:143], v[64:67], a[96:99], v[128:143]
    s_waitcnt vmcnt(6)
    v_mfma_f32_32x32x16_bf16 v[128:143], v[68:71], a[100:103], v[128:143]
    s_waitcnt vmcnt(5)
    v_mfma_f32_32x32x16_bf16 v[128:143], v[72:75], a[104:107], v[128:143]
    s_waitcnt vmcnt(4)
    v_mfma_f32_32x32x16_bf16 v[128:143], v[76:79], a[108:111], v[128:143]
    s_waitcnt vmcnt(3)
    v_mfma_f32_32x32x16_bf16 v[128:143], v[80:83], a[112:115], v[128:143]
    s_waitcnt vmcnt(2)
    v_mfma_f32_32x32x16_bf16 v[128:143], v[84:87], a[116:119], v[128:143]
    s_waitcnt vmcnt(1)
    v_mfma_f32_32x32x16_bf16 v[128:143], v[88:91], a[120:123], v[128:143]
    s_waitcnt vmcnt(0)
    v_mfma_f32_32x32x16_bf16 v[128:143], v[92:95], a[124:127], v[128:143]
    buffer_load_dwordx4 v[64:67], v9, s[60:63], 0 offen offset:0
    buffer_load_dwordx4 v[68:71], v9, s[60:63], 0 offen offset:32
    buffer_load_dwordx4 v[72:75], v9, s[60:63], 0 offen offset:64
    buffer_load_dwordx4 v[76:79], v9, s[60:63], 0 offen offset:96
    buffer_load_dwordx4 v[80:83], v9, s[60:63], 0 offen offset:128
    buffer_load_dwordx4 v[84:87], v9, s[60:63], 0 offen offset:160
    buffer_load_dwordx4 v[88:91], v9, s[60:63], 0 offen offset:192
    buffer_load_dwordx4 v[92:95], v9, s[60:63], 0 offen offset:224
    s_waitcnt vmcnt(7)
    v_mfma_f32_32x32x16_bf16 v[144:159], v[64:67], a[128:131], 0
    s_waitcnt vmcnt(6)
    v_mfma_f32_32x32x16_bf16 v[144:159], v[68:71], a[132:135], v[144:159]
    s_waitcnt vmcnt(5)
    v_mfma_f32_32x32x16_bf16 v[144:159], v[72:75], a[136:139], v[144:159]
    s_waitcnt vmcnt(4)
    v_mfma_f32_32x32x16_bf16 v[144:159], v[76:79], a[140:143], v[144:159]
    s_waitcnt vmcnt(3)
    v_mfma_f32_32x32x16_bf16 v[144:159], v[80:83], a[144:147], v[144:159]
    s_waitcnt vmcnt(2)
    v_mfma_f32_32x32x16_bf16 v[144:159], v[84:87], a[148:151], v[144:159]
    s_waitcnt vmcnt(1)
    v_mfma_f32_32x32x16_bf16 v[144:159], v[88:91], a[152:155], v[144:159]
    s_waitcnt vmcnt(0)
    v_mfma_f32_32x32x16_bf16 v[144:159], v[92:95], a[156:159], v[144:159]
    buffer_load_dwordx4 v[64:67], v9, s[60:63], 0 offen offset:256
    buffer_load_dwordx4 v[68:71], v9, s[60:63], 0 offen offset:288
    buffer_load_dwordx4 v[72:75], v9, s[60:63], 0 offen offset:320
    buffer_load_dwordx4 v[76:79], v9, s[60:63], 0 offen offset:352
    buffer_load_dwordx4 v[80:83], v9, s[60:63], 0 offen offset:384
    buffer_load_dwordx4 v[84:87], v9, s[60:63], 0 offen offset:416
    buffer_load_dwordx4 v[88:91], v9, s[60:63], 0 offen offset:448
    buffer_load_dwordx4 v[92:95], v9, s[60:63], 0 offen offset:480
    s_waitcnt vmcnt(7)
    v_mfma_f32_32x32x16_bf16 v[144:159], v[64:67], a[160:163], v[144:159]
    s_waitcnt vmcnt(6)
    v_mfma_f32_32x32x16_bf16 v[144:159], v[68:71], a[164:167], v[144:159]
    s_waitcnt vmcnt(5)
    v_mfma_f32_32x32x16_bf16 v[144:159], v[72:75], a[168:171], v[144:159]
    s_waitcnt vmcnt(4)
    v_mfma_f32_32x32x16_bf16 v[144:159], v[76:79], a[172:175], v[144:159]
    s_waitcnt vmcnt(3)
    v_mfma_f32_32x32x16_bf16 v[144:159], v[80:83], a[176:179], v[144:159]
    s_waitcnt vmcnt(2)
    v_mfma_f32_32x32x16_bf16 v[144:159], v[84:87], a[180:183], v[144:159]
    s_waitcnt vmcnt(1)
    v_mfma_f32_32x32x16_bf16 v[144:159], v[88:91], a[184:187], v[144:159]
    s_waitcnt vmcnt(0)
    v_mfma_f32_32x32x16_bf16 v[144:159], v[92:95], a[188:191], v[144:159]
    buffer_load_dwordx4 v[64:67], v9, s[60:63], 0 offen offset:512
    buffer_load_dwordx4 v[68:71], v9, s[60:63], 0 offen offset:544
    buffer_load_dwordx4 v[72:75], v9, s[60:63], 0 offen offset:576
    buffer_load_dwordx4 v[76:79], v9, s[60:63], 0 offen offset:608
    buffer_load_dwordx4 v[80:83], v9, s[60:63], 0 offen offset:640
    buffer_load_dwordx4 v[84:87], v9, s[60:63], 0 offen offset:672
    buffer_load_dwordx4 v[88:91], v9, s[60:63], 0 offen offset:704
    buffer_load_dwordx4 v[92:95], v9, s[60:63], 0 offen offset:736
    s_waitcnt vmcnt(7)
    v_mfma_f32_32x32x16_bf16 v[144:159], v[64:67], a[192:195], v[144:159]
    s_waitcnt vmcnt(6)
    v_mfma_f32_32x32x16_bf16 v[144:159], v[68:71], a[196:199], v[144:159]
    s_waitcnt vmcnt(5)
    v_mfma_f32_32x32x16_bf16 v[144:159], v[72:75], a[200:203], v[144:159]
    s_waitcnt vmcnt(4)
    v_mfma_f32_32x32x16_bf16 v[144:159], v[76:79], a[204:207], v[144:159]
    s_waitcnt vmcnt(3)
    v_mfma_f32_32x32x16_bf16 v[144:159], v[80:83], a[208:211], v[144:159]
    s_waitcnt vmcnt(2)
    v_mfma_f32_32x32x16_bf16 v[144:159], v[84:87], a[212:215], v[144:159]
    s_waitcnt vmcnt(1)
    v_mfma_f32_32x32x16_bf16 v[144:159], v[88:91], a[216:219], v[144:159]
    s_waitcnt vmcnt(0)
    v_mfma_f32_32x32x16_bf16 v[144:159], v[92:95], a[220:223], v[144:159]
    buffer_load_dwordx4 v[64:67], v9, s[60:63], 0 offen offset:768
    buffer_load_dwordx4 v[68:71], v9, s[60:63], 0 offen offset:800
    buffer_load_dwordx4 v[72:75], v9, s[60:63], 0 offen offset:832
    buffer_load_dwordx4 v[76:79], v9, s[60:63], 0 offen offset:864
    buffer_load_dwordx4 v[80:83], v9, s[60:63], 0 offen offset:896
    buffer_load_dwordx4 v[84:87], v9, s[60:63], 0 offen offset:928
    buffer_load_dwordx4 v[88:91], v9, s[60:63], 0 offen offset:960
    buffer_load_dwordx4 v[92:95], v9, s[60:63], 0 offen offset:992
    s_waitcnt vmcnt(7)
    v_mfma_f32_32x32x16_bf16 v[144:159], v[64:67], a[224:227], v[144:159]
    s_waitcnt vmcnt(6)
    v_mfma_f32_32x32x16_bf16 v[144:159], v[68:71], a[228:231], v[144:159]
    s_waitcnt vmcnt(5)
    v_mfma_f32_32x32x16_bf16 v[144:159], v[72:75], a[232:235], v[144:159]
    s_waitcnt vmcnt(4)
    v_mfma_f32_32x32x16_bf16 v[144:159], v[76:79], a[236:239], v[144:159]
    s_waitcnt vmcnt(3)
    v_mfma_f32_32x32x16_bf16 v[144:159], v[80:83], a[240:243], v[144:159]
    s_waitcnt vmcnt(2)
    v_mfma_f32_32x32x16_bf16 v[144:159], v[84:87], a[244:247], v[144:159]
    s_waitcnt vmcnt(1)
    v_mfma_f32_32x32x16_bf16 v[144:159], v[88:91], a[248:251], v[144:159]
    s_waitcnt vmcnt(0)
    v_mfma_f32_32x32x16_bf16 v[144:159], v[92:95], a[252:255], v[144:159]
    v_cvt_pk_bf16_f32 v128, v128, v128
    v_and_b32 v128, 0xffff0000, v128
    v_mul_f32 v128, s54, v128
    v_exp_f32 v128, v128
    s_nop 0
    v_add_f32 v128, 1.0, v128
    v_rcp_f32 v128, v128
    s_nop 0
    v_cvt_pk_bf16_f32 v128, v128, v128
    v_and_b32 v128, 0xffff0000, v128
    s_nop 1
    v_cvt_pk_bf16_f32 v144, v144, v144
    v_and_b32 v144, 0xffff0000, v144
    v_mul_f32 v144, s54, v144
    v_exp_f32 v144, v144
    s_nop 0
    v_add_f32 v144, 1.0, v144
    v_rcp_f32 v144, v144
    s_nop 0
    v_cvt_pk_bf16_f32 v144, v144, v144
    v_and_b32 v144, 0xffff0000, v144
    s_lshl_b32 s46, s5, 8
    s_lshl_b32 s47, s4, 6
    s_add_u32 s46, s46, s47
    s_lshl_b32 s46, s46, 2
    s_add_u32 s46, s46, 3145728
    v_lshlrev_b32 v9, 2, v8
    s_mov_b32 exec_hi, 0
    buffer_store_dword v128, v9, s[8:11], s46 offen sc1
    buffer_store_dword v144, v9, s[8:11], s46 offen offset:128 sc1
    s_mov_b64 exec, -1
    s_waitcnt vmcnt(0)
    s_barrier
    s_mov_b32 s72, 16777216
    s_mov_b32 s74, s5
    s_cmp_eq_u32 s72, 0
    s_cbranch_scc1 L_gfl
    s_cmp_lg_u32 s4, 0
    s_cbranch_scc1 L_gfl_c
    s_cmp_lg_u32 s89, 0
    s_cbranch_scc1 L_gfl_i
    v_mov_b32 v9, 28
    s_mov_b32 s78, 0
L_gfl_w:
    global_load_dword v10, v9, s[68:69] sc1
    s_waitcnt vmcnt(0)
    v_readfirstlane_b32 s89, v10
    s_cmp_lg_u32 s89, 0
    s_cbranch_scc1 L_gfl_i
    s_sleep 8
    s_add_u32 s78, s78, 1
    s_cmp_lt_u32 s78, 100000
    s_cbranch_scc1 L_gfl_w
L_gfl_i:
    s_lshl_b32 s46, s74, 7
    s_add_u32 s46, s46, 262144
    v_mov_b32 v9, 0
    v_mov_b32 v10, s72
    s_mov_b64 exec, 1
    buffer_atomic_add v10, v9, s[8:11], s46 offen sc1
    s_mov_b64 exec, -1
L_gfl_c:
    s_mov_b32 s72, 0
L_gfl:
L_g1w_nog:
    s_lshl_b32 s46, s4, 11
    s_add_u32 m0, s46, 32768
    s_nop 0
    buffer_load_dwordx4 v3, s[16:19], s53 offen lds
    s_lshl_b32 s46, s4, 11
    s_add_u32 m0, s46, 33792
    s_add_u32 s47, s53, s45
    buffer_load_dwordx4 v3, s[16:19], s47 offen lds
    s_lshl_b32 s46, s4, 11
    s_add_u32 m0, s46, 40960
    s_nop 0
    buffer_load_dwordx4 v3, s[20:23], s53 offen lds
    s_lshl_b32 s46, s4, 11
    s_add_u32 m0, s46, 41984
    s_add_u32 s47, s53, s45
    buffer_load_dwordx4 v3, s[20:23], s47 offen lds
    s_lshl_b32 s46, s45, 3
    s_add_u32 s53, s53, s46
    s_lshl_b32 s46, s4, 11
    s_add_u32 m0, s46, 49152
    s_nop 0
    buffer_load_dwordx4 v3, s[16:19], s53 offen lds
    s_lshl_b32 s46, s4, 11
    s_add_u32 m0, s46, 50176
    s_add_u32 s47, s53, s45
    buffer_load_dwordx4 v3, s[16:19], s47 offen lds
    s_lshl_b32 s46, s4, 11
    s_add_u32 m0, s46, 57344
    s_nop 0
    buffer_load_dwordx4 v3, s[20:23], s53 offen lds
    s_lshl_b32 s46, s4, 11
    s_add_u32 m0, s46, 58368
    s_add_u32 s47, s53, s45
    buffer_load_dwordx4 v3, s[20:23], s47 offen lds
    s_lshl_b32 s46, s45, 3
    s_add_u32 s53, s53, s46
    s_lshl_b32 s46, s4, 11
    s_add_u32 m0, s46, 65536
    s_nop 0
    buffer_load_dwordx4 v3, s[16:19], s53 offen lds
    s_lshl_b32 s46, s4, 11
    s_add_u32 m0, s46, 66560
    s_add_u32 s47, s53, s45
    buffer_load_dwordx4 v3, s[16:19], s47 offen lds
    s_lshl_b32 s46, s4, 11
    s_add_u32 m0, s46, 73728
    s_nop 0
    buffer_load_dwordx4 v3, s[20:23], s53 offen lds
    s_lshl_b32 s46, s4, 11
    s_add_u32 m0, s46, 74752
    s_add_u32 s47, s53, s45
    buffer_load_dwordx4 v3, s[20:23], s47 offen lds
    s_lshl_b32 s46, s45, 3
    s_add_u32 s53, s53, s46
    s_lshl_b32 s46, s4, 11
    s_add_u32 m0, s46, 81920
    s_nop 0
    buffer_load_dwordx4 v3, s[16:19], s53 offen lds
    s_lshl_b32 s46, s4, 11
    s_add_u32 m0, s46, 82944
    s_add_u32 s47, s53, s45
    buffer_load_dwordx4 v3, s[16:19], s47 offen lds
    s_lshl_b32 s46, s4, 11
    s_add_u32 m0, s46, 90112
    s_nop 0
    buffer_load_dwordx4 v3, s[20:23], s53 offen lds
    s_lshl_b32 s46, s4, 11
    s_add_u32 m0, s46, 91136
    s_add_u32 s47, s53, s45
    buffer_load_dwordx4 v3, s[20:23], s47 offen lds
    s_lshl_b32 s46, s45, 3
    s_add_u32 s53, s53, s46
    buffer_load_dword v14, v0, s[12:15], 0 offen
    buffer_load_dword v14, v0, s[12:15], 0 offen
    buffer_load_dword v14, v0, s[12:15], 0 offen
    buffer_load_dword v14, v0, s[12:15], 0 offen
    buffer_load_dword v14, v0, s[12:15], 0 offen
    buffer_load_dword v14, v0, s[12:15], 0 offen
    buffer_load_dword v14, v0, s[12:15], 0 offen
    buffer_load_dword v14, v0, s[12:15], 0 offen
    buffer_load_dword v14, v0, s[12:15], 0 offen
    buffer_load_dword v14, v0, s[12:15], 0 offen
    buffer_load_dword v14, v0, s[12:15], 0 offen
    buffer_load_dword v14, v0, s[12:15], 0 offen
    buffer_load_dword v14, v0, s[12:15], 0 offen
    buffer_load_dword v14, v0, s[12:15], 0 offen
    buffer_load_dword v14, v0, s[12:15], 0 offen
    buffer_load_dword v14, v0, s[12:15], 0 offen
L_g1w_unit:
    s_cmp_eq_u32 s49, 1
    s_cbranch_scc1 L_g1w_v
    s_waitcnt vmcnt(36)
    s_barrier
    ds_read_b64_tr_b16 v[64:65], v4 offset:0
    ds_read_b64_tr_b16 v[66:67], v4 offset:512
    ds_read_b64_tr_b16 v[68:69], v5 offset:0
    ds_read_b64_tr_b16 v[70:71], v5 offset:512
    ds_read_b64_tr_b16 v[72:73], v4 offset:8192
    ds_read_b64_tr_b16 v[74:75], v4 offset:8704
    ds_read_b64_tr_b16 v[76:77], v5 offset:8192
    ds_read_b64_tr_b16 v[78:79], v5 offset:8704
    s_waitcnt lgkmcnt(0)
    v_mfma_f32_32x32x16_bf16 v[128:143], v[64:67], a[0:3], 0
    ds_read_b64_tr_b16 v[80:81], v4 offset:2048
    ds_read_b64_tr_b16 v[82:83], v4 offset:2560
    v_mfma_f32_32x32x16_bf16 v[144:159], v[64:67], a[128:131], 0
    ds_read_b64_tr_b16 v[84:85], v5 offset:2048
    ds_read_b64_tr_b16 v[86:87], v5 offset:2560
    v_mfma_f32_32x32x16_bf16 v[160:175], v[68:71], a[0:3], 0
    ds_read_b64_tr_b16 v[88:89], v4 offset:10240
    ds_read_b64_tr_b16 v[90:91], v4 offset:10752
    v_mfma_f32_32x32x16_bf16 v[176:191], v[68:71], a[128:131], 0
    ds_read_b64_tr_b16 v[92:93], v5 offset:10240
    ds_read_b64_tr_b16 v[94:95], v5 offset:10752
    v_mfma_f32_32x32x16_bf16 v[192:207], v[72:75], a[0:3], 0
    s_lshl_b32 s46, s4, 11
    s_add_u32 m0, s46, 98304
    s_nop 0
    buffer_load_dwordx4 v3, s[16:19], s53 offen lds
    s_lshl_b32 s46, s4, 11
    s_add_u32 m0, s46, 99328
    s_add_u32 s47, s53, s45
    buffer_load_dwordx4 v3, s[16:19], s47 offen lds
    s_lshl_b32 s46, s4, 11
    s_add_u32 m0, s46, 106496
    s_nop 0
    buffer_load_dwordx4 v3, s[20:23], s53 offen lds
    s_lshl_b32 s46, s4, 11
    s_add_u32 m0, s46, 107520
    s_add_u32 s47, s53, s45
    buffer_load_dwordx4 v3, s[20:23], s47 offen lds
    s_lshl_b32 s46, s45, 3
    s_add_u32 s53, s53, s46
    v_mfma_f32_32x32x16_bf16 v[208:223], v[72:75], a[128:131], 0
    v_mfma_f32_32x32x16_bf16 v[224:239], v[76:79], a[0:3], 0
    v_mfma_f32_32x32x16_bf16 v[240:255], v[76:79], a[128:131], 0
    s_waitcnt lgkmcnt(0)
    v_mfma_f32_32x32x16_bf16 v[128:143], v[80:83], a[4:7], v[128:143]
    ds_read_b64_tr_b16 v[64:65], v4 offset:4096
    ds_read_b64_tr_b16 v[66:67], v4 offset:4608
    v_mfma_f32_32x32x16_bf16 v[144:159], v[80:83], a[132:135], v[144:159]
    ds_read_b64_tr_b16 v[68:69], v5 offset:4096
    ds_read_b64_tr_b16 v[70:71], v5 offset:4608
    v_mfma_f32_32x32x16_bf16 v[160:175], v[84:87], a[4:7], v[160:175]
    ds_read_b64_tr_b16 v[72:73], v4 offset:12288
    ds_read_b64_tr_b16 v[74:75], v4 offset:12800
    v_mfma_f32_32x32x16_bf16 v[176:191], v[84:87], a[132:135], v[176:191]
    ds_read_b64_tr_b16 v[76:77], v5 offset:12288
    ds_read_b64_tr_b16 v[78:79], v5 offset:12800
    v_mfma_f32_32x32x16_bf16 v[192:207], v[88:91], a[4:7], v[192:207]
    v_mfma_f32_32x32x16_bf16 v[208:223], v[88:91], a[132:135], v[208:223]
    v_mfma_f32_32x32x16_bf16 v[224:239], v[92:95], a[4:7], v[224:239]
    v_mfma_f32_32x32x16_bf16 v[240:255], v[92:95], a[132:135], v[240:255]
    s_waitcnt lgkmcnt(0)
    v_mfma_f32_32x32x16_bf16 v[128:143], v[64:67], a[8:11], v[128:143]
    ds_read_b64_tr_b16 v[80:81], v4 offset:6144
    ds_read_b64_tr_b16 v[82:83], v4 offset:6656
    v_mfma_f32_32x32x16_bf16 v[144:159], v[64:67], a[136:139], v[144:159]
    ds_read_b64_tr_b16 v[84:85], v5 offset:6144
    ds_read_b64_tr_b16 v[86:87], v5 offset:6656
    v_mfma_f32_32x32x16_bf16 v[160:175], v[68:71], a[8:11], v[160:175]
    ds_read_b64_tr_b16 v[88:89], v4 offset:14336
    ds_read_b64_tr_b16 v[90:91], v4 offset:14848
    v_mfma_f32_32x32x16_bf16 v[176:191], v[68:71], a[136:139], v[176:191]
    ds_read_b64_tr_b16 v[92:93], v5 offset:14336
    ds_read_b64_tr_b16 v[94:95], v5 offset:14848
    v_mfma_f32_32x32x16_bf16 v[192:207], v[72:75], a[8:11], v[192:207]
    v_mfma_f32_32x32x16_bf16 v[208:223], v[72:75], a[136:139], v[208:223]
    v_mfma_f32_32x32x16_bf16 v[224:239], v[76:79], a[8:11], v[224:239]
    v_mfma_f32_32x32x16_bf16 v[240:255], v[76:79], a[136:139], v[240:255]
    s_waitcnt lgkmcnt(0)
    s_waitcnt vmcnt(36)
    s_barrier
    v_mfma_f32_32x32x16_bf16 v[128:143], v[80:83], a[12:15], v[128:143]
    ds_read_b64_tr_b16 v[64:65], v4 offset:16384
    ds_read_b64_tr_b16 v[66:67], v4 offset:16896
    v_mfma_f32_32x32x16_bf16 v[144:159], v[80:83], a[140:143], v[144:159]
    ds_read_b64_tr_b16 v[68:69], v5 offset:16384
    ds_read_b64_tr_b16 v[70:71], v5 offset:16896
    v_mfma_f32_32x32x16_bf16 v[160:175], v[84:87], a[12:15], v[160:175]
    ds_read_b64_tr_b16 v[72:73], v4 offset:24576
    ds_read_b64_tr_b16 v[74:75], v4 offset:25088
    v_mfma_f32_32x32x16_bf16 v[176:191], v[84:87], a[140:143], v[176:191]
    ds_read_b64_tr_b16 v[76:77], v5 offset:24576
    ds_read_b64_tr_b16 v[78:79], v5 offset:25088
    v_mfma_f32_32x32x16_bf16 v[192:207], v[88:91], a[12:15], v[192:207]
    v_mfma_f32_32x32x16_bf16 v[208:223], v[88:91], a[140:143], v[208:223]
    v_mfma_f32_32x32x16_bf16 v[224:239], v[92:95], a[12:15], v[224:239]
    v_mfma_f32_32x32x16_bf16 v[240:255], v[92:95], a[140:143], v[240:255]
    s_waitcnt lgkmcnt(0)
    v_mfma_f32_32x32x16_bf16 v[128:143], v[64:67], a[16:19], v[128:143]
    ds_read_b64_tr_b16 v[80:81], v4 offset:18432
    ds_read_b64_tr_b16 v[82:83], v4 offset:18944
    v_mfma_f32_32x32x16_bf16 v[144:159], v[64:67], a[144:147], v[144:159]
    ds_read_b64_tr_b16 v[84:85], v5 offset:18432
    ds_read_b64_tr_b16 v[86:87], v5 offset:18944
    v_mfma_f32_32x32x16_bf16 v[160:175], v[68:71], a[16:19], v[160:175]
    ds_read_b64_tr_b16 v[88:89], v4 offset:26624
    ds_read_b64_tr_b16 v[90:91], v4 offset:27136
    v_mfma_f32_32x32x16_bf16 v[176:191], v[68:71], a[144:147], v[176:191]
    ds_read_b64_tr_b16 v[92:93], v5 offset:26624
    ds_read_b64_tr_b16 v[94:95], v5 offset:27136
    v_mfma_f32_32x32x16_bf16 v[192:207], v[72:75], a[16:19], v[192:207]
    s_lshl_b32 s46, s4, 11
    s_add_u32 m0, s46, 114688
    s_nop 0
    buffer_load_dwordx4 v3, s[16:19], s53 offen lds
    s_lshl_b32 s46, s4, 11
    s_add_u32 m0, s46, 115712
    s_add_u32 s47, s53, s45
    buffer_load_dwordx4 v3, s[16:19], s47 offen lds
    s_lshl_b32 s46, s4, 11
    s_add_u32 m0, s46, 122880
    s_nop 0
    buffer_load_dwordx4 v3, s[20:23], s53 offen lds
    s_lshl_b32 s46, s4, 11
    s_add_u32 m0, s46, 123904
    s_add_u32 s47, s53, s45
    buffer_load_dwordx4 v3, s[20:23], s47 offen lds
    s_lshl_b32 s46, s45, 3
    s_add_u32 s53, s53, s46
    v_mfma_f32_32x32x16_bf16 v[208:223], v[72:75], a[144:147], v[208:223]
    v_mfma_f32_32x32x16_bf16 v[224:239], v[76:79], a[16:19], v[224:239]
    v_mfma_f32_32x32x16_bf16 v[240:255], v[76:79], a[144:147], v[240:255]
    s_waitcnt lgkmcnt(0)
    v_mfma_f32_32x32x16_bf16 v[128:143], v[80:83], a[20:23], v[128:143]
    ds_read_b64_tr_b16 v[64:65], v4 offset:20480
    ds_read_b64_tr_b16 v[66:67], v4 offset:20992
    v_mfma_f32_32x32x16_bf16 v[144:159], v[80:83], a[148:151], v[144:159]
    ds_read_b64_tr_b16 v[68:69], v5 offset:20480
    ds_read_b64_tr_b16 v[70:71], v5 offset:20992
    v_mfma_f32_32x32x16_bf16 v[160:175], v[84:87], a[20:23], v[160:175]
    ds_read_b64_tr_b16 v[72:73], v4 offset:28672
    ds_read_b64_tr_b16 v[74:75], v4 offset:29184
    v_mfma_f32_32x32x16_bf16 v[176:191], v[84:87], a[148:151], v[176:191]
    ds_read_b64_tr_b16 v[76:77], v5 offset:28672
    ds_read_b64_tr_b16 v[78:79], v5 offset:29184
    v_mfma_f32_32x32x16_bf16 v[192:207], v[88:91], a[20:23], v[192:207]
    v_mfma_f32_32x32x16_bf16 v[208:223], v[88:91], a[148:151], v[208:223]
    v_mfma_f32_32x32x16_bf16 v[224:239], v[92:95], a[20:23], v[224:239]
    v_mfma_f32_32x32x16_bf16 v[240:255], v[92:95], a[148:151], v[240:255]
    s_waitcnt lgkmcnt(0)
    v_mfma_f32_32x32x16_bf16 v[128:143], v[64:67], a[24:27], v[128:143]
    ds_read_b64_tr_b16 v[80:81], v4 offset:22528
    ds_read_b64_tr_b16 v[82:83], v4 offset:23040
    v_mfma_f32_32x32x16_bf16 v[144:159], v[64:67], a[152:155], v[144:159]
    ds_read_b64_tr_b16 v[84:85], v5 offset:22528
    ds_read_b64_tr_b16 v[86:87], v5 offset:23040
    v_mfma_f32_32x32x16_bf16 v[160:175], v[68:71], a[24:27], v[160:175]
    ds_read_b64_tr_b16 v[88:89], v4 offset:30720
    ds_read_b64_tr_b16 v[90:91], v4 offset:31232
    v_mfma_f32_32x32x16_bf16 v[176:191], v[68:71], a[152:155], v[176:191]
    ds_read_b64_tr_b16 v[92:93], v5 offset:30720
    ds_read_b64_tr_b16 v[94:95], v5 offset:31232
    v_mfma_f32_32x32x16_bf16 v[192:207], v[72:75], a[24:27], v[192:207]
    v_mfma_f32_32x32x16_bf16 v[208:223], v[72:75], a[152:155], v[208:223]
    v_mfma_f32_32x32x16_bf16 v[224:239], v[76:79], a[24:27], v[224:239]
    v_mfma_f32_32x32x16_bf16 v[240:255], v[76:79], a[152:155], v[240:255]
    s_waitcnt lgkmcnt(0)
    s_waitcnt vmcnt(36)
    s_barrier
    v_mfma_f32_32x32x16_bf16 v[128:143], v[80:83], a[28:31], v[128:143]
    ds_read_b64_tr_b16 v[64:65], v4 offset:32768
    ds_read_b64_tr_b16 v[66:67], v4 offset:33280
    v_mfma_f32_32x32x16_bf16 v[144:159], v[80:83], a[156:159], v[144:159]
    ds_read_b64_tr_b16 v[68:69], v5 offset:32768
    ds_read_b64_tr_b16 v[70:71], v5 offset:33280
    v_mfma_f32_32x32x16_bf16 v[160:175], v[84:87], a[28:31], v[160:175]
    ds_read_b64_tr_b16 v[72:73], v4 offset:40960
    ds_read_b64_tr_b16 v[74:75], v4 offset:41472
    v_mfma_f32_32x32x16_bf16 v[176:191], v[84:87], a[156:159], v[176:191]
    ds_read_b64_tr_b16 v[76:77], v5 offset:40960
    ds_read_b64_tr_b16 v[78:79], v5 offset:41472
    v_mfma_f32_32x32x16_bf16 v[192:207], v[88:91], a[28:31], v[192:207]
    v_mfma_f32_32x32x16_bf16 v[208:223], v[88:91], a[156:159], v[208:223]
    v_mfma_f32_32x32x16_bf16 v[224:239], v[92:95], a[28:31], v[224:239]
    v_mfma_f32_32x32x16_bf16 v[240:255], v[92:95], a[156:159], v[240:255]
    s_waitcnt lgkmcnt(0)
    v_mfma_f32_32x32x16_bf16 v[128:143], v[64:67], a[32:35], v[128:143]
    ds_read_b64_tr_b16 v[80:81], v4 offset:34816
    ds_read_b64_tr_b16 v[82:83], v4 offset:35328
    v_mfma_f32_32x32x16_bf16 v[144:159], v[64:67], a[160:163], v[144:159]
    ds_read_b64_tr_b16 v[84:85], v5 offset:34816
    ds_read_b64_tr_b16 v[86:87], v5 offset:35328
    v_mfma_f32_32x32x16_bf16 v[160:175], v[68:71], a[32:35], v[160:175]
    ds_read_b64_tr_b16 v[88:89], v4 offset:43008
    ds_read_b64_tr_b16 v[90:91], v4 offset:43520
    v_mfma_f32_32x32x16_bf16 v[176:191], v[68:71], a[160:163], v[176:191]
    ds_read_b64_tr_b16 v[92:93], v5 offset:43008
    ds_read_b64_tr_b16 v[94:95], v5 offset:43520
    v_mfma_f32_32x32x16_bf16 v[192:207], v[72:75], a[32:35], v[192:207]
    s_cmp_ge_u32 s77, 124
    s_cselect_b32 s67, s6, s77
    s_cmp_eq_u32 s73, 0
    s_cselect_b32 s67, s6, s67
    s_lshr_b32 s46, s67, 5
    s_and_b32 s47, s67, 31
    s_mov_b32 s51, s46
    s_cmp_eq_u32 s46, 3
    s_cbranch_scc1 L_decF_u12493
    s_lshl_b32 s44, s47, 8
    s_mov_b32 s45, 65536
    v_mov_b32 v3, v1
    s_cmp_eq_u32 s46, 0
    s_cselect_b32 s16, s28, s32
    s_cselect_b32 s17, s29, s33
    s_mov_b32 s48, 33554432
    s_cselect_b32 s48, 16777216, s48
    s_cmp_eq_u32 s46, 2
    s_cselect_b32 s16, s24, s16
    s_cselect_b32 s17, s25, s17
    s_cselect_b32 s48, 50331648, s48
    s_mov_b32 s18, 0x400000
    s_mov_b32 s19, 0x20000
    s_add_u32 s20, s16, 128
    s_addc_u32 s21, s17, 0
    s_mov_b32 s22, 4194176
    s_mov_b32 s23, 0x20000
    s_lshl_b32 s52, s5, 3
    s_lshl_b32 s46, s4, 1
    s_add_u32 s52, s52, s46
    s_lshl_b32 s52, s52, 5
    s_add_u32 s52, s52, s47
    s_lshl_b32 s52, s52, 13
    s_add_u32 s52, s52, s48
    s_branch L_decD_u12493
L_decF_u12493:
    s_lshl_b32 s44, s47, 7
    s_mov_b32 s45, 28672
    v_mov_b32 v3, v2
    s_mov_b32 s16, s36
    s_mov_b32 s17, s37
    s_mov_b32 s18, 1835008
    s_mov_b32 s19, 0x20000
    s_mov_b32 s20, s40
    s_mov_b32 s21, s41
    s_mov_b32 s22, 1835008
    s_mov_b32 s23, 0x20000
    s_lshl_b32 s52, s5, 3
    s_lshl_b32 s46, s4, 1
    s_add_u32 s52, s52, s46
    s_mul_i32 s52, s52, 114688
    s_lshl_b32 s47, s47, 12
    s_add_u32 s52, s52, s47
    s_add_u32 s52, s52, 109051904
L_decD_u12493:
    s_mul_i32 s53, s45, s4
    s_lshl_b32 s53, s53, 1
    s_add_u32 s53, s53, s44
    s_lshl_b32 s46, s4, 11
    s_add_u32 m0, s46, 0
    s_nop 0
    buffer_load_dwordx4 v3, s[16:19], s53 offen lds
    s_lshl_b32 s46, s4, 11
    s_add_u32 m0, s46, 1024
    s_add_u32 s47, s53, s45
    buffer_load_dwordx4 v3, s[16:19], s47 offen lds
    s_lshl_b32 s46, s4, 11
    s_add_u32 m0, s46, 8192
    s_nop 0
    buffer_load_dwordx4 v3, s[20:23], s53 offen lds
    s_lshl_b32 s46, s4, 11
    s_add_u32 m0, s46, 9216
    s_add_u32 s47, s53, s45
    buffer_load_dwordx4 v3, s[20:23], s47 offen lds
    s_lshl_b32 s46, s45, 3
    s_add_u32 s53, s53, s46
    v_mfma_f32_32x32x16_bf16 v[208:223], v[72:75], a[160:163], v[208:223]
    v_mfma_f32_32x32x16_bf16 v[224:239], v[76:79], a[32:35], v[224:239]
    v_mfma_f32_32x32x16_bf16 v[240:255], v[76:79], a[160:163], v[240:255]
    s_waitcnt lgkmcnt(0)
    v_mfma_f32_32x32x16_bf16 v[128:143], v[80:83], a[36:39], v[128:143]
    ds_read_b64_tr_b16 v[64:65], v4 offset:36864
    ds_read_b64_tr_b16 v[66:67], v4 offset:37376
    v_mfma_f32_32x32x16_bf16 v[144:159], v[80:83], a[164:167], v[144:159]
    ds_read_b64_tr_b16 v[68:69], v5 offset:36864
    ds_read_b64_tr_b16 v[70:71], v5 offset:37376
    v_mfma_f32_32x32x16_bf16 v[160:175], v[84:87], a[36:39], v[160:175]
    ds_read_b64_tr_b16 v[72:73], v4 offset:45056
    ds_read_b64_tr_b16 v[74:75], v4 offset:45568
    v_mfma_f32_32x32x16_bf16 v[176:191], v[84:87], a[164:167], v[176:191]
    ds_read_b64_tr_b16 v[76:77], v5 offset:45056
    ds_read_b64_tr_b16 v[78:79], v5 offset:45568
    v_mfma_f32_32x32x16_bf16 v[192:207], v[88:91], a[36:39], v[192:207]
    v_mfma_f32_32x32x16_bf16 v[208:223], v[88:91], a[164:167], v[208:223]
    v_mfma_f32_32x32x16_bf16 v[224:239], v[92:95], a[36:39], v[224:239]
    v_mfma_f32_32x32x16_bf16 v[240:255], v[92:95], a[164:167], v[240:255]
    s_waitcnt lgkmcnt(0)
    v_mfma_f32_32x32x16_bf16 v[128:143], v[64:67], a[40:43], v[128:143]
    ds_read_b64_tr_b16 v[80:81], v4 offset:38912
    ds_read_b64_tr_b16 v[82:83], v4 offset:39424
    v_mfma_f32_32x32x16_bf16 v[144:159], v[64:67], a[168:171], v[144:159]
    ds_read_b64_tr_b16 v[84:85], v5 offset:38912
    ds_read_b64_tr_b16 v[86:87], v5 offset:39424
    v_mfma_f32_32x32x16_bf16 v[160:175], v[68:71], a[40:43], v[160:175]
    ds_read_b64_tr_b16 v[88:89], v4 offset:47104
    ds_read_b64_tr_b16 v[90:91], v4 offset:47616
    v_mfma_f32_32x32x16_bf16 v[176:191], v[68:71], a[168:171], v[176:191]
    ds_read_b64_tr_b16 v[92:93], v5 offset:47104
    ds_read_b64_tr_b16 v[94:95], v5 offset:47616
    v_mfma_f32_32x32x16_bf16 v[192:207], v[72:75], a[40:43], v[192:207]
    v_mfma_f32_32x32x16_bf16 v[208:223], v[72:75], a[168:171], v[208:223]
    v_mfma_f32_32x32x16_bf16 v[224:239], v[76:79], a[40:43], v[224:239]
    v_mfma_f32_32x32x16_bf16 v[240:255], v[76:79], a[168:171], v[240:255]
    s_waitcnt lgkmcnt(0)
    s_waitcnt vmcnt(36)
    s_barrier
    v_mfma_f32_32x32x16_bf16 v[128:143], v[80:83], a[44:47], v[128:143]
    ds_read_b64_tr_b16 v[64:65], v4 offset:49152
    ds_read_b64_tr_b16 v[66:67], v4 offset:49664
    v_mfma_f32_32x32x16_bf16 v[144:159], v[80:83], a[172:175], v[144:159]
    ds_read_b64_tr_b16 v[68:69], v5 offset:49152
    ds_read_b64_tr_b16 v[70:71], v5 offset:49664
    v_mfma_f32_32x32x16_bf16 v[160:175], v[84:87], a[44:47], v[160:175]
    ds_read_b64_tr_b16 v[72:73], v4 offset:57344
    ds_read_b64_tr_b16 v[74:75], v4 offset:57856
    v_mfma_f32_32x32x16_bf16 v[176:191], v[84:87], a[172:175], v[176:191]
    ds_read_b64_tr_b16 v[76:77], v5 offset:57344
    ds_read_b64_tr_b16 v[78:79], v5 offset:57856
    v_mfma_f32_32x32x16_bf16 v[192:207], v[88:91], a[44:47], v[192:207]
    v_mfma_f32_32x32x16_bf16 v[208:223], v[88:91], a[172:175], v[208:223]
    v_mfma_f32_32x32x16_bf16 v[224:239], v[92:95], a[44:47], v[224:239]
    v_mfma_f32_32x32x16_bf16 v[240:255], v[92:95], a[172:175], v[240:255]
    s_waitcnt lgkmcnt(0)
    v_mfma_f32_32x32x16_bf16 v[128:143], v[64:67], a[48:51], v[128:143]
    ds_read_b64_tr_b16 v[80:81], v4 offset:51200
    ds_read_b64_tr_b16 v[82:83], v4 offset:51712
    v_mfma_f32_32x32x16_bf16 v[144:159], v[64:67], a[176:179], v[144:159]
    ds_read_b64_tr_b16 v[84:85], v5 offset:51200
    ds_read_b64_tr_b16 v[86:87], v5 offset:51712
    v_mfma_f32_32x32x16_bf16 v[160:175], v[68:71], a[48:51], v[160:175]
    ds_read_b64_tr_b16 v[88:89], v4 offset:59392
    ds_read_b64_tr_b16 v[90:91], v4 offset:59904
    v_mfma_f32_32x32x16_bf16 v[176:191], v[68:71], a[176:179], v[176:191]
    ds_read_b64_tr_b16 v[92:93], v5 offset:59392
    ds_read_b64_tr_b16 v[94:95], v5 offset:59904
    v_mfma_f32_32x32x16_bf16 v[192:207], v[72:75], a[48:51], v[192:207]
    s_lshl_b32 s46, s4, 11
    s_add_u32 m0, s46, 16384
    s_nop 0
    buffer_load_dwordx4 v3, s[16:19], s53 offen lds
    s_lshl_b32 s46, s4, 11
    s_add_u32 m0, s46, 17408
    s_add_u32 s47, s53, s45
    buffer_load_dwordx4 v3, s[16:19], s47 offen lds
    s_lshl_b32 s46, s4, 11
    s_add_u32 m0, s46, 24576
    s_nop 0
    buffer_load_dwordx4 v3, s[20:23], s53 offen lds
    s_lshl_b32 s46, s4, 11
    s_add_u32 m0, s46, 25600
    s_add_u32 s47, s53, s45
    buffer_load_dwordx4 v3, s[20:23], s47 offen lds
    s_lshl_b32 s46, s45, 3
    s_add_u32 s53, s53, s46
    v_mfma_f32_32x32x16_bf16 v[208:223], v[72:75], a[176:179], v[208:223]
    v_mfma_f32_32x32x16_bf16 v[224:239], v[76:79], a[48:51], v[224:239]
    v_mfma_f32_32x32x16_bf16 v[240:255], v[76:79], a[176:179], v[240:255]
    s_waitcnt lgkmcnt(0)
    v_mfma_f32_32x32x16_bf16 v[128:143], v[80:83], a[52:55], v[128:143]
    ds_read_b64_tr_b16 v[64:65], v4 offset:53248
    ds_read_b64_tr_b16 v[66:67], v4 offset:53760
    v_mfma_f32_32x32x16_bf16 v[144:159], v[80:83], a[180:183], v[144:159]
    ds_read_b64_tr_b16 v[68:69], v5 offset:53248
    ds_read_b64_tr_b16 v[70:71], v5 offset:53760
    v_mfma_f32_32x32x16_bf16 v[160:175], v[84:87], a[52:55], v[160:175]
    ds_read_b64_tr_b16 v[72:73], v4 offset:61440
    ds_read_b64_tr_b16 v[74:75], v4 offset:61952
    v_mfma_f32_32x32x16_bf16 v[176:191], v[84:87], a[180:183], v[176:191]
    ds_read_b64_tr_b16 v[76:77], v5 offset:61440
    ds_read_b64_tr_b16 v[78:79], v5 offset:61952
    v_mfma_f32_32x32x16_bf16 v[192:207], v[88:91], a[52:55], v[192:207]
    v_mfma_f32_32x32x16_bf16 v[208:223], v[88:91], a[180:183], v[208:223]
    v_mfma_f32_32x32x16_bf16 v[224:239], v[92:95], a[52:55], v[224:239]
    v_mfma_f32_32x32x16_bf16 v[240:255], v[92:95], a[180:183], v[240:255]
    s_waitcnt lgkmcnt(0)
    v_mfma_f32_32x32x16_bf16 v[128:143], v[64:67], a[56:59], v[128:143]
    ds_read_b64_tr_b16 v[80:81], v4 offset:55296
    ds_read_b64_tr_b16 v[82:83], v4 offset:55808
    v_mfma_f32_32x32x16_bf16 v[144:159], v[64:67], a[184:187], v[144:159]
    ds_read_b64_tr_b16 v[84:85], v5 offset:55296
    ds_read_b64_tr_b16 v[86:87], v5 offset:55808
    v_mfma_f32_32x32x16_bf16 v[160:175], v[68:71], a[56:59], v[160:175]
    ds_read_b64_tr_b16 v[88:89], v4 offset:63488
    ds_read_b64_tr_b16 v[90:91], v4 offset:64000
    v_mfma_f32_32x32x16_bf16 v[176:191], v[68:71], a[184:187], v[176:191]
    ds_read_b64_tr_b16 v[92:93], v5 offset:63488
    ds_read_b64_tr_b16 v[94:95], v5 offset:64000
    v_mfma_f32_32x32x16_bf16 v[192:207], v[72:75], a[56:59], v[192:207]
    v_mfma_f32_32x32x16_bf16 v[208:223], v[72:75], a[184:187], v[208:223]
    v_mfma_f32_32x32x16_bf16 v[224:239], v[76:79], a[56:59], v[224:239]
    v_mfma_f32_32x32x16_bf16 v[240:255], v[76:79], a[184:187], v[240:255]
    s_waitcnt lgkmcnt(0)
    s_waitcnt vmcnt(36)
    s_barrier
    v_mfma_f32_32x32x16_bf16 v[128:143], v[80:83], a[60:63], v[128:143]
    ds_read_b64_tr_b16 v[64:65], v12 offset:0
    ds_read_b64_tr_b16 v[66:67], v12 offset:512
    v_mfma_f32_32x32x16_bf16 v[144:159], v[80:83], a[188:191], v[144:159]
    ds_read_b64_tr_b16 v[68:69], v13 offset:0
    ds_read_b64_tr_b16 v[70:71], v13 offset:512
    v_mfma_f32_32x32x16_bf16 v[160:175], v[84:87], a[60:63], v[160:175]
    ds_read_b64_tr_b16 v[72:73], v12 offset:8192
    ds_read_b64_tr_b16 v[74:75], v12 offset:8704
    v_mfma_f32_32x32x16_bf16 v[176:191], v[84:87], a[188:191], v[176:191]
    ds_read_b64_tr_b16 v[76:77], v13 offset:8192
    ds_read_b64_tr_b16 v[78:79], v13 offset:8704
    v_mfma_f32_32x32x16_bf16 v[192:207], v[88:91], a[60:63], v[192:207]
    v_mfma_f32_32x32x16_bf16 v[208:223], v[88:91], a[188:191], v[208:223]
    v_mfma_f32_32x32x16_bf16 v[224:239], v[92:95], a[60:63], v[224:239]
    v_mfma_f32_32x32x16_bf16 v[240:255], v[92:95], a[188:191], v[240:255]
    s_waitcnt lgkmcnt(0)
    v_mfma_f32_32x32x16_bf16 v[128:143], v[64:67], a[64:67], v[128:143]
    ds_read_b64_tr_b16 v[80:81], v12 offset:2048
    ds_read_b64_tr_b16 v[82:83], v12 offset:2560
    v_mfma_f32_32x32x16_bf16 v[144:159], v[64:67], a[192:195], v[144:159]
    ds_read_b64_tr_b16 v[84:85], v13 offset:2048
    ds_read_b64_tr_b16 v[86:87], v13 offset:2560
    v_mfma_f32_32x32x16_bf16 v[160:175], v[68:71], a[64:67], v[160:175]
    ds_read_b64_tr_b16 v[88:89], v12 offset:10240
    ds_read_b64_tr_b16 v[90:91], v12 offset:10752
    v_mfma_f32_32x32x16_bf16 v[176:191], v[68:71], a[192:195], v[176:191]
    ds_read_b64_tr_b16 v[92:93], v13 offset:10240
    ds_read_b64_tr_b16 v[94:95], v13 offset:10752
    v_mfma_f32_32x32x16_bf16 v[192:207], v[72:75], a[64:67], v[192:207]
    s_lshl_b32 s46, s4, 11
    s_add_u32 m0, s46, 32768
    s_nop 0
    buffer_load_dwordx4 v3, s[16:19], s53 offen lds
    s_lshl_b32 s46, s4, 11
    s_add_u32 m0, s46, 33792
    s_add_u32 s47, s53, s45
    buffer_load_dwordx4 v3, s[16:19], s47 offen lds
    s_lshl_b32 s46, s4, 11
    s_add_u32 m0, s46, 40960
    s_nop 0
    buffer_load_dwordx4 v3, s[20:23], s53 offen lds
    s_lshl_b32 s46, s4, 11
    s_add_u32 m0, s46, 41984
    s_add_u32 s47, s53, s45
    buffer_load_dwordx4 v3, s[20:23], s47 offen lds
    s_lshl_b32 s46, s45, 3
    s_add_u32 s53, s53, s46
    v_mfma_f32_32x32x16_bf16 v[208:223], v[72:75], a[192:195], v[208:223]
    v_mfma_f32_32x32x16_bf16 v[224:239], v[76:79], a[64:67], v[224:239]
    v_mfma_f32_32x32x16_bf16 v[240:255], v[76:79], a[192:195], v[240:255]
    s_waitcnt lgkmcnt(0)
    v_mfma_f32_32x32x16_bf16 v[128:143], v[80:83], a[68:71], v[128:143]
    ds_read_b64_tr_b16 v[64:65], v12 offset:4096
    ds_read_b64_tr_b16 v[66:67], v12 offset:4608
    v_mfma_f32_32x32x16_bf16 v[144:159], v[80:83], a[196:199], v[144:159]
    ds_read_b64_tr_b16 v[68:69], v13 offset:4096
    ds_read_b64_tr_b16 v[70:71], v13 offset:4608
    v_mfma_f32_32x32x16_bf16 v[160:175], v[84:87], a[68:71], v[160:175]
    ds_read_b64_tr_b16 v[72:73], v12 offset:12288
    ds_read_b64_tr_b16 v[74:75], v12 offset:12800
    v_mfma_f32_32x32x16_bf16 v[176:191], v[84:87], a[196:199], v[176:191]
    ds_read_b64_tr_b16 v[76:77], v13 offset:12288
    ds_read_b64_tr_b16 v[78:79], v13 offset:12800
    v_mfma_f32_32x32x16_bf16 v[192:207], v[88:91], a[68:71], v[192:207]
    v_mfma_f32_32x32x16_bf16 v[208:223], v[88:91], a[196:199], v[208:223]
    v_mfma_f32_32x32x16_bf16 v[224:239], v[92:95], a[68:71], v[224:239]
    v_mfma_f32_32x32x16_bf16 v[240:255], v[92:95], a[196:199], v[240:255]
    s_waitcnt lgkmcnt(0)
    v_mfma_f32_32x32x16_bf16 v[128:143], v[64:67], a[72:75], v[128:143]
    ds_read_b64_tr_b16 v[80:81], v12 offset:6144
    ds_read_b64_tr_b16 v[82:83], v12 offset:6656
    v_mfma_f32_32x32x16_bf16 v[144:159], v[64:67], a[200:203], v[144:159]
    ds_read_b64_tr_b16 v[84:85], v13 offset:6144
    ds_read_b64_tr_b16 v[86:87], v13 offset:6656
    v_mfma_f32_32x32x16_bf16 v[160:175], v[68:71], a[72:75], v[160:175]
    ds_read_b64_tr_b16 v[88:89], v12 offset:14336
    ds_read_b64_tr_b16 v[90:91], v12 offset:14848
    v_mfma_f32_32x32x16_bf16 v[176:191], v[68:71], a[200:203], v[176:191]
    ds_read_b64_tr_b16 v[92:93], v13 offset:14336
    ds_read_b64_tr_b16 v[94:95], v13 offset:14848
    v_mfma_f32_32x32x16_bf16 v[192:207], v[72:75], a[72:75], v[192:207]
    v_mfma_f32_32x32x16_bf16 v[208:223], v[72:75], a[200:203], v[208:223]
    v_mfma_f32_32x32x16_bf16 v[224:239], v[76:79], a[72:75], v[224:239]
    v_mfma_f32_32x32x16_bf16 v[240:255], v[76:79], a[200:203], v[240:255]
    s_waitcnt lgkmcnt(0)
    s_waitcnt vmcnt(36)
    s_barrier
    v_mfma_f32_32x32x16_bf16 v[128:143], v[80:83], a[76:79], v[128:143]
    ds_read_b64_tr_b16 v[64:65], v12 offset:16384
    ds_read_b64_tr_b16 v[66:67], v12 offset:16896
    v_mfma_f32_32x32x16_bf16 v[144:159], v[80:83], a[204:207], v[144:159]
    ds_read_b64_tr_b16 v[68:69], v13 offset:16384
    ds_read_b64_tr_b16 v[70:71], v13 offset:16896
    v_mfma_f32_32x32x16_bf16 v[160:175], v[84:87], a[76:79], v[160:175]
    ds_read_b64_tr_b16 v[72:73], v12 offset:24576
    ds_read_b64_tr_b16 v[74:75], v12 offset:25088
    v_mfma_f32_32x32x16_bf16 v[176:191], v[84:87], a[204:207], v[176:191]
    ds_read_b64_tr_b16 v[76:77], v13 offset:24576
    ds_read_b64_tr_b16 v[78:79], v13 offset:25088
    v_mfma_f32_32x32x16_bf16 v[192:207], v[88:91], a[76:79], v[192:207]
    v_mfma_f32_32x32x16_bf16 v[208:223], v[88:91], a[204:207], v[208:223]
    v_mfma_f32_32x32x16_bf16 v[224:239], v[92:95], a[76:79], v[224:239]
    v_mfma_f32_32x32x16_bf16 v[240:255], v[92:95], a[204:207], v[240:255]
    s_waitcnt lgkmcnt(0)
    v_mfma_f32_32x32x16_bf16 v[128:143], v[64:67], a[80:83], v[128:143]
    ds_read_b64_tr_b16 v[80:81], v12 offset:18432
    ds_read_b64_tr_b16 v[82:83], v12 offset:18944
    v_mfma_f32_32x32x16_bf16 v[144:159], v[64:67], a[208:211], v[144:159]
    ds_read_b64_tr_b16 v[84:85], v13 offset:18432
    ds_read_b64_tr_b16 v[86:87], v13 offset:18944
    v_mfma_f32_32x32x16_bf16 v[160:175], v[68:71], a[80:83], v[160:175]
    ds_read_b64_tr_b16 v[88:89], v12 offset:26624
    ds_read_b64_tr_b16 v[90:91], v12 offset:27136
    v_mfma_f32_32x32x16_bf16 v[176:191], v[68:71], a[208:211], v[176:191]
    ds_read_b64_tr_b16 v[92:93], v13 offset:26624
    ds_read_b64_tr_b16 v[94:95], v13 offset:27136
    v_mfma_f32_32x32x16_bf16 v[192:207], v[72:75], a[80:83], v[192:207]
    s_lshl_b32 s46, s4, 11
    s_add_u32 m0, s46, 49152
    s_nop 0
    buffer_load_dwordx4 v3, s[16:19], s53 offen lds
    s_lshl_b32 s46, s4, 11
    s_add_u32 m0, s46, 50176
    s_add_u32 s47, s53, s45
    buffer_load_dwordx4 v3, s[16:19], s47 offen lds
    s_lshl_b32 s46, s4, 11
    s_add_u32 m0, s46, 57344
    s_nop 0
    buffer_load_dwordx4 v3, s[20:23], s53 offen lds
    s_lshl_b32 s46, s4, 11
    s_add_u32 m0, s46, 58368
    s_add_u32 s47, s53, s45
    buffer_load_dwordx4 v3, s[20:23], s47 offen lds
    s_lshl_b32 s46, s45, 3
    s_add_u32 s53, s53, s46
    v_mfma_f32_32x32x16_bf16 v[208:223], v[72:75], a[208:211], v[208:223]
    v_mfma_f32_32x32x16_bf16 v[224:239], v[76:79], a[80:83], v[224:239]
    v_mfma_f32_32x32x16_bf16 v[240:255], v[76:79], a[208:211], v[240:255]
    s_waitcnt lgkmcnt(0)
    v_mfma_f32_32x32x16_bf16 v[128:143], v[80:83], a[84:87], v[128:143]
    ds_read_b64_tr_b16 v[64:65], v12 offset:20480
    ds_read_b64_tr_b16 v[66:67], v12 offset:20992
    v_mfma_f32_32x32x16_bf16 v[144:159], v[80:83], a[212:215], v[144:159]
    ds_read_b64_tr_b16 v[68:69], v13 offset:20480
    ds_read_b64_tr_b16 v[70:71], v13 offset:20992
    v_mfma_f32_32x32x16_bf16 v[160:175], v[84:87], a[84:87], v[160:175]
    ds_read_b64_tr_b16 v[72:73], v12 offset:28672
    ds_read_b64_tr_b16 v[74:75], v12 offset:29184
    v_mfma_f32_32x32x16_bf16 v[176:191], v[84:87], a[212:215], v[176:191]
    ds_read_b64_tr_b16 v[76:77], v13 offset:28672
    ds_read_b64_tr_b16 v[78:79], v13 offset:29184
    v_mfma_f32_32x32x16_bf16 v[192:207], v[88:91], a[84:87], v[192:207]
    v_mfma_f32_32x32x16_bf16 v[208:223], v[88:91], a[212:215], v[208:223]
    v_mfma_f32_32x32x16_bf16 v[224:239], v[92:95], a[84:87], v[224:239]
    v_mfma_f32_32x32x16_bf16 v[240:255], v[92:95], a[212:215], v[240:255]
    s_waitcnt lgkmcnt(0)
    v_mfma_f32_32x32x16_bf16 v[128:143], v[64:67], a[88:91], v[128:143]
    ds_read_b64_tr_b16 v[80:81], v12 offset:22528
    ds_read_b64_tr_b16 v[82:83], v12 offset:23040
    v_mfma_f32_32x32x16_bf16 v[144:159], v[64:67], a[216:219], v[144:159]
    ds_read_b64_tr_b16 v[84:85], v13 offset:22528
    ds_read_b64_tr_b16 v[86:87], v13 offset:23040
    v_mfma_f32_32x32x16_bf16 v[160:175], v[68:71], a[88:91], v[160:175]
    ds_read_b64_tr_b16 v[88:89], v12 offset:30720
    ds_read_b64_tr_b16 v[90:91], v12 offset:31232
    v_mfma_f32_32x32x16_bf16 v[176:191], v[68:71], a[216:219], v[176:191]
    ds_read_b64_tr_b16 v[92:93], v13 offset:30720
    ds_read_b64_tr_b16 v[94:95], v13 offset:31232
    v_mfma_f32_32x32x16_bf16 v[192:207], v[72:75], a[88:91], v[192:207]
    v_mfma_f32_32x32x16_bf16 v[208:223], v[72:75], a[216:219], v[208:223]
    v_mfma_f32_32x32x16_bf16 v[224:239], v[76:79], a[88:91], v[224:239]
    v_mfma_f32_32x32x16_bf16 v[240:255], v[76:79], a[216:219], v[240:255]
    s_waitcnt lgkmcnt(0)
    s_waitcnt vmcnt(20)
    s_barrier
    s_cmp_eq_u32 s72, 0
    s_cbranch_scc1 L_mf_12865
    s_cmp_lg_u32 s4, 0
    s_cbranch_scc1 L_mf_12865_c
    s_cmp_lg_u32 s89, 0
    s_cbranch_scc1 L_mf_12865_i
    v_mov_b32 v9, 28
    s_mov_b32 s78, 0
L_mf_12865_w:
    global_load_dword v10, v9, s[68:69] sc1
    s_waitcnt vmcnt(0)
    v_readfirstlane_b32 s89, v10
    s_cmp_lg_u32 s89, 0
    s_cbranch_scc1 L_mf_12865_i
    s_sleep 8
    s_add_u32 s78, s78, 1
    s_cmp_lt_u32 s78, 100000
    s_cbranch_scc1 L_mf_12865_w
L_mf_12865_i:
    s_lshl_b32 s46, s74, 7
    s_add_u32 s46, s46, 262144
    v_mov_b32 v9, 0
    v_mov_b32 v10, s72
    s_mov_b64 exec, 1
    buffer_atomic_add v10, v9, s[8:11], s46 offen sc1
    s_mov_b64 exec, -1
L_mf_12865_c:
    s_mov_b32 s72, 0
L_mf_12865:
    v_mfma_f32_32x32x16_bf16 v[128:143], v[80:83], a[92:95], v[128:143]
    ds_read_b64_tr_b16 v[64:65], v12 offset:32768
    ds_read_b64_tr_b16 v[66:67], v12 offset:33280
    v_mfma_f32_32x32x16_bf16 v[144:159], v[80:83], a[220:223], v[144:159]
    ds_read_b64_tr_b16 v[68:69], v13 offset:32768
    ds_read_b64_tr_b16 v[70:71], v13 offset:33280
    v_mfma_f32_32x32x16_bf16 v[160:175], v[84:87], a[92:95], v[160:175]
    ds_read_b64_tr_b16 v[72:73], v12 offset:40960
    ds_read_b64_tr_b16 v[74:75], v12 offset:41472
    v_mfma_f32_32x32x16_bf16 v[176:191], v[84:87], a[220:223], v[176:191]
    ds_read_b64_tr_b16 v[76:77], v13 offset:40960
    ds_read_b64_tr_b16 v[78:79], v13 offset:41472
    v_mfma_f32_32x32x16_bf16 v[192:207], v[88:91], a[92:95], v[192:207]
    v_mfma_f32_32x32x16_bf16 v[208:223], v[88:91], a[220:223], v[208:223]
    v_mfma_f32_32x32x16_bf16 v[224:239], v[92:95], a[92:95], v[224:239]
    v_mfma_f32_32x32x16_bf16 v[240:255], v[92:95], a[220:223], v[240:255]
    s_waitcnt lgkmcnt(0)
    v_mfma_f32_32x32x16_bf16 v[128:143], v[64:67], a[96:99], v[128:143]
    ds_read_b64_tr_b16 v[80:81], v12 offset:34816
    ds_read_b64_tr_b16 v[82:83], v12 offset:35328
    v_mfma_f32_32x32x16_bf16 v[144:159], v[64:67], a[224:227], v[144:159]
    ds_read_b64_tr_b16 v[84:85], v13 offset:34816
    ds_read_b64_tr_b16 v[86:87], v13 offset:35328
    v_mfma_f32_32x32x16_bf16 v[160:175], v[68:71], a[96:99], v[160:175]
    ds_read_b64_tr_b16 v[88:89], v12 offset:43008
    ds_read_b64_tr_b16 v[90:91], v12 offset:43520
    v_mfma_f32_32x32x16_bf16 v[176:191], v[68:71], a[224:227], v[176:191]
    ds_read_b64_tr_b16 v[92:93], v13 offset:43008
    ds_read_b64_tr_b16 v[94:95], v13 offset:43520
    v_mfma_f32_32x32x16_bf16 v[192:207], v[72:75], a[96:99], v[192:207]
    s_lshl_b32 s46, s4, 11
    s_add_u32 m0, s46, 65536
    s_nop 0
    buffer_load_dwordx4 v3, s[16:19], s53 offen lds
    s_lshl_b32 s46, s4, 11
    s_add_u32 m0, s46, 66560
    s_add_u32 s47, s53, s45
    buffer_load_dwordx4 v3, s[16:19], s47 offen lds
    s_lshl_b32 s46, s4, 11
    s_add_u32 m0, s46, 73728
    s_nop 0
    buffer_load_dwordx4 v3, s[20:23], s53 offen lds
    s_lshl_b32 s46, s4, 11
    s_add_u32 m0, s46, 74752
    s_add_u32 s47, s53, s45
    buffer_load_dwordx4 v3, s[20:23], s47 offen lds
    s_lshl_b32 s46, s45, 3
    s_add_u32 s53, s53, s46
    v_mfma_f32_32x32x16_bf16 v[208:223], v[72:75], a[224:227], v[208:223]
    v_mfma_f32_32x32x16_bf16 v[224:239], v[76:79], a[96:99], v[224:239]
    v_mfma_f32_32x32x16_bf16 v[240:255], v[76:79], a[224:227], v[240:255]
    s_waitcnt lgkmcnt(0)
    v_mfma_f32_32x32x16_bf16 v[128:143], v[80:83], a[100:103], v[128:143]
    ds_read_b64_tr_b16 v[64:65], v12 offset:36864
    ds_read_b64_tr_b16 v[66:67], v12 offset:37376
    v_mfma_f32_32x32x16_bf16 v[144:159], v[80:83], a[228:231], v[144:159]
    ds_read_b64_tr_b16 v[68:69], v13 offset:36864
    ds_read_b64_tr_b16 v[70:71], v13 offset:37376
    v_mfma_f32_32x32x16_bf16 v[160:175], v[84:87], a[100:103], v[160:175]
    ds_read_b64_tr_b16 v[72:73], v12 offset:45056
    ds_read_b64_tr_b16 v[74:75], v12 offset:45568
    v_mfma_f32_32x32x16_bf16 v[176:191], v[84:87], a[228:231], v[176:191]
    ds_read_b64_tr_b16 v[76:77], v13 offset:45056
    ds_read_b64_tr_b16 v[78:79], v13 offset:45568
    v_mfma_f32_32x32x16_bf16 v[192:207], v[88:91], a[100:103], v[192:207]
    v_mfma_f32_32x32x16_bf16 v[208:223], v[88:91], a[228:231], v[208:223]
    v_mfma_f32_32x32x16_bf16 v[224:239], v[92:95], a[100:103], v[224:239]
    v_mfma_f32_32x32x16_bf16 v[240:255], v[92:95], a[228:231], v[240:255]
    s_waitcnt lgkmcnt(0)
    v_mfma_f32_32x32x16_bf16 v[128:143], v[64:67], a[104:107], v[128:143]
    ds_read_b64_tr_b16 v[80:81], v12 offset:38912
    ds_read_b64_tr_b16 v[82:83], v12 offset:39424
    v_mfma_f32_32x32x16_bf16 v[144:159], v[64:67], a[232:235], v[144:159]
    ds_read_b64_tr_b16 v[84:85], v13 offset:38912
    ds_read_b64_tr_b16 v[86:87], v13 offset:39424
    v_mfma_f32_32x32x16_bf16 v[160:175], v[68:71], a[104:107], v[160:175]
    ds_read_b64_tr_b16 v[88:89], v12 offset:47104
    ds_read_b64_tr_b16 v[90:91], v12 offset:47616
    v_mfma_f32_32x32x16_bf16 v[176:191], v[68:71], a[232:235], v[176:191]
    ds_read_b64_tr_b16 v[92:93], v13 offset:47104
    ds_read_b64_tr_b16 v[94:95], v13 offset:47616
    v_mfma_f32_32x32x16_bf16 v[192:207], v[72:75], a[104:107], v[192:207]
    v_mfma_f32_32x32x16_bf16 v[208:223], v[72:75], a[232:235], v[208:223]
    v_mfma_f32_32x32x16_bf16 v[224:239], v[76:79], a[104:107], v[224:239]
    v_mfma_f32_32x32x16_bf16 v[240:255], v[76:79], a[232:235], v[240:255]
    s_waitcnt lgkmcnt(0)
    s_waitcnt vmcnt(20)
    s_barrier
    v_mfma_f32_32x32x16_bf16 v[128:143], v[80:83], a[108:111], v[128:143]
    ds_read_b64_tr_b16 v[64:65], v12 offset:49152
    ds_read_b64_tr_b16 v[66:67], v12 offset:49664
    v_mfma_f32_32x32x16_bf16 v[144:159], v[80:83], a[236:239], v[144:159]
    ds_read_b64_tr_b16 v[68:69], v13 offset:49152
    ds_read_b64_tr_b16 v[70:71], v13 offset:49664
    v_mfma_f32_32x32x16_bf16 v[160:175], v[84:87], a[108:111], v[160:175]
    ds_read_b64_tr_b16 v[72:73], v12 offset:57344
    ds_read_b64_tr_b16 v[74:75], v12 offset:57856
    v_mfma_f32_32x32x16_bf16 v[176:191], v[84:87], a[236:239], v[176:191]
    ds_read_b64_tr_b16 v[76:77], v13 offset:57344
    ds_read_b64_tr_b16 v[78:79], v13 offset:57856
    v_mfma_f32_32x32x16_bf16 v[192:207], v[88:91], a[108:111], v[192:207]
    v_mfma_f32_32x32x16_bf16 v[208:223], v[88:91], a[236:239], v[208:223]
    v_mfma_f32_32x32x16_bf16 v[224:239], v[92:95], a[108:111], v[224:239]
    v_mfma_f32_32x32x16_bf16 v[240:255], v[92:95], a[236:239], v[240:255]
    s_waitcnt lgkmcnt(0)
    v_mfma_f32_32x32x16_bf16 v[128:143], v[64:67], a[112:115], v[128:143]
    ds_read_b64_tr_b16 v[80:81], v12 offset:51200
    ds_read_b64_tr_b16 v[82:83], v12 offset:51712
    v_mfma_f32_32x32x16_bf16 v[144:159], v[64:67], a[240:243], v[144:159]
    ds_read_b64_tr_b16 v[84:85], v13 offset:51200
    ds_read_b64_tr_b16 v[86:87], v13 offset:51712
    v_mfma_f32_32x32x16_bf16 v[160:175], v[68:71], a[112:115], v[160:175]
    ds_read_b64_tr_b16 v[88:89], v12 offset:59392
    ds_read_b64_tr_b16 v[90:91], v12 offset:59904
    v_mfma_f32_32x32x16_bf16 v[176:191], v[68:71], a[240:243], v[176:191]
    ds_read_b64_tr_b16 v[92:93], v13 offset:59392
    ds_read_b64_tr_b16 v[94:95], v13 offset:59904
    v_mfma_f32_32x32x16_bf16 v[192:207], v[72:75], a[112:115], v[192:207]
    s_lshl_b32 s46, s4, 11
    s_add_u32 m0, s46, 81920
    s_nop 0
    buffer_load_dwordx4 v3, s[16:19], s53 offen lds
    s_lshl_b32 s46, s4, 11
    s_add_u32 m0, s46, 82944
    s_add_u32 s47, s53, s45
    buffer_load_dwordx4 v3, s[16:19], s47 offen lds
    s_lshl_b32 s46, s4, 11
    s_add_u32 m0, s46, 90112
    s_nop 0
    buffer_load_dwordx4 v3, s[20:23], s53 offen lds
    s_lshl_b32 s46, s4, 11
    s_add_u32 m0, s46, 91136
    s_add_u32 s47, s53, s45
    buffer_load_dwordx4 v3, s[20:23], s47 offen lds
    s_lshl_b32 s46, s45, 3
    s_add_u32 s53, s53, s46
    v_mfma_f32_32x32x16_bf16 v[208:223], v[72:75], a[240:243], v[208:223]
    v_mfma_f32_32x32x16_bf16 v[224:239], v[76:79], a[112:115], v[224:239]
    v_mfma_f32_32x32x16_bf16 v[240:255], v[76:79], a[240:243], v[240:255]
    s_waitcnt lgkmcnt(0)
    v_mfma_f32_32x32x16_bf16 v[128:143], v[80:83], a[116:119], v[128:143]
    ds_read_b64_tr_b16 v[64:65], v12 offset:53248
    ds_read_b64_tr_b16 v[66:67], v12 offset:53760
    v_mfma_f32_32x32x16_bf16 v[144:159], v[80:83], a[244:247], v[144:159]
    ds_read_b64_tr_b16 v[68:69], v13 offset:53248
    ds_read_b64_tr_b16 v[70:71], v13 offset:53760
    v_mfma_f32_32x32x16_bf16 v[160:175], v[84:87], a[116:119], v[160:175]
    ds_read_b64_tr_b16 v[72:73], v12 offset:61440
    ds_read_b64_tr_b16 v[74:75], v12 offset:61952
    v_mfma_f32_32x32x16_bf16 v[176:191], v[84:87], a[244:247], v[176:191]
    ds_read_b64_tr_b16 v[76:77], v13 offset:61440
    ds_read_b64_tr_b16 v[78:79], v13 offset:61952
    v_mfma_f32_32x32x16_bf16 v[192:207], v[88:91], a[116:119], v[192:207]
    v_mfma_f32_32x32x16_bf16 v[208:223], v[88:91], a[244:247], v[208:223]
    v_mfma_f32_32x32x16_bf16 v[224:239], v[92:95], a[116:119], v[224:239]
    v_mfma_f32_32x32x16_bf16 v[240:255], v[92:95], a[244:247], v[240:255]
    s_waitcnt lgkmcnt(0)
    v_mfma_f32_32x32x16_bf16 v[128:143], v[64:67], a[120:123], v[128:143]
    ds_read_b64_tr_b16 v[80:81], v12 offset:55296
    ds_read_b64_tr_b16 v[82:83], v12 offset:55808
    v_mfma_f32_32x32x16_bf16 v[144:159], v[64:67], a[248:251], v[144:159]
    ds_read_b64_tr_b16 v[84:85], v13 offset:55296
    ds_read_b64_tr_b16 v[86:87], v13 offset:55808
    v_mfma_f32_32x32x16_bf16 v[160:175], v[68:71], a[120:123], v[160:175]
    ds_read_b64_tr_b16 v[88:89], v12 offset:63488
    ds_read_b64_tr_b16 v[90:91], v12 offset:64000
    v_mfma_f32_32x32x16_bf16 v[176:191], v[68:71], a[248:251], v[176:191]
    ds_read_b64_tr_b16 v[92:93], v13 offset:63488
    ds_read_b64_tr_b16 v[94:95], v13 offset:64000
    v_mfma_f32_32x32x16_bf16 v[192:207], v[72:75], a[120:123], v[192:207]
    v_mfma_f32_32x32x16_bf16 v[208:223], v[72:75], a[248:251], v[208:223]
    v_mfma_f32_32x32x16_bf16 v[224:239], v[76:79], a[120:123], v[224:239]
    v_mfma_f32_32x32x16_bf16 v[240:255], v[76:79], a[248:251], v[240:255]
    s_waitcnt lgkmcnt(0)
    v_mfma_f32_32x32x16_bf16 v[128:143], v[80:83], a[124:127], v[128:143]
    v_mfma_f32_32x32x16_bf16 v[144:159], v[80:83], a[252:255], v[144:159]
    v_mfma_f32_32x32x16_bf16 v[160:175], v[84:87], a[124:127], v[160:175]
    v_mfma_f32_32x32x16_bf16 v[176:191], v[84:87], a[252:255], v[176:191]
    v_mfma_f32_32x32x16_bf16 v[192:207], v[88:91], a[124:127], v[192:207]
    v_mfma_f32_32x32x16_bf16 v[208:223], v[88:91], a[252:255], v[208:223]
    v_mfma_f32_32x32x16_bf16 v[224:239], v[92:95], a[124:127], v[224:239]
    v_mfma_f32_32x32x16_bf16 v[240:255], v[92:95], a[252:255], v[240:255]
    s_branch L_g1w_next
L_g1w_v:
    s_waitcnt vmcnt(36)
    s_barrier
    ds_read_b64_tr_b16 v[64:65], v4 offset:0
    ds_read_b64_tr_b16 v[66:67], v4 offset:512
    ds_read_b64_tr_b16 v[68:69], v5 offset:0
    ds_read_b64_tr_b16 v[70:71], v5 offset:512
    ds_read_b64_tr_b16 v[72:73], v4 offset:8192
    ds_read_b64_tr_b16 v[74:75], v4 offset:8704
    ds_read_b64_tr_b16 v[76:77], v5 offset:8192
    ds_read_b64_tr_b16 v[78:79], v5 offset:8704
    s_waitcnt lgkmcnt(0)
    v_mfma_f32_32x32x16_bf16 v[128:143], a[0:3], v[64:67], 0
    ds_read_b64_tr_b16 v[80:81], v4 offset:2048
    ds_read_b64_tr_b16 v[82:83], v4 offset:2560
    v_mfma_f32_32x32x16_bf16 v[144:159], a[128:131], v[64:67], 0
    ds_read_b64_tr_b16 v[84:85], v5 offset:2048
    ds_read_b64_tr_b16 v[86:87], v5 offset:2560
    v_mfma_f32_32x32x16_bf16 v[160:175], a[0:3], v[68:71], 0
    ds_read_b64_tr_b16 v[88:89], v4 offset:10240
    ds_read_b64_tr_b16 v[90:91], v4 offset:10752
    v_mfma_f32_32x32x16_bf16 v[176:191], a[128:131], v[68:71], 0
    ds_read_b64_tr_b16 v[92:93], v5 offset:10240
    ds_read_b64_tr_b16 v[94:95], v5 offset:10752
    v_mfma_f32_32x32x16_bf16 v[192:207], a[0:3], v[72:75], 0
    s_lshl_b32 s46, s4, 11
    s_add_u32 m0, s46, 98304
    s_nop 0
    buffer_load_dwordx4 v3, s[16:19], s53 offen lds
    s_lshl_b32 s46, s4, 11
    s_add_u32 m0, s46, 99328
    s_add_u32 s47, s53, s45
    buffer_load_dwordx4 v3, s[16:19], s47 offen lds
    s_lshl_b32 s46, s4, 11
    s_add_u32 m0, s46, 106496
    s_nop 0
    buffer_load_dwordx4 v3, s[20:23], s53 offen lds
    s_lshl_b32 s46, s4, 11
    s_add_u32 m0, s46, 107520
    s_add_u32 s47, s53, s45
    buffer_load_dwordx4 v3, s[20:23], s47 offen lds
    s_lshl_b32 s46, s45, 3
    s_add_u32 s53, s53, s46
    v_mfma_f32_32x32x16_bf16 v[208:223], a[128:131], v[72:75], 0
    v_mfma_f32_32x32x16_bf16 v[224:239], a[0:3], v[76:79], 0
    v_mfma_f32_32x32x16_bf16 v[240:255], a[128:131], v[76:79], 0
    s_waitcnt lgkmcnt(0)
    v_mfma_f32_32x32x16_bf16 v[128:143], a[4:7], v[80:83], v[128:143]
    ds_read_b64_tr_b16 v[64:65], v4 offset:4096
    ds_read_b64_tr_b16 v[66:67], v4 offset:4608
    v_mfma_f32_32x32x16_bf16 v[144:159], a[132:135], v[80:83], v[144:159]
    ds_read_b64_tr_b16 v[68:69], v5 offset:4096
    ds_read_b64_tr_b16 v[70:71], v5 offset:4608
    v_mfma_f32_32x32x16_bf16 v[160:175], a[4:7], v[84:87], v[160:175]
    ds_read_b64_tr_b16 v[72:73], v4 offset:12288
    ds_read_b64_tr_b16 v[74:75], v4 offset:12800
    v_mfma_f32_32x32x16_bf16 v[176:191], a[132:135], v[84:87], v[176:191]
    ds_read_b64_tr_b16 v[76:77], v5 offset:12288
    ds_read_b64_tr_b16 v[78:79], v5 offset:12800
    v_mfma_f32_32x32x16_bf16 v[192:207], a[4:7], v[88:91], v[192:207]
    v_mfma_f32_32x32x16_bf16 v[208:223], a[132:135], v[88:91], v[208:223]
    v_mfma_f32_32x32x16_bf16 v[224:239], a[4:7], v[92:95], v[224:239]
    v_mfma_f32_32x32x16_bf16 v[240:255], a[132:135], v[92:95], v[240:255]
    s_waitcnt lgkmcnt(0)
    v_mfma_f32_32x32x16_bf16 v[128:143], a[8:11], v[64:67], v[128:143]
    ds_read_b64_tr_b16 v[80:81], v4 offset:6144
    ds_read_b64_tr_b16 v[82:83], v4 offset:6656
    v_mfma_f32_32x32x16_bf16 v[144:159], a[136:139], v[64:67], v[144:159]
    ds_read_b64_tr_b16 v[84:85], v5 offset:6144
    ds_read_b64_tr_b16 v[86:87], v5 offset:6656
    v_mfma_f32_32x32x16_bf16 v[160:175], a[8:11], v[68:71], v[160:175]
    ds_read_b64_tr_b16 v[88:89], v4 offset:14336
    ds_read_b64_tr_b16 v[90:91], v4 offset:14848
    v_mfma_f32_32x32x16_bf16 v[176:191], a[136:139], v[68:71], v[176:191]
    ds_read_b64_tr_b16 v[92:93], v5 offset:14336
    ds_read_b64_tr_b16 v[94:95], v5 offset:14848
    v_mfma_f32_32x32x16_bf16 v[192:207], a[8:11], v[72:75], v[192:207]
    v_mfma_f32_32x32x16_bf16 v[208:223], a[136:139], v[72:75], v[208:223]
    v_mfma_f32_32x32x16_bf16 v[224:239], a[8:11], v[76:79], v[224:239]
    v_mfma_f32_32x32x16_bf16 v[240:255], a[136:139], v[76:79], v[240:255]
    s_waitcnt lgkmcnt(0)
    s_waitcnt vmcnt(36)
    s_barrier
    v_mfma_f32_32x32x16_bf16 v[128:143], a[12:15], v[80:83], v[128:143]
    ds_read_b64_tr_b16 v[64:65], v4 offset:16384
    ds_read_b64_tr_b16 v[66:67], v4 offset:16896
    v_mfma_f32_32x32x16_bf16 v[144:159], a[140:143], v[80:83], v[144:159]
    ds_read_b64_tr_b16 v[68:69], v5 offset:16384
    ds_read_b64_tr_b16 v[70:71], v5 offset:16896
    v_mfma_f32_32x32x16_bf16 v[160:175], a[12:15], v[84:87], v[160:175]
    ds_read_b64_tr_b16 v[72:73], v4 offset:24576
    ds_read_b64_tr_b16 v[74:75], v4 offset:25088
    v_mfma_f32_32x32x16_bf16 v[176:191], a[140:143], v[84:87], v[176:191]
    ds_read_b64_tr_b16 v[76:77], v5 offset:24576
    ds_read_b64_tr_b16 v[78:79], v5 offset:25088
    v_mfma_f32_32x32x16_bf16 v[192:207], a[12:15], v[88:91], v[192:207]
    v_mfma_f32_32x32x16_bf16 v[208:223], a[140:143], v[88:91], v[208:223]
    v_mfma_f32_32x32x16_bf16 v[224:239], a[12:15], v[92:95], v[224:239]
    v_mfma_f32_32x32x16_bf16 v[240:255], a[140:143], v[92:95], v[240:255]
    s_waitcnt lgkmcnt(0)
    v_mfma_f32_32x32x16_bf16 v[128:143], a[16:19], v[64:67], v[128:143]
    ds_read_b64_tr_b16 v[80:81], v4 offset:18432
    ds_read_b64_tr_b16 v[82:83], v4 offset:18944
    v_mfma_f32_32x32x16_bf16 v[144:159], a[144:147], v[64:67], v[144:159]
    ds_read_b64_tr_b16 v[84:85], v5 offset:18432
    ds_read_b64_tr_b16 v[86:87], v5 offset:18944
    v_mfma_f32_32x32x16_bf16 v[160:175], a[16:19], v[68:71], v[160:175]
    ds_read_b64_tr_b16 v[88:89], v4 offset:26624
    ds_read_b64_tr_b16 v[90:91], v4 offset:27136
    v_mfma_f32_32x32x16_bf16 v[176:191], a[144:147], v[68:71], v[176:191]
    ds_read_b64_tr_b16 v[92:93], v5 offset:26624
    ds_read_b64_tr_b16 v[94:95], v5 offset:27136
    v_mfma_f32_32x32x16_bf16 v[192:207], a[16:19], v[72:75], v[192:207]
    s_lshl_b32 s46, s4, 11
    s_add_u32 m0, s46, 114688
    s_nop 0
    buffer_load_dwordx4 v3, s[16:19], s53 offen lds
    s_lshl_b32 s46, s4, 11
    s_add_u32 m0, s46, 115712
    s_add_u32 s47, s53, s45
    buffer_load_dwordx4 v3, s[16:19], s47 offen lds
    s_lshl_b32 s46, s4, 11
    s_add_u32 m0, s46, 122880
    s_nop 0
    buffer_load_dwordx4 v3, s[20:23], s53 offen lds
    s_lshl_b32 s46, s4, 11
    s_add_u32 m0, s46, 123904
    s_add_u32 s47, s53, s45
    buffer_load_dwordx4 v3, s[20:23], s47 offen lds
    s_lshl_b32 s46, s45, 3
    s_add_u32 s53, s53, s46
    v_mfma_f32_32x32x16_bf16 v[208:223], a[144:147], v[72:75], v[208:223]
    v_mfma_f32_32x32x16_bf16 v[224:239], a[16:19], v[76:79], v[224:239]
    v_mfma_f32_32x32x16_bf16 v[240:255], a[144:147], v[76:79], v[240:255]
    s_waitcnt lgkmcnt(0)
    v_mfma_f32_32x32x16_bf16 v[128:143], a[20:23], v[80:83], v[128:143]
    ds_read_b64_tr_b16 v[64:65], v4 offset:20480
    ds_read_b64_tr_b16 v[66:67], v4 offset:20992
    v_mfma_f32_32x32x16_bf16 v[144:159], a[148:151], v[80:83], v[144:159]
    ds_read_b64_tr_b16 v[68:69], v5 offset:20480
    ds_read_b64_tr_b16 v[70:71], v5 offset:20992
    v_mfma_f32_32x32x16_bf16 v[160:175], a[20:23], v[84:87], v[160:175]
    ds_read_b64_tr_b16 v[72:73], v4 offset:28672
    ds_read_b64_tr_b16 v[74:75], v4 offset:29184
    v_mfma_f32_32x32x16_bf16 v[176:191], a[148:151], v[84:87], v[176:191]
    ds_read_b64_tr_b16 v[76:77], v5 offset:28672
    ds_read_b64_tr_b16 v[78:79], v5 offset:29184
    v_mfma_f32_32x32x16_bf16 v[192:207], a[20:23], v[88:91], v[192:207]
    v_mfma_f32_32x32x16_bf16 v[208:223], a[148:151], v[88:91], v[208:223]
    v_mfma_f32_32x32x16_bf16 v[224:239], a[20:23], v[92:95], v[224:239]
    v_mfma_f32_32x32x16_bf16 v[240:255], a[148:151], v[92:95], v[240:255]
    s_waitcnt lgkmcnt(0)
    v_mfma_f32_32x32x16_bf16 v[128:143], a[24:27], v[64:67], v[128:143]
    ds_read_b64_tr_b16 v[80:81], v4 offset:22528
    ds_read_b64_tr_b16 v[82:83], v4 offset:23040
    v_mfma_f32_32x32x16_bf16 v[144:159], a[152:155], v[64:67], v[144:159]
    ds_read_b64_tr_b16 v[84:85], v5 offset:22528
    ds_read_b64_tr_b16 v[86:87], v5 offset:23040
    v_mfma_f32_32x32x16_bf16 v[160:175], a[24:27], v[68:71], v[160:175]
    ds_read_b64_tr_b16 v[88:89], v4 offset:30720
    ds_read_b64_tr_b16 v[90:91], v4 offset:31232
    v_mfma_f32_32x32x16_bf16 v[176:191], a[152:155], v[68:71], v[176:191]
    ds_read_b64_tr_b16 v[92:93], v5 offset:30720
    ds_read_b64_tr_b16 v[94:95], v5 offset:31232
    v_mfma_f32_32x32x16_bf16 v[192:207], a[24:27], v[72:75], v[192:207]
    v_mfma_f32_32x32x16_bf16 v[208:223], a[152:155], v[72:75], v[208:223]
    v_mfma_f32_32x32x16_bf16 v[224:239], a[24:27], v[76:79], v[224:239]
    v_mfma_f32_32x32x16_bf16 v[240:255], a[152:155], v[76:79], v[240:255]
    s_waitcnt lgkmcnt(0)
    s_waitcnt vmcnt(36)
    s_barrier
    v_mfma_f32_32x32x16_bf16 v[128:143], a[28:31], v[80:83], v[128:143]
    ds_read_b64_tr_b16 v[64:65], v4 offset:32768
    ds_read_b64_tr_b16 v[66:67], v4 offset:33280
    v_mfma_f32_32x32x16_bf16 v[144:159], a[156:159], v[80:83], v[144:159]
    ds_read_b64_tr_b16 v[68:69], v5 offset:32768
    ds_read_b64_tr_b16 v[70:71], v5 offset:33280
    v_mfma_f32_32x32x16_bf16 v[160:175], a[28:31], v[84:87], v[160:175]
    ds_read_b64_tr_b16 v[72:73], v4 offset:40960
    ds_read_b64_tr_b16 v[74:75], v4 offset:41472
    v_mfma_f32_32x32x16_bf16 v[176:191], a[156:159], v[84:87], v[176:191]
    ds_read_b64_tr_b16 v[76:77], v5 offset:40960
    ds_read_b64_tr_b16 v[78:79], v5 offset:41472
    v_mfma_f32_32x32x16_bf16 v[192:207], a[28:31], v[88:91], v[192:207]
    v_mfma_f32_32x32x16_bf16 v[208:223], a[156:159], v[88:91], v[208:223]
    v_mfma_f32_32x32x16_bf16 v[224:239], a[28:31], v[92:95], v[224:239]
    v_mfma_f32_32x32x16_bf16 v[240:255], a[156:159], v[92:95], v[240:255]
    s_waitcnt lgkmcnt(0)
    v_mfma_f32_32x32x16_bf16 v[128:143], a[32:35], v[64:67], v[128:143]
    ds_read_b64_tr_b16 v[80:81], v4 offset:34816
    ds_read_b64_tr_b16 v[82:83], v4 offset:35328
    v_mfma_f32_32x32x16_bf16 v[144:159], a[160:163], v[64:67], v[144:159]
    ds_read_b64_tr_b16 v[84:85], v5 offset:34816
    ds_read_b64_tr_b16 v[86:87], v5 offset:35328
    v_mfma_f32_32x32x16_bf16 v[160:175], a[32:35], v[68:71], v[160:175]
    ds_read_b64_tr_b16 v[88:89], v4 offset:43008
    ds_read_b64_tr_b16 v[90:91], v4 offset:43520
    v_mfma_f32_32x32x16_bf16 v[176:191], a[160:163], v[68:71], v[176:191]
    ds_read_b64_tr_b16 v[92:93], v5 offset:43008
    ds_read_b64_tr_b16 v[94:95], v5 offset:43520
    v_mfma_f32_32x32x16_bf16 v[192:207], a[32:35], v[72:75], v[192:207]
    s_cmp_ge_u32 s77, 124
    s_cselect_b32 s67, s6, s77
    s_cmp_eq_u32 s73, 0
    s_cselect_b32 s67, s6, s67
    s_lshr_b32 s46, s67, 5
    s_and_b32 s47, s67, 31
    s_mov_b32 s51, s46
    s_cmp_eq_u32 s46, 3
    s_cbranch_scc1 L_decF_u13274
    s_lshl_b32 s44, s47, 8
    s_mov_b32 s45, 65536
    v_mov_b32 v3, v1
    s_cmp_eq_u32 s46, 0
    s_cselect_b32 s16, s28, s32
    s_cselect_b32 s17, s29, s33
    s_mov_b32 s48, 33554432
    s_cselect_b32 s48, 16777216, s48
    s_cmp_eq_u32 s46, 2
    s_cselect_b32 s16, s24, s16
    s_cselect_b32 s17, s25, s17
    s_cselect_b32 s48, 50331648, s48
    s_mov_b32 s18, 0x400000
    s_mov_b32 s19, 0x20000
    s_add_u32 s20, s16, 128
    s_addc_u32 s21, s17, 0
    s_mov_b32 s22, 4194176
    s_mov_b32 s23, 0x20000
    s_lshl_b32 s52, s5, 3
    s_lshl_b32 s46, s4, 1
    s_add_u32 s52, s52, s46
    s_lshl_b32 s52, s52, 5
    s_add_u32 s52, s52, s47
    s_lshl_b32 s52, s52, 13
    s_add_u32 s52, s52, s48
    s_branch L_decD_u13274
L_decF_u13274:
    s_lshl_b32 s44, s47, 7
    s_mov_b32 s45, 28672
    v_mov_b32 v3, v2
    s_mov_b32 s16, s36
    s_mov_b32 s17, s37
    s_mov_b32 s18, 1835008
    s_mov_b32 s19, 0x20000
    s_mov_b32 s20, s40
    s_mov_b32 s21, s41
    s_mov_b32 s22, 1835008
    s_mov_b32 s23, 0x20000
    s_lshl_b32 s52, s5, 3
    s_lshl_b32 s46, s4, 1
    s_add_u32 s52, s52, s46
    s_mul_i32 s52, s52, 114688
    s_lshl_b32 s47, s47, 12
    s_add_u32 s52, s52, s47
    s_add_u32 s52, s52, 109051904
L_decD_u13274:
    s_mul_i32 s53, s45, s4
    s_lshl_b32 s53, s53, 1
    s_add_u32 s53, s53, s44
    s_lshl_b32 s46, s4, 11
    s_add_u32 m0, s46, 0
    s_nop 0
    buffer_load_dwordx4 v3, s[16:19], s53 offen lds
    s_lshl_b32 s46, s4, 11
    s_add_u32 m0, s46, 1024
    s_add_u32 s47, s53, s45
    buffer_load_dwordx4 v3, s[16:19], s47 offen lds
    s_lshl_b32 s46, s4, 11
    s_add_u32 m0, s46, 8192
    s_nop 0
    buffer_load_dwordx4 v3, s[20:23], s53 offen lds
    s_lshl_b32 s46, s4, 11
    s_add_u32 m0, s46, 9216
    s_add_u32 s47, s53, s45
    buffer_load_dwordx4 v3, s[20:23], s47 offen lds
    s_lshl_b32 s46, s45, 3
    s_add_u32 s53, s53, s46
    v_mfma_f32_32x32x16_bf16 v[208:223], a[160:163], v[72:75], v[208:223]
    v_mfma_f32_32x32x16_bf16 v[224:239], a[32:35], v[76:79], v[224:239]
    v_mfma_f32_32x32x16_bf16 v[240:255], a[160:163], v[76:79], v[240:255]
    s_waitcnt lgkmcnt(0)
    v_mfma_f32_32x32x16_bf16 v[128:143], a[36:39], v[80:83], v[128:143]
    ds_read_b64_tr_b16 v[64:65], v4 offset:36864
    ds_read_b64_tr_b16 v[66:67], v4 offset:37376
    v_mfma_f32_32x32x16_bf16 v[144:159], a[164:167], v[80:83], v[144:159]
    ds_read_b64_tr_b16 v[68:69], v5 offset:36864
    ds_read_b64_tr_b16 v[70:71], v5 offset:37376
    v_mfma_f32_32x32x16_bf16 v[160:175], a[36:39], v[84:87], v[160:175]
    ds_read_b64_tr_b16 v[72:73], v4 offset:45056
    ds_read_b64_tr_b16 v[74:75], v4 offset:45568
    v_mfma_f32_32x32x16_bf16 v[176:191], a[164:167], v[84:87], v[176:191]
    ds_read_b64_tr_b16 v[76:77], v5 offset:45056
    ds_read_b64_tr_b16 v[78:79], v5 offset:45568
    v_mfma_f32_32x32x16_bf16 v[192:207], a[36:39], v[88:91], v[192:207]
    v_mfma_f32_32x32x16_bf16 v[208:223], a[164:167], v[88:91], v[208:223]
    v_mfma_f32_32x32x16_bf16 v[224:239], a[36:39], v[92:95], v[224:239]
    v_mfma_f32_32x32x16_bf16 v[240:255], a[164:167], v[92:95], v[240:255]
    s_waitcnt lgkmcnt(0)
    v_mfma_f32_32x32x16_bf16 v[128:143], a[40:43], v[64:67], v[128:143]
    ds_read_b64_tr_b16 v[80:81], v4 offset:38912
    ds_read_b64_tr_b16 v[82:83], v4 offset:39424
    v_mfma_f32_32x32x16_bf16 v[144:159], a[168:171], v[64:67], v[144:159]
    ds_read_b64_tr_b16 v[84:85], v5 offset:38912
    ds_read_b64_tr_b16 v[86:87], v5 offset:39424
    v_mfma_f32_32x32x16_bf16 v[160:175], a[40:43], v[68:71], v[160:175]
    ds_read_b64_tr_b16 v[88:89], v4 offset:47104
    ds_read_b64_tr_b16 v[90:91], v4 offset:47616
    v_mfma_f32_32x32x16_bf16 v[176:191], a[168:171], v[68:71], v[176:191]
    ds_read_b64_tr_b16 v[92:93], v5 offset:47104
    ds_read_b64_tr_b16 v[94:95], v5 offset:47616
    v_mfma_f32_32x32x16_bf16 v[192:207], a[40:43], v[72:75], v[192:207]
    v_mfma_f32_32x32x16_bf16 v[208:223], a[168:171], v[72:75], v[208:223]
    v_mfma_f32_32x32x16_bf16 v[224:239], a[40:43], v[76:79], v[224:239]
    v_mfma_f32_32x32x16_bf16 v[240:255], a[168:171], v[76:79], v[240:255]
    s_waitcnt lgkmcnt(0)
    s_waitcnt vmcnt(36)
    s_barrier
    v_mfma_f32_32x32x16_bf16 v[128:143], a[44:47], v[80:83], v[128:143]
    ds_read_b64_tr_b16 v[64:65], v4 offset:49152
    ds_read_b64_tr_b16 v[66:67], v4 offset:49664
    v_mfma_f32_32x32x16_bf16 v[144:159], a[172:175], v[80:83], v[144:159]
    ds_read_b64_tr_b16 v[68:69], v5 offset:49152
    ds_read_b64_tr_b16 v[70:71], v5 offset:49664
    v_mfma_f32_32x32x16_bf16 v[160:175], a[44:47], v[84:87], v[160:175]
    ds_read_b64_tr_b16 v[72:73], v4 offset:57344
    ds_read_b64_tr_b16 v[74:75], v4 offset:57856
    v_mfma_f32_32x32x16_bf16 v[176:191], a[172:175], v[84:87], v[176:191]
    ds_read_b64_tr_b16 v[76:77], v5 offset:57344
    ds_read_b64_tr_b16 v[78:79], v5 offset:57856
    v_mfma_f32_32x32x16_bf16 v[192:207], a[44:47], v[88:91], v[192:207]
    v_mfma_f32_32x32x16_bf16 v[208:223], a[172:175], v[88:91], v[208:223]
    v_mfma_f32_32x32x16_bf16 v[224:239], a[44:47], v[92:95], v[224:239]
    v_mfma_f32_32x32x16_bf16 v[240:255], a[172:175], v[92:95], v[240:255]
    s_waitcnt lgkmcnt(0)
    v_mfma_f32_32x32x16_bf16 v[128:143], a[48:51], v[64:67], v[128:143]
    ds_read_b64_tr_b16 v[80:81], v4 offset:51200
    ds_read_b64_tr_b16 v[82:83], v4 offset:51712
    v_mfma_f32_32x32x16_bf16 v[144:159], a[176:179], v[64:67], v[144:159]
    ds_read_b64_tr_b16 v[84:85], v5 offset:51200
    ds_read_b64_tr_b16 v[86:87], v5 offset:51712
    v_mfma_f32_32x32x16_bf16 v[160:175], a[48:51], v[68:71], v[160:175]
    ds_read_b64_tr_b16 v[88:89], v4 offset:59392
    ds_read_b64_tr_b16 v[90:91], v4 offset:59904
    v_mfma_f32_32x32x16_bf16 v[176:191], a[176:179], v[68:71], v[176:191]
    ds_read_b64_tr_b16 v[92:93], v5 offset:59392
    ds_read_b64_tr_b16 v[94:95], v5 offset:59904
    v_mfma_f32_32x32x16_bf16 v[192:207], a[48:51], v[72:75], v[192:207]
    s_lshl_b32 s46, s4, 11
    s_add_u32 m0, s46, 16384
    s_nop 0
    buffer_load_dwordx4 v3, s[16:19], s53 offen lds
    s_lshl_b32 s46, s4, 11
    s_add_u32 m0, s46, 17408
    s_add_u32 s47, s53, s45
    buffer_load_dwordx4 v3, s[16:19], s47 offen lds
    s_lshl_b32 s46, s4, 11
    s_add_u32 m0, s46, 24576
    s_nop 0
    buffer_load_dwordx4 v3, s[20:23], s53 offen lds
    s_lshl_b32 s46, s4, 11
    s_add_u32 m0, s46, 25600
    s_add_u32 s47, s53, s45
    buffer_load_dwordx4 v3, s[20:23], s47 offen lds
    s_lshl_b32 s46, s45, 3
    s_add_u32 s53, s53, s46
    v_mfma_f32_32x32x16_bf16 v[208:223], a[176:179], v[72:75], v[208:223]
    v_mfma_f32_32x32x16_bf16 v[224:239], a[48:51], v[76:79], v[224:239]
    v_mfma_f32_32x32x16_bf16 v[240:255], a[176:179], v[76:79], v[240:255]
    s_waitcnt lgkmcnt(0)
    v_mfma_f32_32x32x16_bf16 v[128:143], a[52:55], v[80:83], v[128:143]
    ds_read_b64_tr_b16 v[64:65], v4 offset:53248
    ds_read_b64_tr_b16 v[66:67], v4 offset:53760
    v_mfma_f32_32x32x16_bf16 v[144:159], a[180:183], v[80:83], v[144:159]
    ds_read_b64_tr_b16 v[68:69], v5 offset:53248
    ds_read_b64_tr_b16 v[70:71], v5 offset:53760
    v_mfma_f32_32x32x16_bf16 v[160:175], a[52:55], v[84:87], v[160:175]
    ds_read_b64_tr_b16 v[72:73], v4 offset:61440
    ds_read_b64_tr_b16 v[74:75], v4 offset:61952
    v_mfma_f32_32x32x16_bf16 v[176:191], a[180:183], v[84:87], v[176:191]
    ds_read_b64_tr_b16 v[76:77], v5 offset:61440
    ds_read_b64_tr_b16 v[78:79], v5 offset:61952
    v_mfma_f32_32x32x16_bf16 v[192:207], a[52:55], v[88:91], v[192:207]
    v_mfma_f32_32x32x16_bf16 v[208:223], a[180:183], v[88:91], v[208:223]
    v_mfma_f32_32x32x16_bf16 v[224:239], a[52:55], v[92:95], v[224:239]
    v_mfma_f32_32x32x16_bf16 v[240:255], a[180:183], v[92:95], v[240:255]
    s_waitcnt lgkmcnt(0)
    v_mfma_f32_32x32x16_bf16 v[128:143], a[56:59], v[64:67], v[128:143]
    ds_read_b64_tr_b16 v[80:81], v4 offset:55296
    ds_read_b64_tr_b16 v[82:83], v4 offset:55808
    v_mfma_f32_32x32x16_bf16 v[144:159], a[184:187], v[64:67], v[144:159]
    ds_read_b64_tr_b16 v[84:85], v5 offset:55296
    ds_read_b64_tr_b16 v[86:87], v5 offset:55808
    v_mfma_f32_32x32x16_bf16 v[160:175], a[56:59], v[68:71], v[160:175]
    ds_read_b64_tr_b16 v[88:89], v4 offset:63488
    ds_read_b64_tr_b16 v[90:91], v4 offset:64000
    v_mfma_f32_32x32x16_bf16 v[176:191], a[184:187], v[68:71], v[176:191]
    ds_read_b64_tr_b16 v[92:93], v5 offset:63488
    ds_read_b64_tr_b16 v[94:95], v5 offset:64000
    v_mfma_f32_32x32x16_bf16 v[192:207], a[56:59], v[72:75], v[192:207]
    v_mfma_f32_32x32x16_bf16 v[208:223], a[184:187], v[72:75], v[208:223]
    v_mfma_f32_32x32x16_bf16 v[224:239], a[56:59], v[76:79], v[224:239]
    v_mfma_f32_32x32x16_bf16 v[240:255], a[184:187], v[76:79], v[240:255]
    s_waitcnt lgkmcnt(0)
    s_waitcnt vmcnt(36)
    s_barrier
    v_mfma_f32_32x32x16_bf16 v[128:143], a[60:63], v[80:83], v[128:143]
    ds_read_b64_tr_b16 v[64:65], v12 offset:0
    ds_read_b64_tr_b16 v[66:67], v12 offset:512
    v_mfma_f32_32x32x16_bf16 v[144:159], a[188:191], v[80:83], v[144:159]
    ds_read_b64_tr_b16 v[68:69], v13 offset:0
    ds_read_b64_tr_b16 v[70:71], v13 offset:512
    v_mfma_f32_32x32x16_bf16 v[160:175], a[60:63], v[84:87], v[160:175]
    ds_read_b64_tr_b16 v[72:73], v12 offset:8192
    ds_read_b64_tr_b16 v[74:75], v12 offset:8704
    v_mfma_f32_32x32x16_bf16 v[176:191], a[188:191], v[84:87], v[176:191]
    ds_read_b64_tr_b16 v[76:77], v13 offset:8192
    ds_read_b64_tr_b16 v[78:79], v13 offset:8704
    v_mfma_f32_32x32x16_bf16 v[192:207], a[60:63], v[88:91], v[192:207]
    v_mfma_f32_32x32x16_bf16 v[208:223], a[188:191], v[88:91], v[208:223]
    v_mfma_f32_32x32x16_bf16 v[224:239], a[60:63], v[92:95], v[224:239]
    v_mfma_f32_32x32x16_bf16 v[240:255], a[188:191], v[92:95], v[240:255]
    s_waitcnt lgkmcnt(0)
    v_mfma_f32_32x32x16_bf16 v[128:143], a[64:67], v[64:67], v[128:143]
    ds_read_b64_tr_b16 v[80:81], v12 offset:2048
    ds_read_b64_tr_b16 v[82:83], v12 offset:2560
    v_mfma_f32_32x32x16_bf16 v[144:159], a[192:195], v[64:67], v[144:159]
    ds_read_b64_tr_b16 v[84:85], v13 offset:2048
    ds_read_b64_tr_b16 v[86:87], v13 offset:2560
    v_mfma_f32_32x32x16_bf16 v[160:175], a[64:67], v[68:71], v[160:175]
    ds_read_b64_tr_b16 v[88:89], v12 offset:10240
    ds_read_b64_tr_b16 v[90:91], v12 offset:10752
    v_mfma_f32_32x32x16_bf16 v[176:191], a[192:195], v[68:71], v[176:191]
    ds_read_b64_tr_b16 v[92:93], v13 offset:10240
    ds_read_b64_tr_b16 v[94:95], v13 offset:10752
    v_mfma_f32_32x32x16_bf16 v[192:207], a[64:67], v[72:75], v[192:207]
    s_lshl_b32 s46, s4, 11
    s_add_u32 m0, s46, 32768
    s_nop 0
    buffer_load_dwordx4 v3, s[16:19], s53 offen lds
    s_lshl_b32 s46, s4, 11
    s_add_u32 m0, s46, 33792
    s_add_u32 s47, s53, s45
    buffer_load_dwordx4 v3, s[16:19], s47 offen lds
    s_lshl_b32 s46, s4, 11
    s_add_u32 m0, s46, 40960
    s_nop 0
    buffer_load_dwordx4 v3, s[20:23], s53 offen lds
    s_lshl_b32 s46, s4, 11
    s_add_u32 m0, s46, 41984
    s_add_u32 s47, s53, s45
    buffer_load_dwordx4 v3, s[20:23], s47 offen lds
    s_lshl_b32 s46, s45, 3
    s_add_u32 s53, s53, s46
    v_mfma_f32_32x32x16_bf16 v[208:223], a[192:195], v[72:75], v[208:223]
    v_mfma_f32_32x32x16_bf16 v[224:239], a[64:67], v[76:79], v[224:239]
    v_mfma_f32_32x32x16_bf16 v[240:255], a[192:195], v[76:79], v[240:255]
    s_waitcnt lgkmcnt(0)
    v_mfma_f32_32x32x16_bf16 v[128:143], a[68:71], v[80:83], v[128:143]
    ds_read_b64_tr_b16 v[64:65], v12 offset:4096
    ds_read_b64_tr_b16 v[66:67], v12 offset:4608
    v_mfma_f32_32x32x16_bf16 v[144:159], a[196:199], v[80:83], v[144:159]
    ds_read_b64_tr_b16 v[68:69], v13 offset:4096
    ds_read_b64_tr_b16 v[70:71], v13 offset:4608
    v_mfma_f32_32x32x16_bf16 v[160:175], a[68:71], v[84:87], v[160:175]
    ds_read_b64_tr_b16 v[72:73], v12 offset:12288
    ds_read_b64_tr_b16 v[74:75], v12 offset:12800
    v_mfma_f32_32x32x16_bf16 v[176:191], a[196:199], v[84:87], v[176:191]
    ds_read_b64_tr_b16 v[76:77], v13 offset:12288
    ds_read_b64_tr_b16 v[78:79], v13 offset:12800
    v_mfma_f32_32x32x16_bf16 v[192:207], a[68:71], v[88:91], v[192:207]
    v_mfma_f32_32x32x16_bf16 v[208:223], a[196:199], v[88:91], v[208:223]
    v_mfma_f32_32x32x16_bf16 v[224:239], a[68:71], v[92:95], v[224:239]
    v_mfma_f32_32x32x16_bf16 v[240:255], a[196:199], v[92:95], v[240:255]
    s_waitcnt lgkmcnt(0)
    v_mfma_f32_32x32x16_bf16 v[128:143], a[72:75], v[64:67], v[128:143]
    ds_read_b64_tr_b16 v[80:81], v12 offset:6144
    ds_read_b64_tr_b16 v[82:83], v12 offset:6656
    v_mfma_f32_32x32x16_bf16 v[144:159], a[200:203], v[64:67], v[144:159]
    ds_read_b64_tr_b16 v[84:85], v13 offset:6144
    ds_read_b64_tr_b16 v[86:87], v13 offset:6656
    v_mfma_f32_32x32x16_bf16 v[160:175], a[72:75], v[68:71], v[160:175]
    ds_read_b64_tr_b16 v[88:89], v12 offset:14336
    ds_read_b64_tr_b16 v[90:91], v12 offset:14848
    v_mfma_f32_32x32x16_bf16 v[176:191], a[200:203], v[68:71], v[176:191]
    ds_read_b64_tr_b16 v[92:93], v13 offset:14336
    ds_read_b64_tr_b16 v[94:95], v13 offset:14848
    v_mfma_f32_32x32x16_bf16 v[192:207], a[72:75], v[72:75], v[192:207]
    v_mfma_f32_32x32x16_bf16 v[208:223], a[200:203], v[72:75], v[208:223]
    v_mfma_f32_32x32x16_bf16 v[224:239], a[72:75], v[76:79], v[224:239]
    v_mfma_f32_32x32x16_bf16 v[240:255], a[200:203], v[76:79], v[240:255]
    s_waitcnt lgkmcnt(0)
    s_waitcnt vmcnt(36)
    s_barrier
    v_mfma_f32_32x32x16_bf16 v[128:143], a[76:79], v[80:83], v[128:143]
    ds_read_b64_tr_b16 v[64:65], v12 offset:16384
    ds_read_b64_tr_b16 v[66:67], v12 offset:16896
    v_mfma_f32_32x32x16_bf16 v[144:159], a[204:207], v[80:83], v[144:159]
    ds_read_b64_tr_b16 v[68:69], v13 offset:16384
    ds_read_b64_tr_b16 v[70:71], v13 offset:16896
    v_mfma_f32_32x32x16_bf16 v[160:175], a[76:79], v[84:87], v[160:175]
    ds_read_b64_tr_b16 v[72:73], v12 offset:24576
    ds_read_b64_tr_b16 v[74:75], v12 offset:25088
    v_mfma_f32_32x32x16_bf16 v[176:191], a[204:207], v[84:87], v[176:191]
    ds_read_b64_tr_b16 v[76:77], v13 offset:24576
    ds_read_b64_tr_b16 v[78:79], v13 offset:25088
    v_mfma_f32_32x32x16_bf16 v[192:207], a[76:79], v[88:91], v[192:207]
    v_mfma_f32_32x32x16_bf16 v[208:223], a[204:207], v[88:91], v[208:223]
    v_mfma_f32_32x32x16_bf16 v[224:239], a[76:79], v[92:95], v[224:239]
    v_mfma_f32_32x32x16_bf16 v[240:255], a[204:207], v[92:95], v[240:255]
    s_waitcnt lgkmcnt(0)
    v_mfma_f32_32x32x16_bf16 v[128:143], a[80:83], v[64:67], v[128:143]
    ds_read_b64_tr_b16 v[80:81], v12 offset:18432
    ds_read_b64_tr_b16 v[82:83], v12 offset:18944
    v_mfma_f32_32x32x16_bf16 v[144:159], a[208:211], v[64:67], v[144:159]
    ds_read_b64_tr_b16 v[84:85], v13 offset:18432
    ds_read_b64_tr_b16 v[86:87], v13 offset:18944
    v_mfma_f32_32x32x16_bf16 v[160:175], a[80:83], v[68:71], v[160:175]
    ds_read_b64_tr_b16 v[88:89], v12 offset:26624
    ds_read_b64_tr_b16 v[90:91], v12 offset:27136
    v_mfma_f32_32x32x16_bf16 v[176:191], a[208:211], v[68:71], v[176:191]
    ds_read_b64_tr_b16 v[92:93], v13 offset:26624
    ds_read_b64_tr_b16 v[94:95], v13 offset:27136
    v_mfma_f32_32x32x16_bf16 v[192:207], a[80:83], v[72:75], v[192:207]
    s_lshl_b32 s46, s4, 11
    s_add_u32 m0, s46, 49152
    s_nop 0
    buffer_load_dwordx4 v3, s[16:19], s53 offen lds
    s_lshl_b32 s46, s4, 11
    s_add_u32 m0, s46, 50176
    s_add_u32 s47, s53, s45
    buffer_load_dwordx4 v3, s[16:19], s47 offen lds
    s_lshl_b32 s46, s4, 11
    s_add_u32 m0, s46, 57344
    s_nop 0
    buffer_load_dwordx4 v3, s[20:23], s53 offen lds
    s_lshl_b32 s46, s4, 11
    s_add_u32 m0, s46, 58368
    s_add_u32 s47, s53, s45
    buffer_load_dwordx4 v3, s[20:23], s47 offen lds
    s_lshl_b32 s46, s45, 3
    s_add_u32 s53, s53, s46
    v_mfma_f32_32x32x16_bf16 v[208:223], a[208:211], v[72:75], v[208:223]
    v_mfma_f32_32x32x16_bf16 v[224:239], a[80:83], v[76:79], v[224:239]
    v_mfma_f32_32x32x16_bf16 v[240:255], a[208:211], v[76:79], v[240:255]
    s_waitcnt lgkmcnt(0)
    v_mfma_f32_32x32x16_bf16 v[128:143], a[84:87], v[80:83], v[128:143]
    ds_read_b64_tr_b16 v[64:65], v12 offset:20480
    ds_read_b64_tr_b16 v[66:67], v12 offset:20992
    v_mfma_f32_32x32x16_bf16 v[144:159], a[212:215], v[80:83], v[144:159]
    ds_read_b64_tr_b16 v[68:69], v13 offset:20480
    ds_read_b64_tr_b16 v[70:71], v13 offset:20992
    v_mfma_f32_32x32x16_bf16 v[160:175], a[84:87], v[84:87], v[160:175]
    ds_read_b64_tr_b16 v[72:73], v12 offset:28672
    ds_read_b64_tr_b16 v[74:75], v12 offset:29184
    v_mfma_f32_32x32x16_bf16 v[176:191], a[212:215], v[84:87], v[176:191]
    ds_read_b64_tr_b16 v[76:77], v13 offset:28672
    ds_read_b64_tr_b16 v[78:79], v13 offset:29184
    v_mfma_f32_32x32x16_bf16 v[192:207], a[84:87], v[88:91], v[192:207]
    v_mfma_f32_32x32x16_bf16 v[208:223], a[212:215], v[88:91], v[208:223]
    v_mfma_f32_32x32x16_bf16 v[224:239], a[84:87], v[92:95], v[224:239]
    v_mfma_f32_32x32x16_bf16 v[240:255], a[212:215], v[92:95], v[240:255]
    s_waitcnt lgkmcnt(0)
    v_mfma_f32_32x32x16_bf16 v[128:143], a[88:91], v[64:67], v[128:143]
    ds_read_b64_tr_b16 v[80:81], v12 offset:22528
    ds_read_b64_tr_b16 v[82:83], v12 offset:23040
    v_mfma_f32_32x32x16_bf16 v[144:159], a[216:219], v[64:67], v[144:159]
    ds_read_b64_tr_b16 v[84:85], v13 offset:22528
    ds_read_b64_tr_b16 v[86:87], v13 offset:23040
    v_mfma_f32_32x32x16_bf16 v[160:175], a[88:91], v[68:71], v[160:175]
    ds_read_b64_tr_b16 v[88:89], v12 offset:30720
    ds_read_b64_tr_b16 v[90:91], v12 offset:31232
    v_mfma_f32_32x32x16_bf16 v[176:191], a[216:219], v[68:71], v[176:191]
    ds_read_b64_tr_b16 v[92:93], v13 offset:30720
    ds_read_b64_tr_b16 v[94:95], v13 offset:31232
    v_mfma_f32_32x32x16_bf16 v[192:207], a[88:91], v[72:75], v[192:207]
    v_mfma_f32_32x32x16_bf16 v[208:223], a[216:219], v[72:75], v[208:223]
    v_mfma_f32_32x32x16_bf16 v[224:239], a[88:91], v[76:79], v[224:239]
    v_mfma_f32_32x32x16_bf16 v[240:255], a[216:219], v[76:79], v[240:255]
    s_waitcnt lgkmcnt(0)
    s_waitcnt vmcnt(20)
    s_barrier
    s_cmp_eq_u32 s72, 0
    s_cbranch_scc1 L_mf_13646
    s_cmp_lg_u32 s4, 0
    s_cbranch_scc1 L_mf_13646_c
    s_cmp_lg_u32 s89, 0
    s_cbranch_scc1 L_mf_13646_i
    v_mov_b32 v9, 28
    s_mov_b32 s78, 0
L_mf_13646_w:
    global_load_dword v10, v9, s[68:69] sc1
    s_waitcnt vmcnt(0)
    v_readfirstlane_b32 s89, v10
    s_cmp_lg_u32 s89, 0
    s_cbranch_scc1 L_mf_13646_i
    s_sleep 8
    s_add_u32 s78, s78, 1
    s_cmp_lt_u32 s78, 100000
    s_cbranch_scc1 L_mf_13646_w
L_mf_13646_i:
    s_lshl_b32 s46, s74, 7
    s_add_u32 s46, s46, 262144
    v_mov_b32 v9, 0
    v_mov_b32 v10, s72
    s_mov_b64 exec, 1
    buffer_atomic_add v10, v9, s[8:11], s46 offen sc1
    s_mov_b64 exec, -1
L_mf_13646_c:
    s_mov_b32 s72, 0
L_mf_13646:
    v_mfma_f32_32x32x16_bf16 v[128:143], a[92:95], v[80:83], v[128:143]
    ds_read_b64_tr_b16 v[64:65], v12 offset:32768
    ds_read_b64_tr_b16 v[66:67], v12 offset:33280
    v_mfma_f32_32x32x16_bf16 v[144:159], a[220:223], v[80:83], v[144:159]
    ds_read_b64_tr_b16 v[68:69], v13 offset:32768
    ds_read_b64_tr_b16 v[70:71], v13 offset:33280
    v_mfma_f32_32x32x16_bf16 v[160:175], a[92:95], v[84:87], v[160:175]
    ds_read_b64_tr_b16 v[72:73], v12 offset:40960
    ds_read_b64_tr_b16 v[74:75], v12 offset:41472
    v_mfma_f32_32x32x16_bf16 v[176:191], a[220:223], v[84:87], v[176:191]
    ds_read_b64_tr_b16 v[76:77], v13 offset:40960
    ds_read_b64_tr_b16 v[78:79], v13 offset:41472
    v_mfma_f32_32x32x16_bf16 v[192:207], a[92:95], v[88:91], v[192:207]
    v_mfma_f32_32x32x16_bf16 v[208:223], a[220:223], v[88:91], v[208:223]
    v_mfma_f32_32x32x16_bf16 v[224:239], a[92:95], v[92:95], v[224:239]
    v_mfma_f32_32x32x16_bf16 v[240:255], a[220:223], v[92:95], v[240:255]
    s_waitcnt lgkmcnt(0)
    v_mfma_f32_32x32x16_bf16 v[128:143], a[96:99], v[64:67], v[128:143]
    ds_read_b64_tr_b16 v[80:81], v12 offset:34816
    ds_read_b64_tr_b16 v[82:83], v12 offset:35328
    v_mfma_f32_32x32x16_bf16 v[144:159], a[224:227], v[64:67], v[144:159]
    ds_read_b64_tr_b16 v[84:85], v13 offset:34816
    ds_read_b64_tr_b16 v[86:87], v13 offset:35328
    v_mfma_f32_32x32x16_bf16 v[160:175], a[96:99], v[68:71], v[160:175]
    ds_read_b64_tr_b16 v[88:89], v12 offset:43008
    ds_read_b64_tr_b16 v[90:91], v12 offset:43520
    v_mfma_f32_32x32x16_bf16 v[176:191], a[224:227], v[68:71], v[176:191]
    ds_read_b64_tr_b16 v[92:93], v13 offset:43008
    ds_read_b64_tr_b16 v[94:95], v13 offset:43520
    v_mfma_f32_32x32x16_bf16 v[192:207], a[96:99], v[72:75], v[192:207]
    s_lshl_b32 s46, s4, 11
    s_add_u32 m0, s46, 65536
    s_nop 0
    buffer_load_dwordx4 v3, s[16:19], s53 offen lds
    s_lshl_b32 s46, s4, 11
    s_add_u32 m0, s46, 66560
    s_add_u32 s47, s53, s45
    buffer_load_dwordx4 v3, s[16:19], s47 offen lds
    s_lshl_b32 s46, s4, 11
    s_add_u32 m0, s46, 73728
    s_nop 0
    buffer_load_dwordx4 v3, s[20:23], s53 offen lds
    s_lshl_b32 s46, s4, 11
    s_add_u32 m0, s46, 74752
    s_add_u32 s47, s53, s45
    buffer_load_dwordx4 v3, s[20:23], s47 offen lds
    s_lshl_b32 s46, s45, 3
    s_add_u32 s53, s53, s46
    v_mfma_f32_32x32x16_bf16 v[208:223], a[224:227], v[72:75], v[208:223]
    v_mfma_f32_32x32x16_bf16 v[224:239], a[96:99], v[76:79], v[224:239]
    v_mfma_f32_32x32x16_bf16 v[240:255], a[224:227], v[76:79], v[240:255]
    s_waitcnt lgkmcnt(0)
    v_mfma_f32_32x32x16_bf16 v[128:143], a[100:103], v[80:83], v[128:143]
    ds_read_b64_tr_b16 v[64:65], v12 offset:36864
    ds_read_b64_tr_b16 v[66:67], v12 offset:37376
    v_mfma_f32_32x32x16_bf16 v[144:159], a[228:231], v[80:83], v[144:159]
    ds_read_b64_tr_b16 v[68:69], v13 offset:36864
    ds_read_b64_tr_b16 v[70:71], v13 offset:37376
    v_mfma_f32_32x32x16_bf16 v[160:175], a[100:103], v[84:87], v[160:175]
    ds_read_b64_tr_b16 v[72:73], v12 offset:45056
    ds_read_b64_tr_b16 v[74:75], v12 offset:45568
    v_mfma_f32_32x32x16_bf16 v[176:191], a[228:231], v[84:87], v[176:191]
    ds_read_b64_tr_b16 v[76:77], v13 offset:45056
    ds_read_b64_tr_b16 v[78:79], v13 offset:45568
    v_mfma_f32_32x32x16_bf16 v[192:207], a[100:103], v[88:91], v[192:207]
    v_mfma_f32_32x32x16_bf16 v[208:223], a[228:231], v[88:91], v[208:223]
    v_mfma_f32_32x32x16_bf16 v[224:239], a[100:103], v[92:95], v[224:239]
    v_mfma_f32_32x32x16_bf16 v[240:255], a[228:231], v[92:95], v[240:255]
    s_waitcnt lgkmcnt(0)
    v_mfma_f32_32x32x16_bf16 v[128:143], a[104:107], v[64:67], v[128:143]
    ds_read_b64_tr_b16 v[80:81], v12 offset:38912
    ds_read_b64_tr_b16 v[82:83], v12 offset:39424
    v_mfma_f32_32x32x16_bf16 v[144:159], a[232:235], v[64:67], v[144:159]
    ds_read_b64_tr_b16 v[84:85], v13 offset:38912
    ds_read_b64_tr_b16 v[86:87], v13 offset:39424
    v_mfma_f32_32x32x16_bf16 v[160:175], a[104:107], v[68:71], v[160:175]
    ds_read_b64_tr_b16 v[88:89], v12 offset:47104
    ds_read_b64_tr_b16 v[90:91], v12 offset:47616
    v_mfma_f32_32x32x16_bf16 v[176:191], a[232:235], v[68:71], v[176:191]
    ds_read_b64_tr_b16 v[92:93], v13 offset:47104
    ds_read_b64_tr_b16 v[94:95], v13 offset:47616
    v_mfma_f32_32x32x16_bf16 v[192:207], a[104:107], v[72:75], v[192:207]
    v_mfma_f32_32x32x16_bf16 v[208:223], a[232:235], v[72:75], v[208:223]
    v_mfma_f32_32x32x16_bf16 v[224:239], a[104:107], v[76:79], v[224:239]
    v_mfma_f32_32x32x16_bf16 v[240:255], a[232:235], v[76:79], v[240:255]
    s_waitcnt lgkmcnt(0)
    s_waitcnt vmcnt(20)
    s_barrier
    v_mfma_f32_32x32x16_bf16 v[128:143], a[108:111], v[80:83], v[128:143]
    ds_read_b64_tr_b16 v[64:65], v12 offset:49152
    ds_read_b64_tr_b16 v[66:67], v12 offset:49664
    v_mfma_f32_32x32x16_bf16 v[144:159], a[236:239], v[80:83], v[144:159]
    ds_read_b64_tr_b16 v[68:69], v13 offset:49152
    ds_read_b64_tr_b16 v[70:71], v13 offset:49664
    v_mfma_f32_32x32x16_bf16 v[160:175], a[108:111], v[84:87], v[160:175]
    ds_read_b64_tr_b16 v[72:73], v12 offset:57344
    ds_read_b64_tr_b16 v[74:75], v12 offset:57856
    v_mfma_f32_32x32x16_bf16 v[176:191], a[236:239], v[84:87], v[176:191]
    ds_read_b64_tr_b16 v[76:77], v13 offset:57344
    ds_read_b64_tr_b16 v[78:79], v13 offset:57856
    v_mfma_f32_32x32x16_bf16 v[192:207], a[108:111], v[88:91], v[192:207]
    v_mfma_f32_32x32x16_bf16 v[208:223], a[236:239], v[88:91], v[208:223]
    v_mfma_f32_32x32x16_bf16 v[224:239], a[108:111], v[92:95], v[224:239]
    v_mfma_f32_32x32x16_bf16 v[240:255], a[236:239], v[92:95], v[240:255]
    s_waitcnt lgkmcnt(0)
    v_mfma_f32_32x32x16_bf16 v[128:143], a[112:115], v[64:67], v[128:143]
    ds_read_b64_tr_b16 v[80:81], v12 offset:51200
    ds_read_b64_tr_b16 v[82:83], v12 offset:51712
    v_mfma_f32_32x32x16_bf16 v[144:159], a[240:243], v[64:67], v[144:159]
    ds_read_b64_tr_b16 v[84:85], v13 offset:51200
    ds_read_b64_tr_b16 v[86:87], v13 offset:51712
    v_mfma_f32_32x32x16_bf16 v[160:175], a[112:115], v[68:71], v[160:175]
    ds_read_b64_tr_b16 v[88:89], v12 offset:59392
    ds_read_b64_tr_b16 v[90:91], v12 offset:59904
    v_mfma_f32_32x32x16_bf16 v[176:191], a[240:243], v[68:71], v[176:191]
    ds_read_b64_tr_b16 v[92:93], v13 offset:59392
    ds_read_b64_tr_b16 v[94:95], v13 offset:59904
    v_mfma_f32_32x32x16_bf16 v[192:207], a[112:115], v[72:75], v[192:207]
    s_lshl_b32 s46, s4, 11
    s_add_u32 m0, s46, 81920
    s_nop 0
    buffer_load_dwordx4 v3, s[16:19], s53 offen lds
    s_lshl_b32 s46, s4, 11
    s_add_u32 m0, s46, 82944
    s_add_u32 s47, s53, s45
    buffer_load_dwordx4 v3, s[16:19], s47 offen lds
    s_lshl_b32 s46, s4, 11
    s_add_u32 m0, s46, 90112
    s_nop 0
    buffer_load_dwordx4 v3, s[20:23], s53 offen lds
    s_lshl_b32 s46, s4, 11
    s_add_u32 m0, s46, 91136
    s_add_u32 s47, s53, s45
    buffer_load_dwordx4 v3, s[20:23], s47 offen lds
    s_lshl_b32 s46, s45, 3
    s_add_u32 s53, s53, s46
    v_mfma_f32_32x32x16_bf16 v[208:223], a[240:243], v[72:75], v[208:223]
    v_mfma_f32_32x32x16_bf16 v[224:239], a[112:115], v[76:79], v[224:239]
    v_mfma_f32_32x32x16_bf16 v[240:255], a[240:243], v[76:79], v[240:255]
    s_waitcnt lgkmcnt(0)
    v_mfma_f32_32x32x16_bf16 v[128:143], a[116:119], v[80:83], v[128:143]
    ds_read_b64_tr_b16 v[64:65], v12 offset:53248
    ds_read_b64_tr_b16 v[66:67], v12 offset:53760
    v_mfma_f32_32x32x16_bf16 v[144:159], a[244:247], v[80:83], v[144:159]
    ds_read_b64_tr_b16 v[68:69], v13 offset:53248
    ds_read_b64_tr_b16 v[70:71], v13 offset:53760
    v_mfma_f32_32x32x16_bf16 v[160:175], a[116:119], v[84:87], v[160:175]
    ds_read_b64_tr_b16 v[72:73], v12 offset:61440
    ds_read_b64_tr_b16 v[74:75], v12 offset:61952
    v_mfma_f32_32x32x16_bf16 v[176:191], a[244:247], v[84:87], v[176:191]
    ds_read_b64_tr_b16 v[76:77], v13 offset:61440
    ds_read_b64_tr_b16 v[78:79], v13 offset:61952
    v_mfma_f32_32x32x16_bf16 v[192:207], a[116:119], v[88:91], v[192:207]
    v_mfma_f32_32x32x16_bf16 v[208:223], a[244:247], v[88:91], v[208:223]
    v_mfma_f32_32x32x16_bf16 v[224:239], a[116:119], v[92:95], v[224:239]
    v_mfma_f32_32x32x16_bf16 v[240:255], a[244:247], v[92:95], v[240:255]
    s_waitcnt lgkmcnt(0)
    v_mfma_f32_32x32x16_bf16 v[128:143], a[120:123], v[64:67], v[128:143]
    ds_read_b64_tr_b16 v[80:81], v12 offset:55296
    ds_read_b64_tr_b16 v[82:83], v12 offset:55808
    v_mfma_f32_32x32x16_bf16 v[144:159], a[248:251], v[64:67], v[144:159]
    ds_read_b64_tr_b16 v[84:85], v13 offset:55296
    ds_read_b64_tr_b16 v[86:87], v13 offset:55808
    v_mfma_f32_32x32x16_bf16 v[160:175], a[120:123], v[68:71], v[160:175]
    ds_read_b64_tr_b16 v[88:89], v12 offset:63488
    ds_read_b64_tr_b16 v[90:91], v12 offset:64000
    v_mfma_f32_32x32x16_bf16 v[176:191], a[248:251], v[68:71], v[176:191]
    ds_read_b64_tr_b16 v[92:93], v13 offset:63488
    ds_read_b64_tr_b16 v[94:95], v13 offset:64000
    v_mfma_f32_32x32x16_bf16 v[192:207], a[120:123], v[72:75], v[192:207]
    v_mfma_f32_32x32x16_bf16 v[208:223], a[248:251], v[72:75], v[208:223]
    v_mfma_f32_32x32x16_bf16 v[224:239], a[120:123], v[76:79], v[224:239]
    v_mfma_f32_32x32x16_bf16 v[240:255], a[248:251], v[76:79], v[240:255]
    s_waitcnt lgkmcnt(0)
    v_mfma_f32_32x32x16_bf16 v[128:143], a[124:127], v[80:83], v[128:143]
    v_mfma_f32_32x32x16_bf16 v[144:159], a[252:255], v[80:83], v[144:159]
    v_mfma_f32_32x32x16_bf16 v[160:175], a[124:127], v[84:87], v[160:175]
    v_mfma_f32_32x32x16_bf16 v[176:191], a[252:255], v[84:87], v[176:191]
    v_mfma_f32_32x32x16_bf16 v[192:207], a[124:127], v[88:91], v[192:207]
    v_mfma_f32_32x32x16_bf16 v[208:223], a[252:255], v[88:91], v[208:223]
    v_mfma_f32_32x32x16_bf16 v[224:239], a[124:127], v[92:95], v[224:239]
    v_mfma_f32_32x32x16_bf16 v[240:255], a[252:255], v[92:95], v[240:255]
L_g1w_next:
    s_cmp_eq_u32 s49, 3
    s_cbranch_scc1 L_g1w_ef
    s_cmp_eq_u32 s49, 1
    s_cbranch_scc1 L_g1w_ev
    s_add_u32 s64, s50, 0
    s_add_u32 s65, s64, 4096
    v_cvt_pk_bf16_f32 v16, v128, v129
    v_cvt_pk_bf16_f32 v17, v130, v131
    v_cvt_pk_bf16_f32 v18, v132, v133
    v_cvt_pk_bf16_f32 v19, v134, v135
    buffer_store_dwordx4 v[16:19], v6, s[8:11], s64 offen offset:0 sc1
    v_cvt_pk_bf16_f32 v20, v136, v137
    v_cvt_pk_bf16_f32 v21, v138, v139
    v_cvt_pk_bf16_f32 v22, v140, v141
    v_cvt_pk_bf16_f32 v23, v142, v143
    buffer_store_dwordx4 v[20:23], v6, s[8:11], s64 offen offset:1024 sc1
    v_cvt_pk_bf16_f32 v24, v160, v161
    v_cvt_pk_bf16_f32 v25, v162, v163
    v_cvt_pk_bf16_f32 v26, v164, v165
    v_cvt_pk_bf16_f32 v27, v166, v167
    buffer_store_dwordx4 v[24:27], v6, s[8:11], s64 offen offset:2048 sc1
    v_cvt_pk_bf16_f32 v28, v168, v169
    v_cvt_pk_bf16_f32 v29, v170, v171
    v_cvt_pk_bf16_f32 v30, v172, v173
    v_cvt_pk_bf16_f32 v31, v174, v175
    buffer_store_dwordx4 v[28:31], v6, s[8:11], s64 offen offset:3072 sc1
    v_cvt_pk_bf16_f32 v16, v192, v193
    v_cvt_pk_bf16_f32 v17, v194, v195
    v_cvt_pk_bf16_f32 v18, v196, v197
    v_cvt_pk_bf16_f32 v19, v198, v199
    buffer_store_dwordx4 v[16:19], v6, s[8:11], s65 offen offset:0 sc1
    v_cvt_pk_bf16_f32 v20, v200, v201
    v_cvt_pk_bf16_f32 v21, v202, v203
    v_cvt_pk_bf16_f32 v22, v204, v205
    v_cvt_pk_bf16_f32 v23, v206, v207
    buffer_store_dwordx4 v[20:23], v6, s[8:11], s65 offen offset:1024 sc1
    v_cvt_pk_bf16_f32 v24, v224, v225
    v_cvt_pk_bf16_f32 v25, v226, v227
    v_cvt_pk_bf16_f32 v26, v228, v229
    v_cvt_pk_bf16_f32 v27, v230, v231
    buffer_store_dwordx4 v[24:27], v6, s[8:11], s65 offen offset:2048 sc1
    v_cvt_pk_bf16_f32 v28, v232, v233
    v_cvt_pk_bf16_f32 v29, v234, v235
    v_cvt_pk_bf16_f32 v30, v236, v237
    v_cvt_pk_bf16_f32 v31, v238, v239
    buffer_store_dwordx4 v[28:31], v6, s[8:11], s65 offen offset:3072 sc1
    s_add_u32 s64, s50, 262144
    s_add_u32 s65, s64, 4096
    v_cvt_pk_bf16_f32 v16, v144, v145
    v_cvt_pk_bf16_f32 v17, v146, v147
    v_cvt_pk_bf16_f32 v18, v148, v149
    v_cvt_pk_bf16_f32 v19, v150, v151
    buffer_store_dwordx4 v[16:19], v6, s[8:11], s64 offen offset:0 sc1
    v_cvt_pk_bf16_f32 v20, v152, v153
    v_cvt_pk_bf16_f32 v21, v154, v155
    v_cvt_pk_bf16_f32 v22, v156, v157
    v_cvt_pk_bf16_f32 v23, v158, v159
    buffer_store_dwordx4 v[20:23], v6, s[8:11], s64 offen offset:1024 sc1
    v_cvt_pk_bf16_f32 v24, v176, v177
    v_cvt_pk_bf16_f32 v25, v178, v179
    v_cvt_pk_bf16_f32 v26, v180, v181
    v_cvt_pk_bf16_f32 v27, v182, v183
    buffer_store_dwordx4 v[24:27], v6, s[8:11], s64 offen offset:2048 sc1
    v_cvt_pk_bf16_f32 v28, v184, v185
    v_cvt_pk_bf16_f32 v29, v186, v187
    v_cvt_pk_bf16_f32 v30, v188, v189
    v_cvt_pk_bf16_f32 v31, v190, v191
    buffer_store_dwordx4 v[28:31], v6, s[8:11], s64 offen offset:3072 sc1
    v_cvt_pk_bf16_f32 v16, v208, v209
    v_cvt_pk_bf16_f32 v17, v210, v211
    v_cvt_pk_bf16_f32 v18, v212, v213
    v_cvt_pk_bf16_f32 v19, v214, v215
    buffer_store_dwordx4 v[16:19], v6, s[8:11], s65 offen offset:0 sc1
    v_cvt_pk_bf16_f32 v20, v216, v217
    v_cvt_pk_bf16_f32 v21, v218, v219
    v_cvt_pk_bf16_f32 v22, v220, v221
    v_cvt_pk_bf16_f32 v23, v222, v223
    buffer_store_dwordx4 v[20:23], v6, s[8:11], s65 offen offset:1024 sc1
    v_cvt_pk_bf16_f32 v24, v240, v241
    v_cvt_pk_bf16_f32 v25, v242, v243
    v_cvt_pk_bf16_f32 v26, v244, v245
    v_cvt_pk_bf16_f32 v27, v246, v247
    buffer_store_dwordx4 v[24:27], v6, s[8:11], s65 offen offset:2048 sc1
    v_cvt_pk_bf16_f32 v28, v248, v249
    v_cvt_pk_bf16_f32 v29, v250, v251
    v_cvt_pk_bf16_f32 v30, v252, v253
    v_cvt_pk_bf16_f32 v31, v254, v255
    buffer_store_dwordx4 v[28:31], v6, s[8:11], s65 offen offset:3072 sc1
    s_branch L_g1w_ed
L_g1w_ev:
    s_add_u32 s64, s50, 0
    s_add_u32 s65, s64, 4096
    v_cvt_pk_bf16_f32 v16, v128, v129
    v_cvt_pk_bf16_f32 v17, v130, v131
    v_cvt_pk_bf16_f32 v18, v132, v133
    v_cvt_pk_bf16_f32 v19, v134, v135
    buffer_store_dwordx4 v[16:19], v0, s[8:11], s64 offen offset:0 sc1
    v_cvt_pk_bf16_f32 v20, v136, v137
    v_cvt_pk_bf16_f32 v21, v138, v139
    v_cvt_pk_bf16_f32 v22, v140, v141
    v_cvt_pk_bf16_f32 v23, v142, v143
    buffer_store_dwordx4 v[20:23], v0, s[8:11], s64 offen offset:1024 sc1
    v_cvt_pk_bf16_f32 v24, v160, v161
    v_cvt_pk_bf16_f32 v25, v162, v163
    v_cvt_pk_bf16_f32 v26, v164, v165
    v_cvt_pk_bf16_f32 v27, v166, v167
    buffer_store_dwordx4 v[24:27], v0, s[8:11], s64 offen offset:2048 sc1
    v_cvt_pk_bf16_f32 v28, v168, v169
    v_cvt_pk_bf16_f32 v29, v170, v171
    v_cvt_pk_bf16_f32 v30, v172, v173
    v_cvt_pk_bf16_f32 v31, v174, v175
    buffer_store_dwordx4 v[28:31], v0, s[8:11], s64 offen offset:3072 sc1
    v_cvt_pk_bf16_f32 v16, v192, v193
    v_cvt_pk_bf16_f32 v17, v194, v195
    v_cvt_pk_bf16_f32 v18, v196, v197
    v_cvt_pk_bf16_f32 v19, v198, v199
    buffer_store_dwordx4 v[16:19], v0, s[8:11], s65 offen offset:0 sc1
    v_cvt_pk_bf16_f32 v20, v200, v201
    v_cvt_pk_bf16_f32 v21, v202, v203
    v_cvt_pk_bf16_f32 v22, v204, v205
    v_cvt_pk_bf16_f32 v23, v206, v207
    buffer_store_dwordx4 v[20:23], v0, s[8:11], s65 offen offset:1024 sc1
    v_cvt_pk_bf16_f32 v24, v224, v225
    v_cvt_pk_bf16_f32 v25, v226, v227
    v_cvt_pk_bf16_f32 v26, v228, v229
    v_cvt_pk_bf16_f32 v27, v230, v231
    buffer_store_dwordx4 v[24:27], v0, s[8:11], s65 offen offset:2048 sc1
    v_cvt_pk_bf16_f32 v28, v232, v233
    v_cvt_pk_bf16_f32 v29, v234, v235
    v_cvt_pk_bf16_f32 v30, v236, v237
    v_cvt_pk_bf16_f32 v31, v238, v239
    buffer_store_dwordx4 v[28:31], v0, s[8:11], s65 offen offset:3072 sc1
    s_add_u32 s64, s50, 262144
    s_add_u32 s65, s64, 4096
    v_cvt_pk_bf16_f32 v16, v144, v145
    v_cvt_pk_bf16_f32 v17, v146, v147
    v_cvt_pk_bf16_f32 v18, v148, v149
    v_cvt_pk_bf16_f32 v19, v150, v151
    buffer_store_dwordx4 v[16:19], v0, s[8:11], s64 offen offset:0 sc1
    v_cvt_pk_bf16_f32 v20, v152, v153
    v_cvt_pk_bf16_f32 v21, v154, v155
    v_cvt_pk_bf16_f32 v22, v156, v157
    v_cvt_pk_bf16_f32 v23, v158, v159
    buffer_store_dwordx4 v[20:23], v0, s[8:11], s64 offen offset:1024 sc1
    v_cvt_pk_bf16_f32 v24, v176, v177
    v_cvt_pk_bf16_f32 v25, v178, v179
    v_cvt_pk_bf16_f32 v26, v180, v181
    v_cvt_pk_bf16_f32 v27, v182, v183
    buffer_store_dwordx4 v[24:27], v0, s[8:11], s64 offen offset:2048 sc1
    v_cvt_pk_bf16_f32 v28, v184, v185
    v_cvt_pk_bf16_f32 v29, v186, v187
    v_cvt_pk_bf16_f32 v30, v188, v189
    v_cvt_pk_bf16_f32 v31, v190, v191
    buffer_store_dwordx4 v[28:31], v0, s[8:11], s64 offen offset:3072 sc1
    v_cvt_pk_bf16_f32 v16, v208, v209
    v_cvt_pk_bf16_f32 v17, v210, v211
    v_cvt_pk_bf16_f32 v18, v212, v213
    v_cvt_pk_bf16_f32 v19, v214, v215
    buffer_store_dwordx4 v[16:19], v0, s[8:11], s65 offen offset:0 sc1
    v_cvt_pk_bf16_f32 v20, v216, v217
    v_cvt_pk_bf16_f32 v21, v218, v219
    v_cvt_pk_bf16_f32 v22, v220, v221
    v_cvt_pk_bf16_f32 v23, v222, v223
    buffer_store_dwordx4 v[20:23], v0, s[8:11], s65 offen offset:1024 sc1
    v_cvt_pk_bf16_f32 v24, v240, v241
    v_cvt_pk_bf16_f32 v25, v242, v243
    v_cvt_pk_bf16_f32 v26, v244, v245
    v_cvt_pk_bf16_f32 v27, v246, v247
    buffer_store_dwordx4 v[24:27], v0, s[8:11], s65 offen offset:2048 sc1
    v_cvt_pk_bf16_f32 v28, v248, v249
    v_cvt_pk_bf16_f32 v29, v250, v251
    v_cvt_pk_bf16_f32 v30, v252, v253
    v_cvt_pk_bf16_f32 v31, v254, v255
    buffer_store_dwordx4 v[28:31], v0, s[8:11], s65 offen offset:3072 sc1
    s_branch L_g1w_ed
L_g1w_ef:
    s_add_u32 s64, s50, 0
    v_pk_mul_f32 v[32:33], v[128:129], s[54:55]
    v_pk_mul_f32 v[128:129], v[128:129], v[192:193]
    v_exp_f32 v32, v32
    v_exp_f32 v33, v33
    v_pk_mul_f32 v[34:35], v[130:131], s[54:55]
    v_pk_mul_f32 v[130:131], v[130:131], v[194:195]
    v_exp_f32 v34, v34
    v_exp_f32 v35, v35
    v_pk_mul_f32 v[36:37], v[132:133], s[54:55]
    v_pk_mul_f32 v[132:133], v[132:133], v[196:197]
    v_exp_f32 v36, v36
    v_exp_f32 v37, v37
    v_pk_mul_f32 v[38:39], v[134:135], s[54:55]
    v_pk_mul_f32 v[134:135], v[134:135], v[198:199]
    v_exp_f32 v38, v38
    v_exp_f32 v39, v39
    v_pk_add_f32 v[32:33], v[32:33], s[58:59]
    v_pk_add_f32 v[34:35], v[34:35], s[58:59]
    v_pk_add_f32 v[36:37], v[36:37], s[58:59]
    v_pk_add_f32 v[38:39], v[38:39], s[58:59]
    v_rcp_f32 v32, v32
    v_rcp_f32 v33, v33
    v_rcp_f32 v34, v34
    v_rcp_f32 v35, v35
    v_rcp_f32 v36, v36
    v_rcp_f32 v37, v37
    v_rcp_f32 v38, v38
    v_rcp_f32 v39, v39
    v_pk_mul_f32 v[128:129], v[128:129], v[32:33]
    v_cvt_pk_bf16_f32 v16, v128, v129
    v_pk_mul_f32 v[130:131], v[130:131], v[34:35]
    v_cvt_pk_bf16_f32 v17, v130, v131
    v_pk_mul_f32 v[132:133], v[132:133], v[36:37]
    v_cvt_pk_bf16_f32 v18, v132, v133
    v_pk_mul_f32 v[134:135], v[134:135], v[38:39]
    v_cvt_pk_bf16_f32 v19, v134, v135
    buffer_store_dwordx4 v[16:19], v0, s[8:11], s64 offen offset:0 sc1
    v_pk_mul_f32 v[32:33], v[136:137], s[54:55]
    v_pk_mul_f32 v[136:137], v[136:137], v[200:201]
    v_exp_f32 v32, v32
    v_exp_f32 v33, v33
    v_pk_mul_f32 v[34:35], v[138:139], s[54:55]
    v_pk_mul_f32 v[138:139], v[138:139], v[202:203]
    v_exp_f32 v34, v34
    v_exp_f32 v35, v35
    v_pk_mul_f32 v[36:37], v[140:141], s[54:55]
    v_pk_mul_f32 v[140:141], v[140:141], v[204:205]
    v_exp_f32 v36, v36
    v_exp_f32 v37, v37
    v_pk_mul_f32 v[38:39], v[142:143], s[54:55]
    v_pk_mul_f32 v[142:143], v[142:143], v[206:207]
    v_exp_f32 v38, v38
    v_exp_f32 v39, v39
    v_pk_add_f32 v[32:33], v[32:33], s[58:59]
    v_pk_add_f32 v[34:35], v[34:35], s[58:59]
    v_pk_add_f32 v[36:37], v[36:37], s[58:59]
    v_pk_add_f32 v[38:39], v[38:39], s[58:59]
    v_rcp_f32 v32, v32
    v_rcp_f32 v33, v33
    v_rcp_f32 v34, v34
    v_rcp_f32 v35, v35
    v_rcp_f32 v36, v36
    v_rcp_f32 v37, v37
    v_rcp_f32 v38, v38
    v_rcp_f32 v39, v39
    v_pk_mul_f32 v[136:137], v[136:137], v[32:33]
    v_cvt_pk_bf16_f32 v20, v136, v137
    v_pk_mul_f32 v[138:139], v[138:139], v[34:35]
    v_cvt_pk_bf16_f32 v21, v138, v139
    v_pk_mul_f32 v[140:141], v[140:141], v[36:37]
    v_cvt_pk_bf16_f32 v22, v140, v141
    v_pk_mul_f32 v[142:143], v[142:143], v[38:39]
    v_cvt_pk_bf16_f32 v23, v142, v143
    buffer_store_dwordx4 v[20:23], v0, s[8:11], s64 offen offset:1024 sc1
    v_pk_mul_f32 v[32:33], v[160:161], s[54:55]
    v_pk_mul_f32 v[160:161], v[160:161], v[224:225]
    v_exp_f32 v32, v32
    v_exp_f32 v33, v33
    v_pk_mul_f32 v[34:35], v[162:163], s[54:55]
    v_pk_mul_f32 v[162:163], v[162:163], v[226:227]
    v_exp_f32 v34, v34
    v_exp_f32 v35, v35
    v_pk_mul_f32 v[36:37], v[164:165], s[54:55]
    v_pk_mul_f32 v[164:165], v[164:165], v[228:229]
    v_exp_f32 v36, v36
    v_exp_f32 v37, v37
    v_pk_mul_f32 v[38:39], v[166:167], s[54:55]
    v_pk_mul_f32 v[166:167], v[166:167], v[230:231]
    v_exp_f32 v38, v38
    v_exp_f32 v39, v39
    v_pk_add_f32 v[32:33], v[32:33], s[58:59]
    v_pk_add_f32 v[34:35], v[34:35], s[58:59]
    v_pk_add_f32 v[36:37], v[36:37], s[58:59]
    v_pk_add_f32 v[38:39], v[38:39], s[58:59]
    v_rcp_f32 v32, v32
    v_rcp_f32 v33, v33
    v_rcp_f32 v34, v34
    v_rcp_f32 v35, v35
    v_rcp_f32 v36, v36
    v_rcp_f32 v37, v37
    v_rcp_f32 v38, v38
    v_rcp_f32 v39, v39
    v_pk_mul_f32 v[160:161], v[160:161], v[32:33]
    v_cvt_pk_bf16_f32 v24, v160, v161
    v_pk_mul_f32 v[162:163], v[162:163], v[34:35]
    v_cvt_pk_bf16_f32 v25, v162, v163
    v_pk_mul_f32 v[164:165], v[164:165], v[36:37]
    v_cvt_pk_bf16_f32 v26, v164, v165
    v_pk_mul_f32 v[166:167], v[166:167], v[38:39]
    v_cvt_pk_bf16_f32 v27, v166, v167
    buffer_store_dwordx4 v[24:27], v0, s[8:11], s64 offen offset:2048 sc1
    v_pk_mul_f32 v[32:33], v[168:169], s[54:55]
    v_pk_mul_f32 v[168:169], v[168:169], v[232:233]
    v_exp_f32 v32, v32
    v_exp_f32 v33, v33
    v_pk_mul_f32 v[34:35], v[170:171], s[54:55]
    v_pk_mul_f32 v[170:171], v[170:171], v[234:235]
    v_exp_f32 v34, v34
    v_exp_f32 v35, v35
    v_pk_mul_f32 v[36:37], v[172:173], s[54:55]
    v_pk_mul_f32 v[172:173], v[172:173], v[236:237]
    v_exp_f32 v36, v36
    v_exp_f32 v37, v37
    v_pk_mul_f32 v[38:39], v[174:175], s[54:55]
    v_pk_mul_f32 v[174:175], v[174:175], v[238:239]
    v_exp_f32 v38, v38
    v_exp_f32 v39, v39
    v_pk_add_f32 v[32:33], v[32:33], s[58:59]
    v_pk_add_f32 v[34:35], v[34:35], s[58:59]
    v_pk_add_f32 v[36:37], v[36:37], s[58:59]
    v_pk_add_f32 v[38:39], v[38:39], s[58:59]
    v_rcp_f32 v32, v32
    v_rcp_f32 v33, v33
    v_rcp_f32 v34, v34
    v_rcp_f32 v35, v35
    v_rcp_f32 v36, v36
    v_rcp_f32 v37, v37
    v_rcp_f32 v38, v38
    v_rcp_f32 v39, v39
    v_pk_mul_f32 v[168:169], v[168:169], v[32:33]
    v_cvt_pk_bf16_f32 v28, v168, v169
    v_pk_mul_f32 v[170:171], v[170:171], v[34:35]
    v_cvt_pk_bf16_f32 v29, v170, v171
    v_pk_mul_f32 v[172:173], v[172:173], v[36:37]
    v_cvt_pk_bf16_f32 v30, v172, v173
    v_pk_mul_f32 v[174:175], v[174:175], v[38:39]
    v_cvt_pk_bf16_f32 v31, v174, v175
    buffer_store_dwordx4 v[28:31], v0, s[8:11], s64 offen offset:3072 sc1
    s_add_u32 s64, s50, 114688
    v_pk_mul_f32 v[32:33], v[144:145], s[54:55]
    v_pk_mul_f32 v[144:145], v[144:145], v[208:209]
    v_exp_f32 v32, v32
    v_exp_f32 v33, v33
    v_pk_mul_f32 v[34:35], v[146:147], s[54:55]
    v_pk_mul_f32 v[146:147], v[146:147], v[210:211]
    v_exp_f32 v34, v34
    v_exp_f32 v35, v35
    v_pk_mul_f32 v[36:37], v[148:149], s[54:55]
    v_pk_mul_f32 v[148:149], v[148:149], v[212:213]
    v_exp_f32 v36, v36
    v_exp_f32 v37, v37
    v_pk_mul_f32 v[38:39], v[150:151], s[54:55]
    v_pk_mul_f32 v[150:151], v[150:151], v[214:215]
    v_exp_f32 v38, v38
    v_exp_f32 v39, v39
    v_pk_add_f32 v[32:33], v[32:33], s[58:59]
    v_pk_add_f32 v[34:35], v[34:35], s[58:59]
    v_pk_add_f32 v[36:37], v[36:37], s[58:59]
    v_pk_add_f32 v[38:39], v[38:39], s[58:59]
    v_rcp_f32 v32, v32
    v_rcp_f32 v33, v33
    v_rcp_f32 v34, v34
    v_rcp_f32 v35, v35
    v_rcp_f32 v36, v36
    v_rcp_f32 v37, v37
    v_rcp_f32 v38, v38
    v_rcp_f32 v39, v39
    v_pk_mul_f32 v[144:145], v[144:145], v[32:33]
    v_cvt_pk_bf16_f32 v16, v144, v145
    v_pk_mul_f32 v[146:147], v[146:147], v[34:35]
    v_cvt_pk_bf16_f32 v17, v146, v147
    v_pk_mul_f32 v[148:149], v[148:149], v[36:37]
    v_cvt_pk_bf16_f32 v18, v148, v149
    v_pk_mul_f32 v[150:151], v[150:151], v[38:39]
    v_cvt_pk_bf16_f32 v19, v150, v151
    buffer_store_dwordx4 v[16:19], v0, s[8:11], s64 offen offset:0 sc1
    v_pk_mul_f32 v[32:33], v[152:153], s[54:55]
    v_pk_mul_f32 v[152:153], v[152:153], v[216:217]
    v_exp_f32 v32, v32
    v_exp_f32 v33, v33
    v_pk_mul_f32 v[34:35], v[154:155], s[54:55]
    v_pk_mul_f32 v[154:155], v[154:155], v[218:219]
    v_exp_f32 v34, v34
    v_exp_f32 v35, v35
    v_pk_mul_f32 v[36:37], v[156:157], s[54:55]
    v_pk_mul_f32 v[156:157], v[156:157], v[220:221]
    v_exp_f32 v36, v36
    v_exp_f32 v37, v37
    v_pk_mul_f32 v[38:39], v[158:159], s[54:55]
    v_pk_mul_f32 v[158:159], v[158:159], v[222:223]
    v_exp_f32 v38, v38
    v_exp_f32 v39, v39
    v_pk_add_f32 v[32:33], v[32:33], s[58:59]
    v_pk_add_f32 v[34:35], v[34:35], s[58:59]
    v_pk_add_f32 v[36:37], v[36:37], s[58:59]
    v_pk_add_f32 v[38:39], v[38:39], s[58:59]
    v_rcp_f32 v32, v32
    v_rcp_f32 v33, v33
    v_rcp_f32 v34, v34
    v_rcp_f32 v35, v35
    v_rcp_f32 v36, v36
    v_rcp_f32 v37, v37
    v_rcp_f32 v38, v38
    v_rcp_f32 v39, v39
    v_pk_mul_f32 v[152:153], v[152:153], v[32:33]
    v_cvt_pk_bf16_f32 v20, v152, v153
    v_pk_mul_f32 v[154:155], v[154:155], v[34:35]
    v_cvt_pk_bf16_f32 v21, v154, v155
    v_pk_mul_f32 v[156:157], v[156:157], v[36:37]
    v_cvt_pk_bf16_f32 v22, v156, v157
    v_pk_mul_f32 v[158:159], v[158:159], v[38:39]
    v_cvt_pk_bf16_f32 v23, v158, v159
    buffer_store_dwordx4 v[20:23], v0, s[8:11], s64 offen offset:1024 sc1
    v_pk_mul_f32 v[32:33], v[176:177], s[54:55]
    v_pk_mul_f32 v[176:177], v[176:177], v[240:241]
    v_exp_f32 v32, v32
    v_exp_f32 v33, v33
    v_pk_mul_f32 v[34:35], v[178:179], s[54:55]
    v_pk_mul_f32 v[178:179], v[178:179], v[242:243]
    v_exp_f32 v34, v34
    v_exp_f32 v35, v35
    v_pk_mul_f32 v[36:37], v[180:181], s[54:55]
    v_pk_mul_f32 v[180:181], v[180:181], v[244:245]
    v_exp_f32 v36, v36
    v_exp_f32 v37, v37
    v_pk_mul_f32 v[38:39], v[182:183], s[54:55]
    v_pk_mul_f32 v[182:183], v[182:183], v[246:247]
    v_exp_f32 v38, v38
    v_exp_f32 v39, v39
    v_pk_add_f32 v[32:33], v[32:33], s[58:59]
    v_pk_add_f32 v[34:35], v[34:35], s[58:59]
    v_pk_add_f32 v[36:37], v[36:37], s[58:59]
    v_pk_add_f32 v[38:39], v[38:39], s[58:59]
    v_rcp_f32 v32, v32
    v_rcp_f32 v33, v33
    v_rcp_f32 v34, v34
    v_rcp_f32 v35, v35
    v_rcp_f32 v36, v36
    v_rcp_f32 v37, v37
    v_rcp_f32 v38, v38
    v_rcp_f32 v39, v39
    v_pk_mul_f32 v[176:177], v[176:177], v[32:33]
    v_cvt_pk_bf16_f32 v24, v176, v177
    v_pk_mul_f32 v[178:179], v[178:179], v[34:35]
    v_cvt_pk_bf16_f32 v25, v178, v179
    v_pk_mul_f32 v[180:181], v[180:181], v[36:37]
    v_cvt_pk_bf16_f32 v26, v180, v181
    v_pk_mul_f32 v[182:183], v[182:183], v[38:39]
    v_cvt_pk_bf16_f32 v27, v182, v183
    buffer_store_dwordx4 v[24:27], v0, s[8:11], s64 offen offset:2048 sc1
    v_pk_mul_f32 v[32:33], v[184:185], s[54:55]
    v_pk_mul_f32 v[184:185], v[184:185], v[248:249]
    v_exp_f32 v32, v32
    v_exp_f32 v33, v33
    v_pk_mul_f32 v[34:35], v[186:187], s[54:55]
    v_pk_mul_f32 v[186:187], v[186:187], v[250:251]
    v_exp_f32 v34, v34
    v_exp_f32 v35, v35
    v_pk_mul_f32 v[36:37], v[188:189], s[54:55]
    v_pk_mul_f32 v[188:189], v[188:189], v[252:253]
    v_exp_f32 v36, v36
    v_exp_f32 v37, v37
    v_pk_mul_f32 v[38:39], v[190:191], s[54:55]
    v_pk_mul_f32 v[190:191], v[190:191], v[254:255]
    v_exp_f32 v38, v38
    v_exp_f32 v39, v39
    v_pk_add_f32 v[32:33], v[32:33], s[58:59]
    v_pk_add_f32 v[34:35], v[34:35], s[58:59]
    v_pk_add_f32 v[36:37], v[36:37], s[58:59]
    v_pk_add_f32 v[38:39], v[38:39], s[58:59]
    v_rcp_f32 v32, v32
    v_rcp_f32 v33, v33
    v_rcp_f32 v34, v34
    v_rcp_f32 v35, v35
    v_rcp_f32 v36, v36
    v_rcp_f32 v37, v37
    v_rcp_f32 v38, v38
    v_rcp_f32 v39, v39
    v_pk_mul_f32 v[184:185], v[184:185], v[32:33]
    v_cvt_pk_bf16_f32 v28, v184, v185
    v_pk_mul_f32 v[186:187], v[186:187], v[34:35]
    v_cvt_pk_bf16_f32 v29, v186, v187
    v_pk_mul_f32 v[188:189], v[188:189], v[36:37]
    v_cvt_pk_bf16_f32 v30, v188, v189
    v_pk_mul_f32 v[190:191], v[190:191], v[38:39]
    v_cvt_pk_bf16_f32 v31, v190, v191
    buffer_store_dwordx4 v[28:31], v0, s[8:11], s64 offen offset:3072 sc1
    buffer_load_dword v14, v0, s[12:15], 0 offen
    buffer_load_dword v14, v0, s[12:15], 0 offen
    buffer_load_dword v14, v0, s[12:15], 0 offen
    buffer_load_dword v14, v0, s[12:15], 0 offen
    buffer_load_dword v14, v0, s[12:15], 0 offen
    buffer_load_dword v14, v0, s[12:15], 0 offen
    buffer_load_dword v14, v0, s[12:15], 0 offen
    buffer_load_dword v14, v0, s[12:15], 0 offen
L_g1w_ed:
    s_mov_b32 s72, 2
    s_cmp_eq_u32 s49, 2
    s_cselect_b32 s72, 0x100, s72
    s_cmp_eq_u32 s49, 3
    s_cselect_b32 s72, 0x10000, s72
    s_mov_b32 s74, s5
    s_mov_b32 s48, 0
    s_cmp_ge_u32 s77, 124
    s_cselect_b32 s48, 1, s48
    s_cmp_eq_u32 s73, 0
    s_cselect_b32 s48, 1, s48
    s_or_b32 s47, s48, s71
    s_cmp_eq_u32 s47, 0
    s_cbranch_scc1 L_g1w_noflush
    s_waitcnt vmcnt(0)
    s_barrier
    s_cmp_eq_u32 s72, 0
    s_cbranch_scc1 L_fl0
    s_cmp_lg_u32 s4, 0
    s_cbranch_scc1 L_fl0_c
    s_cmp_lg_u32 s89, 0
    s_cbranch_scc1 L_fl0_i
    v_mov_b32 v9, 28
    s_mov_b32 s78, 0
L_fl0_w:
    global_load_dword v10, v9, s[68:69] sc1
    s_waitcnt vmcnt(0)
    v_readfirstlane_b32 s89, v10
    s_cmp_lg_u32 s89, 0
    s_cbranch_scc1 L_fl0_i
    s_sleep 8
    s_add_u32 s78, s78, 1
    s_cmp_lt_u32 s78, 100000
    s_cbranch_scc1 L_fl0_w
L_fl0_i:
    s_lshl_b32 s46, s74, 7
    s_add_u32 s46, s46, 262144
    v_mov_b32 v9, 0
    v_mov_b32 v10, s72
    s_mov_b64 exec, 1
    buffer_atomic_add v10, v9, s[8:11], s46 offen sc1
    s_mov_b64 exec, -1
L_fl0_c:
    s_mov_b32 s72, 0
L_fl0:
    buffer_load_dword v14, v0, s[12:15], 0 offen
    buffer_load_dword v14, v0, s[12:15], 0 offen
    buffer_load_dword v14, v0, s[12:15], 0 offen
    buffer_load_dword v14, v0, s[12:15], 0 offen
    buffer_load_dword v14, v0, s[12:15], 0 offen
    buffer_load_dword v14, v0, s[12:15], 0 offen
    buffer_load_dword v14, v0, s[12:15], 0 offen
    buffer_load_dword v14, v0, s[12:15], 0 offen
    buffer_load_dword v14, v0, s[12:15], 0 offen
    buffer_load_dword v14, v0, s[12:15], 0 offen
    buffer_load_dword v14, v0, s[12:15], 0 offen
    buffer_load_dword v14, v0, s[12:15], 0 offen
    buffer_load_dword v14, v0, s[12:15], 0 offen
    buffer_load_dword v14, v0, s[12:15], 0 offen
    buffer_load_dword v14, v0, s[12:15], 0 offen
    buffer_load_dword v14, v0, s[12:15], 0 offen
L_g1w_noflush:
    s_mov_b32 s71, 0
    s_cmp_eq_u32 s48, 1
    s_cbranch_scc1 L_g1w_sessend
    s_mov_b32 s49, s51
    s_mov_b32 s50, s52
    s_mov_b32 s6, s77
    s_add_u32 s77, s77, 28
    s_branch L_g1w_unit
L_g1w_sessend:
    s_waitcnt vmcnt(0)
    s_barrier
    s_cmp_eq_u32 s73, 0
    s_cbranch_scc0 L_g1w_done
    s_mov_b32 s73, 1
    s_branch L_g1w_own
L_g1w_done:
    v_mov_b32 v0, v15
    s_cmp_ge_u32 s90, 32
    s_cbranch_scc1 L_finrole
    s_load_dwordx2 s[8:9], s[0:1], 112
    s_load_dwordx2 s[22:23], s[0:1], 104
    s_waitcnt lgkmcnt(0)
    s_mov_b32 s10, 268435456
    s_mov_b32 s11, 0x20000
    s_mov_b32 s25, 400000
    s_lshr_b32 s6, s90, 3
    s_and_b32 s7, s90, 7
    s_lshl_b32 s7, s7, 2
    s_add_u32 s7, s7, s4
    v_and_b32 v3, 63, v0
    v_lshlrev_b32 v0, 4, v3
    v_and_b32 v4, 31, v3
    v_bfe_u32 v5, v3, 4, 1
    v_lshlrev_b32 v5, 3, v5
    v_xor_b32 v4, v4, v5
    v_lshlrev_b32 v4, 4, v4
    v_lshrrev_b32 v5, 5, v3
    v_lshlrev_b32 v5, 9, v5
    v_add_u32 v1, v4, v5
    v_lshrrev_b32 v4, 5, v3
    v_lshlrev_b32 v4, 7, v4
    v_and_b32 v5, 7, v3
    v_lshlrev_b32 v5, 4, v5
    v_add_u32 v2, v4, v5
    v_and_b32 v4, 31, v3
    v_lshrrev_b32 v5, 5, v3
    v_lshlrev_b32 v5, 2, v5
    v_sub_u32 v4, v4, v5
    v_mov_b32 v5, 0xf149f2ca
    v_cmp_le_i32 vcc, 0, v4
    s_nop 1
    v_cndmask_b32_e64 v16, v5, 0, vcc
    v_cmp_le_i32 vcc, 1, v4
    s_nop 1
    v_cndmask_b32_e64 v17, v5, 0, vcc
    v_cmp_le_i32 vcc, 2, v4
    s_nop 1
    v_cndmask_b32_e64 v18, v5, 0, vcc
    v_cmp_le_i32 vcc, 3, v4
    s_nop 1
    v_cndmask_b32_e64 v19, v5, 0, vcc
    v_cmp_le_i32 vcc, 8, v4
    s_nop 1
    v_cndmask_b32_e64 v20, v5, 0, vcc
    v_cmp_le_i32 vcc, 9, v4
    s_nop 1
    v_cndmask_b32_e64 v21, v5, 0, vcc
    v_cmp_le_i32 vcc, 10, v4
    s_nop 1
    v_cndmask_b32_e64 v22, v5, 0, vcc
    v_cmp_le_i32 vcc, 11, v4
    s_nop 1
    v_cndmask_b32_e64 v23, v5, 0, vcc
    v_cmp_le_i32 vcc, 16, v4
    s_nop 1
    v_cndmask_b32_e64 v24, v5, 0, vcc
    v_cmp_le_i32 vcc, 17, v4
    s_nop 1
    v_cndmask_b32_e64 v25, v5, 0, vcc
    v_cmp_le_i32 vcc, 18, v4
    s_nop 1
    v_cndmask_b32_e64 v26, v5, 0, vcc
    v_cmp_le_i32 vcc, 19, v4
    s_nop 1
    v_cndmask_b32_e64 v27, v5, 0, vcc
    v_cmp_le_i32 vcc, 24, v4
    s_nop 1
    v_cndmask_b32_e64 v28, v5, 0, vcc
    v_cmp_le_i32 vcc, 25, v4
    s_nop 1
    v_cndmask_b32_e64 v29, v5, 0, vcc
    v_cmp_le_i32 vcc, 26, v4
    s_nop 1
    v_cndmask_b32_e64 v30, v5, 0, vcc
    v_cmp_le_i32 vcc, 27, v4
    s_nop 1
    v_cndmask_b32_e64 v31, v5, 0, vcc
    s_mov_b32 s20, 0x3e0293ee
    s_mov_b32 s21, 0x3e0293ee
L_atw_loop:
    s_lshr_b32 s19, s6, 3
    s_lshl_b32 s19, s19, 7
    s_add_u32 s19, s19, 262144
    v_mov_b32 v7, s19
    s_mov_b32 s24, 0
L_atw_p1:
    buffer_load_dword v6, v7, s[8:11], 0 offen sc1
    s_waitcnt vmcnt(0)
    v_readfirstlane_b32 s18, v6
    s_and_b32 s18, s18, 0xffff
    s_cmp_eq_u32 s18, 8320
    s_cbranch_scc1 L_atw_p1_d
    s_sleep 16
    s_add_u32 s24, s24, 1
    s_cmp_lt_u32 s24, s25
    s_cbranch_scc1 L_atw_p1
    s_mov_b32 s25, 0
L_atw_p1_d:
    s_lshl_b32 s18, s6, 5
    s_add_u32 s18, s18, s7
    s_lshl_b32 s19, s18, 13
    s_add_u32 s12, s19, 50331648
    s_add_u32 s13, s19, 16777216
    s_add_u32 s14, s19, 33554432
    s_add_u32 s17, s19, 67108864
    s_lshl_b32 s19, s18, 11
    s_add_u32 s15, s19, 83886080
    s_lshl_b32 s19, s18, 12
    s_add_u32 s16, s19, 92274688
    buffer_load_dwordx4 v[32:35], v1, s[8:11], s12 offen offset:0
    buffer_load_dwordx4 v[36:39], v1, s[8:11], s12 offen offset:1024
    buffer_load_dwordx4 v[40:43], v1, s[8:11], s12 offen offset:2048
    buffer_load_dwordx4 v[44:47], v1, s[8:11], s12 offen offset:3072
    s_add_u32 s18, s12, 4096
    buffer_load_dwordx4 v[48:51], v1, s[8:11], s18 offen offset:0
    s_add_u32 s18, s12, 4096
    buffer_load_dwordx4 v[52:55], v1, s[8:11], s18 offen offset:1024
    s_add_u32 s18, s12, 4096
    buffer_load_dwordx4 v[56:59], v1, s[8:11], s18 offen offset:2048
    s_add_u32 s18, s12, 4096
    buffer_load_dwordx4 v[60:63], v1, s[8:11], s18 offen offset:3072
    buffer_load_dwordx4 v[64:67], v1, s[8:11], s13 offen offset:0
    buffer_load_dwordx4 v[68:71], v1, s[8:11], s13 offen offset:1024
    buffer_load_dwordx4 v[72:75], v1, s[8:11], s13 offen offset:2048
    buffer_load_dwordx4 v[76:79], v1, s[8:11], s13 offen offset:3072
    s_add_u32 s18, s13, 4096
    buffer_load_dwordx4 v[80:83], v1, s[8:11], s18 offen offset:0
    s_add_u32 s18, s13, 4096
    buffer_load_dwordx4 v[84:87], v1, s[8:11], s18 offen offset:1024
    s_add_u32 s18, s13, 4096
    buffer_load_dwordx4 v[88:91], v1, s[8:11], s18 offen offset:2048
    s_add_u32 s18, s13, 4096
    buffer_load_dwordx4 v[92:95], v1, s[8:11], s18 offen offset:3072
    buffer_load_dwordx4 v[96:99], v0, s[8:11], s14 offen offset:0
    buffer_load_dwordx4 v[100:103], v0, s[8:11], s14 offen offset:1024
    buffer_load_dwordx4 v[104:107], v0, s[8:11], s14 offen offset:2048
    buffer_load_dwordx4 v[108:111], v0, s[8:11], s14 offen offset:3072
    s_add_u32 s18, s14, 4096
    buffer_load_dwordx4 v[112:115], v0, s[8:11], s18 offen offset:0
    s_add_u32 s18, s14, 4096
    buffer_load_dwordx4 v[116:119], v0, s[8:11], s18 offen offset:1024
    s_add_u32 s18, s14, 4096
    buffer_load_dwordx4 v[120:123], v0, s[8:11], s18 offen offset:2048
    s_add_u32 s18, s14, 4096
    buffer_load_dwordx4 v[124:127], v0, s[8:11], s18 offen offset:3072
    s_waitcnt vmcnt(8)
    v_mfma_f32_32x32x16_bf16 v[176:191], v[64:67], v[32:35], v[16:31]
    v_mfma_f32_32x32x16_bf16 v[176:191], v[68:71], v[36:39], v[176:191]
    v_mfma_f32_32x32x16_bf16 v[176:191], v[72:75], v[40:43], v[176:191]
    v_mfma_f32_32x32x16_bf16 v[176:191], v[76:79], v[44:47], v[176:191]
    v_mfma_f32_32x32x16_bf16 v[176:191], v[80:83], v[48:51], v[176:191]
    v_mfma_f32_32x32x16_bf16 v[176:191], v[84:87], v[52:55], v[176:191]
    v_mfma_f32_32x32x16_bf16 v[176:191], v[88:91], v[56:59], v[176:191]
    v_mfma_f32_32x32x16_bf16 v[176:191], v[92:95], v[60:63], v[176:191]
    s_lshl_b32 s19, s7, 7
    s_add_u32 s19, s19, 271360
    v_mov_b32 v7, s19
    s_mov_b32 s24, 0
L_atw_p2:
    buffer_load_dword v6, v7, s[8:11], 0 offen sc1
    s_waitcnt vmcnt(0)
    v_readfirstlane_b32 s18, v6
    s_cmp_gt_u32 s18, s6
    s_cbranch_scc1 L_atw_p2_d
    s_sleep 4
    s_add_u32 s24, s24, 1
    s_cmp_lt_u32 s24, s25
    s_cbranch_scc1 L_atw_p2
    s_mov_b32 s25, 0
L_atw_p2_d:
    buffer_load_dwordx4 v[128:131], v2, s[8:11], s15 offen offset:0
    buffer_load_dwordx4 v[132:135], v2, s[8:11], s15 offen offset:256
    buffer_load_dwordx4 v[136:139], v2, s[8:11], s15 offen offset:512
    buffer_load_dwordx4 v[140:143], v2, s[8:11], s15 offen offset:768
    buffer_load_dwordx4 v[144:147], v2, s[8:11], s15 offen offset:1024
    buffer_load_dwordx4 v[148:151], v2, s[8:11], s15 offen offset:1280
    buffer_load_dwordx4 v[152:155], v2, s[8:11], s15 offen offset:1536
    buffer_load_dwordx4 v[156:159], v2, s[8:11], s15 offen offset:1792
    buffer_load_dwordx4 v[160:163], v0, s[8:11], s16 offen offset:0
    buffer_load_dwordx4 v[164:167], v0, s[8:11], s16 offen offset:1024
    buffer_load_dwordx4 v[168:171], v0, s[8:11], s16 offen offset:2048
    buffer_load_dwordx4 v[172:175], v0, s[8:11], s16 offen offset:3072
    s_waitcnt vmcnt(11)
    v_mfma_f32_32x32x16_bf16 v[192:207], v[128:131], v[32:35], 0
    s_waitcnt vmcnt(10)
    v_mfma_f32_32x32x16_bf16 v[192:207], v[132:135], v[36:39], v[192:207]
    s_waitcnt vmcnt(9)
    v_mfma_f32_32x32x16_bf16 v[192:207], v[136:139], v[40:43], v[192:207]
    s_waitcnt vmcnt(8)
    v_mfma_f32_32x32x16_bf16 v[192:207], v[140:143], v[44:47], v[192:207]
    s_waitcnt vmcnt(7)
    v_mfma_f32_32x32x16_bf16 v[192:207], v[144:147], v[48:51], v[192:207]
    s_waitcnt vmcnt(6)
    v_mfma_f32_32x32x16_bf16 v[192:207], v[148:151], v[52:55], v[192:207]
    s_waitcnt vmcnt(5)
    v_mfma_f32_32x32x16_bf16 v[192:207], v[152:155], v[56:59], v[192:207]
    s_waitcnt vmcnt(4)
    v_mfma_f32_32x32x16_bf16 v[192:207], v[156:159], v[60:63], v[192:207]
    v_max3_f32 v220, v176, v177, v178
    v_max3_f32 v220, v220, v179, v180
    v_max3_f32 v220, v220, v181, v182
    v_max3_f32 v220, v220, v183, v184
    v_max3_f32 v220, v220, v185, v186
    v_max3_f32 v220, v220, v187, v188
    v_max3_f32 v220, v220, v189, v190
    v_max_f32 v220, v220, v191
    s_nop 3
    v_max3_f32 v220, v220, v192, v193
    v_max3_f32 v220, v220, v194, v195
    v_mov_b32 v221, v220
    s_nop 1
    v_permlane32_swap_b32 v220, v221
    v_max_f32 v220, v220, v221
    v_mul_f32 v222, s20, v220
    v_pk_fma_f32 v[176:177], v[176:177], s[20:21], v[222:223] op_sel_hi:[1,1,0] neg_lo:[0,0,1] neg_hi:[0,0,1]
    v_pk_fma_f32 v[178:179], v[178:179], s[20:21], v[222:223] op_sel_hi:[1,1,0] neg_lo:[0,0,1] neg_hi:[0,0,1]
    v_pk_fma_f32 v[180:181], v[180:181], s[20:21], v[222:223] op_sel_hi:[1,1,0] neg_lo:[0,0,1] neg_hi:[0,0,1]
    v_pk_fma_f32 v[182:183], v[182:183], s[20:21], v[222:223] op_sel_hi:[1,1,0] neg_lo:[0,0,1] neg_hi:[0,0,1]
    v_pk_fma_f32 v[184:185], v[184:185], s[20:21], v[222:223] op_sel_hi:[1,1,0] neg_lo:[0,0,1] neg_hi:[0,0,1]
    v_pk_fma_f32 v[186:187], v[186:187], s[20:21], v[222:223] op_sel_hi:[1,1,0] neg_lo:[0,0,1] neg_hi:[0,0,1]
    v_pk_fma_f32 v[188:189], v[188:189], s[20:21], v[222:223] op_sel_hi:[1,1,0] neg_lo:[0,0,1] neg_hi:[0,0,1]
    v_pk_fma_f32 v[190:191], v[190:191], s[20:21], v[222:223] op_sel_hi:[1,1,0] neg_lo:[0,0,1] neg_hi:[0,0,1]
    v_pk_fma_f32 v[192:193], v[192:193], s[20:21], v[222:223] op_sel_hi:[1,1,0] neg_lo:[0,0,1] neg_hi:[0,0,1]
    v_pk_fma_f32 v[194:195], v[194:195], s[20:21], v[222:223] op_sel_hi:[1,1,0] neg_lo:[0,0,1] neg_hi:[0,0,1]
    v_exp_f32 v176, v176
    v_exp_f32 v177, v177
    v_exp_f32 v178, v178
    v_exp_f32 v179, v179
    v_exp_f32 v180, v180
    v_exp_f32 v181, v181
    v_exp_f32 v182, v182
    v_exp_f32 v183, v183
    v_exp_f32 v184, v184
    v_exp_f32 v185, v185
    v_exp_f32 v186, v186
    v_exp_f32 v187, v187
    v_exp_f32 v188, v188
    v_exp_f32 v189, v189
    v_exp_f32 v190, v190
    v_exp_f32 v191, v191
    v_exp_f32 v192, v192
    v_exp_f32 v193, v193
    v_exp_f32 v194, v194
    v_exp_f32 v195, v195
    v_cvt_pk_bf16_f32 v208, v176, v177
    v_cvt_pk_bf16_f32 v209, v178, v179
    v_cvt_pk_bf16_f32 v210, v180, v181
    v_cvt_pk_bf16_f32 v211, v182, v183
    v_cvt_pk_bf16_f32 v212, v184, v185
    v_cvt_pk_bf16_f32 v213, v186, v187
    v_cvt_pk_bf16_f32 v214, v188, v189
    v_cvt_pk_bf16_f32 v215, v190, v191
    v_cvt_pk_bf16_f32 v216, v192, v193
    v_mov_b32 v217, 0
    v_cvt_pk_bf16_f32 v218, v194, v195
    v_mov_b32 v219, 0
    v_pk_add_f32 v[176:177], v[176:177], v[178:179]
    v_pk_add_f32 v[176:177], v[176:177], v[180:181]
    v_pk_add_f32 v[176:177], v[176:177], v[182:183]
    v_pk_add_f32 v[176:177], v[176:177], v[184:185]
    v_pk_add_f32 v[176:177], v[176:177], v[186:187]
    v_pk_add_f32 v[176:177], v[176:177], v[188:189]
    v_pk_add_f32 v[176:177], v[176:177], v[190:191]
    v_pk_add_f32 v[176:177], v[176:177], v[192:193]
    v_pk_add_f32 v[176:177], v[176:177], v[194:195]
    v_add_f32 v220, v176, v177
    v_mov_b32 v221, v220
    s_nop 1
    v_permlane32_swap_b32 v220, v221
    v_add_f32 v220, v220, v221
    v_rcp_f32 v222, v220
    s_waitcnt vmcnt(0)
    v_permlane16_swap_b32 v160, v162
    v_permlane16_swap_b32 v164, v166
    v_permlane16_swap_b32 v168, v170
    v_permlane16_swap_b32 v172, v174
    v_mfma_f32_32x32x16_bf16 v[32:47], v[96:99], v[208:211], 0
    v_mfma_f32_32x32x16_bf16 v[32:47], v[100:103], v[212:215], v[32:47]
    v_mfma_f32_32x32x16_bf16 v[32:47], v[160:163], v[216:219], v[32:47]
    v_mfma_f32_32x32x16_bf16 v[48:63], v[104:107], v[208:211], 0
    v_mfma_f32_32x32x16_bf16 v[48:63], v[108:111], v[212:215], v[48:63]
    v_mfma_f32_32x32x16_bf16 v[48:63], v[164:167], v[216:219], v[48:63]
    v_mfma_f32_32x32x16_bf16 v[64:79], v[112:115], v[208:211], 0
    v_mfma_f32_32x32x16_bf16 v[64:79], v[116:119], v[212:215], v[64:79]
    v_mfma_f32_32x32x16_bf16 v[64:79], v[168:171], v[216:219], v[64:79]
    v_mfma_f32_32x32x16_bf16 v[80:95], v[120:123], v[208:211], 0
    v_mfma_f32_32x32x16_bf16 v[80:95], v[124:127], v[212:215], v[80:95]
    v_mfma_f32_32x32x16_bf16 v[80:95], v[172:175], v[216:219], v[80:95]
    s_add_u32 s19, s17, 4096
    v_pk_mul_f32 v[32:33], v[32:33], v[222:223] op_sel_hi:[1,0]
    v_cvt_pk_bf16_f32 v176, v32, v33
    v_pk_mul_f32 v[34:35], v[34:35], v[222:223] op_sel_hi:[1,0]
    v_cvt_pk_bf16_f32 v177, v34, v35
    v_pk_mul_f32 v[36:37], v[36:37], v[222:223] op_sel_hi:[1,0]
    v_cvt_pk_bf16_f32 v178, v36, v37
    v_pk_mul_f32 v[38:39], v[38:39], v[222:223] op_sel_hi:[1,0]
    v_cvt_pk_bf16_f32 v179, v38, v39
    buffer_store_dwordx4 v[176:179], v0, s[8:11], s17 offen offset:0 sc1
    v_pk_mul_f32 v[40:41], v[40:41], v[222:223] op_sel_hi:[1,0]
    v_cvt_pk_bf16_f32 v180, v40, v41
    v_pk_mul_f32 v[42:43], v[42:43], v[222:223] op_sel_hi:[1,0]
    v_cvt_pk_bf16_f32 v181, v42, v43
    v_pk_mul_f32 v[44:45], v[44:45], v[222:223] op_sel_hi:[1,0]
    v_cvt_pk_bf16_f32 v182, v44, v45
    v_pk_mul_f32 v[46:47], v[46:47], v[222:223] op_sel_hi:[1,0]
    v_cvt_pk_bf16_f32 v183, v46, v47
    buffer_store_dwordx4 v[180:183], v0, s[8:11], s17 offen offset:1024 sc1
    v_pk_mul_f32 v[48:49], v[48:49], v[222:223] op_sel_hi:[1,0]
    v_cvt_pk_bf16_f32 v184, v48, v49
    v_pk_mul_f32 v[50:51], v[50:51], v[222:223] op_sel_hi:[1,0]
    v_cvt_pk_bf16_f32 v185, v50, v51
    v_pk_mul_f32 v[52:53], v[52:53], v[222:223] op_sel_hi:[1,0]
    v_cvt_pk_bf16_f32 v186, v52, v53
    v_pk_mul_f32 v[54:55], v[54:55], v[222:223] op_sel_hi:[1,0]
    v_cvt_pk_bf16_f32 v187, v54, v55
    buffer_store_dwordx4 v[184:187], v0, s[8:11], s17 offen offset:2048 sc1
    v_pk_mul_f32 v[56:57], v[56:57], v[222:223] op_sel_hi:[1,0]
    v_cvt_pk_bf16_f32 v188, v56, v57
    v_pk_mul_f32 v[58:59], v[58:59], v[222:223] op_sel_hi:[1,0]
    v_cvt_pk_bf16_f32 v189, v58, v59
    v_pk_mul_f32 v[60:61], v[60:61], v[222:223] op_sel_hi:[1,0]
    v_cvt_pk_bf16_f32 v190, v60, v61
    v_pk_mul_f32 v[62:63], v[62:63], v[222:223] op_sel_hi:[1,0]
    v_cvt_pk_bf16_f32 v191, v62, v63
    buffer_store_dwordx4 v[188:191], v0, s[8:11], s17 offen offset:3072 sc1
    v_pk_mul_f32 v[64:65], v[64:65], v[222:223] op_sel_hi:[1,0]
    v_cvt_pk_bf16_f32 v176, v64, v65
    v_pk_mul_f32 v[66:67], v[66:67], v[222:223] op_sel_hi:[1,0]
    v_cvt_pk_bf16_f32 v177, v66, v67
    v_pk_mul_f32 v[68:69], v[68:69], v[222:223] op_sel_hi:[1,0]
    v_cvt_pk_bf16_f32 v178, v68, v69
    v_pk_mul_f32 v[70:71], v[70:71], v[222:223] op_sel_hi:[1,0]
    v_cvt_pk_bf16_f32 v179, v70, v71
    buffer_store_dwordx4 v[176:179], v0, s[8:11], s19 offen offset:0 sc1
    v_pk_mul_f32 v[72:73], v[72:73], v[222:223] op_sel_hi:[1,0]
    v_cvt_pk_bf16_f32 v180, v72, v73
    v_pk_mul_f32 v[74:75], v[74:75], v[222:223] op_sel_hi:[1,0]
    v_cvt_pk_bf16_f32 v181, v74, v75
    v_pk_mul_f32 v[76:77], v[76:77], v[222:223] op_sel_hi:[1,0]
    v_cvt_pk_bf16_f32 v182, v76, v77
    v_pk_mul_f32 v[78:79], v[78:79], v[222:223] op_sel_hi:[1,0]
    v_cvt_pk_bf16_f32 v183, v78, v79
    buffer_store_dwordx4 v[180:183], v0, s[8:11], s19 offen offset:1024 sc1
    v_pk_mul_f32 v[80:81], v[80:81], v[222:223] op_sel_hi:[1,0]
    v_cvt_pk_bf16_f32 v184, v80, v81
    v_pk_mul_f32 v[82:83], v[82:83], v[222:223] op_sel_hi:[1,0]
    v_cvt_pk_bf16_f32 v185, v82, v83
    v_pk_mul_f32 v[84:85], v[84:85], v[222:223] op_sel_hi:[1,0]
    v_cvt_pk_bf16_f32 v186, v84, v85
    v_pk_mul_f32 v[86:87], v[86:87], v[222:223] op_sel_hi:[1,0]
    v_cvt_pk_bf16_f32 v187, v86, v87
    buffer_store_dwordx4 v[184:187], v0, s[8:11], s19 offen offset:2048 sc1
    v_pk_mul_f32 v[88:89], v[88:89], v[222:223] op_sel_hi:[1,0]
    v_cvt_pk_bf16_f32 v188, v88, v89
    v_pk_mul_f32 v[90:91], v[90:91], v[222:223] op_sel_hi:[1,0]
    v_cvt_pk_bf16_f32 v189, v90, v91
    v_pk_mul_f32 v[92:93], v[92:93], v[222:223] op_sel_hi:[1,0]
    v_cvt_pk_bf16_f32 v190, v92, v93
    v_pk_mul_f32 v[94:95], v[94:95], v[222:223] op_sel_hi:[1,0]
    v_cvt_pk_bf16_f32 v191, v94, v95
    buffer_store_dwordx4 v[188:191], v0, s[8:11], s19 offen offset:3072 sc1
    s_waitcnt vmcnt(0)
    s_lshl_b32 s18, s6, 7
    s_add_u32 s18, s18, 263168
    v_mov_b32 v6, 0
    v_mov_b32 v7, 1
    s_mov_b64 exec, 1
    buffer_atomic_add v7, v6, s[8:11], s18 offen sc1
    s_mov_b64 exec, -1
    s_add_u32 s6, s6, 4
    s_cmp_lt_u32 s6, 64
    s_cbranch_scc1 L_atw_loop
    s_waitcnt vmcnt(0)
    s_branch L_wk_end
L_finrole:
    s_cmp_ge_u32 s90, 224
    s_cbranch_scc1 L_wk_end
    s_load_dwordx2 s[8:9], s[0:1], 112
    s_load_dwordx2 s[12:13], s[0:1], 40
    s_load_dwordx2 s[16:17], s[0:1], 80
    s_load_dwordx2 s[20:21], s[0:1], 96
    s_load_dwordx2 s[34:35], s[0:1], 104
    s_waitcnt lgkmcnt(0)
    s_mov_b32 s10, 268435456
    s_mov_b32 s11, 0x20000
    s_mov_b32 s14, 0x400000
    s_mov_b32 s15, 0x20000
    s_mov_b32 s18, 1835008
    s_mov_b32 s19, 0x20000
    s_mov_b32 s22, 2097152
    s_mov_b32 s23, 0x20000
    s_mov_b32 s37, 400000
    s_sub_u32 s28, s90, 32
    s_and_b32 s5, s28, 15
    s_lshr_b32 s6, s28, 4
    s_and_b32 s38, s6, 1
    s_lshr_b32 s6, s6, 1
    s_mov_b32 s40, 0x0000ffff
    s_cmp_eq_u32 s38, 1
    s_cselect_b32 s40, 0xffff0000, s40
    s_mov_b32 s41, s40
    s_lshr_b32 s42, s4, 1
    s_cmp_eq_u32 s42, s38
    s_cselect_b32 s42, -1, 0
    s_mov_b32 s43, s42
    v_and_b32 v1, 63, v0
    v_lshlrev_b32 v0, 4, v1
    v_lshrrev_b32 v16, 2, v1
    v_lshlrev_b32 v16, 10, v16
    v_and_b32 v17, 3, v1
    v_lshlrev_b32 v17, 4, v17
    v_add_u32 v3, v16, v17
    v_lshrrev_b32 v16, 5, v1
    v_lshlrev_b32 v16, 8, v16
    v_bfe_u32 v17, v1, 2, 2
    v_lshlrev_b32 v17, 6, v17
    v_add_u32 v16, v16, v17
    v_bfe_u32 v17, v1, 4, 1
    v_lshlrev_b32 v17, 5, v17
    v_and_b32 v18, 3, v1
    v_lshlrev_b32 v18, 3, v18
    v_add3_u32 v16, v16, v17, v18
    s_lshl_b32 s28, s4, 15
    v_add_u32 v2, s28, v16
    v_and_b32 v16, 31, v1
    v_lshlrev_b32 v17, 7, v16
    v_and_b32 v16, 7, v16
    v_lshrrev_b32 v18, 5, v1
    v_xor_b32 v16, v16, v18
    v_lshlrev_b32 v16, 4, v16
    v_add_u32 v16, v16, v17
    s_lshl_b32 s28, s4, 13
    v_add_u32 v4, s28, v16
    v_lshrrev_b32 v16, 3, v1
    v_and_b32 v17, 7, v1
    v_xor_b32 v18, v16, v17
    v_lshlrev_b32 v18, 4, v18
    v_lshlrev_b32 v16, 7, v16
    v_add_u32 v18, v18, v16
    s_lshl_b32 s28, s4, 10
    v_add_u32 v5, s28, v18
    v_lshrrev_b32 v16, 3, v1
    s_lshl_b32 s28, s4, 3
    v_add_u32 v16, s28, v16
    v_lshlrev_b32 v6, 2, v16
    v_lshlrev_b32 v16, 10, v16
    v_lshlrev_b32 v17, 3, v17
    v_add_u32 v7, v16, v17
    s_lshl_b32 s28, s4, 20
    s_lshl_b32 s30, s5, 6
    s_add_u32 s28, s28, s30
    s_lshl_b32 s29, s4, 15
    s_mov_b32 m0, s29
    s_nop 0
    buffer_load_dwordx4 v3, s[12:15], s28 offen lds
    s_add_u32 s28, s28, 16384
    s_add_u32 s29, s29, 1024
    s_mov_b32 m0, s29
    s_nop 0
    buffer_load_dwordx4 v3, s[12:15], s28 offen lds
    s_add_u32 s28, s28, 16384
    s_add_u32 s29, s29, 1024
    s_mov_b32 m0, s29
    s_nop 0
    buffer_load_dwordx4 v3, s[12:15], s28 offen lds
    s_add_u32 s28, s28, 16384
    s_add_u32 s29, s29, 1024
    s_mov_b32 m0, s29
    s_nop 0
    buffer_load_dwordx4 v3, s[12:15], s28 offen lds
    s_add_u32 s28, s28, 16384
    s_add_u32 s29, s29, 1024
    s_mov_b32 m0, s29
    s_nop 0
    buffer_load_dwordx4 v3, s[12:15], s28 offen lds
    s_add_u32 s28, s28, 16384
    s_add_u32 s29, s29, 1024
    s_mov_b32 m0, s29
    s_nop 0
    buffer_load_dwordx4 v3, s[12:15], s28 offen lds
    s_add_u32 s28, s28, 16384
    s_add_u32 s29, s29, 1024
    s_mov_b32 m0, s29
    s_nop 0
    buffer_load_dwordx4 v3, s[12:15], s28 offen lds
    s_add_u32 s28, s28, 16384
    s_add_u32 s29, s29, 1024
    s_mov_b32 m0, s29
    s_nop 0
    buffer_load_dwordx4 v3, s[12:15], s28 offen lds
    s_add_u32 s28, s28, 16384
    s_add_u32 s29, s29, 1024
    s_mov_b32 m0, s29
    s_nop 0
    buffer_load_dwordx4 v3, s[12:15], s28 offen lds
    s_add_u32 s28, s28, 16384
    s_add_u32 s29, s29, 1024
    s_mov_b32 m0, s29
    s_nop 0
    buffer_load_dwordx4 v3, s[12:15], s28 offen lds
    s_add_u32 s28, s28, 16384
    s_add_u32 s29, s29, 1024
    s_mov_b32 m0, s29
    s_nop 0
    buffer_load_dwordx4 v3, s[12:15], s28 offen lds
    s_add_u32 s28, s28, 16384
    s_add_u32 s29, s29, 1024
    s_mov_b32 m0, s29
    s_nop 0
    buffer_load_dwordx4 v3, s[12:15], s28 offen lds
    s_add_u32 s28, s28, 16384
    s_add_u32 s29, s29, 1024
    s_mov_b32 m0, s29
    s_nop 0
    buffer_load_dwordx4 v3, s[12:15], s28 offen lds
    s_add_u32 s28, s28, 16384
    s_add_u32 s29, s29, 1024
    s_mov_b32 m0, s29
    s_nop 0
    buffer_load_dwordx4 v3, s[12:15], s28 offen lds
    s_add_u32 s28, s28, 16384
    s_add_u32 s29, s29, 1024
    s_mov_b32 m0, s29
    s_nop 0
    buffer_load_dwordx4 v3, s[12:15], s28 offen lds
    s_add_u32 s28, s28, 16384
    s_add_u32 s29, s29, 1024
    s_mov_b32 m0, s29
    s_nop 0
    buffer_load_dwordx4 v3, s[12:15], s28 offen lds
    s_add_u32 s28, s28, 16384
    s_add_u32 s29, s29, 1024
    s_mov_b32 m0, s29
    s_nop 0
    buffer_load_dwordx4 v3, s[12:15], s28 offen lds
    s_add_u32 s28, s28, 16384
    s_add_u32 s29, s29, 1024
    s_mov_b32 m0, s29
    s_nop 0
    buffer_load_dwordx4 v3, s[12:15], s28 offen lds
    s_add_u32 s28, s28, 16384
    s_add_u32 s29, s29, 1024
    s_mov_b32 m0, s29
    s_nop 0
    buffer_load_dwordx4 v3, s[12:15], s28 offen lds
    s_add_u32 s28, s28, 16384
    s_add_u32 s29, s29, 1024
    s_mov_b32 m0, s29
    s_nop 0
    buffer_load_dwordx4 v3, s[12:15], s28 offen lds
    s_add_u32 s28, s28, 16384
    s_add_u32 s29, s29, 1024
    s_mov_b32 m0, s29
    s_nop 0
    buffer_load_dwordx4 v3, s[12:15], s28 offen lds
    s_add_u32 s28, s28, 16384
    s_add_u32 s29, s29, 1024
    s_mov_b32 m0, s29
    s_nop 0
    buffer_load_dwordx4 v3, s[12:15], s28 offen lds
    s_add_u32 s28, s28, 16384
    s_add_u32 s29, s29, 1024
    s_mov_b32 m0, s29
    s_nop 0
    buffer_load_dwordx4 v3, s[12:15], s28 offen lds
    s_add_u32 s28, s28, 16384
    s_add_u32 s29, s29, 1024
    s_mov_b32 m0, s29
    s_nop 0
    buffer_load_dwordx4 v3, s[12:15], s28 offen lds
    s_add_u32 s28, s28, 16384
    s_add_u32 s29, s29, 1024
    s_mov_b32 m0, s29
    s_nop 0
    buffer_load_dwordx4 v3, s[12:15], s28 offen lds
    s_add_u32 s28, s28, 16384
    s_add_u32 s29, s29, 1024
    s_mov_b32 m0, s29
    s_nop 0
    buffer_load_dwordx4 v3, s[12:15], s28 offen lds
    s_add_u32 s28, s28, 16384
    s_add_u32 s29, s29, 1024
    s_mov_b32 m0, s29
    s_nop 0
    buffer_load_dwordx4 v3, s[12:15], s28 offen lds
    s_add_u32 s28, s28, 16384
    s_add_u32 s29, s29, 1024
    s_mov_b32 m0, s29
    s_nop 0
    buffer_load_dwordx4 v3, s[12:15], s28 offen lds
    s_add_u32 s28, s28, 16384
    s_add_u32 s29, s29, 1024
    s_mov_b32 m0, s29
    s_nop 0
    buffer_load_dwordx4 v3, s[12:15], s28 offen lds
    s_add_u32 s28, s28, 16384
    s_add_u32 s29, s29, 1024
    s_mov_b32 m0, s29
    s_nop 0
    buffer_load_dwordx4 v3, s[12:15], s28 offen lds
    s_add_u32 s28, s28, 16384
    s_add_u32 s29, s29, 1024
    s_mov_b32 m0, s29
    s_nop 0
    buffer_load_dwordx4 v3, s[12:15], s28 offen lds
    s_add_u32 s28, s28, 16384
    s_add_u32 s29, s29, 1024
    s_mov_b32 m0, s29
    s_nop 0
    buffer_load_dwordx4 v3, s[12:15], s28 offen lds
    s_add_u32 s28, s28, 16384
    s_add_u32 s29, s29, 1024
    s_waitcnt vmcnt(0)
    ds_read_b64_tr_b16 a[0:1], v2 offset:0
    ds_read_b64_tr_b16 a[2:3], v2 offset:512
    ds_read_b64_tr_b16 a[4:5], v2 offset:1024
    ds_read_b64_tr_b16 a[6:7], v2 offset:1536
    ds_read_b64_tr_b16 a[8:9], v2 offset:2048
    ds_read_b64_tr_b16 a[10:11], v2 offset:2560
    ds_read_b64_tr_b16 a[12:13], v2 offset:3072
    ds_read_b64_tr_b16 a[14:15], v2 offset:3584
    ds_read_b64_tr_b16 a[16:17], v2 offset:4096
    ds_read_b64_tr_b16 a[18:19], v2 offset:4608
    ds_read_b64_tr_b16 a[20:21], v2 offset:5120
    ds_read_b64_tr_b16 a[22:23], v2 offset:5632
    s_waitcnt lgkmcnt(0)
    ds_read_b64_tr_b16 a[24:25], v2 offset:6144
    ds_read_b64_tr_b16 a[26:27], v2 offset:6656
    ds_read_b64_tr_b16 a[28:29], v2 offset:7168
    ds_read_b64_tr_b16 a[30:31], v2 offset:7680
    ds_read_b64_tr_b16 a[32:33], v2 offset:8192
    ds_read_b64_tr_b16 a[34:35], v2 offset:8704
    ds_read_b64_tr_b16 a[36:37], v2 offset:9216
    ds_read_b64_tr_b16 a[38:39], v2 offset:9728
    ds_read_b64_tr_b16 a[40:41], v2 offset:10240
    ds_read_b64_tr_b16 a[42:43], v2 offset:10752
    ds_read_b64_tr_b16 a[44:45], v2 offset:11264
    ds_read_b64_tr_b16 a[46:47], v2 offset:11776
    s_waitcnt lgkmcnt(0)
    ds_read_b64_tr_b16 a[48:49], v2 offset:12288
    ds_read_b64_tr_b16 a[50:51], v2 offset:12800
    ds_read_b64_tr_b16 a[52:53], v2 offset:13312
    ds_read_b64_tr_b16 a[54:55], v2 offset:13824
    ds_read_b64_tr_b16 a[56:57], v2 offset:14336
    ds_read_b64_tr_b16 a[58:59], v2 offset:14848
    ds_read_b64_tr_b16 a[60:61], v2 offset:15360
    ds_read_b64_tr_b16 a[62:63], v2 offset:15872
    ds_read_b64_tr_b16 a[64:65], v2 offset:16384
    ds_read_b64_tr_b16 a[66:67], v2 offset:16896
    ds_read_b64_tr_b16 a[68:69], v2 offset:17408
    ds_read_b64_tr_b16 a[70:71], v2 offset:17920
    s_waitcnt lgkmcnt(0)
    ds_read_b64_tr_b16 a[72:73], v2 offset:18432
    ds_read_b64_tr_b16 a[74:75], v2 offset:18944
    ds_read_b64_tr_b16 a[76:77], v2 offset:19456
    ds_read_b64_tr_b16 a[78:79], v2 offset:19968
    ds_read_b64_tr_b16 a[80:81], v2 offset:20480
    ds_read_b64_tr_b16 a[82:83], v2 offset:20992
    ds_read_b64_tr_b16 a[84:85], v2 offset:21504
    ds_read_b64_tr_b16 a[86:87], v2 offset:22016
    ds_read_b64_tr_b16 a[88:89], v2 offset:22528
    ds_read_b64_tr_b16 a[90:91], v2 offset:23040
    ds_read_b64_tr_b16 a[92:93], v2 offset:23552
    ds_read_b64_tr_b16 a[94:95], v2 offset:24064
    s_waitcnt lgkmcnt(0)
    ds_read_b64_tr_b16 a[96:97], v2 offset:24576
    ds_read_b64_tr_b16 a[98:99], v2 offset:25088
    ds_read_b64_tr_b16 a[100:101], v2 offset:25600
    ds_read_b64_tr_b16 a[102:103], v2 offset:26112
    ds_read_b64_tr_b16 a[104:105], v2 offset:26624
    ds_read_b64_tr_b16 a[106:107], v2 offset:27136
    ds_read_b64_tr_b16 a[108:109], v2 offset:27648
    ds_read_b64_tr_b16 a[110:111], v2 offset:28160
    ds_read_b64_tr_b16 a[112:113], v2 offset:28672
    ds_read_b64_tr_b16 a[114:115], v2 offset:29184
    ds_read_b64_tr_b16 a[116:117], v2 offset:29696
    ds_read_b64_tr_b16 a[118:119], v2 offset:30208
    s_waitcnt lgkmcnt(0)
    ds_read_b64_tr_b16 a[120:121], v2 offset:30720
    ds_read_b64_tr_b16 a[122:123], v2 offset:31232
    ds_read_b64_tr_b16 a[124:125], v2 offset:31744
    ds_read_b64_tr_b16 a[126:127], v2 offset:32256
    s_waitcnt lgkmcnt(0)
    s_lshl_b32 s29, s4, 15
    s_mov_b32 m0, s29
    s_nop 0
    buffer_load_dwordx4 v3, s[12:15], s28 offen lds
    s_add_u32 s28, s28, 16384
    s_add_u32 s29, s29, 1024
    s_mov_b32 m0, s29
    s_nop 0
    buffer_load_dwordx4 v3, s[12:15], s28 offen lds
    s_add_u32 s28, s28, 16384
    s_add_u32 s29, s29, 1024
    s_mov_b32 m0, s29
    s_nop 0
    buffer_load_dwordx4 v3, s[12:15], s28 offen lds
    s_add_u32 s28, s28, 16384
    s_add_u32 s29, s29, 1024
    s_mov_b32 m0, s29
    s_nop 0
    buffer_load_dwordx4 v3, s[12:15], s28 offen lds
    s_add_u32 s28, s28, 16384
    s_add_u32 s29, s29, 1024
    s_mov_b32 m0, s29
    s_nop 0
    buffer_load_dwordx4 v3, s[12:15], s28 offen lds
    s_add_u32 s28, s28, 16384
    s_add_u32 s29, s29, 1024
    s_mov_b32 m0, s29
    s_nop 0
    buffer_load_dwordx4 v3, s[12:15], s28 offen lds
    s_add_u32 s28, s28, 16384
    s_add_u32 s29, s29, 1024
    s_mov_b32 m0, s29
    s_nop 0
    buffer_load_dwordx4 v3, s[12:15], s28 offen lds
    s_add_u32 s28, s28, 16384
    s_add_u32 s29, s29, 1024
    s_mov_b32 m0, s29
    s_nop 0
    buffer_load_dwordx4 v3, s[12:15], s28 offen lds
    s_add_u32 s28, s28, 16384
    s_add_u32 s29, s29, 1024
    s_mov_b32 m0, s29
    s_nop 0
    buffer_load_dwordx4 v3, s[12:15], s28 offen lds
    s_add_u32 s28, s28, 16384
    s_add_u32 s29, s29, 1024
    s_mov_b32 m0, s29
    s_nop 0
    buffer_load_dwordx4 v3, s[12:15], s28 offen lds
    s_add_u32 s28, s28, 16384
    s_add_u32 s29, s29, 1024
    s_mov_b32 m0, s29
    s_nop 0
    buffer_load_dwordx4 v3, s[12:15], s28 offen lds
    s_add_u32 s28, s28, 16384
    s_add_u32 s29, s29, 1024
    s_mov_b32 m0, s29
    s_nop 0
    buffer_load_dwordx4 v3, s[12:15], s28 offen lds
    s_add_u32 s28, s28, 16384
    s_add_u32 s29, s29, 1024
    s_mov_b32 m0, s29
    s_nop 0
    buffer_load_dwordx4 v3, s[12:15], s28 offen lds
    s_add_u32 s28, s28, 16384
    s_add_u32 s29, s29, 1024
    s_mov_b32 m0, s29
    s_nop 0
    buffer_load_dwordx4 v3, s[12:15], s28 offen lds
    s_add_u32 s28, s28, 16384
    s_add_u32 s29, s29, 1024
    s_mov_b32 m0, s29
    s_nop 0
    buffer_load_dwordx4 v3, s[12:15], s28 offen lds
    s_add_u32 s28, s28, 16384
    s_add_u32 s29, s29, 1024
    s_mov_b32 m0, s29
    s_nop 0
    buffer_load_dwordx4 v3, s[12:15], s28 offen lds
    s_add_u32 s28, s28, 16384
    s_add_u32 s29, s29, 1024
    s_mov_b32 m0, s29
    s_nop 0
    buffer_load_dwordx4 v3, s[12:15], s28 offen lds
    s_add_u32 s28, s28, 16384
    s_add_u32 s29, s29, 1024
    s_mov_b32 m0, s29
    s_nop 0
    buffer_load_dwordx4 v3, s[12:15], s28 offen lds
    s_add_u32 s28, s28, 16384
    s_add_u32 s29, s29, 1024
    s_mov_b32 m0, s29
    s_nop 0
    buffer_load_dwordx4 v3, s[12:15], s28 offen lds
    s_add_u32 s28, s28, 16384
    s_add_u32 s29, s29, 1024
    s_mov_b32 m0, s29
    s_nop 0
    buffer_load_dwordx4 v3, s[12:15], s28 offen lds
    s_add_u32 s28, s28, 16384
    s_add_u32 s29, s29, 1024
    s_mov_b32 m0, s29
    s_nop 0
    buffer_load_dwordx4 v3, s[12:15], s28 offen lds
    s_add_u32 s28, s28, 16384
    s_add_u32 s29, s29, 1024
    s_mov_b32 m0, s29
    s_nop 0
    buffer_load_dwordx4 v3, s[12:15], s28 offen lds
    s_add_u32 s28, s28, 16384
    s_add_u32 s29, s29, 1024
    s_mov_b32 m0, s29
    s_nop 0
    buffer_load_dwordx4 v3, s[12:15], s28 offen lds
    s_add_u32 s28, s28, 16384
    s_add_u32 s29, s29, 1024
    s_mov_b32 m0, s29
    s_nop 0
    buffer_load_dwordx4 v3, s[12:15], s28 offen lds
    s_add_u32 s28, s28, 16384
    s_add_u32 s29, s29, 1024
    s_mov_b32 m0, s29
    s_nop 0
    buffer_load_dwordx4 v3, s[12:15], s28 offen lds
    s_add_u32 s28, s28, 16384
    s_add_u32 s29, s29, 1024
    s_mov_b32 m0, s29
    s_nop 0
    buffer_load_dwordx4 v3, s[12:15], s28 offen lds
    s_add_u32 s28, s28, 16384
    s_add_u32 s29, s29, 1024
    s_mov_b32 m0, s29
    s_nop 0
    buffer_load_dwordx4 v3, s[12:15], s28 offen lds
    s_add_u32 s28, s28, 16384
    s_add_u32 s29, s29, 1024
    s_mov_b32 m0, s29
    s_nop 0
    buffer_load_dwordx4 v3, s[12:15], s28 offen lds
    s_add_u32 s28, s28, 16384
    s_add_u32 s29, s29, 1024
    s_mov_b32 m0, s29
    s_nop 0
    buffer_load_dwordx4 v3, s[12:15], s28 offen lds
    s_add_u32 s28, s28, 16384
    s_add_u32 s29, s29, 1024
    s_mov_b32 m0, s29
    s_nop 0
    buffer_load_dwordx4 v3, s[12:15], s28 offen lds
    s_add_u32 s28, s28, 16384
    s_add_u32 s29, s29, 1024
    s_mov_b32 m0, s29
    s_nop 0
    buffer_load_dwordx4 v3, s[12:15], s28 offen lds
    s_add_u32 s28, s28, 16384
    s_add_u32 s29, s29, 1024
    s_mov_b32 m0, s29
    s_nop 0
    buffer_load_dwordx4 v3, s[12:15], s28 offen lds
    s_add_u32 s28, s28, 16384
    s_add_u32 s29, s29, 1024
    s_waitcnt vmcnt(0)
    ds_read_b64_tr_b16 a[128:129], v2 offset:0
    ds_read_b64_tr_b16 a[130:131], v2 offset:512
    ds_read_b64_tr_b16 a[132:133], v2 offset:1024
    ds_read_b64_tr_b16 a[134:135], v2 offset:1536
    ds_read_b64_tr_b16 a[136:137], v2 offset:2048
    ds_read_b64_tr_b16 a[138:139], v2 offset:2560
    ds_read_b64_tr_b16 a[140:141], v2 offset:3072
    ds_read_b64_tr_b16 a[142:143], v2 offset:3584
    ds_read_b64_tr_b16 a[144:145], v2 offset:4096
    ds_read_b64_tr_b16 a[146:147], v2 offset:4608
    ds_read_b64_tr_b16 a[148:149], v2 offset:5120
    ds_read_b64_tr_b16 a[150:151], v2 offset:5632
    s_waitcnt lgkmcnt(0)
    ds_read_b64_tr_b16 a[152:153], v2 offset:6144
    ds_read_b64_tr_b16 a[154:155], v2 offset:6656
    ds_read_b64_tr_b16 a[156:157], v2 offset:7168
    ds_read_b64_tr_b16 a[158:159], v2 offset:7680
    ds_read_b64_tr_b16 a[160:161], v2 offset:8192
    ds_read_b64_tr_b16 a[162:163], v2 offset:8704
    ds_read_b64_tr_b16 a[164:165], v2 offset:9216
    ds_read_b64_tr_b16 a[166:167], v2 offset:9728
    ds_read_b64_tr_b16 a[168:169], v2 offset:10240
    ds_read_b64_tr_b16 a[170:171], v2 offset:10752
    ds_read_b64_tr_b16 a[172:173], v2 offset:11264
    ds_read_b64_tr_b16 a[174:175], v2 offset:11776
    s_waitcnt lgkmcnt(0)
    ds_read_b64_tr_b16 a[176:177], v2 offset:12288
    ds_read_b64_tr_b16 a[178:179], v2 offset:12800
    ds_read_b64_tr_b16 a[180:181], v2 offset:13312
    ds_read_b64_tr_b16 a[182:183], v2 offset:13824
    ds_read_b64_tr_b16 a[184:185], v2 offset:14336
    ds_read_b64_tr_b16 a[186:187], v2 offset:14848
    ds_read_b64_tr_b16 a[188:189], v2 offset:15360
    ds_read_b64_tr_b16 a[190:191], v2 offset:15872
    ds_read_b64_tr_b16 a[192:193], v2 offset:16384
    ds_read_b64_tr_b16 a[194:195], v2 offset:16896
    ds_read_b64_tr_b16 a[196:197], v2 offset:17408
    ds_read_b64_tr_b16 a[198:199], v2 offset:17920
    s_waitcnt lgkmcnt(0)
    ds_read_b64_tr_b16 a[200:201], v2 offset:18432
    ds_read_b64_tr_b16 a[202:203], v2 offset:18944
    ds_read_b64_tr_b16 a[204:205], v2 offset:19456
    ds_read_b64_tr_b16 a[206:207], v2 offset:19968
    ds_read_b64_tr_b16 a[208:209], v2 offset:20480
    ds_read_b64_tr_b16 a[210:211], v2 offset:20992
    ds_read_b64_tr_b16 a[212:213], v2 offset:21504
    ds_read_b64_tr_b16 a[214:215], v2 offset:22016
    ds_read_b64_tr_b16 a[216:217], v2 offset:22528
    ds_read_b64_tr_b16 a[218:219], v2 offset:23040
    ds_read_b64_tr_b16 a[220:221], v2 offset:23552
    ds_read_b64_tr_b16 a[222:223], v2 offset:24064
    s_waitcnt lgkmcnt(0)
    ds_read_b64_tr_b16 a[224:225], v2 offset:24576
    ds_read_b64_tr_b16 a[226:227], v2 offset:25088
    ds_read_b64_tr_b16 a[228:229], v2 offset:25600
    ds_read_b64_tr_b16 a[230:231], v2 offset:26112
    ds_read_b64_tr_b16 a[232:233], v2 offset:26624
    ds_read_b64_tr_b16 a[234:235], v2 offset:27136
    ds_read_b64_tr_b16 a[236:237], v2 offset:27648
    ds_read_b64_tr_b16 a[238:239], v2 offset:28160
    ds_read_b64_tr_b16 a[240:241], v2 offset:28672
    ds_read_b64_tr_b16 a[242:243], v2 offset:29184
    ds_read_b64_tr_b16 a[244:245], v2 offset:29696
    ds_read_b64_tr_b16 a[246:247], v2 offset:30208
    s_waitcnt lgkmcnt(0)
    ds_read_b64_tr_b16 a[248:249], v2 offset:30720
    ds_read_b64_tr_b16 a[250:251], v2 offset:31232
    ds_read_b64_tr_b16 a[252:253], v2 offset:31744
    ds_read_b64_tr_b16 a[254:255], v2 offset:32256
    s_waitcnt lgkmcnt(0)
    s_mul_i32 s28, s4, 458752
    s_add_u32 s28, s28, s30
    s_lshl_b32 s29, s4, 15
    s_mov_b32 m0, s29
    s_nop 0
    buffer_load_dwordx4 v3, s[16:19], s28 offen lds
    s_add_u32 s28, s28, 16384
    s_add_u32 s29, s29, 1024
    s_mov_b32 m0, s29
    s_nop 0
    buffer_load_dwordx4 v3, s[16:19], s28 offen lds
    s_add_u32 s28, s28, 16384
    s_add_u32 s29, s29, 1024
    s_mov_b32 m0, s29
    s_nop 0
    buffer_load_dwordx4 v3, s[16:19], s28 offen lds
    s_add_u32 s28, s28, 16384
    s_add_u32 s29, s29, 1024
    s_mov_b32 m0, s29
    s_nop 0
    buffer_load_dwordx4 v3, s[16:19], s28 offen lds
    s_add_u32 s28, s28, 16384
    s_add_u32 s29, s29, 1024
    s_mov_b32 m0, s29
    s_nop 0
    buffer_load_dwordx4 v3, s[16:19], s28 offen lds
    s_add_u32 s28, s28, 16384
    s_add_u32 s29, s29, 1024
    s_mov_b32 m0, s29
    s_nop 0
    buffer_load_dwordx4 v3, s[16:19], s28 offen lds
    s_add_u32 s28, s28, 16384
    s_add_u32 s29, s29, 1024
    s_mov_b32 m0, s29
    s_nop 0
    buffer_load_dwordx4 v3, s[16:19], s28 offen lds
    s_add_u32 s28, s28, 16384
    s_add_u32 s29, s29, 1024
    s_mov_b32 m0, s29
    s_nop 0
    buffer_load_dwordx4 v3, s[16:19], s28 offen lds
    s_add_u32 s28, s28, 16384
    s_add_u32 s29, s29, 1024
    s_mov_b32 m0, s29
    s_nop 0
    buffer_load_dwordx4 v3, s[16:19], s28 offen lds
    s_add_u32 s28, s28, 16384
    s_add_u32 s29, s29, 1024
    s_mov_b32 m0, s29
    s_nop 0
    buffer_load_dwordx4 v3, s[16:19], s28 offen lds
    s_add_u32 s28, s28, 16384
    s_add_u32 s29, s29, 1024
    s_mov_b32 m0, s29
    s_nop 0
    buffer_load_dwordx4 v3, s[16:19], s28 offen lds
    s_add_u32 s28, s28, 16384
    s_add_u32 s29, s29, 1024
    s_mov_b32 m0, s29
    s_nop 0
    buffer_load_dwordx4 v3, s[16:19], s28 offen lds
    s_add_u32 s28, s28, 16384
    s_add_u32 s29, s29, 1024
    s_mov_b32 m0, s29
    s_nop 0
    buffer_load_dwordx4 v3, s[16:19], s28 offen lds
    s_add_u32 s28, s28, 16384
    s_add_u32 s29, s29, 1024
    s_mov_b32 m0, s29
    s_nop 0
    buffer_load_dwordx4 v3, s[16:19], s28 offen lds
    s_add_u32 s28, s28, 16384
    s_add_u32 s29, s29, 1024
    s_mov_b32 m0, s29
    s_nop 0
    buffer_load_dwordx4 v3, s[16:19], s28 offen lds
    s_add_u32 s28, s28, 16384
    s_add_u32 s29, s29, 1024
    s_mov_b32 m0, s29
    s_nop 0
    buffer_load_dwordx4 v3, s[16:19], s28 offen lds
    s_add_u32 s28, s28, 16384
    s_add_u32 s29, s29, 1024
    s_mov_b32 m0, s29
    s_nop 0
    buffer_load_dwordx4 v3, s[16:19], s28 offen lds
    s_add_u32 s28, s28, 16384
    s_add_u32 s29, s29, 1024
    s_mov_b32 m0, s29
    s_nop 0
    buffer_load_dwordx4 v3, s[16:19], s28 offen lds
    s_add_u32 s28, s28, 16384
    s_add_u32 s29, s29, 1024
    s_mov_b32 m0, s29
    s_nop 0
    buffer_load_dwordx4 v3, s[16:19], s28 offen lds
    s_add_u32 s28, s28, 16384
    s_add_u32 s29, s29, 1024
    s_mov_b32 m0, s29
    s_nop 0
    buffer_load_dwordx4 v3, s[16:19], s28 offen lds
    s_add_u32 s28, s28, 16384
    s_add_u32 s29, s29, 1024
    s_mov_b32 m0, s29
    s_nop 0
    buffer_load_dwordx4 v3, s[16:19], s28 offen lds
    s_add_u32 s28, s28, 16384
    s_add_u32 s29, s29, 1024
    s_mov_b32 m0, s29
    s_nop 0
    buffer_load_dwordx4 v3, s[16:19], s28 offen lds
    s_add_u32 s28, s28, 16384
    s_add_u32 s29, s29, 1024
    s_mov_b32 m0, s29
    s_nop 0
    buffer_load_dwordx4 v3, s[16:19], s28 offen lds
    s_add_u32 s28, s28, 16384
    s_add_u32 s29, s29, 1024
    s_mov_b32 m0, s29
    s_nop 0
    buffer_load_dwordx4 v3, s[16:19], s28 offen lds
    s_add_u32 s28, s28, 16384
    s_add_u32 s29, s29, 1024
    s_mov_b32 m0, s29
    s_nop 0
    buffer_load_dwordx4 v3, s[16:19], s28 offen lds
    s_add_u32 s28, s28, 16384
    s_add_u32 s29, s29, 1024
    s_mov_b32 m0, s29
    s_nop 0
    buffer_load_dwordx4 v3, s[16:19], s28 offen lds
    s_add_u32 s28, s28, 16384
    s_add_u32 s29, s29, 1024
    s_mov_b32 m0, s29
    s_nop 0
    buffer_load_dwordx4 v3, s[16:19], s28 offen lds
    s_add_u32 s28, s28, 16384
    s_add_u32 s29, s29, 1024
    s_mov_b32 m0, s29
    s_nop 0
    buffer_load_dwordx4 v3, s[16:19], s28 offen lds
    s_add_u32 s28, s28, 16384
    s_add_u32 s29, s29, 1024
    s_waitcnt vmcnt(0)
    ds_read_b64_tr_b16 v[144:145], v2 offset:0
    ds_read_b64_tr_b16 v[146:147], v2 offset:512
    ds_read_b64_tr_b16 v[148:149], v2 offset:1024
    ds_read_b64_tr_b16 v[150:151], v2 offset:1536
    ds_read_b64_tr_b16 v[152:153], v2 offset:2048
    ds_read_b64_tr_b16 v[154:155], v2 offset:2560
    ds_read_b64_tr_b16 v[156:157], v2 offset:3072
    ds_read_b64_tr_b16 v[158:159], v2 offset:3584
    ds_read_b64_tr_b16 v[160:161], v2 offset:4096
    ds_read_b64_tr_b16 v[162:163], v2 offset:4608
    ds_read_b64_tr_b16 v[164:165], v2 offset:5120
    ds_read_b64_tr_b16 v[166:167], v2 offset:5632
    s_waitcnt lgkmcnt(0)
    ds_read_b64_tr_b16 v[168:169], v2 offset:6144
    ds_read_b64_tr_b16 v[170:171], v2 offset:6656
    ds_read_b64_tr_b16 v[172:173], v2 offset:7168
    ds_read_b64_tr_b16 v[174:175], v2 offset:7680
    ds_read_b64_tr_b16 v[176:177], v2 offset:8192
    ds_read_b64_tr_b16 v[178:179], v2 offset:8704
    ds_read_b64_tr_b16 v[180:181], v2 offset:9216
    ds_read_b64_tr_b16 v[182:183], v2 offset:9728
    ds_read_b64_tr_b16 v[184:185], v2 offset:10240
    ds_read_b64_tr_b16 v[186:187], v2 offset:10752
    ds_read_b64_tr_b16 v[188:189], v2 offset:11264
    ds_read_b64_tr_b16 v[190:191], v2 offset:11776
    s_waitcnt lgkmcnt(0)
    ds_read_b64_tr_b16 v[192:193], v2 offset:12288
    ds_read_b64_tr_b16 v[194:195], v2 offset:12800
    ds_read_b64_tr_b16 v[196:197], v2 offset:13312
    ds_read_b64_tr_b16 v[198:199], v2 offset:13824
    ds_read_b64_tr_b16 v[200:201], v2 offset:14336
    ds_read_b64_tr_b16 v[202:203], v2 offset:14848
    ds_read_b64_tr_b16 v[204:205], v2 offset:15360
    ds_read_b64_tr_b16 v[206:207], v2 offset:15872
    ds_read_b64_tr_b16 v[208:209], v2 offset:16384
    ds_read_b64_tr_b16 v[210:211], v2 offset:16896
    ds_read_b64_tr_b16 v[212:213], v2 offset:17408
    ds_read_b64_tr_b16 v[214:215], v2 offset:17920
    s_waitcnt lgkmcnt(0)
    ds_read_b64_tr_b16 v[216:217], v2 offset:18432
    ds_read_b64_tr_b16 v[218:219], v2 offset:18944
    ds_read_b64_tr_b16 v[220:221], v2 offset:19456
    ds_read_b64_tr_b16 v[222:223], v2 offset:19968
    ds_read_b64_tr_b16 v[224:225], v2 offset:20480
    ds_read_b64_tr_b16 v[226:227], v2 offset:20992
    ds_read_b64_tr_b16 v[228:229], v2 offset:21504
    ds_read_b64_tr_b16 v[230:231], v2 offset:22016
    ds_read_b64_tr_b16 v[232:233], v2 offset:22528
    ds_read_b64_tr_b16 v[234:235], v2 offset:23040
    ds_read_b64_tr_b16 v[236:237], v2 offset:23552
    ds_read_b64_tr_b16 v[238:239], v2 offset:24064
    s_waitcnt lgkmcnt(0)
    ds_read_b64_tr_b16 v[240:241], v2 offset:24576
    ds_read_b64_tr_b16 v[242:243], v2 offset:25088
    ds_read_b64_tr_b16 v[244:245], v2 offset:25600
    ds_read_b64_tr_b16 v[246:247], v2 offset:26112
    ds_read_b64_tr_b16 v[248:249], v2 offset:26624
    ds_read_b64_tr_b16 v[250:251], v2 offset:27136
    ds_read_b64_tr_b16 v[252:253], v2 offset:27648
    ds_read_b64_tr_b16 v[254:255], v2 offset:28160
    s_waitcnt lgkmcnt(0)
    s_barrier
L_finw_loop:
    s_lshl_b32 s24, s6, 18
    s_lshl_b32 s28, s4, 16
    s_add_u32 s24, s24, s28
    s_add_u32 s24, s24, 67108864
    s_mul_i32 s25, s6, 114688
    s_mul_i32 s28, s4, 28672
    s_add_u32 s25, s25, s28
    s_add_u32 s25, s25, 109051904
    s_lshr_b32 s29, s6, 3
    s_lshl_b32 s29, s29, 7
    s_add_u32 s29, s29, 262144
    s_cmp_lg_u32 s4, 0
    s_cbranch_scc1 L_finw_p1_d
    v_mov_b32 v11, s29
    s_mov_b32 s36, 0
L_finw_p1:
    buffer_load_dword v10, v11, s[8:11], 0 offen sc1
    s_waitcnt vmcnt(0)
    v_readfirstlane_b32 s28, v10
    s_lshr_b32 s28, s28, 16
    s_cmp_eq_u32 s28, 284
    s_cbranch_scc1 L_finw_p1_d
    s_sleep 16
    s_add_u32 s36, s36, 1
    s_cmp_lt_u32 s36, s37
    s_cbranch_scc1 L_finw_p1
    s_mov_b32 s37, 0
L_finw_p1_d:
    s_barrier
    s_lshl_b32 s28, s6, 7
    s_add_u32 s28, s28, 3145728
    buffer_load_dword v9, v6, s[8:11], s28 offen
    s_mov_b64 exec, s[40:41]
    buffer_load_dwordx4 v[48:51], v0, s[8:11], s25 offen offset:0
    s_mov_b64 exec, -1
    s_mov_b64 exec, s[40:41]
    buffer_load_dwordx4 v[52:55], v0, s[8:11], s25 offen offset:1024
    s_mov_b64 exec, -1
    s_mov_b64 exec, s[40:41]
    buffer_load_dwordx4 v[56:59], v0, s[8:11], s25 offen offset:2048
    s_mov_b64 exec, -1
    s_mov_b64 exec, s[40:41]
    buffer_load_dwordx4 v[60:63], v0, s[8:11], s25 offen offset:3072
    s_mov_b64 exec, -1
    s_mov_b64 exec, s[40:41]
    s_add_u32 s29, s25, 4096
    buffer_load_dwordx4 v[64:67], v0, s[8:11], s29 offen offset:0
    s_mov_b64 exec, -1
    s_mov_b64 exec, s[40:41]
    s_add_u32 s29, s25, 4096
    buffer_load_dwordx4 v[68:71], v0, s[8:11], s29 offen offset:1024
    s_mov_b64 exec, -1
    s_mov_b64 exec, s[40:41]
    s_add_u32 s29, s25, 4096
    buffer_load_dwordx4 v[72:75], v0, s[8:11], s29 offen offset:2048
    s_mov_b64 exec, -1
    s_mov_b64 exec, s[40:41]
    s_add_u32 s29, s25, 4096
    buffer_load_dwordx4 v[76:79], v0, s[8:11], s29 offen offset:3072
    s_mov_b64 exec, -1
    s_mov_b64 exec, s[40:41]
    s_add_u32 s29, s25, 8192
    buffer_load_dwordx4 v[80:83], v0, s[8:11], s29 offen offset:0
    s_mov_b64 exec, -1
    s_mov_b64 exec, s[40:41]
    s_add_u32 s29, s25, 8192
    buffer_load_dwordx4 v[84:87], v0, s[8:11], s29 offen offset:1024
    s_mov_b64 exec, -1
    s_mov_b64 exec, s[40:41]
    s_add_u32 s29, s25, 8192
    buffer_load_dwordx4 v[88:91], v0, s[8:11], s29 offen offset:2048
    s_mov_b64 exec, -1
    s_mov_b64 exec, s[40:41]
    s_add_u32 s29, s25, 8192
    buffer_load_dwordx4 v[92:95], v0, s[8:11], s29 offen offset:3072
    s_mov_b64 exec, -1
    s_mov_b64 exec, s[40:41]
    s_add_u32 s29, s25, 12288
    buffer_load_dwordx4 v[96:99], v0, s[8:11], s29 offen offset:0
    s_mov_b64 exec, -1
    s_mov_b64 exec, s[40:41]
    s_add_u32 s29, s25, 12288
    buffer_load_dwordx4 v[100:103], v0, s[8:11], s29 offen offset:1024
    s_mov_b64 exec, -1
    s_mov_b64 exec, s[40:41]
    s_add_u32 s29, s25, 12288
    buffer_load_dwordx4 v[104:107], v0, s[8:11], s29 offen offset:2048
    s_mov_b64 exec, -1
    s_mov_b64 exec, s[40:41]
    s_add_u32 s29, s25, 12288
    buffer_load_dwordx4 v[108:111], v0, s[8:11], s29 offen offset:3072
    s_mov_b64 exec, -1
    s_mov_b64 exec, s[40:41]
    s_add_u32 s29, s25, 16384
    buffer_load_dwordx4 v[112:115], v0, s[8:11], s29 offen offset:0
    s_mov_b64 exec, -1
    s_mov_b64 exec, s[40:41]
    s_add_u32 s29, s25, 16384
    buffer_load_dwordx4 v[116:119], v0, s[8:11], s29 offen offset:1024
    s_mov_b64 exec, -1
    s_mov_b64 exec, s[40:41]
    s_add_u32 s29, s25, 16384
    buffer_load_dwordx4 v[120:123], v0, s[8:11], s29 offen offset:2048
    s_mov_b64 exec, -1
    s_mov_b64 exec, s[40:41]
    s_add_u32 s29, s25, 16384
    buffer_load_dwordx4 v[124:127], v0, s[8:11], s29 offen offset:3072
    s_mov_b64 exec, -1
    s_mov_b64 exec, s[40:41]
    s_add_u32 s29, s25, 20480
    buffer_load_dwordx4 v[128:131], v0, s[8:11], s29 offen offset:0
    s_mov_b64 exec, -1
    s_mov_b64 exec, s[40:41]
    s_add_u32 s29, s25, 20480
    buffer_load_dwordx4 v[132:135], v0, s[8:11], s29 offen offset:1024
    s_mov_b64 exec, -1
    s_mov_b64 exec, s[40:41]
    s_add_u32 s29, s25, 20480
    buffer_load_dwordx4 v[136:139], v0, s[8:11], s29 offen offset:2048
    s_mov_b64 exec, -1
    s_mov_b64 exec, s[40:41]
    s_add_u32 s29, s25, 20480
    buffer_load_dwordx4 v[140:143], v0, s[8:11], s29 offen offset:3072
    s_mov_b64 exec, -1
    s_waitcnt vmcnt(23)
    v_mfma_f32_32x32x16_bf16 v[32:47], v[144:147], v[48:51], 0
    s_mov_b64 exec, s[40:41]
    s_add_u32 s29, s25, 24576
    buffer_load_dwordx4 v[48:51], v0, s[8:11], s29 offen offset:0
    s_mov_b64 exec, -1
    s_waitcnt vmcnt(23)
    v_mfma_f32_32x32x16_bf16 v[32:47], v[148:151], v[52:55], v[32:47]
    s_mov_b64 exec, s[40:41]
    s_add_u32 s29, s25, 24576
    buffer_load_dwordx4 v[52:55], v0, s[8:11], s29 offen offset:1024
    s_mov_b64 exec, -1
    s_waitcnt vmcnt(23)
    v_mfma_f32_32x32x16_bf16 v[32:47], v[152:155], v[56:59], v[32:47]
    s_mov_b64 exec, s[40:41]
    s_add_u32 s29, s25, 24576
    buffer_load_dwordx4 v[56:59], v0, s[8:11], s29 offen offset:2048
    s_mov_b64 exec, -1
    s_waitcnt vmcnt(23)
    v_mfma_f32_32x32x16_bf16 v[32:47], v[156:159], v[60:63], v[32:47]
    s_mov_b64 exec, s[40:41]
    s_add_u32 s29, s25, 24576
    buffer_load_dwordx4 v[60:63], v0, s[8:11], s29 offen offset:3072
    s_mov_b64 exec, -1
    s_waitcnt vmcnt(23)
    v_mfma_f32_32x32x16_bf16 v[32:47], v[160:163], v[64:67], v[32:47]
    s_waitcnt vmcnt(22)
    v_mfma_f32_32x32x16_bf16 v[32:47], v[164:167], v[68:71], v[32:47]
    s_waitcnt vmcnt(21)
    v_mfma_f32_32x32x16_bf16 v[32:47], v[168:171], v[72:75], v[32:47]
    s_waitcnt vmcnt(20)
    v_mfma_f32_32x32x16_bf16 v[32:47], v[172:175], v[76:79], v[32:47]
    s_waitcnt vmcnt(19)
    v_mfma_f32_32x32x16_bf16 v[32:47], v[176:179], v[80:83], v[32:47]
    s_waitcnt vmcnt(18)
    v_mfma_f32_32x32x16_bf16 v[32:47], v[180:183], v[84:87], v[32:47]
    s_waitcnt vmcnt(17)
    v_mfma_f32_32x32x16_bf16 v[32:47], v[184:187], v[88:91], v[32:47]
    s_waitcnt vmcnt(16)
    v_mfma_f32_32x32x16_bf16 v[32:47], v[188:191], v[92:95], v[32:47]
    s_waitcnt vmcnt(15)
    v_mfma_f32_32x32x16_bf16 v[32:47], v[192:195], v[96:99], v[32:47]
    s_waitcnt vmcnt(14)
    v_mfma_f32_32x32x16_bf16 v[32:47], v[196:199], v[100:103], v[32:47]
    s_waitcnt vmcnt(13)
    v_mfma_f32_32x32x16_bf16 v[32:47], v[200:203], v[104:107], v[32:47]
    s_waitcnt vmcnt(12)
    v_mfma_f32_32x32x16_bf16 v[32:47], v[204:207], v[108:111], v[32:47]
    s_waitcnt vmcnt(11)
    v_mfma_f32_32x32x16_bf16 v[32:47], v[208:211], v[112:115], v[32:47]
    s_waitcnt vmcnt(10)
    v_mfma_f32_32x32x16_bf16 v[32:47], v[212:215], v[116:119], v[32:47]
    s_waitcnt vmcnt(9)
    v_mfma_f32_32x32x16_bf16 v[32:47], v[216:219], v[120:123], v[32:47]
    s_waitcnt vmcnt(8)
    v_mfma_f32_32x32x16_bf16 v[32:47], v[220:223], v[124:127], v[32:47]
    s_waitcnt vmcnt(7)
    v_mfma_f32_32x32x16_bf16 v[32:47], v[224:227], v[128:131], v[32:47]
    s_waitcnt vmcnt(6)
    v_mfma_f32_32x32x16_bf16 v[32:47], v[228:231], v[132:135], v[32:47]
    s_waitcnt vmcnt(5)
    v_mfma_f32_32x32x16_bf16 v[32:47], v[232:235], v[136:139], v[32:47]
    s_waitcnt vmcnt(4)
    v_mfma_f32_32x32x16_bf16 v[32:47], v[236:239], v[140:143], v[32:47]
    s_waitcnt vmcnt(3)
    v_mfma_f32_32x32x16_bf16 v[32:47], v[240:243], v[48:51], v[32:47]
    s_waitcnt vmcnt(2)
    v_mfma_f32_32x32x16_bf16 v[32:47], v[244:247], v[52:55], v[32:47]
    s_waitcnt vmcnt(1)
    v_mfma_f32_32x32x16_bf16 v[32:47], v[248:251], v[56:59], v[32:47]
    s_waitcnt vmcnt(0)
    v_mfma_f32_32x32x16_bf16 v[32:47], v[252:255], v[60:63], v[32:47]
    s_lshl_b32 s29, s6, 7
    s_add_u32 s29, s29, 263168
    s_cmp_lg_u32 s4, 0
    s_cbranch_scc1 L_finw_p2_d
    v_mov_b32 v11, s29
    s_mov_b32 s36, 0
L_finw_p2:
    buffer_load_dword v10, v11, s[8:11], 0 offen sc1
    s_waitcnt vmcnt(0)
    v_readfirstlane_b32 s28, v10
    s_cmp_eq_u32 s28, 32
    s_cbranch_scc1 L_finw_p2_d
    s_sleep 6
    s_add_u32 s36, s36, 1
    s_cmp_lt_u32 s36, s37
    s_cbranch_scc1 L_finw_p2
    s_mov_b32 s37, 0
L_finw_p2_d:
    s_barrier
    s_mov_b64 exec, s[40:41]
    buffer_load_dwordx4 v[64:67], v0, s[8:11], s24 offen offset:0
    s_mov_b64 exec, -1
    s_mov_b64 exec, s[40:41]
    buffer_load_dwordx4 v[68:71], v0, s[8:11], s24 offen offset:1024
    s_mov_b64 exec, -1
    s_mov_b64 exec, s[40:41]
    buffer_load_dwordx4 v[72:75], v0, s[8:11], s24 offen offset:2048
    s_mov_b64 exec, -1
    s_mov_b64 exec, s[40:41]
    buffer_load_dwordx4 v[76:79], v0, s[8:11], s24 offen offset:3072
    s_mov_b64 exec, -1
    s_mov_b64 exec, s[40:41]
    s_add_u32 s29, s24, 4096
    buffer_load_dwordx4 v[80:83], v0, s[8:11], s29 offen offset:0
    s_mov_b64 exec, -1
    s_mov_b64 exec, s[40:41]
    s_add_u32 s29, s24, 4096
    buffer_load_dwordx4 v[84:87], v0, s[8:11], s29 offen offset:1024
    s_mov_b64 exec, -1
    s_mov_b64 exec, s[40:41]
    s_add_u32 s29, s24, 4096
    buffer_load_dwordx4 v[88:91], v0, s[8:11], s29 offen offset:2048
    s_mov_b64 exec, -1
    s_mov_b64 exec, s[40:41]
    s_add_u32 s29, s24, 4096
    buffer_load_dwordx4 v[92:95], v0, s[8:11], s29 offen offset:3072
    s_mov_b64 exec, -1
    s_mov_b64 exec, s[40:41]
    s_add_u32 s29, s24, 8192
    buffer_load_dwordx4 v[96:99], v0, s[8:11], s29 offen offset:0
    s_mov_b64 exec, -1
    s_mov_b64 exec, s[40:41]
    s_add_u32 s29, s24, 8192
    buffer_load_dwordx4 v[100:103], v0, s[8:11], s29 offen offset:1024
    s_mov_b64 exec, -1
    s_mov_b64 exec, s[40:41]
    s_add_u32 s29, s24, 8192
    buffer_load_dwordx4 v[104:107], v0, s[8:11], s29 offen offset:2048
    s_mov_b64 exec, -1
    s_mov_b64 exec, s[40:41]
    s_add_u32 s29, s24, 8192
    buffer_load_dwordx4 v[108:111], v0, s[8:11], s29 offen offset:3072
    s_mov_b64 exec, -1
    s_mov_b64 exec, s[40:41]
    s_add_u32 s29, s24, 12288
    buffer_load_dwordx4 v[112:115], v0, s[8:11], s29 offen offset:0
    s_mov_b64 exec, -1
    s_mov_b64 exec, s[40:41]
    s_add_u32 s29, s24, 12288
    buffer_load_dwordx4 v[116:119], v0, s[8:11], s29 offen offset:1024
    s_mov_b64 exec, -1
    s_mov_b64 exec, s[40:41]
    s_add_u32 s29, s24, 12288
    buffer_load_dwordx4 v[120:123], v0, s[8:11], s29 offen offset:2048
    s_mov_b64 exec, -1
    s_mov_b64 exec, s[40:41]
    s_add_u32 s29, s24, 12288
    buffer_load_dwordx4 v[124:127], v0, s[8:11], s29 offen offset:3072
    s_mov_b64 exec, -1
    s_mov_b64 exec, s[40:41]
    s_add_u32 s29, s24, 16384
    buffer_load_dwordx4 v[128:131], v0, s[8:11], s29 offen offset:0
    s_mov_b64 exec, -1
    s_mov_b64 exec, s[40:41]
    s_add_u32 s29, s24, 16384
    buffer_load_dwordx4 v[132:135], v0, s[8:11], s29 offen offset:1024
    s_mov_b64 exec, -1
    s_mov_b64 exec, s[40:41]
    s_add_u32 s29, s24, 16384
    buffer_load_dwordx4 v[136:139], v0, s[8:11], s29 offen offset:2048
    s_mov_b64 exec, -1
    s_mov_b64 exec, s[40:41]
    s_add_u32 s29, s24, 16384
    buffer_load_dwordx4 v[140:143], v0, s[8:11], s29 offen offset:3072
    s_mov_b64 exec, -1
    s_mov_b64 exec, s[40:41]
    s_add_u32 s29, s24, 20480
    buffer_load_dwordx4 v[48:51], v0, s[8:11], s29 offen offset:0
    s_mov_b64 exec, -1
    s_mov_b64 exec, s[40:41]
    s_add_u32 s29, s24, 20480
    buffer_load_dwordx4 v[52:55], v0, s[8:11], s29 offen offset:1024
    s_mov_b64 exec, -1
    s_mov_b64 exec, s[40:41]
    s_add_u32 s29, s24, 20480
    buffer_load_dwordx4 v[56:59], v0, s[8:11], s29 offen offset:2048
    s_mov_b64 exec, -1
    s_mov_b64 exec, s[40:41]
    s_add_u32 s29, s24, 20480
    buffer_load_dwordx4 v[60:63], v0, s[8:11], s29 offen offset:3072
    s_mov_b64 exec, -1
    s_waitcnt vmcnt(23)
    v_mfma_f32_32x32x16_bf16 v[16:31], a[0:3], v[64:67], 0
    s_mov_b64 exec, s[40:41]
    s_add_u32 s29, s24, 24576
    buffer_load_dwordx4 v[64:67], v0, s[8:11], s29 offen offset:0
    s_mov_b64 exec, -1
    s_waitcnt vmcnt(23)
    v_mfma_f32_32x32x16_bf16 v[16:31], a[4:7], v[68:71], v[16:31]
    s_mov_b64 exec, s[40:41]
    s_add_u32 s29, s24, 24576
    buffer_load_dwordx4 v[68:71], v0, s[8:11], s29 offen offset:1024
    s_mov_b64 exec, -1
    s_waitcnt vmcnt(23)
    v_mfma_f32_32x32x16_bf16 v[16:31], a[8:11], v[72:75], v[16:31]
    s_mov_b64 exec, s[40:41]
    s_add_u32 s29, s24, 24576
    buffer_load_dwordx4 v[72:75], v0, s[8:11], s29 offen offset:2048
    s_mov_b64 exec, -1
    s_waitcnt vmcnt(23)
    v_mfma_f32_32x32x16_bf16 v[16:31], a[12:15], v[76:79], v[16:31]
    s_mov_b64 exec, s[40:41]
    s_add_u32 s29, s24, 24576
    buffer_load_dwordx4 v[76:79], v0, s[8:11], s29 offen offset:3072
    s_mov_b64 exec, -1
    s_waitcnt vmcnt(23)
    v_mfma_f32_32x32x16_bf16 v[16:31], a[16:19], v[80:83], v[16:31]
    s_mov_b64 exec, s[40:41]
    s_add_u32 s29, s24, 28672
    buffer_load_dwordx4 v[80:83], v0, s[8:11], s29 offen offset:0
    s_mov_b64 exec, -1
    s_waitcnt vmcnt(23)
    v_mfma_f32_32x32x16_bf16 v[16:31], a[20:23], v[84:87], v[16:31]
    s_mov_b64 exec, s[40:41]
    s_add_u32 s29, s24, 28672
    buffer_load_dwordx4 v[84:87], v0, s[8:11], s29 offen offset:1024
    s_mov_b64 exec, -1
    s_waitcnt vmcnt(23)
    v_mfma_f32_32x32x16_bf16 v[16:31], a[24:27], v[88:91], v[16:31]
    s_mov_b64 exec, s[40:41]
    s_add_u32 s29, s24, 28672
    buffer_load_dwordx4 v[88:91], v0, s[8:11], s29 offen offset:2048
    s_mov_b64 exec, -1
    s_waitcnt vmcnt(23)
    v_mfma_f32_32x32x16_bf16 v[16:31], a[28:31], v[92:95], v[16:31]
    s_mov_b64 exec, s[40:41]
    s_add_u32 s29, s24, 28672
    buffer_load_dwordx4 v[92:95], v0, s[8:11], s29 offen offset:3072
    s_mov_b64 exec, -1
    s_waitcnt vmcnt(23)
    v_mfma_f32_32x32x16_bf16 v[16:31], a[32:35], v[96:99], v[16:31]
    s_mov_b64 exec, s[40:41]
    s_add_u32 s29, s24, 32768
    buffer_load_dwordx4 v[96:99], v0, s[8:11], s29 offen offset:0
    s_mov_b64 exec, -1
    s_waitcnt vmcnt(23)
    v_mfma_f32_32x32x16_bf16 v[16:31], a[36:39], v[100:103], v[16:31]
    s_mov_b64 exec, s[40:41]
    s_add_u32 s29, s24, 32768
    buffer_load_dwordx4 v[100:103], v0, s[8:11], s29 offen offset:1024
    s_mov_b64 exec, -1
    s_waitcnt vmcnt(23)
    v_mfma_f32_32x32x16_bf16 v[16:31], a[40:43], v[104:107], v[16:31]
    s_mov_b64 exec, s[40:41]
    s_add_u32 s29, s24, 32768
    buffer_load_dwordx4 v[104:107], v0, s[8:11], s29 offen offset:2048
    s_mov_b64 exec, -1
    s_waitcnt vmcnt(23)
    v_mfma_f32_32x32x16_bf16 v[16:31], a[44:47], v[108:111], v[16:31]
    s_mov_b64 exec, s[40:41]
    s_add_u32 s29, s24, 32768
    buffer_load_dwordx4 v[108:111], v0, s[8:11], s29 offen offset:3072
    s_mov_b64 exec, -1
    s_waitcnt vmcnt(23)
    v_mfma_f32_32x32x16_bf16 v[16:31], a[48:51], v[112:115], v[16:31]
    s_mov_b64 exec, s[40:41]
    s_add_u32 s29, s24, 36864
    buffer_load_dwordx4 v[112:115], v0, s[8:11], s29 offen offset:0
    s_mov_b64 exec, -1
    s_waitcnt vmcnt(23)
    v_mfma_f32_32x32x16_bf16 v[16:31], a[52:55], v[116:119], v[16:31]
    s_mov_b64 exec, s[40:41]
    s_add_u32 s29, s24, 36864
    buffer_load_dwordx4 v[116:119], v0, s[8:11], s29 offen offset:1024
    s_mov_b64 exec, -1
    s_waitcnt vmcnt(23)
    v_mfma_f32_32x32x16_bf16 v[16:31], a[56:59], v[120:123], v[16:31]
    s_mov_b64 exec, s[40:41]
    s_add_u32 s29, s24, 36864
    buffer_load_dwordx4 v[120:123], v0, s[8:11], s29 offen offset:2048
    s_mov_b64 exec, -1
    s_waitcnt vmcnt(23)
    v_mfma_f32_32x32x16_bf16 v[16:31], a[60:63], v[124:127], v[16:31]
    s_mov_b64 exec, s[40:41]
    s_add_u32 s29, s24, 36864
    buffer_load_dwordx4 v[124:127], v0, s[8:11], s29 offen offset:3072
    s_mov_b64 exec, -1
    s_waitcnt vmcnt(23)
    v_mfma_f32_32x32x16_bf16 v[16:31], a[64:67], v[128:131], v[16:31]
    s_mov_b64 exec, s[40:41]
    s_add_u32 s29, s24, 40960
    buffer_load_dwordx4 v[128:131], v0, s[8:11], s29 offen offset:0
    s_mov_b64 exec, -1
    s_waitcnt vmcnt(23)
    v_mfma_f32_32x32x16_bf16 v[16:31], a[68:71], v[132:135], v[16:31]
    s_mov_b64 exec, s[40:41]
    s_add_u32 s29, s24, 40960
    buffer_load_dwordx4 v[132:135], v0, s[8:11], s29 offen offset:1024
    s_mov_b64 exec, -1
    s_waitcnt vmcnt(23)
    v_mfma_f32_32x32x16_bf16 v[16:31], a[72:75], v[136:139], v[16:31]
    s_mov_b64 exec, s[40:41]
    s_add_u32 s29, s24, 40960
    buffer_load_dwordx4 v[136:139], v0, s[8:11], s29 offen offset:2048
    s_mov_b64 exec, -1
    s_waitcnt vmcnt(23)
    v_mfma_f32_32x32x16_bf16 v[16:31], a[76:79], v[140:143], v[16:31]
    s_mov_b64 exec, s[40:41]
    s_add_u32 s29, s24, 40960
    buffer_load_dwordx4 v[140:143], v0, s[8:11], s29 offen offset:3072
    s_mov_b64 exec, -1
    s_waitcnt vmcnt(23)
    v_mfma_f32_32x32x16_bf16 v[16:31], a[80:83], v[48:51], v[16:31]
    s_mov_b64 exec, s[40:41]
    s_add_u32 s29, s24, 45056
    buffer_load_dwordx4 v[48:51], v0, s[8:11], s29 offen offset:0
    s_mov_b64 exec, -1
    s_waitcnt vmcnt(23)
    v_mfma_f32_32x32x16_bf16 v[16:31], a[84:87], v[52:55], v[16:31]
    s_mov_b64 exec, s[40:41]
    s_add_u32 s29, s24, 45056
    buffer_load_dwordx4 v[52:55], v0, s[8:11], s29 offen offset:1024
    s_mov_b64 exec, -1
    s_waitcnt vmcnt(23)
    v_mfma_f32_32x32x16_bf16 v[16:31], a[88:91], v[56:59], v[16:31]
    s_mov_b64 exec, s[40:41]
    s_add_u32 s29, s24, 45056
    buffer_load_dwordx4 v[56:59], v0, s[8:11], s29 offen offset:2048
    s_mov_b64 exec, -1
    s_waitcnt vmcnt(23)
    v_mfma_f32_32x32x16_bf16 v[16:31], a[92:95], v[60:63], v[16:31]
    s_mov_b64 exec, s[40:41]
    s_add_u32 s29, s24, 45056
    buffer_load_dwordx4 v[60:63], v0, s[8:11], s29 offen offset:3072
    s_mov_b64 exec, -1
    s_waitcnt vmcnt(23)
    v_mfma_f32_32x32x16_bf16 v[16:31], a[96:99], v[64:67], v[16:31]
    s_mov_b64 exec, s[40:41]
    s_add_u32 s29, s24, 49152
    buffer_load_dwordx4 v[64:67], v0, s[8:11], s29 offen offset:0
    s_mov_b64 exec, -1
    s_waitcnt vmcnt(23)
    v_mfma_f32_32x32x16_bf16 v[16:31], a[100:103], v[68:71], v[16:31]
    s_mov_b64 exec, s[40:41]
    s_add_u32 s29, s24, 49152
    buffer_load_dwordx4 v[68:71], v0, s[8:11], s29 offen offset:1024
    s_mov_b64 exec, -1
    s_waitcnt vmcnt(23)
    v_mfma_f32_32x32x16_bf16 v[16:31], a[104:107], v[72:75], v[16:31]
    s_mov_b64 exec, s[40:41]
    s_add_u32 s29, s24, 49152
    buffer_load_dwordx4 v[72:75], v0, s[8:11], s29 offen offset:2048
    s_mov_b64 exec, -1
    s_waitcnt vmcnt(23)
    v_mfma_f32_32x32x16_bf16 v[16:31], a[108:111], v[76:79], v[16:31]
    s_mov_b64 exec, s[40:41]
    s_add_u32 s29, s24, 49152
    buffer_load_dwordx4 v[76:79], v0, s[8:11], s29 offen offset:3072
    s_mov_b64 exec, -1
    s_waitcnt vmcnt(23)
    v_mfma_f32_32x32x16_bf16 v[16:31], a[112:115], v[80:83], v[16:31]
    s_mov_b64 exec, s[40:41]
    s_add_u32 s29, s24, 53248
    buffer_load_dwordx4 v[80:83], v0, s[8:11], s29 offen offset:0
    s_mov_b64 exec, -1
    s_waitcnt vmcnt(23)
    v_mfma_f32_32x32x16_bf16 v[16:31], a[116:119], v[84:87], v[16:31]
    s_mov_b64 exec, s[40:41]
    s_add_u32 s29, s24, 53248
    buffer_load_dwordx4 v[84:87], v0, s[8:11], s29 offen offset:1024
    s_mov_b64 exec, -1
    s_waitcnt vmcnt(23)
    v_mfma_f32_32x32x16_bf16 v[16:31], a[120:123], v[88:91], v[16:31]
    s_mov_b64 exec, s[40:41]
    s_add_u32 s29, s24, 53248
    buffer_load_dwordx4 v[88:91], v0, s[8:11], s29 offen offset:2048
    s_mov_b64 exec, -1
    s_waitcnt vmcnt(23)
    v_mfma_f32_32x32x16_bf16 v[16:31], a[124:127], v[92:95], v[16:31]
    s_mov_b64 exec, s[40:41]
    s_add_u32 s29, s24, 53248
    buffer_load_dwordx4 v[92:95], v0, s[8:11], s29 offen offset:3072
    s_mov_b64 exec, -1
    s_waitcnt vmcnt(23)
    v_mfma_f32_32x32x16_bf16 v[16:31], a[128:131], v[96:99], v[16:31]
    s_mov_b64 exec, s[40:41]
    s_add_u32 s29, s24, 57344
    buffer_load_dwordx4 v[96:99], v0, s[8:11], s29 offen offset:0
    s_mov_b64 exec, -1
    s_waitcnt vmcnt(23)
    v_mfma_f32_32x32x16_bf16 v[16:31], a[132:135], v[100:103], v[16:31]
    s_mov_b64 exec, s[40:41]
    s_add_u32 s29, s24, 57344
    buffer_load_dwordx4 v[100:103], v0, s[8:11], s29 offen offset:1024
    s_mov_b64 exec, -1
    s_waitcnt vmcnt(23)
    v_mfma_f32_32x32x16_bf16 v[16:31], a[136:139], v[104:107], v[16:31]
    s_mov_b64 exec, s[40:41]
    s_add_u32 s29, s24, 57344
    buffer_load_dwordx4 v[104:107], v0, s[8:11], s29 offen offset:2048
    s_mov_b64 exec, -1
    s_waitcnt vmcnt(23)
    v_mfma_f32_32x32x16_bf16 v[16:31], a[140:143], v[108:111], v[16:31]
    s_mov_b64 exec, s[40:41]
    s_add_u32 s29, s24, 57344
    buffer_load_dwordx4 v[108:111], v0, s[8:11], s29 offen offset:3072
    s_mov_b64 exec, -1
    s_waitcnt vmcnt(23)
    v_mfma_f32_32x32x16_bf16 v[16:31], a[144:147], v[112:115], v[16:31]
    s_mov_b64 exec, s[40:41]
    s_add_u32 s29, s24, 61440
    buffer_load_dwordx4 v[112:115], v0, s[8:11], s29 offen offset:0
    s_mov_b64 exec, -1
    s_waitcnt vmcnt(23)
    v_mfma_f32_32x32x16_bf16 v[16:31], a[148:151], v[116:119], v[16:31]
    s_mov_b64 exec, s[40:41]
    s_add_u32 s29, s24, 61440
    buffer_load_dwordx4 v[116:119], v0, s[8:11], s29 offen offset:1024
    s_mov_b64 exec, -1
    s_waitcnt vmcnt(23)
    v_mfma_f32_32x32x16_bf16 v[16:31], a[152:155], v[120:123], v[16:31]
    s_mov_b64 exec, s[40:41]
    s_add_u32 s29, s24, 61440
    buffer_load_dwordx4 v[120:123], v0, s[8:11], s29 offen offset:2048
    s_mov_b64 exec, -1
    s_waitcnt vmcnt(23)
    v_mfma_f32_32x32x16_bf16 v[16:31], a[156:159], v[124:127], v[16:31]
    s_mov_b64 exec, s[40:41]
    s_add_u32 s29, s24, 61440
    buffer_load_dwordx4 v[124:127], v0, s[8:11], s29 offen offset:3072
    s_mov_b64 exec, -1
    s_waitcnt vmcnt(23)
    v_mfma_f32_32x32x16_bf16 v[16:31], a[160:163], v[128:131], v[16:31]
    s_waitcnt vmcnt(22)
    v_mfma_f32_32x32x16_bf16 v[16:31], a[164:167], v[132:135], v[16:31]
    s_waitcnt vmcnt(21)
    v_mfma_f32_32x32x16_bf16 v[16:31], a[168:171], v[136:139], v[16:31]
    s_waitcnt vmcnt(20)
    v_mfma_f32_32x32x16_bf16 v[16:31], a[172:175], v[140:143], v[16:31]
    s_waitcnt vmcnt(19)
    v_mfma_f32_32x32x16_bf16 v[16:31], a[176:179], v[48:51], v[16:31]
    s_waitcnt vmcnt(18)
    v_mfma_f32_32x32x16_bf16 v[16:31], a[180:183], v[52:55], v[16:31]
    s_waitcnt vmcnt(17)
    v_mfma_f32_32x32x16_bf16 v[16:31], a[184:187], v[56:59], v[16:31]
    s_waitcnt vmcnt(16)
    v_mfma_f32_32x32x16_bf16 v[16:31], a[188:191], v[60:63], v[16:31]
    s_waitcnt vmcnt(15)
    v_mfma_f32_32x32x16_bf16 v[16:31], a[192:195], v[64:67], v[16:31]
    s_waitcnt vmcnt(14)
    v_mfma_f32_32x32x16_bf16 v[16:31], a[196:199], v[68:71], v[16:31]
    s_waitcnt vmcnt(13)
    v_mfma_f32_32x32x16_bf16 v[16:31], a[200:203], v[72:75], v[16:31]
    s_waitcnt vmcnt(12)
    v_mfma_f32_32x32x16_bf16 v[16:31], a[204:207], v[76:79], v[16:31]
    s_waitcnt vmcnt(11)
    v_mfma_f32_32x32x16_bf16 v[16:31], a[208:211], v[80:83], v[16:31]
    s_waitcnt vmcnt(10)
    v_mfma_f32_32x32x16_bf16 v[16:31], a[212:215], v[84:87], v[16:31]
    s_waitcnt vmcnt(9)
    v_mfma_f32_32x32x16_bf16 v[16:31], a[216:219], v[88:91], v[16:31]
    s_waitcnt vmcnt(8)
    v_mfma_f32_32x32x16_bf16 v[16:31], a[220:223], v[92:95], v[16:31]
    s_waitcnt vmcnt(7)
    v_mfma_f32_32x32x16_bf16 v[16:31], a[224:227], v[96:99], v[16:31]
    s_waitcnt vmcnt(6)
    v_mfma_f32_32x32x16_bf16 v[16:31], a[228:231], v[100:103], v[16:31]
    s_waitcnt vmcnt(5)
    v_mfma_f32_32x32x16_bf16 v[16:31], a[232:235], v[104:107], v[16:31]
    s_waitcnt vmcnt(4)
    v_mfma_f32_32x32x16_bf16 v[16:31], a[236:239], v[108:111], v[16:31]
    s_waitcnt vmcnt(3)
    v_mfma_f32_32x32x16_bf16 v[16:31], a[240:243], v[112:115], v[16:31]
    s_waitcnt vmcnt(2)
    v_mfma_f32_32x32x16_bf16 v[16:31], a[244:247], v[116:119], v[16:31]
    s_waitcnt vmcnt(1)
    v_mfma_f32_32x32x16_bf16 v[16:31], a[248:251], v[120:123], v[16:31]
    s_waitcnt vmcnt(0)
    v_mfma_f32_32x32x16_bf16 v[16:31], a[252:255], v[124:127], v[16:31]
    v_xor_b32 v8, 0, v4
    s_nop 10
    ds_write_b128 v8, v[16:19] offset:0
    v_xor_b32 v8, 32, v4
    ds_write_b128 v8, v[20:23] offset:0
    v_xor_b32 v8, 64, v4
    ds_write_b128 v8, v[24:27] offset:0
    v_xor_b32 v8, 96, v4
    ds_write_b128 v8, v[28:31] offset:0
    v_xor_b32 v8, 0, v4
    ds_write_b128 v8, v[32:35] offset:4096
    v_xor_b32 v8, 32, v4
    ds_write_b128 v8, v[36:39] offset:4096
    v_xor_b32 v8, 64, v4
    ds_write_b128 v8, v[40:43] offset:4096
    v_xor_b32 v8, 96, v4
    ds_write_b128 v8, v[44:47] offset:4096
    s_waitcnt lgkmcnt(0)
    s_barrier
    ds_read_b128 v[16:19], v5 offset:0
    ds_read_b128 v[20:23], v5 offset:8192
    ds_read_b128 v[24:27], v5 offset:16384
    ds_read_b128 v[28:31], v5 offset:24576
    ds_read_b128 v[32:35], v5 offset:4096
    ds_read_b128 v[36:39], v5 offset:12288
    ds_read_b128 v[40:43], v5 offset:20480
    ds_read_b128 v[44:47], v5 offset:28672
    s_waitcnt lgkmcnt(0)
    s_barrier
    v_pk_add_f32 v[16:17], v[16:17], v[20:21]
    v_pk_add_f32 v[24:25], v[24:25], v[28:29]
    v_pk_add_f32 v[18:19], v[18:19], v[22:23]
    v_pk_add_f32 v[26:27], v[26:27], v[30:31]
    v_pk_add_f32 v[16:17], v[16:17], v[24:25]
    v_pk_add_f32 v[18:19], v[18:19], v[26:27]
    v_pk_add_f32 v[32:33], v[32:33], v[36:37]
    v_pk_add_f32 v[40:41], v[40:41], v[44:45]
    v_pk_add_f32 v[34:35], v[34:35], v[38:39]
    v_pk_add_f32 v[42:43], v[42:43], v[46:47]
    v_pk_add_f32 v[32:33], v[32:33], v[40:41]
    v_pk_add_f32 v[34:35], v[34:35], v[42:43]
    v_sub_f32 v10, 1.0, v9
    v_cvt_pk_bf16_f32 v10, v10, v10
    v_and_b32 v10, 0xffff0000, v10
    v_cvt_pk_bf16_f32 v8, v16, v17
    v_lshlrev_b32 v16, 16, v8
    v_and_b32 v17, 0xffff0000, v8
    v_cvt_pk_bf16_f32 v8, v32, v33
    v_lshlrev_b32 v32, 16, v8
    v_and_b32 v33, 0xffff0000, v8
    v_cvt_pk_bf16_f32 v8, v18, v19
    v_lshlrev_b32 v18, 16, v8
    v_and_b32 v19, 0xffff0000, v8
    v_cvt_pk_bf16_f32 v8, v34, v35
    v_lshlrev_b32 v34, 16, v8
    v_and_b32 v35, 0xffff0000, v8
    v_mul_f32 v16, v16, v9
    v_mul_f32 v32, v32, v10
    v_mul_f32 v17, v17, v9
    v_mul_f32 v33, v33, v10
    v_mul_f32 v18, v18, v9
    v_mul_f32 v34, v34, v10
    v_mul_f32 v19, v19, v9
    v_mul_f32 v35, v35, v10
    v_cvt_pk_bf16_f32 v8, v16, v17
    v_lshlrev_b32 v16, 16, v8
    v_and_b32 v17, 0xffff0000, v8
    v_cvt_pk_bf16_f32 v8, v32, v33
    v_lshlrev_b32 v32, 16, v8
    v_and_b32 v33, 0xffff0000, v8
    v_cvt_pk_bf16_f32 v8, v18, v19
    v_lshlrev_b32 v18, 16, v8
    v_and_b32 v19, 0xffff0000, v8
    v_cvt_pk_bf16_f32 v8, v34, v35
    v_lshlrev_b32 v34, 16, v8
    v_and_b32 v35, 0xffff0000, v8
    v_pk_add_f32 v[16:17], v[16:17], v[32:33]
    v_pk_add_f32 v[18:19], v[18:19], v[34:35]
    v_cvt_pk_bf16_f32 v20, v16, v17
    v_cvt_pk_bf16_f32 v21, v18, v19
    s_lshl_b32 s28, s6, 15
    s_lshl_b32 s29, s5, 6
    s_add_u32 s28, s28, s29
    s_mov_b64 exec, s[42:43]
    s_cbranch_execz L_fin_nost
    buffer_store_dwordx2 v[20:21], v7, s[20:23], s28 offen
L_fin_nost:
    s_mov_b64 exec, -1
    s_add_u32 s6, s6, 6
    s_cmp_lt_u32 s6, 64
    s_cbranch_scc1 L_finw_loop
    s_waitcnt vmcnt(0)
L_wk_end:
L_all_end:
L_exit_gated_mix__memory_aug_recurrent_mem_tr__glu_gated_swiglu__prompt_kernel:
    s_endpgm

.section .rodata,"a"
.p2align 6
.amdhsa_kernel gated_mix__memory_aug_recurrent_mem_tr__glu_gated_swiglu__prompt_kernel
  .amdhsa_next_free_vgpr 512
  .amdhsa_next_free_sgpr 102
  .amdhsa_accum_offset 256
  .amdhsa_group_segment_fixed_size 0
  .amdhsa_kernarg_size 120
  .amdhsa_user_sgpr_count 2
  .amdhsa_user_sgpr_kernarg_segment_ptr 1
  .amdhsa_system_sgpr_workgroup_id_x 1
.end_amdhsa_kernel
.text
```
